```python
import torch

def _softmax(x, axis=-1):
    return torch.softmax(x, dim=axis)
def _gelu(x):
    return torch.nn.functional.gelu(x, approximate="tanh")
def _silu(x):
    return torch.nn.functional.silu(x)
def _sigmoid(x):
    return torch.sigmoid(x)
def _layernorm(x, axis=-1, eps=1e-5):
    m = x.mean(dim=axis, keepdim=True)
    v = x.var(dim=axis, keepdim=True, unbiased=False)
    return (x - m) / torch.sqrt(v + eps)
def _scatter_add(tgt, idx, src, axis=0):
    return tgt.clone().index_add_(axis, idx, src)
def _segment_sum(src, seg, n):
    out = torch.zeros((n,) + src.shape[1:], dtype=src.dtype)
    return out.index_add_(0, seg, src)
def _pad(x, pw):
    flat = tuple(v for pair in reversed(pw) for v in pair)
    return torch.nn.functional.pad(x, flat)

kernel_name = 'standalone__mha_block_cached__near_ridge'

def setup_inputs():

    _w = (lambda a: (lambda t: t.to(torch.bfloat16) if t.is_floating_point() else t)(torch.as_tensor(a)))
    B, Sq, D = 32, 96, 448
    H, Sk, Dh = 16, 512, 256
    return {
        "x": _w((lambda *s: torch.randn(*s, dtype=torch.bfloat16) * 0.8)(B, Sq, D)),
        "k_cache": _w((lambda *s: torch.randn(*s, dtype=torch.bfloat16) * 0.8)(B, H, Sk, Dh)),
        "v_cache": _w((lambda *s: torch.randn(*s, dtype=torch.bfloat16) * 0.05)(B, H, Sk, Dh)),
        "wq": _w((lambda *s: torch.randn(*s, dtype=torch.bfloat16) * 0.8)(D, H * Dh) * (D ** -0.5)),
        "wo": _w((lambda *s: torch.randn(*s, dtype=torch.bfloat16) * 0.05)(H * Dh, D) * ((H * Dh) ** -0.5)),
    }

def reference(x, k_cache, v_cache, wq, wo):
    B, Sq, D = x.shape
    H, Dh = 16, 256
    q = (lambda x, *d: x.permute(*d))((x @ wq).reshape(B, Sq, H, Dh), 0, 2, 1, 3)
    scores = torch.einsum("bhqd,bhkd->bhqk", q, k_cache) * (Dh ** -0.5)
    p = _softmax(scores, axis=-1)
    o = torch.einsum("bhqk,bhkd->bhqd", p, v_cache)
    return (lambda x, *d: x.permute(*d))(o, 0, 2, 1, 3).reshape(B, Sq, H * Dh) @ wo
```

```asm
; @launch grid=(256,1,1) block=(512,1,1) lds=163840
.amdgcn_target "amdgcn-amd-amdhsa--gfx950"
.text
.p2align 12
.globl standalone__mha_block_cached__near_ridge_kernel
.p2align 8
.type standalone__mha_block_cached__near_ridge_kernel,@function
standalone__mha_block_cached__near_ridge_kernel:
L_start:
  s_cmp_ge_u32 s2, 256
  s_cbranch_scc1 L_end
  s_load_dwordx16 s[4:19], s[0:1], 0
  v_lshrrev_b32 v1, 6, v0
  s_nop 0
  v_readfirstlane_b32 s44, v1
  v_and_b32 v0, 63, v0
  s_and_b32 s48, s2, 7
  s_lshr_b32 s49, s2, 3
  s_cmp_eq_u32 s44, 4
  s_cbranch_scc0 L_nopf
  s_getpc_b64 s[20:21]
L_pc:
  s_sub_u32 s20, s20, L_pc-L_start
  s_subb_u32 s21, s21, 0
  s_mov_b32 s22, L_codeend-L_start
  s_mov_b32 s23, 0x20000
  s_mul_i32 s50, s49, 3072
  v_lshlrev_b32 v16, 4, v0
  buffer_load_dwordx4 v[140:143], v16, s[20:23], s50 offen
  buffer_load_dwordx4 v[140:143], v16, s[20:23], s50 offen offset:1024
  buffer_load_dwordx4 v[140:143], v16, s[20:23], s50 offen offset:2048
L_nopf:
  s_lshr_b32 s47, s49, 1
  s_mov_b32 s45, s49
  s_mov_b32 s46, s48
  s_mov_b32 s52, s49
  s_cmp_ge_u32 s52, 7
  s_cselect_b32 s50, 7, 0
  s_sub_u32 s52, s52, s50
  s_cmp_ge_u32 s52, 7
  s_cselect_b32 s50, 7, 0
  s_sub_u32 s52, s52, s50
  s_lshr_b32 s50, s48, 0
  s_add_u32 s52, s52, s50
  s_cmp_ge_u32 s52, 7
  s_cselect_b32 s50, 7, 0
  s_sub_u32 s52, s52, s50
  s_cmp_ge_u32 s52, 7
  s_cselect_b32 s50, 7, 0
  s_sub_u32 s52, s52, s50
  s_cmp_ge_u32 s52, 7
  s_cselect_b32 s50, 7, 0
  s_sub_u32 s52, s52, s50
  v_lshrrev_b32 v3, 4, v0
  v_and_b32 v4, 15, v0
  s_and_b32 s50, s44, 3
  s_cmp_eq_u32 s50, 3
  s_cbranch_scc0 L_compute
L_loader:
  s_setprio 3
  s_cmp_eq_u32 s44, 3
  s_cselect_b32 s54, 1, 0
  s_and_b32 s53, s47, 1
  v_lshlrev_b32 v5, 1, v3
  v_xor_b32 v5, v5, v4
  v_lshlrev_b32 v5, 4, v5
  v_xor_b32 v6, 128, v5
  v_lshlrev_b32 v7, 13, v3
  v_add_u32 v64, v5, v7
  v_add_u32 v65, v5, v7
  v_add_u32 v65, 31744, v65
  v_add_u32 v66, v6, v7
  v_add_u32 v66, 63488, v66
  v_add_u32 v67, v6, v7
  v_add_u32 v67, 95232, v67
  v_lshrrev_b32 v7, 3, v0
  v_mul_u32_u24 v7, 896, v7
  v_and_b32 v8, 7, v0
  v_xor_b32 v8, v8, v3
  v_lshlrev_b32 v8, 4, v8
  v_add_u32 v68, v7, v8
  v_xor_b32 v8, 64, v8
  v_add_u32 v69, v7, v8
  s_lshl_b32 s55, s46, 10
  s_lshl_b32 s50, s54, 18
  s_add_u32 s55, s55, s50
  s_mul_i32 s56, s45, 86016
  s_mul_i32 s50, s54, 43008
  s_add_u32 s56, s56, s50
  s_lshl_b32 s57, s45, 3
  s_add_u32 s57, s57, s46
  s_lshl_b32 s57, s57, 19
  s_lshl_b32 s63, s54, 13
  s_add_u32 s58, s57, s63
  s_add_u32 s59, s58, s63
  s_mul_i32 s79, s46, 458752
  s_mul_i32 s50, s54, 14336
  s_add_u32 s79, s79, s50
  s_mul_i32 s65, s54, 6144
  s_mov_b32 s34, 3670016
  s_mov_b32 s35, 0x20000
  s_mov_b32 s22, 2752512
  s_mov_b32 s23, 0x20000
  s_waitcnt lgkmcnt(0)
  s_mov_b32 s32, s10
  s_mov_b32 s33, s11
  s_mov_b32 s20, s4
  s_mov_b32 s21, s5
  s_add_u32 s62, s52, 0
  s_cmp_ge_u32 s62, 7
  s_cselect_b32 s50, 7, 0
  s_sub_u32 s62, s62, s50
  s_lshl_b32 s62, s62, 19
  s_add_u32 s62, s62, s55
  s_add_u32 m0, s63, 0
  s_nop 0
  buffer_load_dwordx4 v64, s[32:35], s62 offen offset:0 lds
  buffer_load_dwordx4 v65, s[32:35], s62 offen offset:1024 lds
  buffer_load_dwordx4 v66, s[32:35], s62 offen offset:2048 lds
  buffer_load_dwordx4 v67, s[32:35], s62 offen offset:3072 lds
  s_add_u32 s62, s62, 131072
  s_add_u32 m0, m0, 4096
  s_nop 0
  buffer_load_dwordx4 v64, s[32:35], s62 offen offset:0 lds
  buffer_load_dwordx4 v65, s[32:35], s62 offen offset:1024 lds
  buffer_load_dwordx4 v66, s[32:35], s62 offen offset:2048 lds
  buffer_load_dwordx4 v67, s[32:35], s62 offen offset:3072 lds
  s_add_u32 s62, s52, 0
  s_cmp_ge_u32 s62, 7
  s_cselect_b32 s50, 7, 0
  s_sub_u32 s62, s62, s50
  s_lshl_b32 s62, s62, 7
  s_add_u32 s62, s62, s56
  s_add_u32 m0, s65, 114688
  s_nop 0
  buffer_load_dwordx4 v68, s[20:23], s62 offen lds
  s_add_u32 s62, s62, 7168
  s_add_u32 m0, m0, 1024
  s_nop 0
  buffer_load_dwordx4 v69, s[20:23], s62 offen lds
  s_add_u32 s62, s62, 7168
  s_add_u32 m0, m0, 1024
  s_nop 0
  buffer_load_dwordx4 v68, s[20:23], s62 offen lds
  s_add_u32 s62, s62, 7168
  s_add_u32 m0, m0, 1024
  s_nop 0
  buffer_load_dwordx4 v69, s[20:23], s62 offen lds
  s_add_u32 s62, s62, 7168
  s_add_u32 m0, m0, 1024
  s_nop 0
  buffer_load_dwordx4 v68, s[20:23], s62 offen lds
  s_add_u32 s62, s62, 7168
  s_add_u32 m0, m0, 1024
  s_nop 0
  buffer_load_dwordx4 v69, s[20:23], s62 offen lds
  s_mov_b32 s24, s6
  s_mov_b32 s25, s7
  s_mov_b32 s26, 134217728
  s_mov_b32 s27, 0x20000
  s_mov_b32 s28, s8
  s_mov_b32 s29, s9
  s_mov_b32 s30, 134217728
  s_mov_b32 s31, 0x20000
  s_mov_b32 s36, s12
  s_mov_b32 s37, s13
  s_mov_b32 s38, 3670016
  s_mov_b32 s39, 0x20000
  s_mov_b32 s40, s18
  s_mov_b32 s41, s19
  s_mov_b32 s42, 23134208
  s_mov_b32 s43, 0x20000
  s_mul_i32 s50, s49, 7168
  s_mul_i32 s51, s46, 458752
  s_add_u32 s50, s50, s51
  s_cmp_eq_u32 s54, 0
  s_cselect_b32 s51, 229376, 0
  s_add_u32 s50, s50, s51
  s_add_u32 s66, s12, s50
  s_addc_u32 s67, s13, 0
  v_lshrrev_b32 v7, 5, v0
  v_and_b32 v8, 31, v0
  v_lshlrev_b32 v9, 9, v7
  s_lshl_b32 s50, s54, 3
  v_add_u32 v10, 0, v7
  v_xor_b32 v10, s50, v10
  v_xor_b32 v10, v10, v8
  v_lshlrev_b32 v10, 4, v10
  v_add_u32 v72, v10, v9
  v_add_u32 v10, 2, v7
  v_xor_b32 v10, s50, v10
  v_xor_b32 v10, v10, v8
  v_lshlrev_b32 v10, 4, v10
  v_add_u32 v73, v10, v9
  v_add_u32 v10, 4, v7
  v_xor_b32 v10, s50, v10
  v_xor_b32 v10, v10, v8
  v_lshlrev_b32 v10, 4, v10
  v_add_u32 v74, v10, v9
  v_add_u32 v10, 6, v7
  v_xor_b32 v10, s50, v10
  v_xor_b32 v10, v10, v8
  v_lshlrev_b32 v10, 4, v10
  v_add_u32 v75, v10, v9
  v_add_u32 v10, 8, v7
  v_xor_b32 v10, s50, v10
  v_xor_b32 v10, v10, v8
  v_lshlrev_b32 v10, 4, v10
  v_add_u32 v76, v10, v9
  v_add_u32 v10, 10, v7
  v_xor_b32 v10, s50, v10
  v_xor_b32 v10, v10, v8
  v_lshlrev_b32 v10, 4, v10
  v_add_u32 v77, v10, v9
  v_add_u32 v10, 12, v7
  v_xor_b32 v10, s50, v10
  v_xor_b32 v10, v10, v8
  v_lshlrev_b32 v10, 4, v10
  v_add_u32 v78, v10, v9
  v_add_u32 v10, 14, v7
  v_xor_b32 v10, s50, v10
  v_xor_b32 v10, v10, v8
  v_lshlrev_b32 v10, 4, v10
  v_add_u32 v79, v10, v9
  v_lshlrev_b32 v10, 13, v3
  v_add_u32 v48, v5, v10
  v_add_u32 v49, v5, v10
  v_add_u32 v49, 31744, v49
  v_add_u32 v50, v6, v10
  v_add_u32 v50, 63488, v50
  v_add_u32 v51, v6, v10
  v_add_u32 v51, 95232, v51
  v_lshlrev_b32 v10, 9, v3
  v_add_u32 v80, v5, v10
  v_add_u32 v81, v5, v10
  v_add_u32 v81, 1024, v81
  v_add_u32 v82, v6, v10
  v_add_u32 v82, 2048, v82
  v_add_u32 v83, v6, v10
  v_add_u32 v83, 3072, v83
  v_mul_u32_u24 v9, 896, v7
  v_add_u32 v10, 0, v7
  v_lshlrev_b32 v10, 1, v10
  v_xor_b32 v10, v10, v8
  v_lshlrev_b32 v10, 4, v10
  v_add_u32 v10, 0, v10
  v_add_u32 v40, v10, v9
  v_add_u32 v10, 2, v7
  v_lshlrev_b32 v10, 1, v10
  v_xor_b32 v10, v10, v8
  v_lshlrev_b32 v10, 4, v10
  v_add_u32 v10, 768, v10
  v_add_u32 v41, v10, v9
  v_add_u32 v10, 4, v7
  v_lshlrev_b32 v10, 1, v10
  v_xor_b32 v10, v10, v8
  v_lshlrev_b32 v10, 4, v10
  v_add_u32 v10, 1536, v10
  v_add_u32 v42, v10, v9
  v_add_u32 v10, 6, v7
  v_lshlrev_b32 v10, 1, v10
  v_xor_b32 v10, v10, v8
  v_lshlrev_b32 v10, 4, v10
  v_add_u32 v10, 2304, v10
  v_add_u32 v43, v10, v9
  v_add_u32 v7, 0, v0
  v_mul_u32_u24 v8, 2731, v7
  v_lshrrev_b32 v8, 16, v8
  v_mul_u32_u24 v9, 24, v8
  v_sub_u32 v7, v7, v9
  v_and_b32 v9, 6, v8
  v_xor_b32 v7, v7, v9
  v_lshlrev_b32 v7, 4, v7
  v_mul_u32_u24 v8, 896, v8
  v_add_u32 v7, v7, v8
  v_add_u32 v44, 512, v7
  v_add_u32 v7, 64, v0
  v_mul_u32_u24 v8, 2731, v7
  v_lshrrev_b32 v8, 16, v8
  v_mul_u32_u24 v9, 24, v8
  v_sub_u32 v7, v7, v9
  v_and_b32 v9, 6, v8
  v_xor_b32 v7, v7, v9
  v_lshlrev_b32 v7, 4, v7
  v_mul_u32_u24 v8, 896, v8
  v_add_u32 v7, v7, v8
  v_add_u32 v45, 4294966784, v7
  v_add_u32 v7, 128, v0
  v_mul_u32_u24 v8, 2731, v7
  v_lshrrev_b32 v8, 16, v8
  v_mul_u32_u24 v9, 24, v8
  v_sub_u32 v7, v7, v9
  v_and_b32 v9, 6, v8
  v_xor_b32 v7, v7, v9
  v_lshlrev_b32 v7, 4, v7
  v_mul_u32_u24 v8, 896, v8
  v_add_u32 v7, v7, v8
  v_add_u32 v46, 4294965760, v7
  s_add_u32 s62, s52, 1
  s_cmp_ge_u32 s62, 7
  s_cselect_b32 s50, 7, 0
  s_sub_u32 s62, s62, s50
  s_lshl_b32 s62, s62, 7
  s_add_u32 s62, s62, s56
  s_add_u32 m0, s65, 126976
  s_nop 0
  buffer_load_dwordx4 v68, s[20:23], s62 offen lds
  s_add_u32 s62, s62, 7168
  s_add_u32 m0, m0, 1024
  s_nop 0
  buffer_load_dwordx4 v69, s[20:23], s62 offen lds
  s_add_u32 s62, s62, 7168
  s_add_u32 m0, m0, 1024
  s_nop 0
  buffer_load_dwordx4 v68, s[20:23], s62 offen lds
  s_add_u32 s62, s62, 7168
  s_add_u32 m0, m0, 1024
  s_nop 0
  buffer_load_dwordx4 v69, s[20:23], s62 offen lds
  s_add_u32 s62, s62, 7168
  s_add_u32 m0, m0, 1024
  s_nop 0
  buffer_load_dwordx4 v68, s[20:23], s62 offen lds
  s_add_u32 s62, s62, 7168
  s_add_u32 m0, m0, 1024
  s_nop 0
  buffer_load_dwordx4 v69, s[20:23], s62 offen lds
  s_add_u32 s62, s52, 1
  s_cmp_ge_u32 s62, 7
  s_cselect_b32 s50, 7, 0
  s_sub_u32 s62, s62, s50
  s_lshl_b32 s62, s62, 19
  s_add_u32 s62, s62, s55
  s_add_u32 m0, s63, 16384
  s_nop 0
  buffer_load_dwordx4 v64, s[32:35], s62 offen offset:0 lds
  buffer_load_dwordx4 v65, s[32:35], s62 offen offset:1024 lds
  buffer_load_dwordx4 v66, s[32:35], s62 offen offset:2048 lds
  buffer_load_dwordx4 v67, s[32:35], s62 offen offset:3072 lds
  s_add_u32 s62, s62, 131072
  s_add_u32 m0, m0, 4096
  s_nop 0
  buffer_load_dwordx4 v64, s[32:35], s62 offen offset:0 lds
  buffer_load_dwordx4 v65, s[32:35], s62 offen offset:1024 lds
  buffer_load_dwordx4 v66, s[32:35], s62 offen offset:2048 lds
  buffer_load_dwordx4 v67, s[32:35], s62 offen offset:3072 lds
  s_waitcnt vmcnt(14)
  s_barrier
  s_add_u32 s62, s52, 2
  s_cmp_ge_u32 s62, 7
  s_cselect_b32 s50, 7, 0
  s_sub_u32 s62, s62, s50
  s_lshl_b32 s62, s62, 7
  s_add_u32 s62, s62, s56
  s_add_u32 m0, s65, 139264
  s_nop 0
  buffer_load_dwordx4 v68, s[20:23], s62 offen lds
  s_add_u32 s62, s62, 7168
  s_add_u32 m0, m0, 1024
  s_nop 0
  buffer_load_dwordx4 v69, s[20:23], s62 offen lds
  s_add_u32 s62, s62, 7168
  s_add_u32 m0, m0, 1024
  s_nop 0
  buffer_load_dwordx4 v68, s[20:23], s62 offen lds
  s_add_u32 s62, s62, 7168
  s_add_u32 m0, m0, 1024
  s_nop 0
  buffer_load_dwordx4 v69, s[20:23], s62 offen lds
  s_add_u32 s62, s62, 7168
  s_add_u32 m0, m0, 1024
  s_nop 0
  buffer_load_dwordx4 v68, s[20:23], s62 offen lds
  s_add_u32 s62, s62, 7168
  s_add_u32 m0, m0, 1024
  s_nop 0
  buffer_load_dwordx4 v69, s[20:23], s62 offen lds
  s_add_u32 s62, s52, 2
  s_cmp_ge_u32 s62, 7
  s_cselect_b32 s50, 7, 0
  s_sub_u32 s62, s62, s50
  s_lshl_b32 s62, s62, 19
  s_add_u32 s62, s62, s55
  s_add_u32 m0, s63, 32768
  s_call_b64 s[60:61], L_issQ
  s_add_u32 s62, s52, 3
  s_cmp_ge_u32 s62, 7
  s_cselect_b32 s50, 7, 0
  s_sub_u32 s62, s62, s50
  s_lshl_b32 s62, s62, 19
  s_add_u32 s62, s62, s55
  s_add_u32 m0, s63, 49152
  s_call_b64 s[60:61], L_issQ
  s_waitcnt vmcnt(22)
  s_barrier
  s_add_u32 s62, s52, 3
  s_cmp_ge_u32 s62, 7
  s_cselect_b32 s50, 7, 0
  s_sub_u32 s62, s62, s50
  s_lshl_b32 s62, s62, 7
  s_add_u32 s62, s62, s56
  s_add_u32 m0, s65, 151552
  s_nop 0
  buffer_load_dwordx4 v68, s[20:23], s62 offen lds
  s_add_u32 s62, s62, 7168
  s_add_u32 m0, m0, 1024
  s_nop 0
  buffer_load_dwordx4 v69, s[20:23], s62 offen lds
  s_add_u32 s62, s62, 7168
  s_add_u32 m0, m0, 1024
  s_nop 0
  buffer_load_dwordx4 v68, s[20:23], s62 offen lds
  s_add_u32 s62, s62, 7168
  s_add_u32 m0, m0, 1024
  s_nop 0
  buffer_load_dwordx4 v69, s[20:23], s62 offen lds
  s_add_u32 s62, s62, 7168
  s_add_u32 m0, m0, 1024
  s_nop 0
  buffer_load_dwordx4 v68, s[20:23], s62 offen lds
  s_add_u32 s62, s62, 7168
  s_add_u32 m0, m0, 1024
  s_nop 0
  buffer_load_dwordx4 v69, s[20:23], s62 offen lds
  s_add_u32 s62, s52, 4
  s_cmp_ge_u32 s62, 7
  s_cselect_b32 s50, 7, 0
  s_sub_u32 s62, s62, s50
  s_lshl_b32 s62, s62, 19
  s_add_u32 s62, s62, s55
  s_add_u32 m0, s63, 0
  s_call_b64 s[60:61], L_issQ
  s_add_u32 s62, s52, 5
  s_cmp_ge_u32 s62, 7
  s_cselect_b32 s50, 7, 0
  s_sub_u32 s62, s62, s50
  s_lshl_b32 s62, s62, 19
  s_add_u32 s62, s62, s55
  s_add_u32 m0, s63, 65536
  s_call_b64 s[60:61], L_issQ
  s_waitcnt vmcnt(30)
  s_barrier
  s_add_u32 s62, s52, 4
  s_cmp_ge_u32 s62, 7
  s_cselect_b32 s50, 7, 0
  s_sub_u32 s62, s62, s50
  s_lshl_b32 s62, s62, 7
  s_add_u32 s62, s62, s56
  s_add_u32 m0, s65, 114688
  s_nop 0
  buffer_load_dwordx4 v68, s[20:23], s62 offen lds
  s_add_u32 s62, s62, 7168
  s_add_u32 m0, m0, 1024
  s_nop 0
  buffer_load_dwordx4 v69, s[20:23], s62 offen lds
  s_add_u32 s62, s62, 7168
  s_add_u32 m0, m0, 1024
  s_nop 0
  buffer_load_dwordx4 v68, s[20:23], s62 offen lds
  s_add_u32 s62, s62, 7168
  s_add_u32 m0, m0, 1024
  s_nop 0
  buffer_load_dwordx4 v69, s[20:23], s62 offen lds
  s_add_u32 s62, s62, 7168
  s_add_u32 m0, m0, 1024
  s_nop 0
  buffer_load_dwordx4 v68, s[20:23], s62 offen lds
  s_add_u32 s62, s62, 7168
  s_add_u32 m0, m0, 1024
  s_nop 0
  buffer_load_dwordx4 v69, s[20:23], s62 offen lds
  s_add_u32 s62, s52, 6
  s_cmp_ge_u32 s62, 7
  s_cselect_b32 s50, 7, 0
  s_sub_u32 s62, s62, s50
  s_lshl_b32 s62, s62, 19
  s_add_u32 s62, s62, s55
  s_add_u32 m0, s63, 16384
  s_call_b64 s[60:61], L_issQ
  s_waitcnt vmcnt(30)
  s_barrier
  s_add_u32 s62, s52, 5
  s_cmp_ge_u32 s62, 7
  s_cselect_b32 s50, 7, 0
  s_sub_u32 s62, s62, s50
  s_lshl_b32 s62, s62, 7
  s_add_u32 s62, s62, s56
  s_add_u32 m0, s65, 126976
  s_nop 0
  buffer_load_dwordx4 v68, s[20:23], s62 offen lds
  s_add_u32 s62, s62, 7168
  s_add_u32 m0, m0, 1024
  s_nop 0
  buffer_load_dwordx4 v69, s[20:23], s62 offen lds
  s_add_u32 s62, s62, 7168
  s_add_u32 m0, m0, 1024
  s_nop 0
  buffer_load_dwordx4 v68, s[20:23], s62 offen lds
  s_add_u32 s62, s62, 7168
  s_add_u32 m0, m0, 1024
  s_nop 0
  buffer_load_dwordx4 v69, s[20:23], s62 offen lds
  s_add_u32 s62, s62, 7168
  s_add_u32 m0, m0, 1024
  s_nop 0
  buffer_load_dwordx4 v68, s[20:23], s62 offen lds
  s_add_u32 s62, s62, 7168
  s_add_u32 m0, m0, 1024
  s_nop 0
  buffer_load_dwordx4 v69, s[20:23], s62 offen lds
  s_add_u32 s62, s52, 0
  s_cmp_ge_u32 s62, 7
  s_cselect_b32 s50, 7, 0
  s_sub_u32 s62, s62, s50
  s_lshl_b32 s62, s62, 19
  s_add_u32 s62, s62, s55
  s_add_u32 s62, s62, 256
  s_add_u32 m0, s63, 32768
  s_call_b64 s[60:61], L_issQ
  s_waitcnt vmcnt(22)
  s_barrier
  s_load_dwordx2 s[68:69], s[66:67], 60
  s_load_dwordx2 s[68:69], s[66:67], 188
  s_load_dwordx2 s[68:69], s[66:67], 316
  s_add_u32 s62, s52, 6
  s_cmp_ge_u32 s62, 7
  s_cselect_b32 s50, 7, 0
  s_sub_u32 s62, s62, s50
  s_lshl_b32 s62, s62, 7
  s_add_u32 s62, s62, s56
  s_add_u32 m0, s65, 139264
  s_nop 0
  buffer_load_dwordx4 v68, s[20:23], s62 offen lds
  s_add_u32 s62, s62, 7168
  s_add_u32 m0, m0, 1024
  s_nop 0
  buffer_load_dwordx4 v69, s[20:23], s62 offen lds
  s_add_u32 s62, s62, 7168
  s_add_u32 m0, m0, 1024
  s_nop 0
  buffer_load_dwordx4 v68, s[20:23], s62 offen lds
  s_add_u32 s62, s62, 7168
  s_add_u32 m0, m0, 1024
  s_nop 0
  buffer_load_dwordx4 v69, s[20:23], s62 offen lds
  s_add_u32 s62, s62, 7168
  s_add_u32 m0, m0, 1024
  s_nop 0
  buffer_load_dwordx4 v68, s[20:23], s62 offen lds
  s_add_u32 s62, s62, 7168
  s_add_u32 m0, m0, 1024
  s_nop 0
  buffer_load_dwordx4 v69, s[20:23], s62 offen lds
  s_add_u32 s62, s52, 1
  s_cmp_ge_u32 s62, 7
  s_cselect_b32 s50, 7, 0
  s_sub_u32 s62, s62, s50
  s_lshl_b32 s62, s62, 19
  s_add_u32 s62, s62, s55
  s_add_u32 s62, s62, 256
  s_add_u32 m0, s63, 49152
  s_call_b64 s[60:61], L_issQ
  s_waitcnt vmcnt(22)
  s_barrier
  s_load_dwordx2 s[68:69], s[66:67], 444
  s_load_dwordx2 s[68:69], s[66:67], 572
  s_load_dwordx2 s[68:69], s[66:67], 700
  s_add_u32 s62, s52, 2
  s_cmp_ge_u32 s62, 7
  s_cselect_b32 s50, 7, 0
  s_sub_u32 s62, s62, s50
  s_lshl_b32 s62, s62, 19
  s_add_u32 s62, s62, s55
  s_add_u32 s62, s62, 256
  s_add_u32 m0, s63, 0
  s_call_b64 s[60:61], L_issQ
  s_add_u32 s62, s58, 0
  s_add_u32 m0, s63, 98304
  s_call_b64 s[60:61], L_issK0d
  s_waitcnt vmcnt(24)
  s_barrier
  s_load_dwordx2 s[68:69], s[66:67], 828
  s_load_dwordx2 s[68:69], s[66:67], 956
  s_load_dwordx2 s[68:69], s[66:67], 1084
  s_add_u32 s62, s52, 3
  s_cmp_ge_u32 s62, 7
  s_cselect_b32 s50, 7, 0
  s_sub_u32 s62, s62, s50
  s_lshl_b32 s62, s62, 19
  s_add_u32 s62, s62, s55
  s_add_u32 s62, s62, 256
  s_add_u32 m0, s63, 65536
  s_call_b64 s[60:61], L_issQ
  s_add_u32 s62, s58, 16384
  s_add_u32 m0, s63, 81920
  s_call_b64 s[60:61], L_issK0d
  s_barrier
  s_load_dwordx2 s[68:69], s[66:67], 1212
  s_load_dwordx2 s[68:69], s[66:67], 1340
  s_load_dwordx2 s[68:69], s[66:67], 1468
  s_add_u32 s62, s52, 4
  s_cmp_ge_u32 s62, 7
  s_cselect_b32 s50, 7, 0
  s_sub_u32 s62, s62, s50
  s_lshl_b32 s62, s62, 19
  s_add_u32 s62, s62, s55
  s_add_u32 s62, s62, 256
  s_add_u32 m0, s63, 16384
  s_call_b64 s[60:61], L_issQ
  s_add_u32 s62, s58, 32768
  s_add_u32 m0, s63, 147456
  s_call_b64 s[60:61], L_issK0d
  s_waitcnt vmcnt(48)
  s_barrier
  s_load_dwordx2 s[68:69], s[66:67], 1596
  s_load_dwordx2 s[68:69], s[66:67], 1724
  s_load_dwordx2 s[68:69], s[66:67], 1852
  s_add_u32 s62, s52, 5
  s_cmp_ge_u32 s62, 7
  s_cselect_b32 s50, 7, 0
  s_sub_u32 s62, s62, s50
  s_lshl_b32 s62, s62, 19
  s_add_u32 s62, s62, s55
  s_add_u32 s62, s62, 256
  s_add_u32 m0, s63, 32768
  s_call_b64 s[60:61], L_issQ
  s_waitcnt vmcnt(48)
  s_barrier
  s_load_dwordx2 s[68:69], s[66:67], 1980
  s_load_dwordx2 s[68:69], s[66:67], 2108
  s_load_dwordx2 s[68:69], s[66:67], 2236
  s_add_u32 s62, s52, 6
  s_cmp_ge_u32 s62, 7
  s_cselect_b32 s50, 7, 0
  s_sub_u32 s62, s62, s50
  s_lshl_b32 s62, s62, 19
  s_add_u32 s62, s62, s55
  s_add_u32 s62, s62, 256
  s_add_u32 m0, s63, 49152
  s_call_b64 s[60:61], L_issQ
  s_waitcnt vmcnt(55)
  s_add_u32 s62, s58, 49152
  s_add_u32 m0, s63, 131072
  s_call_b64 s[60:61], L_issK0d
  s_waitcnt vmcnt(48)
  s_barrier
  s_load_dwordx2 s[68:69], s[66:67], 2364
  s_load_dwordx2 s[68:69], s[66:67], 2492
  s_load_dwordx2 s[68:69], s[66:67], 2620
  s_add_u32 s62, s58, 65536
  s_add_u32 m0, s63, 114688
  s_call_b64 s[60:61], L_issK0d
  s_waitcnt vmcnt(40)
  s_barrier
  s_load_dwordx2 s[68:69], s[66:67], 2748
  s_load_dwordx2 s[68:69], s[66:67], 2876
  s_load_dwordx2 s[68:69], s[66:67], 3004
  s_add_u32 s62, s58, 81920
  s_add_u32 m0, s63, 65536
  s_call_b64 s[60:61], L_issK0d
  s_waitcnt vmcnt(32)
  s_barrier
  s_load_dwordx2 s[68:69], s[66:67], 3132
  s_load_dwordx2 s[68:69], s[66:67], 3260
  s_load_dwordx2 s[68:69], s[66:67], 3388
  s_add_u32 s62, s58, 98304
  s_add_u32 m0, s63, 16384
  s_call_b64 s[60:61], L_issK0d
  s_waitcnt vmcnt(32)
  s_barrier
  s_load_dwordx2 s[68:69], s[66:67], 3516
  s_load_dwordx2 s[68:69], s[66:67], 3644
  s_load_dwordx2 s[68:69], s[66:67], 3772
  s_add_u32 s62, s58, 114688
  s_add_u32 m0, s63, 32768
  s_call_b64 s[60:61], L_issK0d
  s_cmp_eq_u32 s54, 0
  s_cbranch_scc1 L_solo
  s_barrier
  s_setprio 0
  s_mov_b32 s36, s12
  s_mov_b32 s37, s13
  s_mov_b32 s38, 3670016
  s_mov_b32 s39, 0x20000
  v_lshrrev_b32 v21, 4, v0
  v_and_b32 v22, 15, v0
  v_lshrrev_b32 v23, 2, v22
  v_lshlrev_b32 v24, 2, v21
  v_add_u32 v24, v24, v23
  v_and_b32 v25, 3, v0
  v_lshlrev_b32 v25, 3, v25
  v_and_b32 v26, 7, v24
  s_lshl_b32 s50, s44, 2
  v_xor_b32 v26, s50, v26
  v_lshlrev_b32 v26, 5, v26
  v_lshlrev_b32 v4, 9, v24
  v_add3_u32 v4, v4, v26, v25
  v_mul_u32_u24 v27, 384, v24
  v_add_u32 v27, v27, v25
  v_bfe_u32 v26, v24, 1, 2
  s_mul_i32 s74, s44, 3
  s_add_u32 s50, s74, 0
  v_xor_b32 v28, s50, v26
  v_lshlrev_b32 v28, 5, v28
  v_add_u32 v5, v27, v28
  s_add_u32 s50, s74, 1
  v_xor_b32 v28, s50, v26
  v_lshlrev_b32 v28, 5, v28
  v_add_u32 v6, v27, v28
  s_add_u32 s50, s74, 2
  v_xor_b32 v28, s50, v26
  v_lshlrev_b32 v28, 5, v28
  v_add_u32 v7, v27, v28
  v_lshlrev_b32 v15, 4, v0
  v_add_u32 v15, 114688, v15
  s_lshl_b32 s80, s45, 3
  s_add_u32 s80, s80, s46
  s_mul_i32 s80, s80, 86016
  s_mul_i32 s51, s44, 1152
  s_add_u32 s86, s80, s51
  s_add_u32 s86, s86, 6144
  s_mul_i32 s51, s44, 1536
  s_add_u32 s80, s80, s51
  s_lshl_b32 s87, s45, 9
  s_lshl_b32 s51, s46, 4
  s_add_u32 s87, s87, s51
  s_lshl_b32 s51, s44, 2
  s_add_u32 s87, s87, s51
  s_add_u32 s87, s87, 23068672
  v_and_b32 v21, 31, v0
  v_lshrrev_b32 v22, 2, v21
  v_mul_u32_u24 v22, 10752, v22
  v_and_b32 v21, 3, v0
  v_lshlrev_b32 v21, 5, v21
  v_add_u32 v22, v22, v21
  v_lshrrev_b32 v21, 5, v0
  v_lshlrev_b32 v21, 4, v21
  v_add_u32 v11, v22, v21
  v_bfe_u32 v22, v0, 2, 3
  v_cmp_eq_u32 vcc, s46, v22
  v_mov_b32 v23, 0x7f000000
  s_nop 0
  v_cndmask_b32 v11, v11, v23, vcc
  s_mov_b64 s[90:91], vcc
  v_and_b32 v22, 3, v0
  v_lshlrev_b32 v22, 5, v22
  v_add_u32 v22, v22, v21
  s_mul_i32 s50, s44, 1536
  s_add_u32 s50, s50, 81920
  v_add_u32 v3, s50, v22
  v_mov_b32 v13, 1
  v_mov_b32 v14, 0
  s_load_dwordx2 s[68:69], s[66:67], 3900
  s_load_dwordx2 s[68:69], s[66:67], 4028
  s_load_dwordx2 s[68:69], s[66:67], 4156
  s_waitcnt vmcnt(36)
  s_add_u32 s62, s52, 0
  s_cmp_ge_u32 s62, 7
  s_cselect_b32 s50, 7, 0
  s_sub_u32 s62, s62, s50
  s_branch L_pads1
L_pad1:
  s_setpc_b64 s[60:61]
L_pads1:
  s_lshl_b32 s62, s62, 19
  s_add_u32 s62, s62, s55
  s_add_u32 s62, s62, 4294705664
  s_add_u32 m0, s63, 4294959104
  s_call_b64 s[60:61], L_issQB
  s_barrier
  s_load_dwordx2 s[68:69], s[66:67], 4284
  s_load_dwordx2 s[68:69], s[66:67], 4412
  s_load_dwordx2 s[68:69], s[66:67], 4540
  s_waitcnt vmcnt(36)
  s_add_u32 s62, s52, 0
  s_cmp_ge_u32 s62, 7
  s_cselect_b32 s50, 7, 0
  s_sub_u32 s62, s62, s50
  s_lshl_b32 s62, s62, 19
  s_add_u32 s62, s62, s55
  s_add_u32 s62, s62, 512
  s_add_u32 m0, s63, 0
  s_call_b64 s[60:61], L_issQB
  s_barrier
  s_load_dwordx2 s[68:69], s[66:67], 4668
  s_load_dwordx2 s[68:69], s[66:67], 4796
  s_load_dwordx2 s[68:69], s[66:67], 4924
  s_waitcnt vmcnt(36)
  s_add_u32 s62, s52, 1
  s_cmp_ge_u32 s62, 7
  s_cselect_b32 s50, 7, 0
  s_sub_u32 s62, s62, s50
  s_lshl_b32 s62, s62, 19
  s_add_u32 s62, s62, s55
  s_add_u32 s62, s62, 4294705664
  s_add_u32 m0, s63, 40960
  s_call_b64 s[60:61], L_issQB
  s_waitcnt vmcnt(8)
  s_barrier
  s_load_dwordx2 s[68:69], s[66:67], 5052
  s_load_dwordx2 s[68:69], s[66:67], 5180
  s_load_dwordx2 s[68:69], s[66:67], 5308
  s_add_u32 s62, s52, 1
  s_cmp_ge_u32 s62, 7
  s_cselect_b32 s50, 7, 0
  s_sub_u32 s62, s62, s50
  s_lshl_b32 s62, s62, 19
  s_add_u32 s62, s62, s55
  s_add_u32 s62, s62, 512
  s_add_u32 m0, s63, 49152
  s_call_b64 s[60:61], L_issQB
  s_barrier
  s_load_dwordx2 s[68:69], s[66:67], 5436
  s_load_dwordx2 s[68:69], s[66:67], 5564
  s_load_dwordx2 s[68:69], s[66:67], 5692
  s_add_u32 s62, s52, 2
  s_cmp_ge_u32 s62, 7
  s_cselect_b32 s50, 7, 0
  s_sub_u32 s62, s62, s50
  s_lshl_b32 s62, s62, 19
  s_add_u32 s62, s62, s55
  s_add_u32 s62, s62, 4294705664
  s_add_u32 m0, s63, 73728
  s_call_b64 s[60:61], L_issQB
  s_waitcnt vmcnt(8)
  s_barrier
  s_load_dwordx2 s[68:69], s[66:67], 5820
  s_load_dwordx2 s[68:69], s[66:67], 5948
  s_load_dwordx2 s[68:69], s[66:67], 6076
  s_add_u32 s62, s52, 2
  s_cmp_ge_u32 s62, 7
  s_cselect_b32 s50, 7, 0
  s_sub_u32 s62, s62, s50
  s_lshl_b32 s62, s62, 19
  s_add_u32 s62, s62, s55
  s_add_u32 s62, s62, 512
  s_add_u32 m0, s63, 81920
  s_call_b64 s[60:61], L_issQB
  s_barrier
  s_load_dwordx2 s[68:69], s[66:67], 6204
  s_load_dwordx2 s[68:69], s[66:67], 6332
  s_load_dwordx2 s[68:69], s[66:67], 6460
  s_add_u32 s62, s52, 3
  s_cmp_ge_u32 s62, 7
  s_cselect_b32 s50, 7, 0
  s_sub_u32 s62, s62, s50
  s_lshl_b32 s62, s62, 19
  s_add_u32 s62, s62, s55
  s_add_u32 s62, s62, 4294705664
  s_add_u32 m0, s63, 4294959104
  s_call_b64 s[60:61], L_issQB
  s_waitcnt vmcnt(8)
  s_barrier
  s_load_dwordx2 s[68:69], s[66:67], 6588
  s_load_dwordx2 s[68:69], s[66:67], 6716
  s_load_dwordx2 s[68:69], s[66:67], 6844
  s_add_u32 s62, s52, 3
  s_cmp_ge_u32 s62, 7
  s_cselect_b32 s50, 7, 0
  s_sub_u32 s62, s62, s50
  s_lshl_b32 s62, s62, 19
  s_add_u32 s62, s62, s55
  s_add_u32 s62, s62, 512
  s_add_u32 m0, s63, 0
  s_call_b64 s[60:61], L_issQB
  s_barrier
  s_load_dwordx2 s[68:69], s[66:67], 6972
  s_load_dwordx2 s[68:69], s[66:67], 7100
  s_add_u32 s62, s52, 4
  s_cmp_ge_u32 s62, 7
  s_cselect_b32 s50, 7, 0
  s_sub_u32 s62, s62, s50
  s_lshl_b32 s62, s62, 19
  s_add_u32 s62, s62, s55
  s_add_u32 s62, s62, 4294705664
  s_add_u32 m0, s63, 8192
  s_call_b64 s[60:61], L_issQB
  s_waitcnt vmcnt(8)
  s_barrier
  s_add_u32 s62, s52, 4
  s_cmp_ge_u32 s62, 7
  s_cselect_b32 s50, 7, 0
  s_sub_u32 s62, s62, s50
  s_lshl_b32 s62, s62, 19
  s_add_u32 s62, s62, s55
  s_add_u32 s62, s62, 512
  s_add_u32 m0, s63, 16384
  s_call_b64 s[60:61], L_issQB
  s_barrier
  s_add_u32 s62, s52, 5
  s_cmp_ge_u32 s62, 7
  s_cselect_b32 s50, 7, 0
  s_sub_u32 s62, s62, s50
  s_lshl_b32 s62, s62, 19
  s_add_u32 s62, s62, s55
  s_add_u32 s62, s62, 4294705664
  s_add_u32 m0, s63, 24576
  s_call_b64 s[60:61], L_issQB
  s_waitcnt vmcnt(8)
  s_barrier
  s_add_u32 s62, s52, 5
  s_cmp_ge_u32 s62, 7
  s_cselect_b32 s50, 7, 0
  s_sub_u32 s62, s62, s50
  s_lshl_b32 s62, s62, 19
  s_add_u32 s62, s62, s55
  s_add_u32 s62, s62, 512
  s_add_u32 m0, s63, 32768
  s_call_b64 s[60:61], L_issQB
  s_barrier
  s_add_u32 s62, s52, 6
  s_cmp_ge_u32 s62, 7
  s_cselect_b32 s50, 7, 0
  s_sub_u32 s62, s62, s50
  s_lshl_b32 s62, s62, 19
  s_add_u32 s62, s62, s55
  s_add_u32 s62, s62, 4294705664
  s_add_u32 m0, s63, 4294959104
  s_call_b64 s[60:61], L_issQB
  s_waitcnt vmcnt(8)
  s_barrier
  s_add_u32 s62, s52, 6
  s_cmp_ge_u32 s62, 7
  s_cselect_b32 s50, 7, 0
  s_sub_u32 s62, s62, s50
  s_lshl_b32 s62, s62, 19
  s_add_u32 s62, s62, s55
  s_add_u32 s62, s62, 512
  s_add_u32 m0, s63, 0
  s_call_b64 s[60:61], L_issQB
  s_barrier
  s_add_u32 s62, s52, 0
  s_cmp_ge_u32 s62, 7
  s_cselect_b32 s50, 7, 0
  s_sub_u32 s62, s62, s50
  s_lshl_b32 s62, s62, 19
  s_add_u32 s62, s62, s55
  s_add_u32 s62, s62, 4294705920
  s_add_u32 m0, s63, 8192
  s_call_b64 s[60:61], L_issQB
  s_waitcnt vmcnt(8)
  s_barrier
  s_add_u32 s62, s52, 0
  s_cmp_ge_u32 s62, 7
  s_cselect_b32 s50, 7, 0
  s_sub_u32 s62, s62, s50
  s_lshl_b32 s62, s62, 19
  s_add_u32 s62, s62, s55
  s_add_u32 s62, s62, 768
  s_add_u32 m0, s63, 16384
  s_call_b64 s[60:61], L_issQB
  s_barrier
  s_add_u32 s62, s52, 1
  s_cmp_ge_u32 s62, 7
  s_cselect_b32 s50, 7, 0
  s_sub_u32 s62, s62, s50
  s_lshl_b32 s62, s62, 19
  s_add_u32 s62, s62, s55
  s_add_u32 s62, s62, 4294705920
  s_add_u32 m0, s63, 24576
  s_call_b64 s[60:61], L_issQB
  s_waitcnt vmcnt(8)
  s_barrier
  s_add_u32 s62, s52, 1
  s_cmp_ge_u32 s62, 7
  s_cselect_b32 s50, 7, 0
  s_sub_u32 s62, s62, s50
  s_lshl_b32 s62, s62, 19
  s_add_u32 s62, s62, s55
  s_add_u32 s62, s62, 768
  s_add_u32 m0, s63, 32768
  s_call_b64 s[60:61], L_issQB
  s_barrier
  s_add_u32 s62, s52, 2
  s_cmp_ge_u32 s62, 7
  s_cselect_b32 s50, 7, 0
  s_sub_u32 s62, s62, s50
  s_lshl_b32 s62, s62, 19
  s_add_u32 s62, s62, s55
  s_add_u32 s62, s62, 4294705920
  s_add_u32 m0, s63, 4294959104
  s_call_b64 s[60:61], L_issQB
  s_waitcnt vmcnt(8)
  s_barrier
  s_add_u32 s62, s52, 2
  s_cmp_ge_u32 s62, 7
  s_cselect_b32 s50, 7, 0
  s_sub_u32 s62, s62, s50
  s_lshl_b32 s62, s62, 19
  s_add_u32 s62, s62, s55
  s_add_u32 s62, s62, 768
  s_add_u32 m0, s63, 0
  s_call_b64 s[60:61], L_issQB
  s_barrier
  s_add_u32 s62, s52, 3
  s_cmp_ge_u32 s62, 7
  s_cselect_b32 s50, 7, 0
  s_sub_u32 s62, s62, s50
  s_lshl_b32 s62, s62, 19
  s_add_u32 s62, s62, s55
  s_add_u32 s62, s62, 4294705920
  s_add_u32 m0, s63, 8192
  s_call_b64 s[60:61], L_issQB
  s_waitcnt vmcnt(8)
  s_barrier
  s_add_u32 s62, s52, 3
  s_cmp_ge_u32 s62, 7
  s_cselect_b32 s50, 7, 0
  s_sub_u32 s62, s62, s50
  s_lshl_b32 s62, s62, 19
  s_add_u32 s62, s62, s55
  s_add_u32 s62, s62, 768
  s_add_u32 m0, s63, 16384
  s_call_b64 s[60:61], L_issQB
  s_barrier
  s_add_u32 s62, s52, 4
  s_cmp_ge_u32 s62, 7
  s_cselect_b32 s50, 7, 0
  s_sub_u32 s62, s62, s50
  s_lshl_b32 s62, s62, 19
  s_add_u32 s62, s62, s55
  s_add_u32 s62, s62, 4294705920
  s_add_u32 m0, s63, 24576
  s_call_b64 s[60:61], L_issQB
  s_waitcnt vmcnt(8)
  s_barrier
  s_add_u32 s62, s52, 4
  s_cmp_ge_u32 s62, 7
  s_cselect_b32 s50, 7, 0
  s_sub_u32 s62, s62, s50
  s_lshl_b32 s62, s62, 19
  s_add_u32 s62, s62, s55
  s_add_u32 s62, s62, 768
  s_add_u32 m0, s63, 32768
  s_call_b64 s[60:61], L_issQB
  s_barrier
  s_add_u32 s62, s52, 5
  s_cmp_ge_u32 s62, 7
  s_cselect_b32 s50, 7, 0
  s_sub_u32 s62, s62, s50
  s_lshl_b32 s62, s62, 19
  s_add_u32 s62, s62, s55
  s_add_u32 s62, s62, 4294705920
  s_add_u32 m0, s63, 4294959104
  s_call_b64 s[60:61], L_issQB
  s_waitcnt vmcnt(8)
  s_barrier
  s_add_u32 s62, s52, 5
  s_cmp_ge_u32 s62, 7
  s_cselect_b32 s50, 7, 0
  s_sub_u32 s62, s62, s50
  s_lshl_b32 s62, s62, 19
  s_add_u32 s62, s62, s55
  s_add_u32 s62, s62, 768
  s_add_u32 m0, s63, 0
  s_call_b64 s[60:61], L_issQB
  s_barrier
  s_add_u32 s62, s52, 6
  s_cmp_ge_u32 s62, 7
  s_cselect_b32 s50, 7, 0
  s_sub_u32 s62, s62, s50
  s_lshl_b32 s62, s62, 19
  s_add_u32 s62, s62, s55
  s_add_u32 s62, s62, 4294705920
  s_add_u32 m0, s63, 8192
  s_call_b64 s[60:61], L_issQB
  s_waitcnt vmcnt(8)
  s_barrier
  s_add_u32 s62, s52, 6
  s_cmp_ge_u32 s62, 7
  s_cselect_b32 s50, 7, 0
  s_sub_u32 s62, s62, s50
  s_lshl_b32 s62, s62, 19
  s_add_u32 s62, s62, s55
  s_add_u32 s62, s62, 768
  s_add_u32 m0, s63, 16384
  s_call_b64 s[60:61], L_issQB
  s_barrier
  s_lshl_b32 s50, s45, 3
  s_add_u32 s70, s16, s50
  s_addc_u32 s71, s17, 0
  s_load_dword s72, s[70:71], 0
  s_waitcnt vmcnt(0)
  s_barrier
  s_add_u32 s62, s79, 4294952960
  s_add_u32 m0, s63, 4294959104
  s_call_b64 s[60:61], L_issO0
  s_barrier
  s_add_u32 s62, s79, 0
  s_add_u32 m0, s63, 0
  s_call_b64 s[60:61], L_issO0
  s_barrier
  s_add_u32 s62, s79, 4294952960
  s_add_u32 m0, s65, 10240
  s_call_b64 s[60:61], L_issO1
  s_waitcnt lgkmcnt(0)
  s_mov_b32 s28, s16
  s_mov_b32 s29, s17
  s_mov_b32 s30, 256
  s_mov_b32 s31, 0x20000
  s_lshl_b32 s50, s45, 3
  v_mov_b32 v30, s50
  s_mov_b32 s51, 0
L_chk:
  s_cmp_eq_u32 s72, 1
  s_cbranch_scc1 L_chkd
  s_add_u32 s51, s51, 1
  s_cmp_ge_u32 s51, 0x200000
  s_cbranch_scc1 L_chkd
  buffer_load_dword v32, v30, s[28:31], 0 offen sc1
  s_waitcnt vmcnt(0)
  v_readfirstlane_b32 s72, v32
  s_branch L_chk
L_chkd:
  s_waitcnt vmcnt(6)
  s_branch L_op46
L_solo:
  s_barrier
  s_load_dwordx2 s[68:69], s[66:67], 3900
  s_load_dwordx2 s[68:69], s[66:67], 4028
  s_load_dwordx2 s[68:69], s[66:67], 4156
  s_barrier
  s_load_dwordx2 s[68:69], s[66:67], 4284
  s_load_dwordx2 s[68:69], s[66:67], 4412
  s_load_dwordx2 s[68:69], s[66:67], 4540
  s_add_u32 s62, s58, 131072
  s_mov_b32 m0, 98304
  s_call_b64 s[60:61], L_qK0_14_14
  s_barrier
  s_load_dwordx2 s[68:69], s[66:67], 4668
  s_load_dwordx2 s[68:69], s[66:67], 4796
  s_load_dwordx2 s[68:69], s[66:67], 4924
  s_call_b64 s[60:61], L_qK1_14_14
  s_call_b64 s[60:61], L_qK2_14_14
  s_call_b64 s[60:61], L_qK3_14_14
  s_barrier
  s_load_dwordx2 s[68:69], s[66:67], 5052
  s_load_dwordx2 s[68:69], s[66:67], 5180
  s_load_dwordx2 s[68:69], s[66:67], 5308
  s_add_u32 s62, s58, 147456
  s_mov_b32 m0, 147456
  s_call_b64 s[60:61], L_qK0_14_14
  s_call_b64 s[60:61], L_qK1_14_14
  s_call_b64 s[60:61], L_qK2_14_14
  s_barrier
  s_load_dwordx2 s[68:69], s[66:67], 5436
  s_load_dwordx2 s[68:69], s[66:67], 5564
  s_load_dwordx2 s[68:69], s[66:67], 5692
  s_call_b64 s[60:61], L_qK3_14_14
  s_add_u32 s62, s58, 163840
  s_mov_b32 m0, 131072
  s_call_b64 s[60:61], L_qK0_14_14
  s_call_b64 s[60:61], L_qK1_14_14
  s_barrier
  s_load_dwordx2 s[68:69], s[66:67], 5820
  s_load_dwordx2 s[68:69], s[66:67], 5948
  s_load_dwordx2 s[68:69], s[66:67], 6076
  s_call_b64 s[60:61], L_qK2_14_14
  s_call_b64 s[60:61], L_qK3_14_14
  s_add_u32 s62, s58, 180224
  s_mov_b32 m0, 114688
  s_call_b64 s[60:61], L_qK0_14_14
  s_barrier
  s_load_dwordx2 s[68:69], s[66:67], 6204
  s_load_dwordx2 s[68:69], s[66:67], 6332
  s_load_dwordx2 s[68:69], s[66:67], 6460
  s_call_b64 s[60:61], L_qK1_14_14
  s_call_b64 s[60:61], L_qK2_14_14
  s_call_b64 s[60:61], L_qK3_14_14
  s_add_u32 s62, s58, 196608
  s_mov_b32 m0, 65536
  s_call_b64 s[60:61], L_qK0_14_14
  s_barrier
  s_load_dwordx2 s[68:69], s[66:67], 6588
  s_load_dwordx2 s[68:69], s[66:67], 6716
  s_load_dwordx2 s[68:69], s[66:67], 6844
  s_call_b64 s[60:61], L_qK1_14_14
  s_call_b64 s[60:61], L_qK2_14_14
  s_call_b64 s[60:61], L_qK3_14_14
  s_barrier
  s_load_dwordx2 s[68:69], s[66:67], 6972
  s_load_dwordx2 s[68:69], s[66:67], 7100
  s_add_u32 s62, s58, 212992
  s_mov_b32 m0, 49152
  s_call_b64 s[60:61], L_qK0_14_14
  s_call_b64 s[60:61], L_qK1_14_14
  s_call_b64 s[60:61], L_qK2_14_14
  s_barrier
  s_call_b64 s[60:61], L_qK3_14_14
  s_add_u32 s62, s58, 229376
  s_mov_b32 m0, 98304
  s_call_b64 s[60:61], L_qK0_14_14
  s_call_b64 s[60:61], L_qK1_14_14
  s_barrier
  s_call_b64 s[60:61], L_qK2_14_14
  s_call_b64 s[60:61], L_qK3_14_14
  s_add_u32 s62, s58, 245760
  s_mov_b32 m0, 147456
  s_call_b64 s[60:61], L_qK0_14_14
  s_barrier
  s_call_b64 s[60:61], L_qK1_14_14
  s_call_b64 s[60:61], L_qK2_14_14
  s_call_b64 s[60:61], L_qK3_14_14
  s_barrier
  s_add_u32 s62, s59, 0
  s_mov_b32 m0, 131072
  s_call_b64 s[60:61], L_qV0_14_14
  s_call_b64 s[60:61], L_qV0_14_14
  s_call_b64 s[60:61], L_qV0_14_14
  s_barrier
  s_call_b64 s[60:61], L_qV0_14_14
  s_add_u32 s62, s59, 32768
  s_mov_b32 m0, 114688
  s_call_b64 s[60:61], L_qV0_14_14
  s_call_b64 s[60:61], L_qV0_14_14
  s_barrier
  s_call_b64 s[60:61], L_qV0_14_14
  s_call_b64 s[60:61], L_qV0_14_14
  s_add_u32 s62, s59, 65536
  s_mov_b32 m0, 81920
  s_call_b64 s[60:61], L_qV0_14_14
  s_call_b64 s[60:61], L_qV0_14_14
  s_barrier
  s_call_b64 s[60:61], L_qV0_14_14
  s_call_b64 s[60:61], L_qV0_14_14
  s_add_u32 s62, s59, 98304
  s_mov_b32 m0, 98304
  s_call_b64 s[60:61], L_qV0_14_14
  s_barrier
  s_call_b64 s[60:61], L_qV0_17_17
  s_call_b64 s[60:61], L_qV0_17_17
  s_call_b64 s[60:61], L_qV0_17_17
  s_add_u32 s62, s59, 131072
  s_mov_b32 m0, 147456
  s_call_b64 s[60:61], L_qV0_17_17
  s_call_b64 s[60:61], L_qV0_17_17
  s_barrier
  s_call_b64 s[60:61], L_qV0_17_17
  s_call_b64 s[60:61], L_qV0_17_17
  s_add_u32 s62, s59, 163840
  s_mov_b32 m0, 131072
  s_call_b64 s[60:61], L_qV0_17_17
  s_call_b64 s[60:61], L_qV0_17_17
  s_barrier
  s_call_b64 s[60:61], L_qV0_17_17
  s_call_b64 s[60:61], L_qV0_17_17
  s_add_u32 s62, s59, 196608
  s_mov_b32 m0, 114688
  s_call_b64 s[60:61], L_qV0_17_17
  s_call_b64 s[60:61], L_qV0_17_17
  s_barrier
  s_call_b64 s[60:61], L_qV0_17_17
  s_call_b64 s[60:61], L_qV0_17_17
  s_add_u32 s62, s59, 229376
  s_mov_b32 m0, 81920
  s_call_b64 s[60:61], L_qV0_17_17
  s_call_b64 s[60:61], L_qV0_17_17
  s_barrier
  s_call_b64 s[60:61], L_qV0_17_17
  s_call_b64 s[60:61], L_qV0_17_17
  s_add_u32 s62, s59, 256
  s_mov_b32 m0, 98304
  s_call_b64 s[60:61], L_qV0_17_17
  s_call_b64 s[60:61], L_qV0_17_17
  s_barrier
  s_call_b64 s[60:61], L_qV0_17_17
  s_call_b64 s[60:61], L_qV0_17_17
  s_add_u32 s62, s59, 33024
  s_mov_b32 m0, 147456
  s_call_b64 s[60:61], L_qV0_17_17
  s_call_b64 s[60:61], L_qV0_17_17
  s_barrier
  s_call_b64 s[60:61], L_qV0_17_17
  s_call_b64 s[60:61], L_qV0_17_17
  s_add_u32 s62, s59, 65792
  s_mov_b32 m0, 65536
  s_call_b64 s[60:61], L_qV0_17_17
  s_call_b64 s[60:61], L_qV0_17_17
  s_barrier
  s_call_b64 s[60:61], L_qV0_17_17
  s_call_b64 s[60:61], L_qV0_17_17
  s_add_u32 s62, s59, 98560
  s_mov_b32 m0, 49152
  s_call_b64 s[60:61], L_qV0_17_17
  s_call_b64 s[60:61], L_qV0_17_17
  s_call_b64 s[60:61], L_qV0_17_17
  s_barrier
  s_call_b64 s[60:61], L_qV0_17_17
  s_add_u32 s62, s59, 131328
  s_mov_b32 m0, 81920
  s_call_b64 s[60:61], L_qV0_17_17
  s_call_b64 s[60:61], L_qV0_17_17
  s_call_b64 s[60:61], L_qV0_17_17
  s_call_b64 s[60:61], L_qV0_17_17
  s_barrier
  s_add_u32 s62, s59, 164096
  s_mov_b32 m0, 98304
  s_call_b64 s[60:61], L_qV0_17_17
  s_call_b64 s[60:61], L_qV0_17_17
  s_call_b64 s[60:61], L_qV0_17_17
  s_call_b64 s[60:61], L_qV0_17_17
  s_barrier
  s_add_u32 s62, s59, 196864
  s_mov_b32 m0, 147456
  s_call_b64 s[60:61], L_qV0_17_17
  s_call_b64 s[60:61], L_qV0_17_17
  s_call_b64 s[60:61], L_qV0_17_17
  s_call_b64 s[60:61], L_qV0_17_17
  s_barrier
  s_add_u32 s62, s59, 229632
  s_mov_b32 m0, 65536
  s_call_b64 s[60:61], L_qV0_17_17
  s_call_b64 s[60:61], L_qV0_17_17
  s_call_b64 s[60:61], L_qV0_17_17
  s_call_b64 s[60:61], L_qV0_17_17
  s_barrier
  s_add_u32 s62, s58, 262144
  s_mov_b32 m0, 49152
  s_call_b64 s[60:61], L_qK0_17_17
  s_call_b64 s[60:61], L_qK1_17_17
  s_call_b64 s[60:61], L_qK2_17_17
  s_call_b64 s[60:61], L_qK3_17_17
  s_barrier
  s_add_u32 s62, s58, 278528
  s_mov_b32 m0, 81920
  s_call_b64 s[60:61], L_qK0_17_17
  s_call_b64 s[60:61], L_qK1_17_17
  s_call_b64 s[60:61], L_qK2_17_17
  s_call_b64 s[60:61], L_qK3_17_17
  s_barrier
  s_add_u32 s62, s58, 294912
  s_mov_b32 m0, 98304
  s_call_b64 s[60:61], L_qK0_17_17
  s_call_b64 s[60:61], L_qK1_17_17
  s_call_b64 s[60:61], L_qK2_17_17
  s_call_b64 s[60:61], L_qK3_17_17
  s_barrier
  s_add_u32 s62, s58, 311296
  s_mov_b32 m0, 32768
  s_call_b64 s[60:61], L_qK0_17_17
  s_call_b64 s[60:61], L_qK1_17_17
  s_call_b64 s[60:61], L_qK2_17_17
  s_call_b64 s[60:61], L_qK3_17_17
  s_barrier
  s_add_u32 s62, s58, 327680
  s_mov_b32 m0, 65536
  s_call_b64 s[60:61], L_qK0_17_17
  s_call_b64 s[60:61], L_qK1_17_17
  s_call_b64 s[60:61], L_qK2_17_17
  s_call_b64 s[60:61], L_qK3_17_17
  s_barrier
  s_add_u32 s62, s58, 344064
  s_mov_b32 m0, 49152
  s_call_b64 s[60:61], L_qK0_17_17
  s_call_b64 s[60:61], L_qK1_17_17
  s_call_b64 s[60:61], L_qK2_17_17
  s_call_b64 s[60:61], L_qK3_17_17
  s_barrier
  s_add_u32 s62, s58, 360448
  s_mov_b32 m0, 81920
  s_call_b64 s[60:61], L_qK0_17_17
  s_call_b64 s[60:61], L_qK1_17_17
  s_call_b64 s[60:61], L_qK2_17_17
  s_call_b64 s[60:61], L_qK3_17_17
  s_barrier
  s_add_u32 s62, s58, 376832
  s_mov_b32 m0, 98304
  s_call_b64 s[60:61], L_qK0_17_17
  s_call_b64 s[60:61], L_qK1_17_17
  s_call_b64 s[60:61], L_qK2_17_17
  s_call_b64 s[60:61], L_qK3_17_17
  s_barrier
  s_add_u32 s62, s58, 393216
  s_mov_b32 m0, 32768
  s_call_b64 s[60:61], L_qK0_17_17
  s_call_b64 s[60:61], L_qK1_17_17
  s_call_b64 s[60:61], L_qK2_17_17
  s_call_b64 s[60:61], L_qK3_17_17
  s_barrier
  s_add_u32 s62, s58, 409600
  s_mov_b32 m0, 65536
  s_call_b64 s[60:61], L_qK0_17_17
  s_call_b64 s[60:61], L_qK1_17_17
  s_call_b64 s[60:61], L_qK2_17_17
  s_call_b64 s[60:61], L_qK3_17_17
  s_barrier
  s_add_u32 s62, s58, 425984
  s_mov_b32 m0, 49152
  s_call_b64 s[60:61], L_qK0_17_17
  s_call_b64 s[60:61], L_qK1_17_17
  s_call_b64 s[60:61], L_qK2_17_17
  s_call_b64 s[60:61], L_qK3_17_17
  s_barrier
  s_add_u32 s62, s58, 442368
  s_mov_b32 m0, 81920
  s_call_b64 s[60:61], L_qK0_17_17
  s_call_b64 s[60:61], L_qK1_17_17
  s_call_b64 s[60:61], L_qK2_17_17
  s_call_b64 s[60:61], L_qK3_17_17
  s_barrier
  s_add_u32 s62, s58, 458752
  s_mov_b32 m0, 98304
  s_call_b64 s[60:61], L_qK0_17_17
  s_call_b64 s[60:61], L_qK1_17_17
  s_call_b64 s[60:61], L_qK2_17_17
  s_call_b64 s[60:61], L_qK3_17_17
  s_barrier
  s_add_u32 s62, s58, 475136
  s_mov_b32 m0, 32768
  s_call_b64 s[60:61], L_qK0_17_17
  s_call_b64 s[60:61], L_qK1_17_17
  s_call_b64 s[60:61], L_qK2_17_17
  s_barrier
  s_call_b64 s[60:61], L_qK3_17_17
  s_add_u32 s62, s58, 491520
  s_mov_b32 m0, 65536
  s_call_b64 s[60:61], L_qK0_17_17
  s_call_b64 s[60:61], L_qK1_17_17
  s_call_b64 s[60:61], L_qK2_17_17
  s_barrier
  s_call_b64 s[60:61], L_qK3_17_17
  s_add_u32 s62, s58, 507904
  s_mov_b32 m0, 49152
  s_call_b64 s[60:61], L_qK0_17_17
  s_call_b64 s[60:61], L_qK1_17_17
  s_call_b64 s[60:61], L_qK2_17_17
  s_barrier
  s_call_b64 s[60:61], L_qK3_17_17
  s_add_u32 s62, s59, 262144
  s_mov_b32 m0, 81920
  s_call_b64 s[60:61], L_qV0_17_17
  s_call_b64 s[60:61], L_qV0_17_17
  s_call_b64 s[60:61], L_qV0_17_17
  s_barrier
  s_call_b64 s[60:61], L_qV0_17_17
  s_add_u32 s62, s59, 294912
  s_mov_b32 m0, 98304
  s_call_b64 s[60:61], L_qV0_17_17
  s_call_b64 s[60:61], L_qV0_17_17
  s_call_b64 s[60:61], L_qV0_17_17
  s_barrier
  s_call_b64 s[60:61], L_qV0_17_17
  s_barrier
  s_add_u32 s62, s59, 327680
  s_mov_b32 m0, 65536
  s_call_b64 s[60:61], L_qV0_17_17
  s_call_b64 s[60:61], L_qV0_17_17
  s_call_b64 s[60:61], L_qV0_17_17
  s_call_b64 s[60:61], L_qV0_17_17
  s_barrier
  s_add_u32 s62, s59, 360448
  s_mov_b32 m0, 49152
  s_call_b64 s[60:61], L_qV0_17_17
  s_call_b64 s[60:61], L_qV0_17_17
  s_call_b64 s[60:61], L_qV0_17_17
  s_call_b64 s[60:61], L_qV0_17_17
  s_barrier
  s_add_u32 s62, s59, 393216
  s_mov_b32 m0, 81920
  s_call_b64 s[60:61], L_qV0_17_17
  s_call_b64 s[60:61], L_qV0_17_17
  s_call_b64 s[60:61], L_qV0_17_17
  s_call_b64 s[60:61], L_qV0_17_17
  s_barrier
  s_add_u32 s62, s59, 425984
  s_mov_b32 m0, 98304
  s_call_b64 s[60:61], L_qV0_17_17
  s_call_b64 s[60:61], L_qV0_17_17
  s_call_b64 s[60:61], L_qV0_17_17
  s_call_b64 s[60:61], L_qV0_17_17
  s_barrier
  s_add_u32 s62, s59, 458752
  s_mov_b32 m0, 65536
  s_call_b64 s[60:61], L_qV0_17_17
  s_call_b64 s[60:61], L_qV0_17_17
  s_call_b64 s[60:61], L_qV0_17_17
  s_call_b64 s[60:61], L_qV0_17_17
  s_barrier
  s_add_u32 s62, s59, 491520
  s_mov_b32 m0, 49152
  s_call_b64 s[60:61], L_qV0_22_22
  s_call_b64 s[60:61], L_qV0_22_22
  s_call_b64 s[60:61], L_qV0_22_22
  s_call_b64 s[60:61], L_qV0_22_22
  s_barrier
  s_add_u32 s62, s59, 262400
  s_mov_b32 m0, 81920
  s_call_b64 s[60:61], L_qV0_22_22
  s_call_b64 s[60:61], L_qV0_22_22
  s_call_b64 s[60:61], L_qV0_22_22
  s_call_b64 s[60:61], L_qV0_22_22
  s_barrier
  s_add_u32 s62, s59, 295168
  s_mov_b32 m0, 98304
  s_call_b64 s[60:61], L_qV0_22_22
  s_call_b64 s[60:61], L_qV0_22_22
  s_call_b64 s[60:61], L_qV0_22_22
  s_call_b64 s[60:61], L_qV0_22_22
  s_barrier
  s_add_u32 s62, s59, 327936
  s_mov_b32 m0, 65536
  s_call_b64 s[60:61], L_qV0_22_22
  s_call_b64 s[60:61], L_qV0_22_22
  s_call_b64 s[60:61], L_qV0_22_22
  s_call_b64 s[60:61], L_qV0_22_22
  s_barrier
  s_add_u32 s62, s59, 360704
  s_mov_b32 m0, 49152
  s_call_b64 s[60:61], L_qV0_22_22
  s_call_b64 s[60:61], L_qV0_22_22
  s_call_b64 s[60:61], L_qV0_22_22
  s_call_b64 s[60:61], L_qV0_22_22
  s_barrier
  s_add_u32 s62, s59, 393472
  s_mov_b32 m0, 81920
  s_call_b64 s[60:61], L_qV0_22_22
  s_call_b64 s[60:61], L_qV0_22_22
  s_call_b64 s[60:61], L_qV0_22_22
  s_call_b64 s[60:61], L_qV0_22_22
  s_barrier
  s_add_u32 s62, s59, 426240
  s_mov_b32 m0, 98304
  s_call_b64 s[60:61], L_qV0_22_22
  s_call_b64 s[60:61], L_qV0_22_22
  s_call_b64 s[60:61], L_qV0_22_22
  s_call_b64 s[60:61], L_qV0_22_22
  s_barrier
  s_add_u32 s62, s59, 459008
  s_mov_b32 m0, 65536
  s_call_b64 s[60:61], L_qV0_22_22
  s_call_b64 s[60:61], L_qV0_22_22
  s_call_b64 s[60:61], L_qV0_22_22
  s_call_b64 s[60:61], L_qV0_22_22
  s_barrier
  s_add_u32 s62, s59, 491776
  s_mov_b32 m0, 49152
  s_call_b64 s[60:61], L_qV0_22_22
  s_call_b64 s[60:61], L_qV0_22_22
  s_call_b64 s[60:61], L_qV0_22_22
  s_call_b64 s[60:61], L_qV0_22_22
  s_barrier
  s_add_u32 s62, s79, 315392
  s_add_u32 m0, s63, 81920
  s_call_b64 s[60:61], L_issO0
  s_add_u32 s62, s79, 329728
  s_add_u32 m0, s63, 90112
  s_call_b64 s[60:61], L_issO0
  s_add_u32 s62, s79, 344064
  s_add_u32 m0, s63, 32768
  s_call_b64 s[60:61], L_issO0
  s_add_u32 s62, s79, 358400
  s_add_u32 m0, s63, 40960
  s_call_b64 s[60:61], L_issO0
  s_waitcnt vmcnt(48)
  s_barrier
  s_add_u32 s62, s79, 372736
  s_add_u32 m0, s63, 98304
  s_call_b64 s[60:61], L_issO0
  s_waitcnt vmcnt(55)
  s_branch L_pads2
L_pad2:
  s_setpc_b64 s[60:61]
L_pads2:
  s_add_u32 s62, s79, 387072
  s_add_u32 m0, s63, 106496
  s_call_b64 s[60:61], L_issO0
  s_waitcnt vmcnt(48)
  s_barrier
  s_add_u32 s62, s79, 401408
  s_add_u32 m0, s63, 65536
  s_call_b64 s[60:61], L_issO0
  s_waitcnt vmcnt(55)
  s_add_u32 s62, s79, 415744
  s_add_u32 m0, s63, 73728
  s_call_b64 s[60:61], L_issO0
  s_waitcnt vmcnt(55)
  s_add_u32 s62, s79, 430080
  s_add_u32 m0, s63, 0
  s_call_b64 s[60:61], L_issO0
  s_waitcnt vmcnt(55)
  s_add_u32 s62, s79, 444416
  s_add_u32 m0, s63, 8192
  s_call_b64 s[60:61], L_issO0
  s_waitcnt vmcnt(48)
  s_barrier
  s_add_u32 s62, s79, 229376
  s_add_u32 m0, s65, 49152
  s_call_b64 s[60:61], L_issO1
  s_add_u32 s62, s79, 243712
  s_add_u32 m0, s65, 55296
  s_call_b64 s[60:61], L_issO1
  s_waitcnt vmcnt(55)
  s_add_u32 s62, s79, 258048
  s_add_u32 m0, s65, 16384
  s_call_b64 s[60:61], L_issO1
  s_waitcnt vmcnt(55)
  s_add_u32 s62, s79, 272384
  s_add_u32 m0, s65, 22528
  s_call_b64 s[60:61], L_issO1
  s_waitcnt vmcnt(40)
  s_barrier
  s_add_u32 s62, s79, 286720
  s_add_u32 m0, s65, 32768
  s_call_b64 s[60:61], L_issO1
  s_add_u32 s62, s79, 301056
  s_add_u32 m0, s65, 38912
  s_call_b64 s[60:61], L_issO1
  s_waitcnt vmcnt(24)
  s_barrier
  s_add_u32 s62, s79, 315392
  s_add_u32 m0, s65, 98304
  s_call_b64 s[60:61], L_issO1
  s_add_u32 s62, s79, 329728
  s_add_u32 m0, s65, 104448
  s_call_b64 s[60:61], L_issO1
  s_add_u32 s62, s79, 344064
  s_add_u32 m0, s65, 65536
  s_call_b64 s[60:61], L_issO1
  s_add_u32 s62, s79, 358400
  s_add_u32 m0, s65, 71680
  s_call_b64 s[60:61], L_issO1
  s_waitcnt vmcnt(24)
  s_barrier
  s_add_u32 s62, s79, 372736
  s_add_u32 m0, s65, 49152
  s_call_b64 s[60:61], L_issO1
  s_add_u32 s62, s79, 387072
  s_add_u32 m0, s65, 55296
  s_call_b64 s[60:61], L_issO1
  s_add_u32 s62, s79, 401408
  s_add_u32 m0, s65, 0
  s_call_b64 s[60:61], L_issO1
  s_add_u32 s62, s79, 415744
  s_add_u32 m0, s65, 6144
  s_call_b64 s[60:61], L_issO1
  s_waitcnt vmcnt(24)
  s_barrier
  s_add_u32 s62, s79, 430080
  s_add_u32 m0, s65, 32768
  s_call_b64 s[60:61], L_issO1
  s_add_u32 s62, s79, 444416
  s_add_u32 m0, s65, 38912
  s_call_b64 s[60:61], L_issO1
  s_waitcnt vmcnt(12)
  s_barrier
  s_waitcnt vmcnt(0)
  s_barrier
  s_branch L_red
L_qK0_14_14:
  s_waitcnt vmcnt(14)
  buffer_load_dwordx4 v72, s[24:27], s62 offen offset:0 nt lds
  buffer_load_dwordx4 v73, s[24:27], s62 offen offset:1024 nt lds
  s_waitcnt vmcnt(14)
  buffer_load_dwordx4 v72, s[24:27], s62 offen offset:2048 nt lds
  buffer_load_dwordx4 v73, s[24:27], s62 offen offset:3072 nt lds
  s_add_u32 s62, s62, 4096
  s_add_u32 m0, m0, 4096
  s_setpc_b64 s[60:61]
L_qK0_17_17:
  s_waitcnt vmcnt(17)
  buffer_load_dwordx4 v72, s[24:27], s62 offen offset:0 nt lds
  buffer_load_dwordx4 v73, s[24:27], s62 offen offset:1024 nt lds
  s_waitcnt vmcnt(17)
  buffer_load_dwordx4 v72, s[24:27], s62 offen offset:2048 nt lds
  buffer_load_dwordx4 v73, s[24:27], s62 offen offset:3072 nt lds
  s_add_u32 s62, s62, 4096
  s_add_u32 m0, m0, 4096
  s_setpc_b64 s[60:61]
L_qK1_14_14:
  s_waitcnt vmcnt(14)
  buffer_load_dwordx4 v74, s[24:27], s62 offen offset:0 nt lds
  buffer_load_dwordx4 v75, s[24:27], s62 offen offset:1024 nt lds
  s_waitcnt vmcnt(14)
  buffer_load_dwordx4 v74, s[24:27], s62 offen offset:2048 nt lds
  buffer_load_dwordx4 v75, s[24:27], s62 offen offset:3072 nt lds
  s_add_u32 s62, s62, 4096
  s_add_u32 m0, m0, 4096
  s_setpc_b64 s[60:61]
L_qK1_17_17:
  s_waitcnt vmcnt(17)
  buffer_load_dwordx4 v74, s[24:27], s62 offen offset:0 nt lds
  buffer_load_dwordx4 v75, s[24:27], s62 offen offset:1024 nt lds
  s_waitcnt vmcnt(17)
  buffer_load_dwordx4 v74, s[24:27], s62 offen offset:2048 nt lds
  buffer_load_dwordx4 v75, s[24:27], s62 offen offset:3072 nt lds
  s_add_u32 s62, s62, 4096
  s_add_u32 m0, m0, 4096
  s_setpc_b64 s[60:61]
L_qK2_14_14:
  s_waitcnt vmcnt(14)
  buffer_load_dwordx4 v76, s[24:27], s62 offen offset:0 nt lds
  buffer_load_dwordx4 v77, s[24:27], s62 offen offset:1024 nt lds
  s_waitcnt vmcnt(14)
  buffer_load_dwordx4 v76, s[24:27], s62 offen offset:2048 nt lds
  buffer_load_dwordx4 v77, s[24:27], s62 offen offset:3072 nt lds
  s_add_u32 s62, s62, 4096
  s_add_u32 m0, m0, 4096
  s_setpc_b64 s[60:61]
L_qK2_17_17:
  s_waitcnt vmcnt(17)
  buffer_load_dwordx4 v76, s[24:27], s62 offen offset:0 nt lds
  buffer_load_dwordx4 v77, s[24:27], s62 offen offset:1024 nt lds
  s_waitcnt vmcnt(17)
  buffer_load_dwordx4 v76, s[24:27], s62 offen offset:2048 nt lds
  buffer_load_dwordx4 v77, s[24:27], s62 offen offset:3072 nt lds
  s_add_u32 s62, s62, 4096
  s_add_u32 m0, m0, 4096
  s_setpc_b64 s[60:61]
L_qK3_14_14:
  s_waitcnt vmcnt(14)
  buffer_load_dwordx4 v78, s[24:27], s62 offen offset:0 nt lds
  buffer_load_dwordx4 v79, s[24:27], s62 offen offset:1024 nt lds
  s_waitcnt vmcnt(14)
  buffer_load_dwordx4 v78, s[24:27], s62 offen offset:2048 nt lds
  buffer_load_dwordx4 v79, s[24:27], s62 offen offset:3072 nt lds
  s_add_u32 s62, s62, 4096
  s_add_u32 m0, m0, 4096
  s_setpc_b64 s[60:61]
L_qK3_17_17:
  s_waitcnt vmcnt(17)
  buffer_load_dwordx4 v78, s[24:27], s62 offen offset:0 nt lds
  buffer_load_dwordx4 v79, s[24:27], s62 offen offset:1024 nt lds
  s_waitcnt vmcnt(17)
  buffer_load_dwordx4 v78, s[24:27], s62 offen offset:2048 nt lds
  buffer_load_dwordx4 v79, s[24:27], s62 offen offset:3072 nt lds
  s_add_u32 s62, s62, 4096
  s_add_u32 m0, m0, 4096
  s_setpc_b64 s[60:61]
L_qV0_14_14:
  s_waitcnt vmcnt(14)
  buffer_load_dwordx4 v80, s[28:31], s62 offen offset:0 nt lds
  buffer_load_dwordx4 v81, s[28:31], s62 offen offset:1024 nt lds
  s_waitcnt vmcnt(14)
  buffer_load_dwordx4 v82, s[28:31], s62 offen offset:2048 nt lds
  buffer_load_dwordx4 v83, s[28:31], s62 offen offset:3072 nt lds
  s_add_u32 s62, s62, 8192
  s_add_u32 m0, m0, 4096
  s_setpc_b64 s[60:61]
L_qV0_17_17:
  s_waitcnt vmcnt(17)
  buffer_load_dwordx4 v80, s[28:31], s62 offen offset:0 nt lds
  buffer_load_dwordx4 v81, s[28:31], s62 offen offset:1024 nt lds
  s_waitcnt vmcnt(17)
  buffer_load_dwordx4 v82, s[28:31], s62 offen offset:2048 nt lds
  buffer_load_dwordx4 v83, s[28:31], s62 offen offset:3072 nt lds
  s_add_u32 s62, s62, 8192
  s_add_u32 m0, m0, 4096
  s_setpc_b64 s[60:61]
L_qV0_22_22:
  s_waitcnt vmcnt(22)
  buffer_load_dwordx4 v80, s[28:31], s62 offen offset:0 nt lds
  buffer_load_dwordx4 v81, s[28:31], s62 offen offset:1024 nt lds
  s_waitcnt vmcnt(22)
  buffer_load_dwordx4 v82, s[28:31], s62 offen offset:2048 nt lds
  buffer_load_dwordx4 v83, s[28:31], s62 offen offset:3072 nt lds
  s_add_u32 s62, s62, 8192
  s_add_u32 m0, m0, 4096
  s_setpc_b64 s[60:61]
L_issQ:
  buffer_load_dwordx4 v64, s[32:35], s62 offen offset:0 lds
  buffer_load_dwordx4 v65, s[32:35], s62 offen offset:1024 lds
  buffer_load_dwordx4 v66, s[32:35], s62 offen offset:2048 lds
  buffer_load_dwordx4 v67, s[32:35], s62 offen offset:3072 lds
  s_add_u32 s62, s62, 131072
  s_add_u32 m0, m0, 4096
  s_nop 0
  buffer_load_dwordx4 v64, s[32:35], s62 offen offset:0 lds
  buffer_load_dwordx4 v65, s[32:35], s62 offen offset:1024 lds
  buffer_load_dwordx4 v66, s[32:35], s62 offen offset:2048 lds
  buffer_load_dwordx4 v67, s[32:35], s62 offen offset:3072 lds
  s_setpc_b64 s[60:61]
L_issQB:
  buffer_load_dwordx4 v48, s[32:35], s62 offen offset:0 lds
  buffer_load_dwordx4 v49, s[32:35], s62 offen offset:1024 lds
  buffer_load_dwordx4 v50, s[32:35], s62 offen offset:2048 lds
  buffer_load_dwordx4 v51, s[32:35], s62 offen offset:3072 lds
  s_add_u32 s62, s62, 131072
  s_add_u32 m0, m0, 4096
  s_nop 0
  buffer_load_dwordx4 v48, s[32:35], s62 offen offset:0 lds
  buffer_load_dwordx4 v49, s[32:35], s62 offen offset:1024 lds
  buffer_load_dwordx4 v50, s[32:35], s62 offen offset:2048 lds
  buffer_load_dwordx4 v51, s[32:35], s62 offen offset:3072 lds
  s_setpc_b64 s[60:61]
L_issK0:
  s_waitcnt vmcnt(17)
  buffer_load_dwordx4 v72, s[24:27], s62 offen offset:0 nt lds
  buffer_load_dwordx4 v73, s[24:27], s62 offen offset:1024 nt lds
  s_waitcnt vmcnt(17)
  buffer_load_dwordx4 v72, s[24:27], s62 offen offset:2048 nt lds
  buffer_load_dwordx4 v73, s[24:27], s62 offen offset:3072 nt lds
  s_add_u32 s62, s62, 4096
  s_add_u32 m0, m0, 4096
  s_waitcnt vmcnt(17)
  buffer_load_dwordx4 v74, s[24:27], s62 offen offset:0 nt lds
  buffer_load_dwordx4 v75, s[24:27], s62 offen offset:1024 nt lds
  s_waitcnt vmcnt(17)
  buffer_load_dwordx4 v74, s[24:27], s62 offen offset:2048 nt lds
  buffer_load_dwordx4 v75, s[24:27], s62 offen offset:3072 nt lds
  s_setpc_b64 s[60:61]
L_issK1:
  s_waitcnt vmcnt(17)
  buffer_load_dwordx4 v76, s[24:27], s62 offen offset:0 nt lds
  buffer_load_dwordx4 v77, s[24:27], s62 offen offset:1024 nt lds
  s_waitcnt vmcnt(17)
  buffer_load_dwordx4 v76, s[24:27], s62 offen offset:2048 nt lds
  buffer_load_dwordx4 v77, s[24:27], s62 offen offset:3072 nt lds
  s_add_u32 s62, s62, 4096
  s_add_u32 m0, m0, 4096
  s_waitcnt vmcnt(17)
  buffer_load_dwordx4 v78, s[24:27], s62 offen offset:0 nt lds
  buffer_load_dwordx4 v79, s[24:27], s62 offen offset:1024 nt lds
  s_waitcnt vmcnt(17)
  buffer_load_dwordx4 v78, s[24:27], s62 offen offset:2048 nt lds
  buffer_load_dwordx4 v79, s[24:27], s62 offen offset:3072 nt lds
  s_setpc_b64 s[60:61]
L_issV:
  s_waitcnt vmcnt(17)
  buffer_load_dwordx4 v80, s[28:31], s62 offen offset:0 nt lds
  buffer_load_dwordx4 v81, s[28:31], s62 offen offset:1024 nt lds
  s_waitcnt vmcnt(17)
  buffer_load_dwordx4 v82, s[28:31], s62 offen offset:2048 nt lds
  buffer_load_dwordx4 v83, s[28:31], s62 offen offset:3072 nt lds
  s_add_u32 s62, s62, 8192
  s_add_u32 m0, m0, 4096
  s_waitcnt vmcnt(17)
  buffer_load_dwordx4 v80, s[28:31], s62 offen offset:0 nt lds
  buffer_load_dwordx4 v81, s[28:31], s62 offen offset:1024 nt lds
  s_waitcnt vmcnt(17)
  buffer_load_dwordx4 v82, s[28:31], s62 offen offset:2048 nt lds
  buffer_load_dwordx4 v83, s[28:31], s62 offen offset:3072 nt lds
  s_setpc_b64 s[60:61]
L_issK0d:
  buffer_load_dwordx4 v72, s[24:27], s62 offen offset:0 nt lds
  buffer_load_dwordx4 v73, s[24:27], s62 offen offset:1024 nt lds
  buffer_load_dwordx4 v72, s[24:27], s62 offen offset:2048 nt lds
  buffer_load_dwordx4 v73, s[24:27], s62 offen offset:3072 nt lds
  s_add_u32 s62, s62, 4096
  s_add_u32 m0, m0, 4096
  s_nop 0
  buffer_load_dwordx4 v74, s[24:27], s62 offen offset:0 nt lds
  buffer_load_dwordx4 v75, s[24:27], s62 offen offset:1024 nt lds
  buffer_load_dwordx4 v74, s[24:27], s62 offen offset:2048 nt lds
  buffer_load_dwordx4 v75, s[24:27], s62 offen offset:3072 nt lds
  s_setpc_b64 s[60:61]
L_issVd:
  buffer_load_dwordx4 v80, s[28:31], s62 offen offset:0 nt lds
  buffer_load_dwordx4 v81, s[28:31], s62 offen offset:1024 nt lds
  buffer_load_dwordx4 v82, s[28:31], s62 offen offset:2048 nt lds
  buffer_load_dwordx4 v83, s[28:31], s62 offen offset:3072 nt lds
  s_add_u32 s62, s62, 8192
  s_add_u32 m0, m0, 4096
  s_nop 0
  buffer_load_dwordx4 v80, s[28:31], s62 offen offset:0 nt lds
  buffer_load_dwordx4 v81, s[28:31], s62 offen offset:1024 nt lds
  buffer_load_dwordx4 v82, s[28:31], s62 offen offset:2048 nt lds
  buffer_load_dwordx4 v83, s[28:31], s62 offen offset:3072 nt lds
  s_setpc_b64 s[60:61]
L_issO0:
  buffer_load_dwordx4 v40, s[36:39], s62 offen offset:0 lds
  buffer_load_dwordx4 v41, s[36:39], s62 offen offset:1024 lds
  buffer_load_dwordx4 v42, s[36:39], s62 offen offset:2048 lds
  buffer_load_dwordx4 v43, s[36:39], s62 offen offset:3072 lds
  s_add_u32 s62, s62, 7168
  s_add_u32 m0, m0, 4096
  s_nop 0
  buffer_load_dwordx4 v40, s[36:39], s62 offen offset:0 lds
  buffer_load_dwordx4 v41, s[36:39], s62 offen offset:1024 lds
  buffer_load_dwordx4 v42, s[36:39], s62 offen offset:2048 lds
  buffer_load_dwordx4 v43, s[36:39], s62 offen offset:3072 lds
  s_setpc_b64 s[60:61]
L_issO1:
  buffer_load_dwordx4 v44, s[36:39], s62 offen offset:0 lds
  buffer_load_dwordx4 v45, s[36:39], s62 offen offset:1024 lds
  buffer_load_dwordx4 v46, s[36:39], s62 offen offset:2048 lds
  s_add_u32 s62, s62, 7168
  s_add_u32 m0, m0, 3072
  s_nop 0
  buffer_load_dwordx4 v44, s[36:39], s62 offen offset:0 lds
  buffer_load_dwordx4 v45, s[36:39], s62 offen offset:1024 lds
  buffer_load_dwordx4 v46, s[36:39], s62 offen offset:2048 lds
  s_setpc_b64 s[60:61]
L_compute:
  s_mov_b32 s56, s50
  s_lshr_b32 s65, s44, 2
  v_lshrrev_b32 v16, 2, v4
  v_lshlrev_b32 v17, 3, v3
  v_add_u32 v17, v17, v16
  v_lshlrev_b32 v5, 8, v17
  v_and_b32 v17, 1, v3
  v_lshlrev_b32 v17, 2, v17
  v_add_u32 v17, v17, v16
  v_lshlrev_b32 v17, 5, v17
  v_add_u32 v5, v5, v17
  v_and_b32 v17, 3, v0
  v_lshlrev_b32 v18, 3, v17
  v_add_u32 v5, v5, v18
  v_lshlrev_b32 v18, 3, v16
  v_add_u32 v18, v18, v17
  v_lshlrev_b32 v6, 9, v18
  v_and_b32 v17, 1, v3
  v_lshlrev_b32 v17, 1, v17
  v_lshrrev_b32 v18, 1, v3
  v_or_b32 v17, v17, v18
  v_xor_b32 v17, v17, v4
  v_lshlrev_b32 v17, 4, v17
  v_add_u32 v6, v6, v17
  v_lshrrev_b32 v17, 1, v4
  v_xor_b32 v17, v17, v3
  v_lshlrev_b32 v17, 4, v17
  v_lshlrev_b32 v18, 7, v4
  v_add_u32 v17, v17, v18
  s_lshl_b32 s50, s56, 12
  s_add_u32 s50, s50, 114688
  v_add_u32 v128, s50, v17
  v_xor_b32 v129, 64, v128
  v_lshlrev_b32 v15, 4, v0
  s_lshl_b32 s50, s56, 11
  s_add_u32 s50, s50, 114688
  v_add_u32 v15, s50, v15
  v_and_b32 v17, 3, v0
  v_cmp_eq_u32 vcc, 0, v17
  v_mov_b32 v17, 0x3f803f80
  s_nop 0
  v_cndmask_b32 v14, 0, v17, vcc
  s_mov_b32 s72, 0x3db8aa3b
  s_mov_b32 s83, 0xffff0000
  s_mov_b32 s82, 0
  s_mul_i32 s50, s65, 3
  s_add_u32 s50, s50, s56
  s_cmp_eq_u32 s50, 0
  s_cbranch_scc0 L_pc0
  s_call_b64 s[60:61], L_pad1
  s_call_b64 s[60:61], L_pad7
  s_call_b64 s[60:61], L_pad13
L_pc0:
  s_cmp_eq_u32 s50, 1
  s_cbranch_scc0 L_pc1
  s_call_b64 s[60:61], L_pad2
  s_call_b64 s[60:61], L_pad8
  s_call_b64 s[60:61], L_pad14
L_pc1:
  s_cmp_eq_u32 s50, 2
  s_cbranch_scc0 L_pc2
  s_call_b64 s[60:61], L_pad3
  s_call_b64 s[60:61], L_pad9
  s_call_b64 s[60:61], L_pad15
L_pc2:
  s_cmp_eq_u32 s50, 3
  s_cbranch_scc0 L_pc3
  s_call_b64 s[60:61], L_pad4
  s_call_b64 s[60:61], L_pad10
  s_call_b64 s[60:61], L_pad16
L_pc3:
  s_cmp_eq_u32 s50, 4
  s_cbranch_scc0 L_pc4
  s_call_b64 s[60:61], L_pad5
  s_call_b64 s[60:61], L_pad11
L_pc4:
  s_cmp_eq_u32 s50, 5
  s_cbranch_scc0 L_pc5
  s_call_b64 s[60:61], L_pad6
  s_call_b64 s[60:61], L_pad12
L_pc5:
  s_waitcnt lgkmcnt(0)
  s_mov_b32 s40, s18
  s_mov_b32 s41, s19
  s_mov_b32 s42, 23134208
  s_mov_b32 s43, 0x20000
  s_mov_b32 s28, s16
  s_mov_b32 s29, s17
  s_mov_b32 s30, 256
  s_mov_b32 s31, 0x20000
  s_mul_i32 s50, s49, 114688
  s_lshl_b32 s51, s46, 10
  s_add_u32 s50, s50, s51
  s_add_u32 s32, s10, s50
  s_addc_u32 s33, s11, 0
  s_mul_i32 s50, s65, 3
  s_add_u32 s50, s50, s56
  s_mul_i32 s50, s50, 5
  s_min_u32 s50, s50, 23
  s_lshl_b32 s50, s50, 13
  s_add_u32 s36, s32, s50
  s_addc_u32 s37, s33, 0
  s_cmp_eq_u32 s65, 0
  s_cbranch_scc1 L_roleA
  s_mul_i32 s50, s56, 5
  s_min_u32 s50, s50, 9
  s_lshl_b32 s50, s50, 13
  s_add_u32 s36, s32, s50
  s_addc_u32 s37, s33, 0
  s_lshl_b32 s84, s46, 3
  s_add_u32 s84, s84, s44
  s_cmp_eq_u32 s84, 5
  s_cbranch_scc0 L_norst
  v_lshlrev_b32 v16, 3, v0
  s_lshl_b32 s50, s45, 9
  s_add_u32 s50, s50, 23068672
  v_mov_b32 v18, 0
  v_mov_b32 v19, 0
  buffer_store_dwordx2 v[18:19], v16, s[40:43], s50 offen sc1
L_norst:
  s_barrier
  ds_read_b128 v[144:147], v128 offset:0
  ds_read_b128 v[148:151], v128 offset:2048
  ds_read_b128 v[152:155], v129 offset:0
  ds_read_b128 v[156:159], v129 offset:2048
  s_waitcnt lgkmcnt(0)
  s_barrier
  ds_read_b128 v[160:163], v128 offset:12288
  ds_read_b128 v[164:167], v128 offset:14336
  ds_read_b128 v[168:171], v129 offset:12288
  ds_read_b128 v[172:175], v129 offset:14336
  s_waitcnt lgkmcnt(0)
  s_barrier
  ds_read_b128 v[176:179], v128 offset:24576
  ds_read_b128 v[180:183], v128 offset:26624
  ds_read_b128 v[184:187], v129 offset:24576
  ds_read_b128 v[188:191], v129 offset:26624
  s_waitcnt lgkmcnt(0)
  s_barrier
  ds_read_b128 v[192:195], v128 offset:36864
  ds_read_b128 v[196:199], v128 offset:38912
  ds_read_b128 v[200:203], v129 offset:36864
  ds_read_b128 v[204:207], v129 offset:38912
  s_waitcnt lgkmcnt(0)
  s_barrier
  ds_read_b128 v[208:211], v128 offset:0
  ds_read_b128 v[212:215], v128 offset:2048
  ds_read_b128 v[216:219], v129 offset:0
  ds_read_b128 v[220:223], v129 offset:2048
  s_waitcnt lgkmcnt(0)
  s_barrier
  ds_read_b128 v[224:227], v128 offset:12288
  ds_read_b128 v[228:231], v128 offset:14336
  ds_read_b128 v[232:235], v129 offset:12288
  ds_read_b128 v[236:239], v129 offset:14336
  s_waitcnt lgkmcnt(0)
  s_barrier
  ds_read_b128 v[240:243], v128 offset:24576
  ds_read_b128 v[244:247], v128 offset:26624
  ds_read_b128 v[248:251], v129 offset:24576
  ds_read_b128 v[252:255], v129 offset:26624
  s_waitcnt lgkmcnt(0)
  s_barrier
  s_barrier
  s_cmp_eq_u32 s84, 5
  s_cbranch_scc0 L_noann
  s_lshl_b32 s51, s45, 3
  v_mov_b32 v130, s51
  v_mov_b32 v131, 1
  s_waitcnt vmcnt(0)
  s_mov_b64 exec, 1
  buffer_store_dword v131, v130, s[28:31], 0 offen sc1
  s_mov_b64 exec, -1
L_noann:
  s_barrier
  s_barrier
  s_barrier
  s_barrier
  s_barrier
  s_barrier
  s_barrier
  s_barrier
  s_waitcnt lgkmcnt(0)
  s_mov_b32 s73, 16383
  s_mov_b32 s66, 0x10210530
  s_mov_b32 s67, 0x102102
  s_mov_b32 s68, 0x65342653
  s_mov_b32 s69, 0x34265342
  s_mov_b32 s70, 0x34653465
  s_mov_b32 s71, 0x34653465
  s_branch L_qpB
L_roleA:
  s_mov_b32 s84, 0
  s_mov_b32 s73, 0
  s_waitcnt lgkmcnt(0)
  s_mov_b32 s66, 0x21403210
  s_mov_b32 s67, 0x321403
  s_mov_b32 s68, 0x21478956
  s_mov_b32 s69, 0x96347896
  s_mov_b32 s70, 0x57896578
  s_mov_b32 s71, 0x49653496
L_qp:
  s_and_b32 s50, s66, 15
  s_lshr_b64 s[66:67], s[66:67], 4
  s_lshl_b32 s50, s50, 14
  v_add_u32 v8, s50, v5
  s_barrier
  ds_read_b128 v[144:147], v128 offset:0
  ds_read_b128 v[148:151], v128 offset:2048
  ds_read_b128 v[152:155], v129 offset:0
  ds_read_b128 v[156:159], v129 offset:2048
  ds_read_b64_tr_b16 v[16:17], v8 offset:0
  ds_read_b64_tr_b16 v[18:19], v8 offset:1024
  v_xor_b32 v9, 32, v8
  ds_read_b64_tr_b16 v[20:21], v9 offset:0
  ds_read_b64_tr_b16 v[22:23], v9 offset:1024
  v_xor_b32 v10, 64, v8
  ds_read_b64_tr_b16 v[24:25], v10 offset:0
  ds_read_b64_tr_b16 v[26:27], v10 offset:1024
  s_waitcnt lgkmcnt(4)
  v_mfma_f32_16x16x32_bf16 v[64:67], v[16:19], v[144:147], 0
  v_xor_b32 v11, 96, v8
  ds_read_b64_tr_b16 v[28:29], v11 offset:0
  v_mfma_f32_16x16x32_bf16 v[68:71], v[16:19], v[148:151], 0
  ds_read_b64_tr_b16 v[30:31], v11 offset:1024
  s_waitcnt lgkmcnt(4)
  v_mfma_f32_16x16x32_bf16 v[72:75], v[20:23], v[144:147], 0
  v_xor_b32 v136, 128, v8
  ds_read_b64_tr_b16 v[16:17], v136 offset:0
  v_mfma_f32_16x16x32_bf16 v[76:79], v[20:23], v[148:151], 0
  ds_read_b64_tr_b16 v[18:19], v136 offset:1024
  s_waitcnt lgkmcnt(4)
  v_mfma_f32_16x16x32_bf16 v[80:83], v[24:27], v[144:147], 0
  v_xor_b32 v137, 160, v8
  ds_read_b64_tr_b16 v[20:21], v137 offset:0
  v_mfma_f32_16x16x32_bf16 v[84:87], v[24:27], v[148:151], 0
  ds_read_b64_tr_b16 v[22:23], v137 offset:1024
  s_waitcnt lgkmcnt(4)
  v_mfma_f32_16x16x32_bf16 v[88:91], v[28:31], v[144:147], 0
  v_xor_b32 v138, 192, v8
  ds_read_b64_tr_b16 v[24:25], v138 offset:0
  v_mfma_f32_16x16x32_bf16 v[92:95], v[28:31], v[148:151], 0
  ds_read_b64_tr_b16 v[26:27], v138 offset:1024
  s_waitcnt lgkmcnt(4)
  v_mfma_f32_16x16x32_bf16 v[96:99], v[16:19], v[144:147], 0
  v_xor_b32 v139, 224, v8
  ds_read_b64_tr_b16 v[28:29], v139 offset:0
  v_mfma_f32_16x16x32_bf16 v[100:103], v[16:19], v[148:151], 0
  ds_read_b64_tr_b16 v[30:31], v139 offset:1024
  s_waitcnt lgkmcnt(4)
  v_mfma_f32_16x16x32_bf16 v[104:107], v[20:23], v[144:147], 0
  ds_read_b64_tr_b16 v[16:17], v8 offset:8192
  v_mfma_f32_16x16x32_bf16 v[108:111], v[20:23], v[148:151], 0
  ds_read_b64_tr_b16 v[18:19], v8 offset:9216
  s_waitcnt lgkmcnt(4)
  v_mfma_f32_16x16x32_bf16 v[112:115], v[24:27], v[144:147], 0
  ds_read_b64_tr_b16 v[20:21], v9 offset:8192
  v_mfma_f32_16x16x32_bf16 v[116:119], v[24:27], v[148:151], 0
  ds_read_b64_tr_b16 v[22:23], v9 offset:9216
  s_waitcnt lgkmcnt(4)
  v_mfma_f32_16x16x32_bf16 v[120:123], v[28:31], v[144:147], 0
  ds_read_b64_tr_b16 v[24:25], v10 offset:8192
  v_mfma_f32_16x16x32_bf16 v[124:127], v[28:31], v[148:151], 0
  ds_read_b64_tr_b16 v[26:27], v10 offset:9216
  s_waitcnt lgkmcnt(4)
  v_mfma_f32_16x16x32_bf16 v[64:67], v[16:19], v[152:155], v[64:67]
  ds_read_b64_tr_b16 v[28:29], v11 offset:8192
  v_mfma_f32_16x16x32_bf16 v[68:71], v[16:19], v[156:159], v[68:71]
  ds_read_b64_tr_b16 v[30:31], v11 offset:9216
  s_waitcnt lgkmcnt(4)
  v_mfma_f32_16x16x32_bf16 v[72:75], v[20:23], v[152:155], v[72:75]
  ds_read_b64_tr_b16 v[16:17], v136 offset:8192
  v_mfma_f32_16x16x32_bf16 v[76:79], v[20:23], v[156:159], v[76:79]
  ds_read_b64_tr_b16 v[18:19], v136 offset:9216
  s_waitcnt lgkmcnt(4)
  v_mfma_f32_16x16x32_bf16 v[80:83], v[24:27], v[152:155], v[80:83]
  ds_read_b64_tr_b16 v[20:21], v137 offset:8192
  v_mfma_f32_16x16x32_bf16 v[84:87], v[24:27], v[156:159], v[84:87]
  ds_read_b64_tr_b16 v[22:23], v137 offset:9216
  s_waitcnt lgkmcnt(4)
  v_mfma_f32_16x16x32_bf16 v[88:91], v[28:31], v[152:155], v[88:91]
  ds_read_b64_tr_b16 v[24:25], v138 offset:8192
  v_mfma_f32_16x16x32_bf16 v[92:95], v[28:31], v[156:159], v[92:95]
  ds_read_b64_tr_b16 v[26:27], v138 offset:9216
  s_waitcnt lgkmcnt(4)
  v_mfma_f32_16x16x32_bf16 v[96:99], v[16:19], v[152:155], v[96:99]
  ds_read_b64_tr_b16 v[28:29], v139 offset:8192
  v_mfma_f32_16x16x32_bf16 v[100:103], v[16:19], v[156:159], v[100:103]
  ds_read_b64_tr_b16 v[30:31], v139 offset:9216
  s_and_b32 s50, s66, 15
  s_lshr_b64 s[66:67], s[66:67], 4
  s_lshl_b32 s50, s50, 14
  v_add_u32 v8, s50, v5
  s_waitcnt lgkmcnt(4)
  v_mfma_f32_16x16x32_bf16 v[104:107], v[20:23], v[152:155], v[104:107]
  v_mfma_f32_16x16x32_bf16 v[108:111], v[20:23], v[156:159], v[108:111]
  s_waitcnt lgkmcnt(0)
  s_barrier
  ds_read_b128 v[160:163], v128 offset:12288
  ds_read_b128 v[164:167], v128 offset:14336
  ds_read_b128 v[168:171], v129 offset:12288
  ds_read_b128 v[172:175], v129 offset:14336
  ds_read_b64_tr_b16 v[16:17], v8 offset:0
  ds_read_b64_tr_b16 v[18:19], v8 offset:1024
  v_mfma_f32_16x16x32_bf16 v[112:115], v[24:27], v[152:155], v[112:115]
  v_xor_b32 v9, 32, v8
  ds_read_b64_tr_b16 v[20:21], v9 offset:0
  v_mfma_f32_16x16x32_bf16 v[116:119], v[24:27], v[156:159], v[116:119]
  ds_read_b64_tr_b16 v[22:23], v9 offset:1024
  v_mfma_f32_16x16x32_bf16 v[120:123], v[28:31], v[152:155], v[120:123]
  v_xor_b32 v10, 64, v8
  ds_read_b64_tr_b16 v[24:25], v10 offset:0
  v_mfma_f32_16x16x32_bf16 v[124:127], v[28:31], v[156:159], v[124:127]
  ds_read_b64_tr_b16 v[26:27], v10 offset:1024
  s_waitcnt lgkmcnt(4)
  v_mfma_f32_16x16x32_bf16 v[64:67], v[16:19], v[160:163], v[64:67]
  v_xor_b32 v11, 96, v8
  ds_read_b64_tr_b16 v[28:29], v11 offset:0
  v_mfma_f32_16x16x32_bf16 v[68:71], v[16:19], v[164:167], v[68:71]
  ds_read_b64_tr_b16 v[30:31], v11 offset:1024
  s_waitcnt lgkmcnt(4)
  v_mfma_f32_16x16x32_bf16 v[72:75], v[20:23], v[160:163], v[72:75]
  v_xor_b32 v136, 128, v8
  ds_read_b64_tr_b16 v[16:17], v136 offset:0
  v_mfma_f32_16x16x32_bf16 v[76:79], v[20:23], v[164:167], v[76:79]
  ds_read_b64_tr_b16 v[18:19], v136 offset:1024
  s_waitcnt lgkmcnt(4)
  v_mfma_f32_16x16x32_bf16 v[80:83], v[24:27], v[160:163], v[80:83]
  v_xor_b32 v137, 160, v8
  ds_read_b64_tr_b16 v[20:21], v137 offset:0
  v_mfma_f32_16x16x32_bf16 v[84:87], v[24:27], v[164:167], v[84:87]
  ds_read_b64_tr_b16 v[22:23], v137 offset:1024
  s_waitcnt lgkmcnt(4)
  v_mfma_f32_16x16x32_bf16 v[88:91], v[28:31], v[160:163], v[88:91]
  v_xor_b32 v138, 192, v8
  ds_read_b64_tr_b16 v[24:25], v138 offset:0
  v_mfma_f32_16x16x32_bf16 v[92:95], v[28:31], v[164:167], v[92:95]
  ds_read_b64_tr_b16 v[26:27], v138 offset:1024
  s_waitcnt lgkmcnt(4)
  v_mfma_f32_16x16x32_bf16 v[96:99], v[16:19], v[160:163], v[96:99]
  v_xor_b32 v139, 224, v8
  ds_read_b64_tr_b16 v[28:29], v139 offset:0
  v_mfma_f32_16x16x32_bf16 v[100:103], v[16:19], v[164:167], v[100:103]
  ds_read_b64_tr_b16 v[30:31], v139 offset:1024
  s_waitcnt lgkmcnt(4)
  v_mfma_f32_16x16x32_bf16 v[104:107], v[20:23], v[160:163], v[104:107]
  ds_read_b64_tr_b16 v[16:17], v8 offset:8192
  v_mfma_f32_16x16x32_bf16 v[108:111], v[20:23], v[164:167], v[108:111]
  ds_read_b64_tr_b16 v[18:19], v8 offset:9216
  s_waitcnt lgkmcnt(4)
  v_mfma_f32_16x16x32_bf16 v[112:115], v[24:27], v[160:163], v[112:115]
  ds_read_b64_tr_b16 v[20:21], v9 offset:8192
  v_mfma_f32_16x16x32_bf16 v[116:119], v[24:27], v[164:167], v[116:119]
  ds_read_b64_tr_b16 v[22:23], v9 offset:9216
  s_waitcnt lgkmcnt(4)
  v_mfma_f32_16x16x32_bf16 v[120:123], v[28:31], v[160:163], v[120:123]
  ds_read_b64_tr_b16 v[24:25], v10 offset:8192
  v_mfma_f32_16x16x32_bf16 v[124:127], v[28:31], v[164:167], v[124:127]
  ds_read_b64_tr_b16 v[26:27], v10 offset:9216
  s_waitcnt lgkmcnt(4)
  v_mfma_f32_16x16x32_bf16 v[64:67], v[16:19], v[168:171], v[64:67]
  ds_read_b64_tr_b16 v[28:29], v11 offset:8192
  v_mfma_f32_16x16x32_bf16 v[68:71], v[16:19], v[172:175], v[68:71]
  s_branch L_pads3
L_pad3:
  s_setpc_b64 s[60:61]
L_pads3:
  ds_read_b64_tr_b16 v[30:31], v11 offset:9216
  s_waitcnt lgkmcnt(4)
  v_mfma_f32_16x16x32_bf16 v[72:75], v[20:23], v[168:171], v[72:75]
  ds_read_b64_tr_b16 v[16:17], v136 offset:8192
  v_mfma_f32_16x16x32_bf16 v[76:79], v[20:23], v[172:175], v[76:79]
  ds_read_b64_tr_b16 v[18:19], v136 offset:9216
  s_waitcnt lgkmcnt(4)
  v_mfma_f32_16x16x32_bf16 v[80:83], v[24:27], v[168:171], v[80:83]
  ds_read_b64_tr_b16 v[20:21], v137 offset:8192
  v_mfma_f32_16x16x32_bf16 v[84:87], v[24:27], v[172:175], v[84:87]
  ds_read_b64_tr_b16 v[22:23], v137 offset:9216
  s_waitcnt lgkmcnt(4)
  v_mfma_f32_16x16x32_bf16 v[88:91], v[28:31], v[168:171], v[88:91]
  ds_read_b64_tr_b16 v[24:25], v138 offset:8192
  v_mfma_f32_16x16x32_bf16 v[92:95], v[28:31], v[172:175], v[92:95]
  ds_read_b64_tr_b16 v[26:27], v138 offset:9216
  s_waitcnt lgkmcnt(4)
  v_mfma_f32_16x16x32_bf16 v[96:99], v[16:19], v[168:171], v[96:99]
  ds_read_b64_tr_b16 v[28:29], v139 offset:8192
  v_mfma_f32_16x16x32_bf16 v[100:103], v[16:19], v[172:175], v[100:103]
  ds_read_b64_tr_b16 v[30:31], v139 offset:9216
  s_and_b32 s50, s66, 15
  s_lshr_b64 s[66:67], s[66:67], 4
  s_lshl_b32 s50, s50, 14
  v_add_u32 v8, s50, v5
  s_waitcnt lgkmcnt(4)
  v_mfma_f32_16x16x32_bf16 v[104:107], v[20:23], v[168:171], v[104:107]
  v_mfma_f32_16x16x32_bf16 v[108:111], v[20:23], v[172:175], v[108:111]
  s_waitcnt lgkmcnt(0)
  s_barrier
  ds_read_b128 v[176:179], v128 offset:24576
  ds_read_b128 v[180:183], v128 offset:26624
  ds_read_b128 v[184:187], v129 offset:24576
  ds_read_b128 v[188:191], v129 offset:26624
  ds_read_b64_tr_b16 v[16:17], v8 offset:0
  ds_read_b64_tr_b16 v[18:19], v8 offset:1024
  v_mfma_f32_16x16x32_bf16 v[112:115], v[24:27], v[168:171], v[112:115]
  v_xor_b32 v9, 32, v8
  ds_read_b64_tr_b16 v[20:21], v9 offset:0
  v_mfma_f32_16x16x32_bf16 v[116:119], v[24:27], v[172:175], v[116:119]
  ds_read_b64_tr_b16 v[22:23], v9 offset:1024
  v_mfma_f32_16x16x32_bf16 v[120:123], v[28:31], v[168:171], v[120:123]
  v_xor_b32 v10, 64, v8
  ds_read_b64_tr_b16 v[24:25], v10 offset:0
  v_mfma_f32_16x16x32_bf16 v[124:127], v[28:31], v[172:175], v[124:127]
  ds_read_b64_tr_b16 v[26:27], v10 offset:1024
  s_waitcnt lgkmcnt(4)
  v_mfma_f32_16x16x32_bf16 v[64:67], v[16:19], v[176:179], v[64:67]
  v_xor_b32 v11, 96, v8
  ds_read_b64_tr_b16 v[28:29], v11 offset:0
  v_mfma_f32_16x16x32_bf16 v[68:71], v[16:19], v[180:183], v[68:71]
  ds_read_b64_tr_b16 v[30:31], v11 offset:1024
  s_waitcnt lgkmcnt(4)
  v_mfma_f32_16x16x32_bf16 v[72:75], v[20:23], v[176:179], v[72:75]
  v_xor_b32 v136, 128, v8
  ds_read_b64_tr_b16 v[16:17], v136 offset:0
  v_mfma_f32_16x16x32_bf16 v[76:79], v[20:23], v[180:183], v[76:79]
  ds_read_b64_tr_b16 v[18:19], v136 offset:1024
  s_waitcnt lgkmcnt(4)
  v_mfma_f32_16x16x32_bf16 v[80:83], v[24:27], v[176:179], v[80:83]
  v_xor_b32 v137, 160, v8
  ds_read_b64_tr_b16 v[20:21], v137 offset:0
  v_mfma_f32_16x16x32_bf16 v[84:87], v[24:27], v[180:183], v[84:87]
  ds_read_b64_tr_b16 v[22:23], v137 offset:1024
  s_waitcnt lgkmcnt(4)
  v_mfma_f32_16x16x32_bf16 v[88:91], v[28:31], v[176:179], v[88:91]
  v_xor_b32 v138, 192, v8
  ds_read_b64_tr_b16 v[24:25], v138 offset:0
  v_mfma_f32_16x16x32_bf16 v[92:95], v[28:31], v[180:183], v[92:95]
  ds_read_b64_tr_b16 v[26:27], v138 offset:1024
  s_waitcnt lgkmcnt(4)
  v_mfma_f32_16x16x32_bf16 v[96:99], v[16:19], v[176:179], v[96:99]
  v_xor_b32 v139, 224, v8
  ds_read_b64_tr_b16 v[28:29], v139 offset:0
  v_mfma_f32_16x16x32_bf16 v[100:103], v[16:19], v[180:183], v[100:103]
  ds_read_b64_tr_b16 v[30:31], v139 offset:1024
  s_waitcnt lgkmcnt(4)
  v_mfma_f32_16x16x32_bf16 v[104:107], v[20:23], v[176:179], v[104:107]
  ds_read_b64_tr_b16 v[16:17], v8 offset:8192
  v_mfma_f32_16x16x32_bf16 v[108:111], v[20:23], v[180:183], v[108:111]
  ds_read_b64_tr_b16 v[18:19], v8 offset:9216
  s_waitcnt lgkmcnt(4)
  v_mfma_f32_16x16x32_bf16 v[112:115], v[24:27], v[176:179], v[112:115]
  ds_read_b64_tr_b16 v[20:21], v9 offset:8192
  v_mfma_f32_16x16x32_bf16 v[116:119], v[24:27], v[180:183], v[116:119]
  ds_read_b64_tr_b16 v[22:23], v9 offset:9216
  s_waitcnt lgkmcnt(4)
  v_mfma_f32_16x16x32_bf16 v[120:123], v[28:31], v[176:179], v[120:123]
  ds_read_b64_tr_b16 v[24:25], v10 offset:8192
  v_mfma_f32_16x16x32_bf16 v[124:127], v[28:31], v[180:183], v[124:127]
  ds_read_b64_tr_b16 v[26:27], v10 offset:9216
  s_waitcnt lgkmcnt(4)
  v_mfma_f32_16x16x32_bf16 v[64:67], v[16:19], v[184:187], v[64:67]
  ds_read_b64_tr_b16 v[28:29], v11 offset:8192
  v_mfma_f32_16x16x32_bf16 v[68:71], v[16:19], v[188:191], v[68:71]
  ds_read_b64_tr_b16 v[30:31], v11 offset:9216
  s_waitcnt lgkmcnt(4)
  v_mfma_f32_16x16x32_bf16 v[72:75], v[20:23], v[184:187], v[72:75]
  ds_read_b64_tr_b16 v[16:17], v136 offset:8192
  v_mfma_f32_16x16x32_bf16 v[76:79], v[20:23], v[188:191], v[76:79]
  ds_read_b64_tr_b16 v[18:19], v136 offset:9216
  s_waitcnt lgkmcnt(4)
  v_mfma_f32_16x16x32_bf16 v[80:83], v[24:27], v[184:187], v[80:83]
  ds_read_b64_tr_b16 v[20:21], v137 offset:8192
  v_mfma_f32_16x16x32_bf16 v[84:87], v[24:27], v[188:191], v[84:87]
  ds_read_b64_tr_b16 v[22:23], v137 offset:9216
  s_waitcnt lgkmcnt(4)
  v_mfma_f32_16x16x32_bf16 v[88:91], v[28:31], v[184:187], v[88:91]
  ds_read_b64_tr_b16 v[24:25], v138 offset:8192
  v_mfma_f32_16x16x32_bf16 v[92:95], v[28:31], v[188:191], v[92:95]
  ds_read_b64_tr_b16 v[26:27], v138 offset:9216
  s_waitcnt lgkmcnt(4)
  v_mfma_f32_16x16x32_bf16 v[96:99], v[16:19], v[184:187], v[96:99]
  ds_read_b64_tr_b16 v[28:29], v139 offset:8192
  v_mfma_f32_16x16x32_bf16 v[100:103], v[16:19], v[188:191], v[100:103]
  ds_read_b64_tr_b16 v[30:31], v139 offset:9216
  s_and_b32 s50, s66, 15
  s_lshr_b64 s[66:67], s[66:67], 4
  s_lshl_b32 s50, s50, 14
  v_add_u32 v8, s50, v5
  s_waitcnt lgkmcnt(4)
  v_mfma_f32_16x16x32_bf16 v[104:107], v[20:23], v[184:187], v[104:107]
  v_mfma_f32_16x16x32_bf16 v[108:111], v[20:23], v[188:191], v[108:111]
  s_waitcnt lgkmcnt(0)
  s_barrier
  ds_read_b128 v[192:195], v128 offset:36864
  ds_read_b128 v[196:199], v128 offset:38912
  ds_read_b128 v[200:203], v129 offset:36864
  ds_read_b128 v[204:207], v129 offset:38912
  ds_read_b64_tr_b16 v[16:17], v8 offset:0
  ds_read_b64_tr_b16 v[18:19], v8 offset:1024
  v_mfma_f32_16x16x32_bf16 v[112:115], v[24:27], v[184:187], v[112:115]
  v_xor_b32 v9, 32, v8
  ds_read_b64_tr_b16 v[20:21], v9 offset:0
  v_mfma_f32_16x16x32_bf16 v[116:119], v[24:27], v[188:191], v[116:119]
  ds_read_b64_tr_b16 v[22:23], v9 offset:1024
  v_mfma_f32_16x16x32_bf16 v[120:123], v[28:31], v[184:187], v[120:123]
  v_xor_b32 v10, 64, v8
  ds_read_b64_tr_b16 v[24:25], v10 offset:0
  v_mfma_f32_16x16x32_bf16 v[124:127], v[28:31], v[188:191], v[124:127]
  ds_read_b64_tr_b16 v[26:27], v10 offset:1024
  s_waitcnt lgkmcnt(4)
  v_mfma_f32_16x16x32_bf16 v[64:67], v[16:19], v[192:195], v[64:67]
  v_xor_b32 v11, 96, v8
  ds_read_b64_tr_b16 v[28:29], v11 offset:0
  v_mfma_f32_16x16x32_bf16 v[68:71], v[16:19], v[196:199], v[68:71]
  ds_read_b64_tr_b16 v[30:31], v11 offset:1024
  s_waitcnt lgkmcnt(4)
  v_mfma_f32_16x16x32_bf16 v[72:75], v[20:23], v[192:195], v[72:75]
  v_xor_b32 v136, 128, v8
  ds_read_b64_tr_b16 v[16:17], v136 offset:0
  v_mfma_f32_16x16x32_bf16 v[76:79], v[20:23], v[196:199], v[76:79]
  ds_read_b64_tr_b16 v[18:19], v136 offset:1024
  s_waitcnt lgkmcnt(4)
  v_mfma_f32_16x16x32_bf16 v[80:83], v[24:27], v[192:195], v[80:83]
  v_xor_b32 v137, 160, v8
  ds_read_b64_tr_b16 v[20:21], v137 offset:0
  v_mfma_f32_16x16x32_bf16 v[84:87], v[24:27], v[196:199], v[84:87]
  ds_read_b64_tr_b16 v[22:23], v137 offset:1024
  s_waitcnt lgkmcnt(4)
  v_mfma_f32_16x16x32_bf16 v[88:91], v[28:31], v[192:195], v[88:91]
  v_xor_b32 v138, 192, v8
  ds_read_b64_tr_b16 v[24:25], v138 offset:0
  v_mfma_f32_16x16x32_bf16 v[92:95], v[28:31], v[196:199], v[92:95]
  ds_read_b64_tr_b16 v[26:27], v138 offset:1024
  s_waitcnt lgkmcnt(4)
  v_mfma_f32_16x16x32_bf16 v[96:99], v[16:19], v[192:195], v[96:99]
  v_xor_b32 v139, 224, v8
  ds_read_b64_tr_b16 v[28:29], v139 offset:0
  v_mfma_f32_16x16x32_bf16 v[100:103], v[16:19], v[196:199], v[100:103]
  ds_read_b64_tr_b16 v[30:31], v139 offset:1024
  s_waitcnt lgkmcnt(4)
  v_mfma_f32_16x16x32_bf16 v[104:107], v[20:23], v[192:195], v[104:107]
  ds_read_b64_tr_b16 v[16:17], v8 offset:8192
  v_mfma_f32_16x16x32_bf16 v[108:111], v[20:23], v[196:199], v[108:111]
  ds_read_b64_tr_b16 v[18:19], v8 offset:9216
  s_waitcnt lgkmcnt(4)
  v_mfma_f32_16x16x32_bf16 v[112:115], v[24:27], v[192:195], v[112:115]
  ds_read_b64_tr_b16 v[20:21], v9 offset:8192
  v_mfma_f32_16x16x32_bf16 v[116:119], v[24:27], v[196:199], v[116:119]
  ds_read_b64_tr_b16 v[22:23], v9 offset:9216
  s_waitcnt lgkmcnt(4)
  v_mfma_f32_16x16x32_bf16 v[120:123], v[28:31], v[192:195], v[120:123]
  ds_read_b64_tr_b16 v[24:25], v10 offset:8192
  v_mfma_f32_16x16x32_bf16 v[124:127], v[28:31], v[196:199], v[124:127]
  ds_read_b64_tr_b16 v[26:27], v10 offset:9216
  s_waitcnt lgkmcnt(4)
  v_mfma_f32_16x16x32_bf16 v[64:67], v[16:19], v[200:203], v[64:67]
  ds_read_b64_tr_b16 v[28:29], v11 offset:8192
  v_mfma_f32_16x16x32_bf16 v[68:71], v[16:19], v[204:207], v[68:71]
  ds_read_b64_tr_b16 v[30:31], v11 offset:9216
  s_waitcnt lgkmcnt(4)
  v_mfma_f32_16x16x32_bf16 v[72:75], v[20:23], v[200:203], v[72:75]
  ds_read_b64_tr_b16 v[16:17], v136 offset:8192
  v_mfma_f32_16x16x32_bf16 v[76:79], v[20:23], v[204:207], v[76:79]
  ds_read_b64_tr_b16 v[18:19], v136 offset:9216
  s_waitcnt lgkmcnt(4)
  v_mfma_f32_16x16x32_bf16 v[80:83], v[24:27], v[200:203], v[80:83]
  ds_read_b64_tr_b16 v[20:21], v137 offset:8192
  v_mfma_f32_16x16x32_bf16 v[84:87], v[24:27], v[204:207], v[84:87]
  ds_read_b64_tr_b16 v[22:23], v137 offset:9216
  s_waitcnt lgkmcnt(4)
  v_mfma_f32_16x16x32_bf16 v[88:91], v[28:31], v[200:203], v[88:91]
  ds_read_b64_tr_b16 v[24:25], v138 offset:8192
  v_mfma_f32_16x16x32_bf16 v[92:95], v[28:31], v[204:207], v[92:95]
  ds_read_b64_tr_b16 v[26:27], v138 offset:9216
  s_waitcnt lgkmcnt(4)
  v_mfma_f32_16x16x32_bf16 v[96:99], v[16:19], v[200:203], v[96:99]
  ds_read_b64_tr_b16 v[28:29], v139 offset:8192
  v_mfma_f32_16x16x32_bf16 v[100:103], v[16:19], v[204:207], v[100:103]
  ds_read_b64_tr_b16 v[30:31], v139 offset:9216
  s_and_b32 s50, s66, 15
  s_lshr_b64 s[66:67], s[66:67], 4
  s_lshl_b32 s50, s50, 14
  v_add_u32 v8, s50, v5
  s_waitcnt lgkmcnt(4)
  v_mfma_f32_16x16x32_bf16 v[104:107], v[20:23], v[200:203], v[104:107]
  v_mfma_f32_16x16x32_bf16 v[108:111], v[20:23], v[204:207], v[108:111]
  s_waitcnt lgkmcnt(0)
  s_barrier
  ds_read_b128 v[208:211], v128 offset:0
  ds_read_b128 v[212:215], v128 offset:2048
  ds_read_b128 v[216:219], v129 offset:0
  ds_read_b128 v[220:223], v129 offset:2048
  ds_read_b64_tr_b16 v[16:17], v8 offset:0
  ds_read_b64_tr_b16 v[18:19], v8 offset:1024
  v_mfma_f32_16x16x32_bf16 v[112:115], v[24:27], v[200:203], v[112:115]
  v_xor_b32 v9, 32, v8
  ds_read_b64_tr_b16 v[20:21], v9 offset:0
  v_mfma_f32_16x16x32_bf16 v[116:119], v[24:27], v[204:207], v[116:119]
  ds_read_b64_tr_b16 v[22:23], v9 offset:1024
  v_mfma_f32_16x16x32_bf16 v[120:123], v[28:31], v[200:203], v[120:123]
  v_xor_b32 v10, 64, v8
  ds_read_b64_tr_b16 v[24:25], v10 offset:0
  v_mfma_f32_16x16x32_bf16 v[124:127], v[28:31], v[204:207], v[124:127]
  ds_read_b64_tr_b16 v[26:27], v10 offset:1024
  s_waitcnt lgkmcnt(4)
  v_mfma_f32_16x16x32_bf16 v[64:67], v[16:19], v[208:211], v[64:67]
  v_xor_b32 v11, 96, v8
  ds_read_b64_tr_b16 v[28:29], v11 offset:0
  v_mfma_f32_16x16x32_bf16 v[68:71], v[16:19], v[212:215], v[68:71]
  ds_read_b64_tr_b16 v[30:31], v11 offset:1024
  s_waitcnt lgkmcnt(4)
  v_mfma_f32_16x16x32_bf16 v[72:75], v[20:23], v[208:211], v[72:75]
  v_xor_b32 v136, 128, v8
  ds_read_b64_tr_b16 v[16:17], v136 offset:0
  v_mfma_f32_16x16x32_bf16 v[76:79], v[20:23], v[212:215], v[76:79]
  ds_read_b64_tr_b16 v[18:19], v136 offset:1024
  s_waitcnt lgkmcnt(4)
  v_mfma_f32_16x16x32_bf16 v[80:83], v[24:27], v[208:211], v[80:83]
  v_xor_b32 v137, 160, v8
  ds_read_b64_tr_b16 v[20:21], v137 offset:0
  v_mfma_f32_16x16x32_bf16 v[84:87], v[24:27], v[212:215], v[84:87]
  ds_read_b64_tr_b16 v[22:23], v137 offset:1024
  s_waitcnt lgkmcnt(4)
  v_mfma_f32_16x16x32_bf16 v[88:91], v[28:31], v[208:211], v[88:91]
  v_xor_b32 v138, 192, v8
  ds_read_b64_tr_b16 v[24:25], v138 offset:0
  v_mfma_f32_16x16x32_bf16 v[92:95], v[28:31], v[212:215], v[92:95]
  ds_read_b64_tr_b16 v[26:27], v138 offset:1024
  s_waitcnt lgkmcnt(4)
  v_mfma_f32_16x16x32_bf16 v[96:99], v[16:19], v[208:211], v[96:99]
  v_xor_b32 v139, 224, v8
  ds_read_b64_tr_b16 v[28:29], v139 offset:0
  v_mfma_f32_16x16x32_bf16 v[100:103], v[16:19], v[212:215], v[100:103]
  ds_read_b64_tr_b16 v[30:31], v139 offset:1024
  s_waitcnt lgkmcnt(4)
  v_mfma_f32_16x16x32_bf16 v[104:107], v[20:23], v[208:211], v[104:107]
  ds_read_b64_tr_b16 v[16:17], v8 offset:8192
  v_mfma_f32_16x16x32_bf16 v[108:111], v[20:23], v[212:215], v[108:111]
  ds_read_b64_tr_b16 v[18:19], v8 offset:9216
  s_waitcnt lgkmcnt(4)
  v_mfma_f32_16x16x32_bf16 v[112:115], v[24:27], v[208:211], v[112:115]
  ds_read_b64_tr_b16 v[20:21], v9 offset:8192
  v_mfma_f32_16x16x32_bf16 v[116:119], v[24:27], v[212:215], v[116:119]
  ds_read_b64_tr_b16 v[22:23], v9 offset:9216
  s_waitcnt lgkmcnt(4)
  v_mfma_f32_16x16x32_bf16 v[120:123], v[28:31], v[208:211], v[120:123]
  ds_read_b64_tr_b16 v[24:25], v10 offset:8192
  v_mfma_f32_16x16x32_bf16 v[124:127], v[28:31], v[212:215], v[124:127]
  ds_read_b64_tr_b16 v[26:27], v10 offset:9216
  s_waitcnt lgkmcnt(4)
  v_mfma_f32_16x16x32_bf16 v[64:67], v[16:19], v[216:219], v[64:67]
  ds_read_b64_tr_b16 v[28:29], v11 offset:8192
  v_mfma_f32_16x16x32_bf16 v[68:71], v[16:19], v[220:223], v[68:71]
  ds_read_b64_tr_b16 v[30:31], v11 offset:9216
  s_waitcnt lgkmcnt(4)
  v_mfma_f32_16x16x32_bf16 v[72:75], v[20:23], v[216:219], v[72:75]
  ds_read_b64_tr_b16 v[16:17], v136 offset:8192
  v_mfma_f32_16x16x32_bf16 v[76:79], v[20:23], v[220:223], v[76:79]
  ds_read_b64_tr_b16 v[18:19], v136 offset:9216
  s_waitcnt lgkmcnt(4)
  v_mfma_f32_16x16x32_bf16 v[80:83], v[24:27], v[216:219], v[80:83]
  ds_read_b64_tr_b16 v[20:21], v137 offset:8192
  v_mfma_f32_16x16x32_bf16 v[84:87], v[24:27], v[220:223], v[84:87]
  ds_read_b64_tr_b16 v[22:23], v137 offset:9216
  s_waitcnt lgkmcnt(4)
  v_mfma_f32_16x16x32_bf16 v[88:91], v[28:31], v[216:219], v[88:91]
  ds_read_b64_tr_b16 v[24:25], v138 offset:8192
  v_mfma_f32_16x16x32_bf16 v[92:95], v[28:31], v[220:223], v[92:95]
  ds_read_b64_tr_b16 v[26:27], v138 offset:9216
  s_waitcnt lgkmcnt(4)
  v_mfma_f32_16x16x32_bf16 v[96:99], v[16:19], v[216:219], v[96:99]
  ds_read_b64_tr_b16 v[28:29], v139 offset:8192
  v_mfma_f32_16x16x32_bf16 v[100:103], v[16:19], v[220:223], v[100:103]
  ds_read_b64_tr_b16 v[30:31], v139 offset:9216
  s_and_b32 s50, s66, 15
  s_lshr_b64 s[66:67], s[66:67], 4
  s_lshl_b32 s50, s50, 14
  v_add_u32 v8, s50, v5
  s_waitcnt lgkmcnt(4)
  v_mfma_f32_16x16x32_bf16 v[104:107], v[20:23], v[216:219], v[104:107]
  v_mfma_f32_16x16x32_bf16 v[108:111], v[20:23], v[220:223], v[108:111]
  s_waitcnt lgkmcnt(0)
  s_barrier
  ds_read_b128 v[224:227], v128 offset:12288
  ds_read_b128 v[228:231], v128 offset:14336
  ds_read_b128 v[232:235], v129 offset:12288
  ds_read_b128 v[236:239], v129 offset:14336
  ds_read_b64_tr_b16 v[16:17], v8 offset:0
  ds_read_b64_tr_b16 v[18:19], v8 offset:1024
  v_mfma_f32_16x16x32_bf16 v[112:115], v[24:27], v[216:219], v[112:115]
  v_xor_b32 v9, 32, v8
  ds_read_b64_tr_b16 v[20:21], v9 offset:0
  v_mfma_f32_16x16x32_bf16 v[116:119], v[24:27], v[220:223], v[116:119]
  ds_read_b64_tr_b16 v[22:23], v9 offset:1024
  v_mfma_f32_16x16x32_bf16 v[120:123], v[28:31], v[216:219], v[120:123]
  v_xor_b32 v10, 64, v8
  ds_read_b64_tr_b16 v[24:25], v10 offset:0
  v_mfma_f32_16x16x32_bf16 v[124:127], v[28:31], v[220:223], v[124:127]
  ds_read_b64_tr_b16 v[26:27], v10 offset:1024
  s_waitcnt lgkmcnt(4)
  v_mfma_f32_16x16x32_bf16 v[64:67], v[16:19], v[224:227], v[64:67]
  v_xor_b32 v11, 96, v8
  ds_read_b64_tr_b16 v[28:29], v11 offset:0
  v_mfma_f32_16x16x32_bf16 v[68:71], v[16:19], v[228:231], v[68:71]
  ds_read_b64_tr_b16 v[30:31], v11 offset:1024
  s_waitcnt lgkmcnt(4)
  v_mfma_f32_16x16x32_bf16 v[72:75], v[20:23], v[224:227], v[72:75]
  v_xor_b32 v136, 128, v8
  ds_read_b64_tr_b16 v[16:17], v136 offset:0
  v_mfma_f32_16x16x32_bf16 v[76:79], v[20:23], v[228:231], v[76:79]
  ds_read_b64_tr_b16 v[18:19], v136 offset:1024
  s_waitcnt lgkmcnt(4)
  v_mfma_f32_16x16x32_bf16 v[80:83], v[24:27], v[224:227], v[80:83]
  v_xor_b32 v137, 160, v8
  ds_read_b64_tr_b16 v[20:21], v137 offset:0
  v_mfma_f32_16x16x32_bf16 v[84:87], v[24:27], v[228:231], v[84:87]
  ds_read_b64_tr_b16 v[22:23], v137 offset:1024
  s_waitcnt lgkmcnt(4)
  v_mfma_f32_16x16x32_bf16 v[88:91], v[28:31], v[224:227], v[88:91]
  v_xor_b32 v138, 192, v8
  ds_read_b64_tr_b16 v[24:25], v138 offset:0
  v_mfma_f32_16x16x32_bf16 v[92:95], v[28:31], v[228:231], v[92:95]
  ds_read_b64_tr_b16 v[26:27], v138 offset:1024
  s_waitcnt lgkmcnt(4)
  v_mfma_f32_16x16x32_bf16 v[96:99], v[16:19], v[224:227], v[96:99]
  v_xor_b32 v139, 224, v8
  ds_read_b64_tr_b16 v[28:29], v139 offset:0
  v_mfma_f32_16x16x32_bf16 v[100:103], v[16:19], v[228:231], v[100:103]
  ds_read_b64_tr_b16 v[30:31], v139 offset:1024
  s_waitcnt lgkmcnt(4)
  v_mfma_f32_16x16x32_bf16 v[104:107], v[20:23], v[224:227], v[104:107]
  ds_read_b64_tr_b16 v[16:17], v8 offset:8192
  v_mfma_f32_16x16x32_bf16 v[108:111], v[20:23], v[228:231], v[108:111]
  ds_read_b64_tr_b16 v[18:19], v8 offset:9216
  s_waitcnt lgkmcnt(4)
  v_mfma_f32_16x16x32_bf16 v[112:115], v[24:27], v[224:227], v[112:115]
  ds_read_b64_tr_b16 v[20:21], v9 offset:8192
  v_mfma_f32_16x16x32_bf16 v[116:119], v[24:27], v[228:231], v[116:119]
  ds_read_b64_tr_b16 v[22:23], v9 offset:9216
  s_waitcnt lgkmcnt(4)
  v_mfma_f32_16x16x32_bf16 v[120:123], v[28:31], v[224:227], v[120:123]
  ds_read_b64_tr_b16 v[24:25], v10 offset:8192
  v_mfma_f32_16x16x32_bf16 v[124:127], v[28:31], v[228:231], v[124:127]
  ds_read_b64_tr_b16 v[26:27], v10 offset:9216
  s_waitcnt lgkmcnt(4)
  v_mfma_f32_16x16x32_bf16 v[64:67], v[16:19], v[232:235], v[64:67]
  ds_read_b64_tr_b16 v[28:29], v11 offset:8192
  v_mfma_f32_16x16x32_bf16 v[68:71], v[16:19], v[236:239], v[68:71]
  ds_read_b64_tr_b16 v[30:31], v11 offset:9216
  s_waitcnt lgkmcnt(4)
  v_mfma_f32_16x16x32_bf16 v[72:75], v[20:23], v[232:235], v[72:75]
  ds_read_b64_tr_b16 v[16:17], v136 offset:8192
  v_mfma_f32_16x16x32_bf16 v[76:79], v[20:23], v[236:239], v[76:79]
  ds_read_b64_tr_b16 v[18:19], v136 offset:9216
  s_waitcnt lgkmcnt(4)
  v_mfma_f32_16x16x32_bf16 v[80:83], v[24:27], v[232:235], v[80:83]
  ds_read_b64_tr_b16 v[20:21], v137 offset:8192
  v_mfma_f32_16x16x32_bf16 v[84:87], v[24:27], v[236:239], v[84:87]
  ds_read_b64_tr_b16 v[22:23], v137 offset:9216
  s_waitcnt lgkmcnt(4)
  v_mfma_f32_16x16x32_bf16 v[88:91], v[28:31], v[232:235], v[88:91]
  ds_read_b64_tr_b16 v[24:25], v138 offset:8192
  v_mfma_f32_16x16x32_bf16 v[92:95], v[28:31], v[236:239], v[92:95]
  ds_read_b64_tr_b16 v[26:27], v138 offset:9216
  s_waitcnt lgkmcnt(4)
  v_mfma_f32_16x16x32_bf16 v[96:99], v[16:19], v[232:235], v[96:99]
  ds_read_b64_tr_b16 v[28:29], v139 offset:8192
  v_mfma_f32_16x16x32_bf16 v[100:103], v[16:19], v[236:239], v[100:103]
  ds_read_b64_tr_b16 v[30:31], v139 offset:9216
  s_and_b32 s50, s66, 15
  s_lshr_b64 s[66:67], s[66:67], 4
  s_lshl_b32 s50, s50, 14
  v_add_u32 v8, s50, v5
  s_waitcnt lgkmcnt(4)
  v_mfma_f32_16x16x32_bf16 v[104:107], v[20:23], v[232:235], v[104:107]
  v_mfma_f32_16x16x32_bf16 v[108:111], v[20:23], v[236:239], v[108:111]
  s_waitcnt lgkmcnt(0)
  s_barrier
  ds_read_b128 v[240:243], v128 offset:24576
  ds_read_b128 v[244:247], v128 offset:26624
  ds_read_b128 v[248:251], v129 offset:24576
  ds_read_b128 v[252:255], v129 offset:26624
  ds_read_b64_tr_b16 v[16:17], v8 offset:0
  ds_read_b64_tr_b16 v[18:19], v8 offset:1024
  v_mfma_f32_16x16x32_bf16 v[112:115], v[24:27], v[232:235], v[112:115]
  ds_read_b64_tr_b16 v[20:21], v8 offset:8192
  v_mfma_f32_16x16x32_bf16 v[116:119], v[24:27], v[236:239], v[116:119]
  ds_read_b64_tr_b16 v[22:23], v8 offset:9216
  v_mfma_f32_16x16x32_bf16 v[120:123], v[28:31], v[232:235], v[120:123]
  v_xor_b32 v10, 32, v8
  ds_read_b64_tr_b16 v[24:25], v10 offset:0
  v_mfma_f32_16x16x32_bf16 v[124:127], v[28:31], v[236:239], v[124:127]
  ds_read_b64_tr_b16 v[26:27], v10 offset:1024
  s_waitcnt lgkmcnt(4)
  v_mfma_f32_16x16x32_bf16 v[64:67], v[16:19], v[240:243], v[64:67]
  ds_read_b64_tr_b16 v[28:29], v10 offset:8192
  v_mfma_f32_16x16x32_bf16 v[68:71], v[16:19], v[244:247], v[68:71]
  ds_read_b64_tr_b16 v[30:31], v10 offset:9216
  s_waitcnt lgkmcnt(4)
  v_mfma_f32_16x16x32_bf16 v[64:67], v[20:23], v[248:251], v[64:67]
  v_xor_b32 v9, 64, v8
  ds_read_b64_tr_b16 v[16:17], v9 offset:0
  v_mfma_f32_16x16x32_bf16 v[68:71], v[20:23], v[252:255], v[68:71]
  ds_read_b64_tr_b16 v[18:19], v9 offset:1024
  s_waitcnt lgkmcnt(4)
  v_mfma_f32_16x16x32_bf16 v[72:75], v[24:27], v[240:243], v[72:75]
  ds_read_b64_tr_b16 v[20:21], v9 offset:8192
  v_mfma_f32_16x16x32_bf16 v[76:79], v[24:27], v[244:247], v[76:79]
  ds_read_b64_tr_b16 v[22:23], v9 offset:9216
  s_waitcnt lgkmcnt(4)
  v_mfma_f32_16x16x32_bf16 v[72:75], v[28:31], v[248:251], v[72:75]
  v_xor_b32 v10, 96, v8
  ds_read_b64_tr_b16 v[24:25], v10 offset:0
  v_mfma_f32_16x16x32_bf16 v[76:79], v[28:31], v[252:255], v[76:79]
  ds_read_b64_tr_b16 v[26:27], v10 offset:1024
  s_waitcnt lgkmcnt(4)
  v_mfma_f32_16x16x32_bf16 v[80:83], v[16:19], v[240:243], v[80:83]
  ds_read_b64_tr_b16 v[28:29], v10 offset:8192
  v_mfma_f32_16x16x32_bf16 v[84:87], v[16:19], v[244:247], v[84:87]
  ds_read_b64_tr_b16 v[30:31], v10 offset:9216
  s_waitcnt lgkmcnt(4)
  v_mfma_f32_16x16x32_bf16 v[80:83], v[20:23], v[248:251], v[80:83]
  v_xor_b32 v9, 128, v8
  ds_read_b64_tr_b16 v[16:17], v9 offset:0
  v_mfma_f32_16x16x32_bf16 v[84:87], v[20:23], v[252:255], v[84:87]
  ds_read_b64_tr_b16 v[18:19], v9 offset:1024
  s_waitcnt lgkmcnt(4)
  v_mfma_f32_16x16x32_bf16 v[88:91], v[24:27], v[240:243], v[88:91]
  ds_read_b64_tr_b16 v[20:21], v9 offset:8192
  v_mfma_f32_16x16x32_bf16 v[92:95], v[24:27], v[244:247], v[92:95]
  ds_read_b64_tr_b16 v[22:23], v9 offset:9216
  s_waitcnt lgkmcnt(4)
  v_mfma_f32_16x16x32_bf16 v[88:91], v[28:31], v[248:251], v[88:91]
  v_xor_b32 v10, 160, v8
  ds_read_b64_tr_b16 v[24:25], v10 offset:0
  v_mul_f32 v64, s72, v64
  v_mul_f32 v65, s72, v65
  v_mul_f32 v66, s72, v66
  v_mfma_f32_16x16x32_bf16 v[92:95], v[28:31], v[252:255], v[92:95]
  ds_read_b64_tr_b16 v[26:27], v10 offset:1024
  v_mul_f32 v67, s72, v67
  v_mul_f32 v68, s72, v68
  s_waitcnt lgkmcnt(4)
  v_mfma_f32_16x16x32_bf16 v[96:99], v[16:19], v[240:243], v[96:99]
  ds_read_b64_tr_b16 v[28:29], v10 offset:8192
  v_mul_f32 v69, s72, v69
  v_mul_f32 v70, s72, v70
  v_mul_f32 v71, s72, v71
  v_mul_f32 v72, s72, v72
  v_mfma_f32_16x16x32_bf16 v[100:103], v[16:19], v[244:247], v[100:103]
  ds_read_b64_tr_b16 v[30:31], v10 offset:9216
  v_mul_f32 v73, s72, v73
  v_mul_f32 v74, s72, v74
  s_waitcnt lgkmcnt(4)
  v_mfma_f32_16x16x32_bf16 v[96:99], v[20:23], v[248:251], v[96:99]
  v_xor_b32 v9, 192, v8
  ds_read_b64_tr_b16 v[16:17], v9 offset:0
  v_mul_f32 v75, s72, v75
  v_mul_f32 v76, s72, v76
  v_mul_f32 v77, s72, v77
  v_mfma_f32_16x16x32_bf16 v[100:103], v[20:23], v[252:255], v[100:103]
  ds_read_b64_tr_b16 v[18:19], v9 offset:1024
  v_mul_f32 v78, s72, v78
  v_mul_f32 v79, s72, v79
  v_cvt_pk_bf16_f32 v32, v64, v65
  s_waitcnt lgkmcnt(4)
  v_mfma_f32_16x16x32_bf16 v[104:107], v[24:27], v[240:243], v[104:107]
  ds_read_b64_tr_b16 v[20:21], v9 offset:8192
  v_cvt_pk_bf16_f32 v33, v66, v67
  v_cvt_pk_bf16_f32 v34, v72, v73
  v_cvt_pk_bf16_f32 v35, v74, v75
  v_mfma_f32_16x16x32_bf16 v[108:111], v[24:27], v[244:247], v[108:111]
  ds_read_b64_tr_b16 v[22:23], v9 offset:9216
  v_cvt_pk_bf16_f32 v36, v68, v69
  v_cvt_pk_bf16_f32 v37, v70, v71
  v_cvt_pk_bf16_f32 v38, v76, v77
  s_waitcnt lgkmcnt(4)
  v_mfma_f32_16x16x32_bf16 v[104:107], v[28:31], v[248:251], v[104:107]
  v_xor_b32 v10, 224, v8
  ds_read_b64_tr_b16 v[24:25], v10 offset:0
  v_cvt_pk_bf16_f32 v39, v78, v79
  v_permlane16_swap_b32 v32, v34
  v_mfma_f32_16x16x32_bf16 v[108:111], v[28:31], v[252:255], v[108:111]
  ds_read_b64_tr_b16 v[26:27], v10 offset:1024
  v_permlane16_swap_b32 v33, v35
  v_permlane16_swap_b32 v36, v38
  v_permlane16_swap_b32 v37, v39
  s_waitcnt lgkmcnt(4)
  v_mfma_f32_16x16x32_bf16 v[112:115], v[16:19], v[240:243], v[112:115]
  ds_read_b64_tr_b16 v[28:29], v10 offset:8192
  v_mul_f32 v80, s72, v80
  v_mul_f32 v81, s72, v81
  v_mul_f32 v82, s72, v82
  v_mfma_f32_16x16x32_bf16 v[116:119], v[16:19], v[244:247], v[116:119]
  ds_read_b64_tr_b16 v[30:31], v10 offset:9216
  v_mul_f32 v83, s72, v83
  v_mul_f32 v84, s72, v84
  v_mul_f32 v85, s72, v85
  s_and_b32 s50, s66, 15
  s_lshr_b64 s[66:67], s[66:67], 4
  s_lshl_b32 s50, s50, 14
  v_add_u32 v8, s50, v5
  s_waitcnt lgkmcnt(4)
  v_mfma_f32_16x16x32_bf16 v[112:115], v[20:23], v[248:251], v[112:115]
  v_mul_f32 v86, s72, v86
  v_mul_f32 v87, s72, v87
  v_mul_f32 v88, s72, v88
  v_mfma_f32_16x16x32_bf16 v[116:119], v[20:23], v[252:255], v[116:119]
  v_mul_f32 v89, s72, v89
  v_mul_f32 v90, s72, v90
  v_mul_f32 v91, s72, v91
  s_waitcnt lgkmcnt(0)
  s_barrier
  ds_read_b64_tr_b16 v[16:17], v8 offset:0
  ds_read_b64_tr_b16 v[18:19], v8 offset:1024
  v_mfma_f32_16x16x32_bf16 v[120:123], v[24:27], v[240:243], v[120:123]
  ds_read_b64_tr_b16 v[20:21], v8 offset:8192
  v_mul_f32 v92, s72, v92
  v_mul_f32 v93, s72, v93
  v_mul_f32 v94, s72, v94
  v_mfma_f32_16x16x32_bf16 v[124:127], v[24:27], v[244:247], v[124:127]
  ds_read_b64_tr_b16 v[22:23], v8 offset:9216
  v_mul_f32 v95, s72, v95
  v_cvt_pk_bf16_f32 v40, v80, v81
  v_mfma_f32_16x16x32_bf16 v[120:123], v[28:31], v[248:251], v[120:123]
  v_xor_b32 v10, 32, v8
  ds_read_b64_tr_b16 v[24:25], v10 offset:0
  v_cvt_pk_bf16_f32 v41, v82, v83
  v_cvt_pk_bf16_f32 v42, v88, v89
  v_cvt_pk_bf16_f32 v43, v90, v91
  v_mfma_f32_16x16x32_bf16 v[124:127], v[28:31], v[252:255], v[124:127]
  ds_read_b64_tr_b16 v[26:27], v10 offset:1024
  v_cvt_pk_bf16_f32 v44, v84, v85
  v_cvt_pk_bf16_f32 v45, v86, v87
  s_waitcnt lgkmcnt(4)
  v_mfma_f32_16x16x32_bf16 v[64:67], v[16:19], v[144:147], 0
  ds_read_b64_tr_b16 v[28:29], v10 offset:8192
  v_cvt_pk_bf16_f32 v46, v92, v93
  v_cvt_pk_bf16_f32 v47, v94, v95
  v_permlane16_swap_b32 v40, v42
  v_permlane16_swap_b32 v41, v43
  v_mfma_f32_16x16x32_bf16 v[68:71], v[16:19], v[148:151], 0
  ds_read_b64_tr_b16 v[30:31], v10 offset:9216
  v_permlane16_swap_b32 v44, v46
  v_permlane16_swap_b32 v45, v47
  s_waitcnt lgkmcnt(4)
  v_mfma_f32_16x16x32_bf16 v[64:67], v[20:23], v[152:155], v[64:67]
  v_xor_b32 v9, 64, v8
  ds_read_b64_tr_b16 v[16:17], v9 offset:0
  v_mul_f32 v96, s72, v96
  v_mul_f32 v97, s72, v97
  v_mul_f32 v98, s72, v98
  v_mfma_f32_16x16x32_bf16 v[68:71], v[20:23], v[156:159], v[68:71]
  ds_read_b64_tr_b16 v[18:19], v9 offset:1024
  v_mul_f32 v99, s72, v99
  v_mul_f32 v100, s72, v100
  s_waitcnt lgkmcnt(4)
  v_mfma_f32_16x16x32_bf16 v[72:75], v[24:27], v[144:147], 0
  ds_read_b64_tr_b16 v[20:21], v9 offset:8192
  v_mul_f32 v101, s72, v101
  v_mul_f32 v102, s72, v102
  v_mul_f32 v103, s72, v103
  v_mul_f32 v104, s72, v104
  v_mfma_f32_16x16x32_bf16 v[76:79], v[24:27], v[148:151], 0
  ds_read_b64_tr_b16 v[22:23], v9 offset:9216
  v_mul_f32 v105, s72, v105
  v_mul_f32 v106, s72, v106
  s_branch L_pads4
L_pad4:
  s_setpc_b64 s[60:61]
L_pads4:
  s_waitcnt lgkmcnt(4)
  v_mfma_f32_16x16x32_bf16 v[72:75], v[28:31], v[152:155], v[72:75]
  v_xor_b32 v10, 96, v8
  ds_read_b64_tr_b16 v[24:25], v10 offset:0
  v_mul_f32 v107, s72, v107
  v_mul_f32 v108, s72, v108
  v_mul_f32 v109, s72, v109
  v_mfma_f32_16x16x32_bf16 v[76:79], v[28:31], v[156:159], v[76:79]
  ds_read_b64_tr_b16 v[26:27], v10 offset:1024
  v_mul_f32 v110, s72, v110
  v_mul_f32 v111, s72, v111
  v_cvt_pk_bf16_f32 v48, v96, v97
  s_waitcnt lgkmcnt(4)
  v_mfma_f32_16x16x32_bf16 v[80:83], v[16:19], v[144:147], 0
  ds_read_b64_tr_b16 v[28:29], v10 offset:8192
  v_cvt_pk_bf16_f32 v49, v98, v99
  v_cvt_pk_bf16_f32 v50, v104, v105
  v_cvt_pk_bf16_f32 v51, v106, v107
  v_mfma_f32_16x16x32_bf16 v[84:87], v[16:19], v[148:151], 0
  ds_read_b64_tr_b16 v[30:31], v10 offset:9216
  v_cvt_pk_bf16_f32 v52, v100, v101
  v_cvt_pk_bf16_f32 v53, v102, v103
  v_cvt_pk_bf16_f32 v54, v108, v109
  s_waitcnt lgkmcnt(4)
  v_mfma_f32_16x16x32_bf16 v[80:83], v[20:23], v[152:155], v[80:83]
  v_xor_b32 v9, 128, v8
  ds_read_b64_tr_b16 v[16:17], v9 offset:0
  v_cvt_pk_bf16_f32 v55, v110, v111
  v_permlane16_swap_b32 v48, v50
  v_mfma_f32_16x16x32_bf16 v[84:87], v[20:23], v[156:159], v[84:87]
  ds_read_b64_tr_b16 v[18:19], v9 offset:1024
  v_permlane16_swap_b32 v49, v51
  v_permlane16_swap_b32 v52, v54
  v_permlane16_swap_b32 v53, v55
  s_waitcnt lgkmcnt(4)
  v_mfma_f32_16x16x32_bf16 v[88:91], v[24:27], v[144:147], 0
  ds_read_b64_tr_b16 v[20:21], v9 offset:8192
  v_mul_f32 v112, s72, v112
  v_mul_f32 v113, s72, v113
  v_mul_f32 v114, s72, v114
  v_mul_f32 v115, s72, v115
  v_mfma_f32_16x16x32_bf16 v[92:95], v[24:27], v[148:151], 0
  ds_read_b64_tr_b16 v[22:23], v9 offset:9216
  v_mul_f32 v116, s72, v116
  v_mul_f32 v117, s72, v117
  s_waitcnt lgkmcnt(4)
  v_mfma_f32_16x16x32_bf16 v[88:91], v[28:31], v[152:155], v[88:91]
  v_xor_b32 v10, 160, v8
  ds_read_b64_tr_b16 v[24:25], v10 offset:0
  v_mul_f32 v118, s72, v118
  v_mul_f32 v119, s72, v119
  v_mul_f32 v120, s72, v120
  v_mfma_f32_16x16x32_bf16 v[92:95], v[28:31], v[156:159], v[92:95]
  ds_read_b64_tr_b16 v[26:27], v10 offset:1024
  v_mul_f32 v121, s72, v121
  v_mul_f32 v122, s72, v122
  s_waitcnt lgkmcnt(4)
  v_mfma_f32_16x16x32_bf16 v[96:99], v[16:19], v[144:147], 0
  ds_read_b64_tr_b16 v[28:29], v10 offset:8192
  v_mul_f32 v123, s72, v123
  v_mul_f32 v124, s72, v124
  v_mul_f32 v125, s72, v125
  v_mul_f32 v126, s72, v126
  v_mfma_f32_16x16x32_bf16 v[100:103], v[16:19], v[148:151], 0
  ds_read_b64_tr_b16 v[30:31], v10 offset:9216
  v_mul_f32 v127, s72, v127
  v_cvt_pk_bf16_f32 v56, v112, v113
  s_waitcnt lgkmcnt(4)
  v_mfma_f32_16x16x32_bf16 v[96:99], v[20:23], v[152:155], v[96:99]
  v_xor_b32 v9, 192, v8
  ds_read_b64_tr_b16 v[16:17], v9 offset:0
  v_cvt_pk_bf16_f32 v57, v114, v115
  v_cvt_pk_bf16_f32 v58, v120, v121
  v_cvt_pk_bf16_f32 v59, v122, v123
  v_mfma_f32_16x16x32_bf16 v[100:103], v[20:23], v[156:159], v[100:103]
  ds_read_b64_tr_b16 v[18:19], v9 offset:1024
  v_cvt_pk_bf16_f32 v60, v116, v117
  v_cvt_pk_bf16_f32 v61, v118, v119
  s_waitcnt lgkmcnt(4)
  v_mfma_f32_16x16x32_bf16 v[104:107], v[24:27], v[144:147], 0
  ds_read_b64_tr_b16 v[20:21], v9 offset:8192
  v_cvt_pk_bf16_f32 v62, v124, v125
  v_cvt_pk_bf16_f32 v63, v126, v127
  v_permlane16_swap_b32 v56, v58
  v_permlane16_swap_b32 v57, v59
  v_mfma_f32_16x16x32_bf16 v[108:111], v[24:27], v[148:151], 0
  ds_read_b64_tr_b16 v[22:23], v9 offset:9216
  v_permlane16_swap_b32 v60, v62
  v_permlane16_swap_b32 v61, v63
  s_waitcnt lgkmcnt(4)
  v_mfma_f32_16x16x32_bf16 v[104:107], v[28:31], v[152:155], v[104:107]
  v_xor_b32 v10, 224, v8
  ds_read_b64_tr_b16 v[24:25], v10 offset:0
  v_mfma_f32_16x16x32_bf16 v[108:111], v[28:31], v[156:159], v[108:111]
  ds_read_b64_tr_b16 v[26:27], v10 offset:1024
  s_waitcnt lgkmcnt(4)
  v_mfma_f32_16x16x32_bf16 v[112:115], v[16:19], v[144:147], 0
  ds_read_b64_tr_b16 v[28:29], v10 offset:8192
  v_mfma_f32_16x16x32_bf16 v[116:119], v[16:19], v[148:151], 0
  ds_read_b64_tr_b16 v[30:31], v10 offset:9216
  s_and_b32 s50, s66, 15
  s_lshr_b64 s[66:67], s[66:67], 4
  s_lshl_b32 s50, s50, 14
  v_add_u32 v8, s50, v5
  s_waitcnt lgkmcnt(4)
  v_mfma_f32_16x16x32_bf16 v[112:115], v[20:23], v[152:155], v[112:115]
  v_mfma_f32_16x16x32_bf16 v[116:119], v[20:23], v[156:159], v[116:119]
  s_waitcnt lgkmcnt(0)
  s_barrier
  ds_read_b64_tr_b16 v[16:17], v8 offset:0
  ds_read_b64_tr_b16 v[18:19], v8 offset:1024
  v_mfma_f32_16x16x32_bf16 v[120:123], v[24:27], v[144:147], 0
  v_xor_b32 v9, 32, v8
  ds_read_b64_tr_b16 v[20:21], v9 offset:0
  v_mfma_f32_16x16x32_bf16 v[124:127], v[24:27], v[148:151], 0
  ds_read_b64_tr_b16 v[22:23], v9 offset:1024
  v_mfma_f32_16x16x32_bf16 v[120:123], v[28:31], v[152:155], v[120:123]
  v_xor_b32 v10, 64, v8
  ds_read_b64_tr_b16 v[24:25], v10 offset:0
  v_mfma_f32_16x16x32_bf16 v[124:127], v[28:31], v[156:159], v[124:127]
  ds_read_b64_tr_b16 v[26:27], v10 offset:1024
  s_waitcnt lgkmcnt(4)
  v_mfma_f32_16x16x32_bf16 v[64:67], v[16:19], v[160:163], v[64:67]
  v_xor_b32 v11, 96, v8
  ds_read_b64_tr_b16 v[28:29], v11 offset:0
  v_mfma_f32_16x16x32_bf16 v[68:71], v[16:19], v[164:167], v[68:71]
  ds_read_b64_tr_b16 v[30:31], v11 offset:1024
  s_waitcnt lgkmcnt(4)
  v_mfma_f32_16x16x32_bf16 v[72:75], v[20:23], v[160:163], v[72:75]
  v_xor_b32 v136, 128, v8
  ds_read_b64_tr_b16 v[16:17], v136 offset:0
  v_mfma_f32_16x16x32_bf16 v[76:79], v[20:23], v[164:167], v[76:79]
  ds_read_b64_tr_b16 v[18:19], v136 offset:1024
  s_waitcnt lgkmcnt(4)
  v_mfma_f32_16x16x32_bf16 v[80:83], v[24:27], v[160:163], v[80:83]
  v_xor_b32 v137, 160, v8
  ds_read_b64_tr_b16 v[20:21], v137 offset:0
  v_mfma_f32_16x16x32_bf16 v[84:87], v[24:27], v[164:167], v[84:87]
  ds_read_b64_tr_b16 v[22:23], v137 offset:1024
  s_waitcnt lgkmcnt(4)
  v_mfma_f32_16x16x32_bf16 v[88:91], v[28:31], v[160:163], v[88:91]
  v_xor_b32 v138, 192, v8
  ds_read_b64_tr_b16 v[24:25], v138 offset:0
  v_mfma_f32_16x16x32_bf16 v[92:95], v[28:31], v[164:167], v[92:95]
  ds_read_b64_tr_b16 v[26:27], v138 offset:1024
  s_waitcnt lgkmcnt(4)
  v_mfma_f32_16x16x32_bf16 v[96:99], v[16:19], v[160:163], v[96:99]
  v_xor_b32 v139, 224, v8
  ds_read_b64_tr_b16 v[28:29], v139 offset:0
  v_mfma_f32_16x16x32_bf16 v[100:103], v[16:19], v[164:167], v[100:103]
  ds_read_b64_tr_b16 v[30:31], v139 offset:1024
  s_waitcnt lgkmcnt(4)
  v_mfma_f32_16x16x32_bf16 v[104:107], v[20:23], v[160:163], v[104:107]
  ds_read_b64_tr_b16 v[16:17], v8 offset:8192
  v_mfma_f32_16x16x32_bf16 v[108:111], v[20:23], v[164:167], v[108:111]
  ds_read_b64_tr_b16 v[18:19], v8 offset:9216
  s_waitcnt lgkmcnt(4)
  v_mfma_f32_16x16x32_bf16 v[112:115], v[24:27], v[160:163], v[112:115]
  ds_read_b64_tr_b16 v[20:21], v9 offset:8192
  v_mfma_f32_16x16x32_bf16 v[116:119], v[24:27], v[164:167], v[116:119]
  ds_read_b64_tr_b16 v[22:23], v9 offset:9216
  s_waitcnt lgkmcnt(4)
  v_mfma_f32_16x16x32_bf16 v[120:123], v[28:31], v[160:163], v[120:123]
  ds_read_b64_tr_b16 v[24:25], v10 offset:8192
  v_mfma_f32_16x16x32_bf16 v[124:127], v[28:31], v[164:167], v[124:127]
  ds_read_b64_tr_b16 v[26:27], v10 offset:9216
  s_waitcnt lgkmcnt(4)
  v_mfma_f32_16x16x32_bf16 v[64:67], v[16:19], v[168:171], v[64:67]
  ds_read_b64_tr_b16 v[28:29], v11 offset:8192
  v_mfma_f32_16x16x32_bf16 v[68:71], v[16:19], v[172:175], v[68:71]
  ds_read_b64_tr_b16 v[30:31], v11 offset:9216
  s_waitcnt lgkmcnt(4)
  v_mfma_f32_16x16x32_bf16 v[72:75], v[20:23], v[168:171], v[72:75]
  ds_read_b64_tr_b16 v[16:17], v136 offset:8192
  v_mfma_f32_16x16x32_bf16 v[76:79], v[20:23], v[172:175], v[76:79]
  ds_read_b64_tr_b16 v[18:19], v136 offset:9216
  s_waitcnt lgkmcnt(4)
  v_mfma_f32_16x16x32_bf16 v[80:83], v[24:27], v[168:171], v[80:83]
  ds_read_b64_tr_b16 v[20:21], v137 offset:8192
  v_mfma_f32_16x16x32_bf16 v[84:87], v[24:27], v[172:175], v[84:87]
  ds_read_b64_tr_b16 v[22:23], v137 offset:9216
  s_waitcnt lgkmcnt(4)
  v_mfma_f32_16x16x32_bf16 v[88:91], v[28:31], v[168:171], v[88:91]
  ds_read_b64_tr_b16 v[24:25], v138 offset:8192
  v_mfma_f32_16x16x32_bf16 v[92:95], v[28:31], v[172:175], v[92:95]
  ds_read_b64_tr_b16 v[26:27], v138 offset:9216
  s_waitcnt lgkmcnt(4)
  v_mfma_f32_16x16x32_bf16 v[96:99], v[16:19], v[168:171], v[96:99]
  ds_read_b64_tr_b16 v[28:29], v139 offset:8192
  v_mfma_f32_16x16x32_bf16 v[100:103], v[16:19], v[172:175], v[100:103]
  ds_read_b64_tr_b16 v[30:31], v139 offset:9216
  s_and_b32 s50, s66, 15
  s_lshr_b64 s[66:67], s[66:67], 4
  s_lshl_b32 s50, s50, 14
  v_add_u32 v8, s50, v5
  s_waitcnt lgkmcnt(4)
  v_mfma_f32_16x16x32_bf16 v[104:107], v[20:23], v[168:171], v[104:107]
  v_mfma_f32_16x16x32_bf16 v[108:111], v[20:23], v[172:175], v[108:111]
  s_waitcnt lgkmcnt(0)
  s_barrier
  ds_read_b64_tr_b16 v[16:17], v8 offset:0
  ds_read_b64_tr_b16 v[18:19], v8 offset:1024
  v_mfma_f32_16x16x32_bf16 v[112:115], v[24:27], v[168:171], v[112:115]
  v_xor_b32 v9, 32, v8
  ds_read_b64_tr_b16 v[20:21], v9 offset:0
  v_mfma_f32_16x16x32_bf16 v[116:119], v[24:27], v[172:175], v[116:119]
  ds_read_b64_tr_b16 v[22:23], v9 offset:1024
  v_mfma_f32_16x16x32_bf16 v[120:123], v[28:31], v[168:171], v[120:123]
  v_xor_b32 v10, 64, v8
  ds_read_b64_tr_b16 v[24:25], v10 offset:0
  v_mfma_f32_16x16x32_bf16 v[124:127], v[28:31], v[172:175], v[124:127]
  ds_read_b64_tr_b16 v[26:27], v10 offset:1024
  s_waitcnt lgkmcnt(4)
  v_mfma_f32_16x16x32_bf16 v[64:67], v[16:19], v[176:179], v[64:67]
  v_xor_b32 v11, 96, v8
  ds_read_b64_tr_b16 v[28:29], v11 offset:0
  v_mfma_f32_16x16x32_bf16 v[68:71], v[16:19], v[180:183], v[68:71]
  ds_read_b64_tr_b16 v[30:31], v11 offset:1024
  s_waitcnt lgkmcnt(4)
  v_mfma_f32_16x16x32_bf16 v[72:75], v[20:23], v[176:179], v[72:75]
  v_xor_b32 v136, 128, v8
  ds_read_b64_tr_b16 v[16:17], v136 offset:0
  v_mfma_f32_16x16x32_bf16 v[76:79], v[20:23], v[180:183], v[76:79]
  ds_read_b64_tr_b16 v[18:19], v136 offset:1024
  s_waitcnt lgkmcnt(4)
  v_mfma_f32_16x16x32_bf16 v[80:83], v[24:27], v[176:179], v[80:83]
  v_xor_b32 v137, 160, v8
  ds_read_b64_tr_b16 v[20:21], v137 offset:0
  v_mfma_f32_16x16x32_bf16 v[84:87], v[24:27], v[180:183], v[84:87]
  ds_read_b64_tr_b16 v[22:23], v137 offset:1024
  s_waitcnt lgkmcnt(4)
  v_mfma_f32_16x16x32_bf16 v[88:91], v[28:31], v[176:179], v[88:91]
  v_xor_b32 v138, 192, v8
  ds_read_b64_tr_b16 v[24:25], v138 offset:0
  v_mfma_f32_16x16x32_bf16 v[92:95], v[28:31], v[180:183], v[92:95]
  ds_read_b64_tr_b16 v[26:27], v138 offset:1024
  s_waitcnt lgkmcnt(4)
  v_mfma_f32_16x16x32_bf16 v[96:99], v[16:19], v[176:179], v[96:99]
  v_xor_b32 v139, 224, v8
  ds_read_b64_tr_b16 v[28:29], v139 offset:0
  v_mfma_f32_16x16x32_bf16 v[100:103], v[16:19], v[180:183], v[100:103]
  ds_read_b64_tr_b16 v[30:31], v139 offset:1024
  s_waitcnt lgkmcnt(4)
  v_mfma_f32_16x16x32_bf16 v[104:107], v[20:23], v[176:179], v[104:107]
  ds_read_b64_tr_b16 v[16:17], v8 offset:8192
  v_mfma_f32_16x16x32_bf16 v[108:111], v[20:23], v[180:183], v[108:111]
  ds_read_b64_tr_b16 v[18:19], v8 offset:9216
  s_waitcnt lgkmcnt(4)
  v_mfma_f32_16x16x32_bf16 v[112:115], v[24:27], v[176:179], v[112:115]
  ds_read_b64_tr_b16 v[20:21], v9 offset:8192
  v_mfma_f32_16x16x32_bf16 v[116:119], v[24:27], v[180:183], v[116:119]
  ds_read_b64_tr_b16 v[22:23], v9 offset:9216
  s_waitcnt lgkmcnt(4)
  v_mfma_f32_16x16x32_bf16 v[120:123], v[28:31], v[176:179], v[120:123]
  ds_read_b64_tr_b16 v[24:25], v10 offset:8192
  v_mfma_f32_16x16x32_bf16 v[124:127], v[28:31], v[180:183], v[124:127]
  ds_read_b64_tr_b16 v[26:27], v10 offset:9216
  s_waitcnt lgkmcnt(4)
  v_mfma_f32_16x16x32_bf16 v[64:67], v[16:19], v[184:187], v[64:67]
  ds_read_b64_tr_b16 v[28:29], v11 offset:8192
  v_mfma_f32_16x16x32_bf16 v[68:71], v[16:19], v[188:191], v[68:71]
  ds_read_b64_tr_b16 v[30:31], v11 offset:9216
  s_waitcnt lgkmcnt(4)
  v_mfma_f32_16x16x32_bf16 v[72:75], v[20:23], v[184:187], v[72:75]
  ds_read_b64_tr_b16 v[16:17], v136 offset:8192
  v_mfma_f32_16x16x32_bf16 v[76:79], v[20:23], v[188:191], v[76:79]
  ds_read_b64_tr_b16 v[18:19], v136 offset:9216
  s_waitcnt lgkmcnt(4)
  v_mfma_f32_16x16x32_bf16 v[80:83], v[24:27], v[184:187], v[80:83]
  ds_read_b64_tr_b16 v[20:21], v137 offset:8192
  v_mfma_f32_16x16x32_bf16 v[84:87], v[24:27], v[188:191], v[84:87]
  ds_read_b64_tr_b16 v[22:23], v137 offset:9216
  s_waitcnt lgkmcnt(4)
  v_mfma_f32_16x16x32_bf16 v[88:91], v[28:31], v[184:187], v[88:91]
  ds_read_b64_tr_b16 v[24:25], v138 offset:8192
  v_mfma_f32_16x16x32_bf16 v[92:95], v[28:31], v[188:191], v[92:95]
  ds_read_b64_tr_b16 v[26:27], v138 offset:9216
  s_waitcnt lgkmcnt(4)
  v_mfma_f32_16x16x32_bf16 v[96:99], v[16:19], v[184:187], v[96:99]
  ds_read_b64_tr_b16 v[28:29], v139 offset:8192
  v_mfma_f32_16x16x32_bf16 v[100:103], v[16:19], v[188:191], v[100:103]
  ds_read_b64_tr_b16 v[30:31], v139 offset:9216
  s_and_b32 s50, s66, 15
  s_lshr_b64 s[66:67], s[66:67], 4
  s_lshl_b32 s50, s50, 14
  v_add_u32 v8, s50, v5
  s_waitcnt lgkmcnt(4)
  v_mfma_f32_16x16x32_bf16 v[104:107], v[20:23], v[184:187], v[104:107]
  v_mfma_f32_16x16x32_bf16 v[108:111], v[20:23], v[188:191], v[108:111]
  s_waitcnt lgkmcnt(0)
  s_barrier
  ds_read_b64_tr_b16 v[16:17], v8 offset:0
  ds_read_b64_tr_b16 v[18:19], v8 offset:1024
  v_mfma_f32_16x16x32_bf16 v[112:115], v[24:27], v[184:187], v[112:115]
  v_xor_b32 v9, 32, v8
  ds_read_b64_tr_b16 v[20:21], v9 offset:0
  v_mfma_f32_16x16x32_bf16 v[116:119], v[24:27], v[188:191], v[116:119]
  ds_read_b64_tr_b16 v[22:23], v9 offset:1024
  v_mfma_f32_16x16x32_bf16 v[120:123], v[28:31], v[184:187], v[120:123]
  v_xor_b32 v10, 64, v8
  ds_read_b64_tr_b16 v[24:25], v10 offset:0
  v_mfma_f32_16x16x32_bf16 v[124:127], v[28:31], v[188:191], v[124:127]
  ds_read_b64_tr_b16 v[26:27], v10 offset:1024
  s_waitcnt lgkmcnt(4)
  v_mfma_f32_16x16x32_bf16 v[64:67], v[16:19], v[192:195], v[64:67]
  v_xor_b32 v11, 96, v8
  ds_read_b64_tr_b16 v[28:29], v11 offset:0
  v_mfma_f32_16x16x32_bf16 v[68:71], v[16:19], v[196:199], v[68:71]
  ds_read_b64_tr_b16 v[30:31], v11 offset:1024
  s_waitcnt lgkmcnt(4)
  v_mfma_f32_16x16x32_bf16 v[72:75], v[20:23], v[192:195], v[72:75]
  v_xor_b32 v136, 128, v8
  ds_read_b64_tr_b16 v[16:17], v136 offset:0
  v_mfma_f32_16x16x32_bf16 v[76:79], v[20:23], v[196:199], v[76:79]
  ds_read_b64_tr_b16 v[18:19], v136 offset:1024
  s_waitcnt lgkmcnt(4)
  v_mfma_f32_16x16x32_bf16 v[80:83], v[24:27], v[192:195], v[80:83]
  v_xor_b32 v137, 160, v8
  ds_read_b64_tr_b16 v[20:21], v137 offset:0
  v_mfma_f32_16x16x32_bf16 v[84:87], v[24:27], v[196:199], v[84:87]
  ds_read_b64_tr_b16 v[22:23], v137 offset:1024
  s_waitcnt lgkmcnt(4)
  v_mfma_f32_16x16x32_bf16 v[88:91], v[28:31], v[192:195], v[88:91]
  v_xor_b32 v138, 192, v8
  ds_read_b64_tr_b16 v[24:25], v138 offset:0
  v_mfma_f32_16x16x32_bf16 v[92:95], v[28:31], v[196:199], v[92:95]
  ds_read_b64_tr_b16 v[26:27], v138 offset:1024
  s_waitcnt lgkmcnt(4)
  v_mfma_f32_16x16x32_bf16 v[96:99], v[16:19], v[192:195], v[96:99]
  v_xor_b32 v139, 224, v8
  ds_read_b64_tr_b16 v[28:29], v139 offset:0
  v_mfma_f32_16x16x32_bf16 v[100:103], v[16:19], v[196:199], v[100:103]
  ds_read_b64_tr_b16 v[30:31], v139 offset:1024
  s_waitcnt lgkmcnt(4)
  v_mfma_f32_16x16x32_bf16 v[104:107], v[20:23], v[192:195], v[104:107]
  ds_read_b64_tr_b16 v[16:17], v8 offset:8192
  v_mfma_f32_16x16x32_bf16 v[108:111], v[20:23], v[196:199], v[108:111]
  ds_read_b64_tr_b16 v[18:19], v8 offset:9216
  s_waitcnt lgkmcnt(4)
  v_mfma_f32_16x16x32_bf16 v[112:115], v[24:27], v[192:195], v[112:115]
  ds_read_b64_tr_b16 v[20:21], v9 offset:8192
  v_mfma_f32_16x16x32_bf16 v[116:119], v[24:27], v[196:199], v[116:119]
  ds_read_b64_tr_b16 v[22:23], v9 offset:9216
  s_waitcnt lgkmcnt(4)
  v_mfma_f32_16x16x32_bf16 v[120:123], v[28:31], v[192:195], v[120:123]
  ds_read_b64_tr_b16 v[24:25], v10 offset:8192
  v_mfma_f32_16x16x32_bf16 v[124:127], v[28:31], v[196:199], v[124:127]
  ds_read_b64_tr_b16 v[26:27], v10 offset:9216
  s_waitcnt lgkmcnt(4)
  v_mfma_f32_16x16x32_bf16 v[64:67], v[16:19], v[200:203], v[64:67]
  ds_read_b64_tr_b16 v[28:29], v11 offset:8192
  v_mfma_f32_16x16x32_bf16 v[68:71], v[16:19], v[204:207], v[68:71]
  ds_read_b64_tr_b16 v[30:31], v11 offset:9216
  s_waitcnt lgkmcnt(4)
  v_mfma_f32_16x16x32_bf16 v[72:75], v[20:23], v[200:203], v[72:75]
  ds_read_b64_tr_b16 v[16:17], v136 offset:8192
  v_mfma_f32_16x16x32_bf16 v[76:79], v[20:23], v[204:207], v[76:79]
  ds_read_b64_tr_b16 v[18:19], v136 offset:9216
  s_waitcnt lgkmcnt(4)
  v_mfma_f32_16x16x32_bf16 v[80:83], v[24:27], v[200:203], v[80:83]
  ds_read_b64_tr_b16 v[20:21], v137 offset:8192
  v_mfma_f32_16x16x32_bf16 v[84:87], v[24:27], v[204:207], v[84:87]
  ds_read_b64_tr_b16 v[22:23], v137 offset:9216
  s_waitcnt lgkmcnt(4)
  v_mfma_f32_16x16x32_bf16 v[88:91], v[28:31], v[200:203], v[88:91]
  ds_read_b64_tr_b16 v[24:25], v138 offset:8192
  v_mfma_f32_16x16x32_bf16 v[92:95], v[28:31], v[204:207], v[92:95]
  ds_read_b64_tr_b16 v[26:27], v138 offset:9216
  s_waitcnt lgkmcnt(4)
  v_mfma_f32_16x16x32_bf16 v[96:99], v[16:19], v[200:203], v[96:99]
  ds_read_b64_tr_b16 v[28:29], v139 offset:8192
  v_mfma_f32_16x16x32_bf16 v[100:103], v[16:19], v[204:207], v[100:103]
  ds_read_b64_tr_b16 v[30:31], v139 offset:9216
  s_and_b32 s50, s66, 15
  s_lshr_b64 s[66:67], s[66:67], 4
  s_lshl_b32 s50, s50, 14
  v_add_u32 v8, s50, v5
  s_waitcnt lgkmcnt(4)
  v_mfma_f32_16x16x32_bf16 v[104:107], v[20:23], v[200:203], v[104:107]
  v_mfma_f32_16x16x32_bf16 v[108:111], v[20:23], v[204:207], v[108:111]
  s_waitcnt lgkmcnt(0)
  s_barrier
  ds_read_b64_tr_b16 v[16:17], v8 offset:0
  ds_read_b64_tr_b16 v[18:19], v8 offset:1024
  v_mfma_f32_16x16x32_bf16 v[112:115], v[24:27], v[200:203], v[112:115]
  v_xor_b32 v9, 32, v8
  ds_read_b64_tr_b16 v[20:21], v9 offset:0
  v_mfma_f32_16x16x32_bf16 v[116:119], v[24:27], v[204:207], v[116:119]
  ds_read_b64_tr_b16 v[22:23], v9 offset:1024
  v_mfma_f32_16x16x32_bf16 v[120:123], v[28:31], v[200:203], v[120:123]
  v_xor_b32 v10, 64, v8
  ds_read_b64_tr_b16 v[24:25], v10 offset:0
  v_mfma_f32_16x16x32_bf16 v[124:127], v[28:31], v[204:207], v[124:127]
  ds_read_b64_tr_b16 v[26:27], v10 offset:1024
  s_waitcnt lgkmcnt(4)
  v_mfma_f32_16x16x32_bf16 v[64:67], v[16:19], v[208:211], v[64:67]
  v_xor_b32 v11, 96, v8
  ds_read_b64_tr_b16 v[28:29], v11 offset:0
  v_mfma_f32_16x16x32_bf16 v[68:71], v[16:19], v[212:215], v[68:71]
  ds_read_b64_tr_b16 v[30:31], v11 offset:1024
  s_waitcnt lgkmcnt(4)
  v_mfma_f32_16x16x32_bf16 v[72:75], v[20:23], v[208:211], v[72:75]
  v_xor_b32 v136, 128, v8
  ds_read_b64_tr_b16 v[16:17], v136 offset:0
  v_mfma_f32_16x16x32_bf16 v[76:79], v[20:23], v[212:215], v[76:79]
  ds_read_b64_tr_b16 v[18:19], v136 offset:1024
  s_waitcnt lgkmcnt(4)
  v_mfma_f32_16x16x32_bf16 v[80:83], v[24:27], v[208:211], v[80:83]
  v_xor_b32 v137, 160, v8
  ds_read_b64_tr_b16 v[20:21], v137 offset:0
  v_mfma_f32_16x16x32_bf16 v[84:87], v[24:27], v[212:215], v[84:87]
  ds_read_b64_tr_b16 v[22:23], v137 offset:1024
  s_waitcnt lgkmcnt(4)
  v_mfma_f32_16x16x32_bf16 v[88:91], v[28:31], v[208:211], v[88:91]
  v_xor_b32 v138, 192, v8
  ds_read_b64_tr_b16 v[24:25], v138 offset:0
  v_mfma_f32_16x16x32_bf16 v[92:95], v[28:31], v[212:215], v[92:95]
  ds_read_b64_tr_b16 v[26:27], v138 offset:1024
  s_waitcnt lgkmcnt(4)
  v_mfma_f32_16x16x32_bf16 v[96:99], v[16:19], v[208:211], v[96:99]
  v_xor_b32 v139, 224, v8
  ds_read_b64_tr_b16 v[28:29], v139 offset:0
  v_mfma_f32_16x16x32_bf16 v[100:103], v[16:19], v[212:215], v[100:103]
  ds_read_b64_tr_b16 v[30:31], v139 offset:1024
  s_waitcnt lgkmcnt(4)
  v_mfma_f32_16x16x32_bf16 v[104:107], v[20:23], v[208:211], v[104:107]
  ds_read_b64_tr_b16 v[16:17], v8 offset:8192
  v_mfma_f32_16x16x32_bf16 v[108:111], v[20:23], v[212:215], v[108:111]
  ds_read_b64_tr_b16 v[18:19], v8 offset:9216
  s_waitcnt lgkmcnt(4)
  v_mfma_f32_16x16x32_bf16 v[112:115], v[24:27], v[208:211], v[112:115]
  ds_read_b64_tr_b16 v[20:21], v9 offset:8192
  v_mfma_f32_16x16x32_bf16 v[116:119], v[24:27], v[212:215], v[116:119]
  ds_read_b64_tr_b16 v[22:23], v9 offset:9216
  s_waitcnt lgkmcnt(4)
  v_mfma_f32_16x16x32_bf16 v[120:123], v[28:31], v[208:211], v[120:123]
  ds_read_b64_tr_b16 v[24:25], v10 offset:8192
  v_mfma_f32_16x16x32_bf16 v[124:127], v[28:31], v[212:215], v[124:127]
  ds_read_b64_tr_b16 v[26:27], v10 offset:9216
  s_waitcnt lgkmcnt(4)
  v_mfma_f32_16x16x32_bf16 v[64:67], v[16:19], v[216:219], v[64:67]
  ds_read_b64_tr_b16 v[28:29], v11 offset:8192
  v_mfma_f32_16x16x32_bf16 v[68:71], v[16:19], v[220:223], v[68:71]
  ds_read_b64_tr_b16 v[30:31], v11 offset:9216
  s_waitcnt lgkmcnt(4)
  v_mfma_f32_16x16x32_bf16 v[72:75], v[20:23], v[216:219], v[72:75]
  ds_read_b64_tr_b16 v[16:17], v136 offset:8192
  v_mfma_f32_16x16x32_bf16 v[76:79], v[20:23], v[220:223], v[76:79]
  ds_read_b64_tr_b16 v[18:19], v136 offset:9216
  s_waitcnt lgkmcnt(4)
  v_mfma_f32_16x16x32_bf16 v[80:83], v[24:27], v[216:219], v[80:83]
  ds_read_b64_tr_b16 v[20:21], v137 offset:8192
  v_mfma_f32_16x16x32_bf16 v[84:87], v[24:27], v[220:223], v[84:87]
  ds_read_b64_tr_b16 v[22:23], v137 offset:9216
  s_waitcnt lgkmcnt(4)
  v_mfma_f32_16x16x32_bf16 v[88:91], v[28:31], v[216:219], v[88:91]
  ds_read_b64_tr_b16 v[24:25], v138 offset:8192
  v_mfma_f32_16x16x32_bf16 v[92:95], v[28:31], v[220:223], v[92:95]
  ds_read_b64_tr_b16 v[26:27], v138 offset:9216
  s_waitcnt lgkmcnt(4)
  v_mfma_f32_16x16x32_bf16 v[96:99], v[16:19], v[216:219], v[96:99]
  ds_read_b64_tr_b16 v[28:29], v139 offset:8192
  v_mfma_f32_16x16x32_bf16 v[100:103], v[16:19], v[220:223], v[100:103]
  ds_read_b64_tr_b16 v[30:31], v139 offset:9216
  s_and_b32 s50, s66, 15
  s_lshr_b64 s[66:67], s[66:67], 4
  s_lshl_b32 s50, s50, 14
  v_add_u32 v8, s50, v5
  s_waitcnt lgkmcnt(4)
  v_mfma_f32_16x16x32_bf16 v[104:107], v[20:23], v[216:219], v[104:107]
  v_mfma_f32_16x16x32_bf16 v[108:111], v[20:23], v[220:223], v[108:111]
  s_waitcnt lgkmcnt(0)
  s_barrier
  ds_read_b64_tr_b16 v[16:17], v8 offset:0
  ds_read_b64_tr_b16 v[18:19], v8 offset:1024
  v_mfma_f32_16x16x32_bf16 v[112:115], v[24:27], v[216:219], v[112:115]
  v_xor_b32 v9, 32, v8
  ds_read_b64_tr_b16 v[20:21], v9 offset:0
  v_mfma_f32_16x16x32_bf16 v[116:119], v[24:27], v[220:223], v[116:119]
  ds_read_b64_tr_b16 v[22:23], v9 offset:1024
  v_mfma_f32_16x16x32_bf16 v[120:123], v[28:31], v[216:219], v[120:123]
  v_xor_b32 v10, 64, v8
  ds_read_b64_tr_b16 v[24:25], v10 offset:0
  v_mfma_f32_16x16x32_bf16 v[124:127], v[28:31], v[220:223], v[124:127]
  ds_read_b64_tr_b16 v[26:27], v10 offset:1024
  s_waitcnt lgkmcnt(4)
  v_mfma_f32_16x16x32_bf16 v[64:67], v[16:19], v[224:227], v[64:67]
  v_xor_b32 v11, 96, v8
  ds_read_b64_tr_b16 v[28:29], v11 offset:0
  v_mfma_f32_16x16x32_bf16 v[68:71], v[16:19], v[228:231], v[68:71]
  ds_read_b64_tr_b16 v[30:31], v11 offset:1024
  s_waitcnt lgkmcnt(4)
  v_mfma_f32_16x16x32_bf16 v[72:75], v[20:23], v[224:227], v[72:75]
  v_xor_b32 v136, 128, v8
  ds_read_b64_tr_b16 v[16:17], v136 offset:0
  v_mfma_f32_16x16x32_bf16 v[76:79], v[20:23], v[228:231], v[76:79]
  ds_read_b64_tr_b16 v[18:19], v136 offset:1024
  s_waitcnt lgkmcnt(4)
  v_mfma_f32_16x16x32_bf16 v[80:83], v[24:27], v[224:227], v[80:83]
  v_xor_b32 v137, 160, v8
  ds_read_b64_tr_b16 v[20:21], v137 offset:0
  v_mfma_f32_16x16x32_bf16 v[84:87], v[24:27], v[228:231], v[84:87]
  ds_read_b64_tr_b16 v[22:23], v137 offset:1024
  s_waitcnt lgkmcnt(4)
  v_mfma_f32_16x16x32_bf16 v[88:91], v[28:31], v[224:227], v[88:91]
  v_xor_b32 v138, 192, v8
  ds_read_b64_tr_b16 v[24:25], v138 offset:0
  v_mfma_f32_16x16x32_bf16 v[92:95], v[28:31], v[228:231], v[92:95]
  ds_read_b64_tr_b16 v[26:27], v138 offset:1024
  s_waitcnt lgkmcnt(4)
  v_mfma_f32_16x16x32_bf16 v[96:99], v[16:19], v[224:227], v[96:99]
  v_xor_b32 v139, 224, v8
  ds_read_b64_tr_b16 v[28:29], v139 offset:0
  v_mfma_f32_16x16x32_bf16 v[100:103], v[16:19], v[228:231], v[100:103]
  ds_read_b64_tr_b16 v[30:31], v139 offset:1024
  s_waitcnt lgkmcnt(4)
  v_mfma_f32_16x16x32_bf16 v[104:107], v[20:23], v[224:227], v[104:107]
  ds_read_b64_tr_b16 v[16:17], v8 offset:8192
  v_mfma_f32_16x16x32_bf16 v[108:111], v[20:23], v[228:231], v[108:111]
  ds_read_b64_tr_b16 v[18:19], v8 offset:9216
  s_waitcnt lgkmcnt(4)
  v_mfma_f32_16x16x32_bf16 v[112:115], v[24:27], v[224:227], v[112:115]
  ds_read_b64_tr_b16 v[20:21], v9 offset:8192
  v_mfma_f32_16x16x32_bf16 v[116:119], v[24:27], v[228:231], v[116:119]
  ds_read_b64_tr_b16 v[22:23], v9 offset:9216
  s_waitcnt lgkmcnt(4)
  v_mfma_f32_16x16x32_bf16 v[120:123], v[28:31], v[224:227], v[120:123]
  ds_read_b64_tr_b16 v[24:25], v10 offset:8192
  v_mfma_f32_16x16x32_bf16 v[124:127], v[28:31], v[228:231], v[124:127]
  ds_read_b64_tr_b16 v[26:27], v10 offset:9216
  s_waitcnt lgkmcnt(4)
  v_mfma_f32_16x16x32_bf16 v[64:67], v[16:19], v[232:235], v[64:67]
  ds_read_b64_tr_b16 v[28:29], v11 offset:8192
  v_mfma_f32_16x16x32_bf16 v[68:71], v[16:19], v[236:239], v[68:71]
  ds_read_b64_tr_b16 v[30:31], v11 offset:9216
  s_waitcnt lgkmcnt(4)
  v_mfma_f32_16x16x32_bf16 v[72:75], v[20:23], v[232:235], v[72:75]
  ds_read_b64_tr_b16 v[16:17], v136 offset:8192
  v_mfma_f32_16x16x32_bf16 v[76:79], v[20:23], v[236:239], v[76:79]
  ds_read_b64_tr_b16 v[18:19], v136 offset:9216
  s_waitcnt lgkmcnt(4)
  v_mfma_f32_16x16x32_bf16 v[80:83], v[24:27], v[232:235], v[80:83]
  ds_read_b64_tr_b16 v[20:21], v137 offset:8192
  v_mfma_f32_16x16x32_bf16 v[84:87], v[24:27], v[236:239], v[84:87]
  ds_read_b64_tr_b16 v[22:23], v137 offset:9216
  s_waitcnt lgkmcnt(4)
  v_mfma_f32_16x16x32_bf16 v[88:91], v[28:31], v[232:235], v[88:91]
  ds_read_b64_tr_b16 v[24:25], v138 offset:8192
  v_mfma_f32_16x16x32_bf16 v[92:95], v[28:31], v[236:239], v[92:95]
  ds_read_b64_tr_b16 v[26:27], v138 offset:9216
  s_waitcnt lgkmcnt(4)
  v_mfma_f32_16x16x32_bf16 v[96:99], v[16:19], v[232:235], v[96:99]
  ds_read_b64_tr_b16 v[28:29], v139 offset:8192
  v_mfma_f32_16x16x32_bf16 v[100:103], v[16:19], v[236:239], v[100:103]
  ds_read_b64_tr_b16 v[30:31], v139 offset:9216
  s_and_b32 s50, s66, 15
  s_lshr_b64 s[66:67], s[66:67], 4
  s_lshl_b32 s50, s50, 14
  v_add_u32 v8, s50, v5
  s_waitcnt lgkmcnt(4)
  v_mfma_f32_16x16x32_bf16 v[104:107], v[20:23], v[232:235], v[104:107]
  v_mfma_f32_16x16x32_bf16 v[108:111], v[20:23], v[236:239], v[108:111]
  s_waitcnt lgkmcnt(0)
  s_barrier
  ds_read_b64_tr_b16 v[16:17], v8 offset:0
  ds_read_b64_tr_b16 v[18:19], v8 offset:1024
  v_mfma_f32_16x16x32_bf16 v[112:115], v[24:27], v[232:235], v[112:115]
  ds_read_b64_tr_b16 v[20:21], v8 offset:8192
  v_mfma_f32_16x16x32_bf16 v[116:119], v[24:27], v[236:239], v[116:119]
  ds_read_b64_tr_b16 v[22:23], v8 offset:9216
  v_mfma_f32_16x16x32_bf16 v[120:123], v[28:31], v[232:235], v[120:123]
  v_xor_b32 v10, 32, v8
  ds_read_b64_tr_b16 v[24:25], v10 offset:0
  v_mfma_f32_16x16x32_bf16 v[124:127], v[28:31], v[236:239], v[124:127]
  ds_read_b64_tr_b16 v[26:27], v10 offset:1024
  s_waitcnt lgkmcnt(4)
  v_mfma_f32_16x16x32_bf16 v[64:67], v[16:19], v[240:243], v[64:67]
  ds_read_b64_tr_b16 v[28:29], v10 offset:8192
  v_mfma_f32_16x16x32_bf16 v[68:71], v[16:19], v[244:247], v[68:71]
  ds_read_b64_tr_b16 v[30:31], v10 offset:9216
  s_waitcnt lgkmcnt(4)
  v_mfma_f32_16x16x32_bf16 v[64:67], v[20:23], v[248:251], v[64:67]
  v_xor_b32 v9, 64, v8
  ds_read_b64_tr_b16 v[16:17], v9 offset:0
  v_mfma_f32_16x16x32_bf16 v[68:71], v[20:23], v[252:255], v[68:71]
  ds_read_b64_tr_b16 v[18:19], v9 offset:1024
  s_waitcnt lgkmcnt(4)
  v_mfma_f32_16x16x32_bf16 v[72:75], v[24:27], v[240:243], v[72:75]
  ds_read_b64_tr_b16 v[20:21], v9 offset:8192
  v_mfma_f32_16x16x32_bf16 v[76:79], v[24:27], v[244:247], v[76:79]
  ds_read_b64_tr_b16 v[22:23], v9 offset:9216
  s_waitcnt lgkmcnt(4)
  s_branch L_pads5
L_pad5:
  s_setpc_b64 s[60:61]
L_pads5:
  v_mfma_f32_16x16x32_bf16 v[72:75], v[28:31], v[248:251], v[72:75]
  v_xor_b32 v10, 96, v8
  ds_read_b64_tr_b16 v[24:25], v10 offset:0
  v_mfma_f32_16x16x32_bf16 v[76:79], v[28:31], v[252:255], v[76:79]
  ds_read_b64_tr_b16 v[26:27], v10 offset:1024
  s_waitcnt lgkmcnt(4)
  v_mfma_f32_16x16x32_bf16 v[80:83], v[16:19], v[240:243], v[80:83]
  ds_read_b64_tr_b16 v[28:29], v10 offset:8192
  v_mfma_f32_16x16x32_bf16 v[84:87], v[16:19], v[244:247], v[84:87]
  ds_read_b64_tr_b16 v[30:31], v10 offset:9216
  s_waitcnt lgkmcnt(4)
  v_mfma_f32_16x16x32_bf16 v[80:83], v[20:23], v[248:251], v[80:83]
  v_xor_b32 v9, 128, v8
  ds_read_b64_tr_b16 v[16:17], v9 offset:0
  v_mfma_f32_16x16x32_bf16 v[84:87], v[20:23], v[252:255], v[84:87]
  ds_read_b64_tr_b16 v[18:19], v9 offset:1024
  s_waitcnt lgkmcnt(4)
  v_mfma_f32_16x16x32_bf16 v[88:91], v[24:27], v[240:243], v[88:91]
  ds_read_b64_tr_b16 v[20:21], v9 offset:8192
  v_mfma_f32_16x16x32_bf16 v[92:95], v[24:27], v[244:247], v[92:95]
  ds_read_b64_tr_b16 v[22:23], v9 offset:9216
  s_waitcnt lgkmcnt(4)
  v_mfma_f32_16x16x32_bf16 v[88:91], v[28:31], v[248:251], v[88:91]
  v_xor_b32 v10, 160, v8
  ds_read_b64_tr_b16 v[24:25], v10 offset:0
  v_mul_f32 v64, s72, v64
  v_mul_f32 v65, s72, v65
  v_mul_f32 v66, s72, v66
  v_mfma_f32_16x16x32_bf16 v[92:95], v[28:31], v[252:255], v[92:95]
  ds_read_b64_tr_b16 v[26:27], v10 offset:1024
  v_mul_f32 v67, s72, v67
  v_mul_f32 v68, s72, v68
  s_waitcnt lgkmcnt(4)
  v_mfma_f32_16x16x32_bf16 v[96:99], v[16:19], v[240:243], v[96:99]
  ds_read_b64_tr_b16 v[28:29], v10 offset:8192
  v_mul_f32 v69, s72, v69
  v_mul_f32 v70, s72, v70
  v_mul_f32 v71, s72, v71
  v_mul_f32 v72, s72, v72
  v_mfma_f32_16x16x32_bf16 v[100:103], v[16:19], v[244:247], v[100:103]
  ds_read_b64_tr_b16 v[30:31], v10 offset:9216
  v_mul_f32 v73, s72, v73
  v_mul_f32 v74, s72, v74
  s_waitcnt lgkmcnt(4)
  v_mfma_f32_16x16x32_bf16 v[96:99], v[20:23], v[248:251], v[96:99]
  v_xor_b32 v9, 192, v8
  ds_read_b64_tr_b16 v[16:17], v9 offset:0
  v_mul_f32 v75, s72, v75
  v_mul_f32 v76, s72, v76
  v_mul_f32 v77, s72, v77
  v_mfma_f32_16x16x32_bf16 v[100:103], v[20:23], v[252:255], v[100:103]
  ds_read_b64_tr_b16 v[18:19], v9 offset:1024
  v_mul_f32 v78, s72, v78
  v_mul_f32 v79, s72, v79
  v_cvt_pk_bf16_f32 v64, v64, v65
  s_waitcnt lgkmcnt(4)
  v_mfma_f32_16x16x32_bf16 v[104:107], v[24:27], v[240:243], v[104:107]
  ds_read_b64_tr_b16 v[20:21], v9 offset:8192
  v_cvt_pk_bf16_f32 v65, v66, v67
  v_cvt_pk_bf16_f32 v66, v72, v73
  v_cvt_pk_bf16_f32 v67, v74, v75
  v_mfma_f32_16x16x32_bf16 v[108:111], v[24:27], v[244:247], v[108:111]
  ds_read_b64_tr_b16 v[22:23], v9 offset:9216
  v_cvt_pk_bf16_f32 v68, v68, v69
  v_cvt_pk_bf16_f32 v69, v70, v71
  v_cvt_pk_bf16_f32 v70, v76, v77
  s_waitcnt lgkmcnt(4)
  v_mfma_f32_16x16x32_bf16 v[104:107], v[28:31], v[248:251], v[104:107]
  v_xor_b32 v10, 224, v8
  ds_read_b64_tr_b16 v[24:25], v10 offset:0
  v_cvt_pk_bf16_f32 v71, v78, v79
  v_permlane16_swap_b32 v64, v66
  v_mfma_f32_16x16x32_bf16 v[108:111], v[28:31], v[252:255], v[108:111]
  ds_read_b64_tr_b16 v[26:27], v10 offset:1024
  v_permlane16_swap_b32 v65, v67
  v_permlane16_swap_b32 v68, v70
  v_permlane16_swap_b32 v69, v71
  s_waitcnt lgkmcnt(4)
  v_mfma_f32_16x16x32_bf16 v[112:115], v[16:19], v[240:243], v[112:115]
  ds_read_b64_tr_b16 v[28:29], v10 offset:8192
  v_mul_f32 v80, s72, v80
  v_mul_f32 v81, s72, v81
  v_mul_f32 v82, s72, v82
  v_mfma_f32_16x16x32_bf16 v[116:119], v[16:19], v[244:247], v[116:119]
  ds_read_b64_tr_b16 v[30:31], v10 offset:9216
  v_mul_f32 v83, s72, v83
  v_mul_f32 v84, s72, v84
  s_and_b32 s50, s68, 15
  s_lshr_b64 s[68:69], s[68:69], 4
  s_lshl_b32 s50, s50, 14
  v_add_u32 v8, s50, v6
  s_waitcnt lgkmcnt(4)
  v_mfma_f32_16x16x32_bf16 v[112:115], v[20:23], v[248:251], v[112:115]
  v_mul_f32 v85, s72, v85
  v_mul_f32 v86, s72, v86
  v_mul_f32 v87, s72, v87
  v_mul_f32 v88, s72, v88
  v_mfma_f32_16x16x32_bf16 v[116:119], v[20:23], v[252:255], v[116:119]
  v_mul_f32 v89, s72, v89
  v_mul_f32 v90, s72, v90
  s_waitcnt lgkmcnt(0)
  s_setprio 2
  s_barrier
  ds_read_b128 v[16:19], v8 offset:0
  v_mfma_f32_16x16x32_bf16 v[120:123], v[24:27], v[240:243], v[120:123]
  ds_read_b128 v[20:23], v8 offset:2048
  v_mul_f32 v91, s72, v91
  v_mul_f32 v92, s72, v92
  v_mul_f32 v93, s72, v93
  v_mfma_f32_16x16x32_bf16 v[124:127], v[24:27], v[244:247], v[124:127]
  v_mul_f32 v94, s72, v94
  v_mul_f32 v95, s72, v95
  v_mfma_f32_16x16x32_bf16 v[120:123], v[28:31], v[248:251], v[120:123]
  v_xor_b32 v10, 64, v8
  v_cvt_pk_bf16_f32 v72, v80, v81
  v_cvt_pk_bf16_f32 v73, v82, v83
  v_mfma_f32_16x16x32_bf16 v[124:127], v[28:31], v[252:255], v[124:127]
  ds_read_b128 v[24:27], v10 offset:0
  v_cvt_pk_bf16_f32 v74, v88, v89
  v_cvt_pk_bf16_f32 v75, v90, v91
  v_cvt_pk_bf16_f32 v76, v84, v85
  s_waitcnt lgkmcnt(2)
  v_mfma_f32_16x16x32_bf16 v[144:147], v[16:19], v[32:35], 0
  ds_read_b128 v[28:31], v10 offset:2048
  v_cvt_pk_bf16_f32 v77, v86, v87
  v_cvt_pk_bf16_f32 v78, v92, v93
  v_cvt_pk_bf16_f32 v79, v94, v95
  v_mfma_f32_16x16x32_bf16 v[148:151], v[16:19], v[36:39], 0
  v_permlane16_swap_b32 v72, v74
  v_permlane16_swap_b32 v73, v75
  v_permlane16_swap_b32 v76, v78
  v_permlane16_swap_b32 v77, v79
  s_waitcnt lgkmcnt(2)
  v_mfma_f32_16x16x32_bf16 v[152:155], v[20:23], v[32:35], 0
  v_xor_b32 v9, 128, v8
  v_mul_f32 v96, s72, v96
  v_mul_f32 v97, s72, v97
  v_mul_f32 v98, s72, v98
  v_mfma_f32_16x16x32_bf16 v[156:159], v[20:23], v[36:39], 0
  ds_read_b128 v[16:19], v9 offset:0
  v_mul_f32 v99, s72, v99
  v_mul_f32 v100, s72, v100
  s_waitcnt lgkmcnt(1)
  v_mfma_f32_16x16x32_bf16 v[144:147], v[24:27], v[40:43], v[144:147]
  ds_read_b128 v[20:23], v9 offset:2048
  v_mul_f32 v101, s72, v101
  v_mul_f32 v102, s72, v102
  v_mfma_f32_16x16x32_bf16 v[148:151], v[24:27], v[44:47], v[148:151]
  v_mul_f32 v103, s72, v103
  v_mul_f32 v104, s72, v104
  v_mul_f32 v105, s72, v105
  v_mul_f32 v106, s72, v106
  v_mfma_f32_16x16x32_bf16 v[152:155], v[28:31], v[40:43], v[152:155]
  v_xor_b32 v10, 192, v8
  v_mul_f32 v107, s72, v107
  v_mul_f32 v108, s72, v108
  v_mul_f32 v109, s72, v109
  v_mfma_f32_16x16x32_bf16 v[156:159], v[28:31], v[44:47], v[156:159]
  ds_read_b128 v[24:27], v10 offset:0
  v_mul_f32 v110, s72, v110
  v_mul_f32 v111, s72, v111
  s_waitcnt lgkmcnt(1)
  v_mfma_f32_16x16x32_bf16 v[144:147], v[16:19], v[48:51], v[144:147]
  ds_read_b128 v[28:31], v10 offset:2048
  v_cvt_pk_bf16_f32 v80, v96, v97
  v_cvt_pk_bf16_f32 v81, v98, v99
  v_cvt_pk_bf16_f32 v82, v104, v105
  v_mfma_f32_16x16x32_bf16 v[148:151], v[16:19], v[52:55], v[148:151]
  v_cvt_pk_bf16_f32 v83, v106, v107
  v_cvt_pk_bf16_f32 v84, v100, v101
  v_cvt_pk_bf16_f32 v85, v102, v103
  v_mfma_f32_16x16x32_bf16 v[152:155], v[20:23], v[48:51], v[152:155]
  ds_read_b128 v[16:19], v8 offset:256
  v_cvt_pk_bf16_f32 v86, v108, v109
  v_cvt_pk_bf16_f32 v87, v110, v111
  v_permlane16_swap_b32 v80, v82
  v_mfma_f32_16x16x32_bf16 v[156:159], v[20:23], v[52:55], v[156:159]
  v_permlane16_swap_b32 v81, v83
  v_permlane16_swap_b32 v84, v86
  v_permlane16_swap_b32 v85, v87
  s_waitcnt lgkmcnt(1)
  v_mfma_f32_16x16x32_bf16 v[144:147], v[24:27], v[56:59], v[144:147]
  ds_read_b128 v[20:23], v8 offset:2304
  v_mul_f32 v112, s72, v112
  v_mul_f32 v113, s72, v113
  v_mul_f32 v114, s72, v114
  v_mfma_f32_16x16x32_bf16 v[148:151], v[24:27], v[60:63], v[148:151]
  v_mul_f32 v115, s72, v115
  v_mul_f32 v116, s72, v116
  v_mul_f32 v117, s72, v117
  v_mfma_f32_16x16x32_bf16 v[152:155], v[28:31], v[56:59], v[152:155]
  v_xor_b32 v10, 64, v8
  v_mul_f32 v118, s72, v118
  v_mul_f32 v119, s72, v119
  v_mul_f32 v120, s72, v120
  v_mfma_f32_16x16x32_bf16 v[156:159], v[28:31], v[60:63], v[156:159]
  ds_read_b128 v[24:27], v10 offset:256
  v_mul_f32 v121, s72, v121
  v_mul_f32 v122, s72, v122
  s_waitcnt lgkmcnt(1)
  v_mfma_f32_16x16x32_bf16 v[144:147], v[16:19], v[64:67], v[144:147]
  ds_read_b128 v[28:31], v10 offset:2304
  v_mul_f32 v123, s72, v123
  v_mul_f32 v124, s72, v124
  v_mul_f32 v125, s72, v125
  v_mfma_f32_16x16x32_bf16 v[148:151], v[16:19], v[68:71], v[148:151]
  v_mul_f32 v126, s72, v126
  v_mul_f32 v127, s72, v127
  v_cvt_pk_bf16_f32 v88, v112, v113
  v_mfma_f32_16x16x32_bf16 v[152:155], v[20:23], v[64:67], v[152:155]
  v_xor_b32 v9, 128, v8
  v_cvt_pk_bf16_f32 v89, v114, v115
  v_cvt_pk_bf16_f32 v90, v120, v121
  v_cvt_pk_bf16_f32 v91, v122, v123
  v_mfma_f32_16x16x32_bf16 v[156:159], v[20:23], v[68:71], v[156:159]
  ds_read_b128 v[16:19], v9 offset:256
  v_cvt_pk_bf16_f32 v92, v116, v117
  v_cvt_pk_bf16_f32 v93, v118, v119
  s_waitcnt lgkmcnt(1)
  v_mfma_f32_16x16x32_bf16 v[144:147], v[24:27], v[72:75], v[144:147]
  ds_read_b128 v[20:23], v9 offset:2304
  v_cvt_pk_bf16_f32 v94, v124, v125
  v_cvt_pk_bf16_f32 v95, v126, v127
  v_mfma_f32_16x16x32_bf16 v[148:151], v[24:27], v[76:79], v[148:151]
  v_permlane16_swap_b32 v88, v90
  v_permlane16_swap_b32 v89, v91
  v_permlane16_swap_b32 v92, v94
  v_permlane16_swap_b32 v93, v95
  v_mfma_f32_16x16x32_bf16 v[152:155], v[28:31], v[72:75], v[152:155]
  v_xor_b32 v10, 192, v8
  v_mfma_f32_16x16x32_bf16 v[156:159], v[28:31], v[76:79], v[156:159]
  ds_read_b128 v[24:27], v10 offset:256
  s_waitcnt lgkmcnt(1)
  v_mfma_f32_16x16x32_bf16 v[144:147], v[16:19], v[80:83], v[144:147]
  ds_read_b128 v[28:31], v10 offset:2304
  v_mfma_f32_16x16x32_bf16 v[148:151], v[16:19], v[84:87], v[148:151]
  s_and_b32 s50, s68, 15
  s_lshr_b64 s[68:69], s[68:69], 4
  s_lshl_b32 s50, s50, 14
  v_add_u32 v8, s50, v6
  v_mfma_f32_16x16x32_bf16 v[152:155], v[20:23], v[80:83], v[152:155]
  v_mfma_f32_16x16x32_bf16 v[156:159], v[20:23], v[84:87], v[156:159]
  s_waitcnt lgkmcnt(0)
L_join:
  s_barrier
  ds_read_b128 v[16:19], v8 offset:0
  v_mfma_f32_16x16x32_bf16 v[144:147], v[24:27], v[88:91], v[144:147]
  ds_read_b128 v[20:23], v8 offset:2048
  v_mfma_f32_16x16x32_bf16 v[148:151], v[24:27], v[92:95], v[148:151]
  v_mfma_f32_16x16x32_bf16 v[152:155], v[28:31], v[88:91], v[152:155]
  ds_read_b128 v[24:27], v8 offset:256
  v_mfma_f32_16x16x32_bf16 v[156:159], v[28:31], v[92:95], v[156:159]
  s_waitcnt lgkmcnt(2)
  v_mfma_f32_16x16x32_bf16 v[112:115], v[16:19], v[32:35], 0
  ds_read_b128 v[28:31], v8 offset:2304
  v_mfma_f32_16x16x32_bf16 v[116:119], v[16:19], v[36:39], 0
  s_waitcnt lgkmcnt(2)
  v_mfma_f32_16x16x32_bf16 v[120:123], v[20:23], v[32:35], 0
  v_xor_b32 v10, 64, v8
  v_mfma_f32_16x16x32_bf16 v[124:127], v[20:23], v[36:39], 0
  ds_read_b128 v[16:19], v10 offset:0
  s_waitcnt lgkmcnt(1)
  v_mfma_f32_16x16x32_bf16 v[112:115], v[24:27], v[64:67], v[112:115]
  ds_read_b128 v[20:23], v10 offset:2048
  v_max3_f32 v12, v144, v145, v146
  v_max3_f32 v7, v148, v149, v150
  v_max3_f32 v12, v12, v147, v152
  v_mfma_f32_16x16x32_bf16 v[116:119], v[24:27], v[68:71], v[116:119]
  v_max3_f32 v7, v7, v151, v156
  v_max3_f32 v12, v12, v153, v154
  v_max3_f32 v7, v7, v157, v158
  v_max_f32 v12, v12, v155
  v_mfma_f32_16x16x32_bf16 v[120:123], v[28:31], v[64:67], v[120:123]
  ds_read_b128 v[24:27], v10 offset:256
  v_max_f32 v7, v7, v159
  v_mfma_f32_16x16x32_bf16 v[124:127], v[28:31], v[68:71], v[124:127]
  v_mov_b32 v3, v12
  s_nop 1
  v_permlane16_swap_b32 v12, v3
  v_max_f32 v12, v12, v3
  v_mov_b32 v3, v12
  s_nop 1
  v_permlane32_swap_b32 v12, v3
  v_max_f32 v12, v12, v3
  s_waitcnt lgkmcnt(1)
  v_mfma_f32_16x16x32_bf16 v[112:115], v[16:19], v[40:43], v[112:115]
  ds_read_b128 v[28:31], v10 offset:2304
  v_mfma_f32_16x16x32_bf16 v[116:119], v[16:19], v[44:47], v[116:119]
  v_mov_b32 v3, v7
  s_nop 1
  v_permlane16_swap_b32 v7, v3
  v_max_f32 v7, v7, v3
  v_mov_b32 v3, v7
  s_nop 1
  v_permlane32_swap_b32 v7, v3
  v_max_f32 v7, v7, v3
  v_sub_f32 v248, 0, v12
  v_mfma_f32_16x16x32_bf16 v[120:123], v[20:23], v[40:43], v[120:123]
  v_xor_b32 v9, 128, v8
  v_sub_f32 v249, 0, v12
  v_sub_f32 v250, 0, v12
  v_mfma_f32_16x16x32_bf16 v[124:127], v[20:23], v[44:47], v[124:127]
  ds_read_b128 v[16:19], v9 offset:0
  v_sub_f32 v251, 0, v12
  v_sub_f32 v252, 0, v7
  s_waitcnt lgkmcnt(1)
  v_mfma_f32_16x16x32_bf16 v[112:115], v[24:27], v[72:75], v[112:115]
  ds_read_b128 v[20:23], v9 offset:2048
  v_sub_f32 v253, 0, v7
  v_sub_f32 v254, 0, v7
  v_sub_f32 v255, 0, v7
  v_mfma_f32_16x16x32_bf16 v[116:119], v[24:27], v[76:79], v[116:119]
  v_add_f32 v144, v248, v144
  v_add_f32 v145, v248, v145
  v_add_f32 v146, v248, v146
  v_add_f32 v147, v248, v147
  v_mfma_f32_16x16x32_bf16 v[120:123], v[28:31], v[72:75], v[120:123]
  ds_read_b128 v[24:27], v9 offset:256
  v_add_f32 v152, v248, v152
  v_add_f32 v153, v248, v153
  v_mfma_f32_16x16x32_bf16 v[124:127], v[28:31], v[76:79], v[124:127]
  v_add_f32 v154, v248, v154
  v_add_f32 v155, v248, v155
  v_add_f32 v148, v252, v148
  s_waitcnt lgkmcnt(1)
  v_mfma_f32_16x16x32_bf16 v[112:115], v[16:19], v[48:51], v[112:115]
  ds_read_b128 v[28:31], v9 offset:2304
  v_add_f32 v149, v252, v149
  v_add_f32 v150, v252, v150
  v_add_f32 v151, v252, v151
  v_mfma_f32_16x16x32_bf16 v[116:119], v[16:19], v[52:55], v[116:119]
  v_add_f32 v156, v252, v156
  v_add_f32 v157, v252, v157
  v_add_f32 v158, v252, v158
  v_add_f32 v159, v252, v159
  v_mfma_f32_16x16x32_bf16 v[120:123], v[20:23], v[48:51], v[120:123]
  v_xor_b32 v10, 192, v8
  v_exp_f32 v144, v144
  v_mfma_f32_16x16x32_bf16 v[124:127], v[20:23], v[52:55], v[124:127]
  ds_read_b128 v[16:19], v10 offset:0
  v_exp_f32 v145, v145
  s_waitcnt lgkmcnt(1)
  v_mfma_f32_16x16x32_bf16 v[112:115], v[24:27], v[80:83], v[112:115]
  ds_read_b128 v[20:23], v10 offset:2048
  v_exp_f32 v148, v148
  v_mfma_f32_16x16x32_bf16 v[116:119], v[24:27], v[84:87], v[116:119]
  v_exp_f32 v149, v149
  v_cvt_pk_bf16_f32 v128, v144, v145
  v_exp_f32 v146, v146
  v_mfma_f32_16x16x32_bf16 v[120:123], v[28:31], v[80:83], v[120:123]
  ds_read_b128 v[24:27], v10 offset:256
  v_exp_f32 v147, v147
  v_mfma_f32_16x16x32_bf16 v[124:127], v[28:31], v[84:87], v[124:127]
  v_cvt_pk_bf16_f32 v132, v148, v149
  v_exp_f32 v150, v150
  s_waitcnt lgkmcnt(1)
  v_mfma_f32_16x16x32_bf16 v[112:115], v[16:19], v[56:59], v[112:115]
  ds_read_b128 v[28:31], v10 offset:2304
  v_exp_f32 v151, v151
  v_cvt_pk_bf16_f32 v129, v146, v147
  v_mfma_f32_16x16x32_bf16 v[116:119], v[16:19], v[60:63], v[116:119]
  v_exp_f32 v152, v152
  v_exp_f32 v153, v153
  s_and_b32 s50, s68, 15
  s_lshr_b64 s[68:69], s[68:69], 4
  s_lshl_b32 s50, s50, 14
  v_add_u32 v8, s50, v6
  v_mfma_f32_16x16x32_bf16 v[120:123], v[20:23], v[56:59], v[120:123]
  v_cvt_pk_bf16_f32 v133, v150, v151
  v_exp_f32 v156, v156
  v_mfma_f32_16x16x32_bf16 v[124:127], v[20:23], v[60:63], v[124:127]
  v_exp_f32 v157, v157
  s_waitcnt lgkmcnt(0)
  s_barrier
  ds_read_b128 v[16:19], v8 offset:0
  v_mfma_f32_16x16x32_bf16 v[112:115], v[24:27], v[88:91], v[112:115]
  ds_read_b128 v[20:23], v8 offset:2048
  v_cvt_pk_bf16_f32 v130, v152, v153
  v_exp_f32 v154, v154
  v_mfma_f32_16x16x32_bf16 v[116:119], v[24:27], v[92:95], v[116:119]
  v_exp_f32 v155, v155
  v_cvt_pk_bf16_f32 v134, v156, v157
  v_mfma_f32_16x16x32_bf16 v[120:123], v[28:31], v[88:91], v[120:123]
  ds_read_b128 v[24:27], v8 offset:256
  v_exp_f32 v158, v158
  v_exp_f32 v159, v159
  v_mfma_f32_16x16x32_bf16 v[124:127], v[28:31], v[92:95], v[124:127]
  v_cvt_pk_bf16_f32 v131, v154, v155
  v_cvt_pk_bf16_f32 v135, v158, v159
  s_waitcnt lgkmcnt(2)
  v_mfma_f32_16x16x32_bf16 v[96:99], v[16:19], v[32:35], v[248:251]
  ds_read_b128 v[28:31], v8 offset:2304
  v_mfma_f32_16x16x32_bf16 v[100:103], v[16:19], v[36:39], v[252:255]
  s_waitcnt lgkmcnt(2)
  v_mfma_f32_16x16x32_bf16 v[104:107], v[20:23], v[32:35], v[248:251]
  v_xor_b32 v10, 64, v8
  v_mfma_f32_16x16x32_bf16 v[108:111], v[20:23], v[36:39], v[252:255]
  ds_read_b128 v[16:19], v10 offset:0
  s_waitcnt lgkmcnt(1)
  v_mfma_f32_16x16x32_bf16 v[96:99], v[24:27], v[64:67], v[96:99]
  ds_read_b128 v[20:23], v10 offset:2048
  v_add_f32 v112, v248, v112
  v_add_f32 v113, v248, v113
  v_mfma_f32_16x16x32_bf16 v[100:103], v[24:27], v[68:71], v[100:103]
  v_add_f32 v114, v248, v114
  v_add_f32 v115, v248, v115
  v_add_f32 v120, v248, v120
  v_add_f32 v121, v248, v121
  v_mfma_f32_16x16x32_bf16 v[104:107], v[28:31], v[64:67], v[104:107]
  ds_read_b128 v[24:27], v10 offset:256
  v_add_f32 v122, v248, v122
  v_add_f32 v123, v248, v123
  v_mfma_f32_16x16x32_bf16 v[108:111], v[28:31], v[68:71], v[108:111]
  v_add_f32 v116, v252, v116
  v_add_f32 v117, v252, v117
  s_waitcnt lgkmcnt(1)
  v_mfma_f32_16x16x32_bf16 v[96:99], v[16:19], v[40:43], v[96:99]
  ds_read_b128 v[28:31], v10 offset:2304
  v_add_f32 v118, v252, v118
  v_add_f32 v119, v252, v119
  v_mfma_f32_16x16x32_bf16 v[100:103], v[16:19], v[44:47], v[100:103]
  v_add_f32 v124, v252, v124
  v_add_f32 v125, v252, v125
  v_add_f32 v126, v252, v126
  v_add_f32 v127, v252, v127
  v_mfma_f32_16x16x32_bf16 v[104:107], v[20:23], v[40:43], v[104:107]
  v_xor_b32 v9, 128, v8
  v_max3_f32 v12, v112, v113, v114
  v_max3_f32 v7, v115, v116, v117
  v_mfma_f32_16x16x32_bf16 v[108:111], v[20:23], v[44:47], v[108:111]
  ds_read_b128 v[16:19], v9 offset:0
  v_max3_f32 v12, v12, v118, v119
  s_waitcnt lgkmcnt(1)
  v_mfma_f32_16x16x32_bf16 v[96:99], v[24:27], v[72:75], v[96:99]
  ds_read_b128 v[20:23], v9 offset:2048
  v_max3_f32 v7, v7, v120, v121
  v_max3_f32 v12, v12, v122, v123
  v_mfma_f32_16x16x32_bf16 v[100:103], v[24:27], v[76:79], v[100:103]
  v_max3_f32 v7, v7, v124, v125
  v_max3_f32 v12, v12, v126, v127
  v_mfma_f32_16x16x32_bf16 v[104:107], v[28:31], v[72:75], v[104:107]
  ds_read_b128 v[24:27], v9 offset:256
  v_max_f32 v3, v12, v7
  v_cmp_lt_f32 vcc, 0x41a00000, v3
  s_mov_b32 s82, 1
  s_nop 0
  s_cbranch_vccz L_ok_1
  s_call_b64 s[60:61], L_rescue
L_ok_1:
  v_mfma_f32_16x16x32_bf16 v[108:111], v[28:31], v[76:79], v[108:111]
  v_exp_f32 v112, v112
  s_waitcnt lgkmcnt(1)
  v_mfma_f32_16x16x32_bf16 v[96:99], v[16:19], v[48:51], v[96:99]
  ds_read_b128 v[28:31], v9 offset:2304
  v_exp_f32 v113, v113
  v_mfma_f32_16x16x32_bf16 v[100:103], v[16:19], v[52:55], v[100:103]
  v_exp_f32 v116, v116
  v_mfma_f32_16x16x32_bf16 v[104:107], v[20:23], v[48:51], v[104:107]
  v_xor_b32 v10, 192, v8
  v_exp_f32 v117, v117
  v_cvt_pk_bf16_f32 v136, v112, v113
  v_mfma_f32_16x16x32_bf16 v[108:111], v[20:23], v[52:55], v[108:111]
  ds_read_b128 v[16:19], v10 offset:0
  v_exp_f32 v114, v114
  s_waitcnt lgkmcnt(1)
  v_mfma_f32_16x16x32_bf16 v[96:99], v[24:27], v[80:83], v[96:99]
  ds_read_b128 v[20:23], v10 offset:2048
  v_exp_f32 v115, v115
  v_mfma_f32_16x16x32_bf16 v[100:103], v[24:27], v[84:87], v[100:103]
  v_cvt_pk_bf16_f32 v140, v116, v117
  v_exp_f32 v118, v118
  v_mfma_f32_16x16x32_bf16 v[104:107], v[28:31], v[80:83], v[104:107]
  ds_read_b128 v[24:27], v10 offset:256
  v_exp_f32 v119, v119
  v_mfma_f32_16x16x32_bf16 v[108:111], v[28:31], v[84:87], v[108:111]
  v_cvt_pk_bf16_f32 v137, v114, v115
  v_exp_f32 v120, v120
  s_waitcnt lgkmcnt(1)
  v_mfma_f32_16x16x32_bf16 v[96:99], v[16:19], v[56:59], v[96:99]
  ds_read_b128 v[28:31], v10 offset:2304
  v_exp_f32 v121, v121
  v_mfma_f32_16x16x32_bf16 v[100:103], v[16:19], v[60:63], v[100:103]
  v_cvt_pk_bf16_f32 v141, v118, v119
  v_exp_f32 v124, v124
  s_and_b32 s50, s68, 15
  s_lshr_b64 s[68:69], s[68:69], 4
  s_lshl_b32 s50, s50, 14
  v_add_u32 v8, s50, v6
  v_mfma_f32_16x16x32_bf16 v[104:107], v[20:23], v[56:59], v[104:107]
  v_exp_f32 v125, v125
  v_mfma_f32_16x16x32_bf16 v[108:111], v[20:23], v[60:63], v[108:111]
  v_cvt_pk_bf16_f32 v138, v120, v121
  v_exp_f32 v122, v122
  s_waitcnt lgkmcnt(0)
  s_barrier
  ds_read_b128 v[16:19], v8 offset:0
  v_mfma_f32_16x16x32_bf16 v[96:99], v[24:27], v[88:91], v[96:99]
  ds_read_b128 v[20:23], v8 offset:2048
  v_exp_f32 v123, v123
  v_mfma_f32_16x16x32_bf16 v[100:103], v[24:27], v[92:95], v[100:103]
  v_cvt_pk_bf16_f32 v142, v124, v125
  v_exp_f32 v126, v126
  v_mfma_f32_16x16x32_bf16 v[104:107], v[28:31], v[88:91], v[104:107]
  ds_read_b128 v[24:27], v8 offset:256
  v_exp_f32 v127, v127
  v_mfma_f32_16x16x32_bf16 v[108:111], v[28:31], v[92:95], v[108:111]
  v_cvt_pk_bf16_f32 v139, v122, v123
  v_cvt_pk_bf16_f32 v143, v126, v127
  s_waitcnt lgkmcnt(2)
  v_mfma_f32_16x16x32_bf16 v[112:115], v[16:19], v[32:35], v[248:251]
  ds_read_b128 v[28:31], v8 offset:2304
  v_mfma_f32_16x16x32_bf16 v[116:119], v[16:19], v[36:39], v[252:255]
  s_waitcnt lgkmcnt(2)
  v_mfma_f32_16x16x32_bf16 v[120:123], v[20:23], v[32:35], v[248:251]
  v_xor_b32 v10, 64, v8
  v_mfma_f32_16x16x32_bf16 v[124:127], v[20:23], v[36:39], v[252:255]
  ds_read_b128 v[16:19], v10 offset:0
  s_waitcnt lgkmcnt(1)
  v_mfma_f32_16x16x32_bf16 v[112:115], v[24:27], v[64:67], v[112:115]
  ds_read_b128 v[20:23], v10 offset:2048
  v_max3_f32 v12, v96, v97, v98
  v_max3_f32 v7, v99, v100, v101
  v_mfma_f32_16x16x32_bf16 v[116:119], v[24:27], v[68:71], v[116:119]
  v_max3_f32 v12, v12, v102, v103
  v_max3_f32 v7, v7, v104, v105
  v_mfma_f32_16x16x32_bf16 v[120:123], v[28:31], v[64:67], v[120:123]
  ds_read_b128 v[24:27], v10 offset:256
  v_max3_f32 v12, v12, v106, v107
  v_max3_f32 v7, v7, v108, v109
  v_mfma_f32_16x16x32_bf16 v[124:127], v[28:31], v[68:71], v[124:127]
  v_max3_f32 v12, v12, v110, v111
  s_waitcnt lgkmcnt(1)
  v_mfma_f32_16x16x32_bf16 v[112:115], v[16:19], v[40:43], v[112:115]
  ds_read_b128 v[28:31], v10 offset:2304
  v_mfma_f32_16x16x32_bf16 v[116:119], v[16:19], v[44:47], v[116:119]
  v_max_f32 v3, v12, v7
  v_cmp_lt_f32 vcc, 0x41a00000, v3
  s_mov_b32 s82, 0
  s_nop 0
  s_cbranch_vccz L_ok_2
  s_call_b64 s[60:61], L_rescue
L_ok_2:
  v_mfma_f32_16x16x32_bf16 v[120:123], v[20:23], v[40:43], v[120:123]
  v_xor_b32 v9, 128, v8
  v_exp_f32 v96, v96
  v_mfma_f32_16x16x32_bf16 v[124:127], v[20:23], v[44:47], v[124:127]
  ds_read_b128 v[16:19], v9 offset:0
  s_waitcnt lgkmcnt(1)
  v_mfma_f32_16x16x32_bf16 v[112:115], v[24:27], v[72:75], v[112:115]
  ds_read_b128 v[20:23], v9 offset:2048
  v_exp_f32 v97, v97
  v_mfma_f32_16x16x32_bf16 v[116:119], v[24:27], v[76:79], v[116:119]
  v_exp_f32 v100, v100
  v_mfma_f32_16x16x32_bf16 v[120:123], v[28:31], v[72:75], v[120:123]
  ds_read_b128 v[24:27], v9 offset:256
  v_exp_f32 v101, v101
  v_mfma_f32_16x16x32_bf16 v[124:127], v[28:31], v[76:79], v[124:127]
  v_cvt_pk_bf16_f32 v144, v96, v97
  v_exp_f32 v98, v98
  s_waitcnt lgkmcnt(1)
  v_mfma_f32_16x16x32_bf16 v[112:115], v[16:19], v[48:51], v[112:115]
  ds_read_b128 v[28:31], v9 offset:2304
  v_mfma_f32_16x16x32_bf16 v[116:119], v[16:19], v[52:55], v[116:119]
  v_exp_f32 v99, v99
  v_cvt_pk_bf16_f32 v148, v100, v101
  v_mfma_f32_16x16x32_bf16 v[120:123], v[20:23], v[48:51], v[120:123]
  v_xor_b32 v10, 192, v8
  v_exp_f32 v102, v102
  v_mfma_f32_16x16x32_bf16 v[124:127], v[20:23], v[52:55], v[124:127]
  ds_read_b128 v[16:19], v10 offset:0
  s_waitcnt lgkmcnt(1)
  v_mfma_f32_16x16x32_bf16 v[112:115], v[24:27], v[80:83], v[112:115]
  ds_read_b128 v[20:23], v10 offset:2048
  v_exp_f32 v103, v103
  v_cvt_pk_bf16_f32 v145, v98, v99
  v_mfma_f32_16x16x32_bf16 v[116:119], v[24:27], v[84:87], v[116:119]
  v_exp_f32 v104, v104
  v_mfma_f32_16x16x32_bf16 v[120:123], v[28:31], v[80:83], v[120:123]
  ds_read_b128 v[24:27], v10 offset:256
  v_exp_f32 v105, v105
  v_mfma_f32_16x16x32_bf16 v[124:127], v[28:31], v[84:87], v[124:127]
  v_cvt_pk_bf16_f32 v149, v102, v103
  s_waitcnt lgkmcnt(1)
  v_mfma_f32_16x16x32_bf16 v[112:115], v[16:19], v[56:59], v[112:115]
  ds_read_b128 v[28:31], v10 offset:2304
  v_exp_f32 v108, v108
  v_mfma_f32_16x16x32_bf16 v[116:119], v[16:19], v[60:63], v[116:119]
  v_exp_f32 v109, v109
  v_cvt_pk_bf16_f32 v146, v104, v105
  s_and_b32 s50, s68, 15
  s_lshr_b64 s[68:69], s[68:69], 4
  s_lshl_b32 s50, s50, 14
  v_add_u32 v8, s50, v6
  v_mfma_f32_16x16x32_bf16 v[120:123], v[20:23], v[56:59], v[120:123]
  v_exp_f32 v106, v106
  v_mfma_f32_16x16x32_bf16 v[124:127], v[20:23], v[60:63], v[124:127]
  v_exp_f32 v107, v107
  s_waitcnt lgkmcnt(0)
  s_barrier
  ds_read_b128 v[16:19], v8 offset:0
  v_mfma_f32_16x16x32_bf16 v[112:115], v[24:27], v[88:91], v[112:115]
  ds_read_b128 v[20:23], v8 offset:2048
  v_cvt_pk_bf16_f32 v150, v108, v109
  v_mfma_f32_16x16x32_bf16 v[116:119], v[24:27], v[92:95], v[116:119]
  v_exp_f32 v110, v110
  v_mfma_f32_16x16x32_bf16 v[120:123], v[28:31], v[88:91], v[120:123]
  ds_read_b128 v[24:27], v8 offset:256
  v_exp_f32 v111, v111
  v_mfma_f32_16x16x32_bf16 v[124:127], v[28:31], v[92:95], v[124:127]
  v_cvt_pk_bf16_f32 v147, v106, v107
  v_cvt_pk_bf16_f32 v151, v110, v111
  s_waitcnt lgkmcnt(2)
  v_mfma_f32_16x16x32_bf16 v[96:99], v[16:19], v[32:35], v[248:251]
  ds_read_b128 v[28:31], v8 offset:2304
  v_mfma_f32_16x16x32_bf16 v[100:103], v[16:19], v[36:39], v[252:255]
  s_waitcnt lgkmcnt(2)
  v_mfma_f32_16x16x32_bf16 v[104:107], v[20:23], v[32:35], v[248:251]
  v_xor_b32 v10, 64, v8
  v_mfma_f32_16x16x32_bf16 v[108:111], v[20:23], v[36:39], v[252:255]
  ds_read_b128 v[16:19], v10 offset:0
  s_waitcnt lgkmcnt(1)
  v_mfma_f32_16x16x32_bf16 v[96:99], v[24:27], v[64:67], v[96:99]
  ds_read_b128 v[20:23], v10 offset:2048
  v_max3_f32 v12, v112, v113, v114
  v_max3_f32 v7, v115, v116, v117
  v_mfma_f32_16x16x32_bf16 v[100:103], v[24:27], v[68:71], v[100:103]
  v_max3_f32 v12, v12, v118, v119
  v_max3_f32 v7, v7, v120, v121
  v_mfma_f32_16x16x32_bf16 v[104:107], v[28:31], v[64:67], v[104:107]
  ds_read_b128 v[24:27], v10 offset:256
  v_max3_f32 v12, v12, v122, v123
  v_max3_f32 v7, v7, v124, v125
  v_mfma_f32_16x16x32_bf16 v[108:111], v[28:31], v[68:71], v[108:111]
  v_max3_f32 v12, v12, v126, v127
  s_waitcnt lgkmcnt(1)
  v_mfma_f32_16x16x32_bf16 v[96:99], v[16:19], v[40:43], v[96:99]
  ds_read_b128 v[28:31], v10 offset:2304
  v_mfma_f32_16x16x32_bf16 v[100:103], v[16:19], v[44:47], v[100:103]
  v_max_f32 v3, v12, v7
  v_cmp_lt_f32 vcc, 0x41a00000, v3
  s_mov_b32 s82, 1
  s_nop 0
  s_cbranch_vccz L_ok_3
  s_call_b64 s[60:61], L_rescue
L_ok_3:
  v_mfma_f32_16x16x32_bf16 v[104:107], v[20:23], v[40:43], v[104:107]
  v_xor_b32 v9, 128, v8
  v_exp_f32 v112, v112
  v_mfma_f32_16x16x32_bf16 v[108:111], v[20:23], v[44:47], v[108:111]
  ds_read_b128 v[16:19], v9 offset:0
  s_waitcnt lgkmcnt(1)
  v_mfma_f32_16x16x32_bf16 v[96:99], v[24:27], v[72:75], v[96:99]
  ds_read_b128 v[20:23], v9 offset:2048
  v_exp_f32 v113, v113
  v_mfma_f32_16x16x32_bf16 v[100:103], v[24:27], v[76:79], v[100:103]
  v_exp_f32 v116, v116
  v_mfma_f32_16x16x32_bf16 v[104:107], v[28:31], v[72:75], v[104:107]
  ds_read_b128 v[24:27], v9 offset:256
  v_exp_f32 v117, v117
  v_mfma_f32_16x16x32_bf16 v[108:111], v[28:31], v[76:79], v[108:111]
  s_branch L_pads6
L_pad6:
  s_setpc_b64 s[60:61]
L_pads6:
  v_cvt_pk_bf16_f32 v152, v112, v113
  v_exp_f32 v114, v114
  s_waitcnt lgkmcnt(1)
  v_mfma_f32_16x16x32_bf16 v[96:99], v[16:19], v[48:51], v[96:99]
  ds_read_b128 v[28:31], v9 offset:2304
  v_mfma_f32_16x16x32_bf16 v[100:103], v[16:19], v[52:55], v[100:103]
  v_exp_f32 v115, v115
  v_cvt_pk_bf16_f32 v156, v116, v117
  v_mfma_f32_16x16x32_bf16 v[104:107], v[20:23], v[48:51], v[104:107]
  v_xor_b32 v10, 192, v8
  v_exp_f32 v118, v118
  v_mfma_f32_16x16x32_bf16 v[108:111], v[20:23], v[52:55], v[108:111]
  ds_read_b128 v[16:19], v10 offset:0
  s_waitcnt lgkmcnt(1)
  v_mfma_f32_16x16x32_bf16 v[96:99], v[24:27], v[80:83], v[96:99]
  ds_read_b128 v[20:23], v10 offset:2048
  v_exp_f32 v119, v119
  v_cvt_pk_bf16_f32 v153, v114, v115
  v_mfma_f32_16x16x32_bf16 v[100:103], v[24:27], v[84:87], v[100:103]
  v_exp_f32 v120, v120
  v_mfma_f32_16x16x32_bf16 v[104:107], v[28:31], v[80:83], v[104:107]
  ds_read_b128 v[24:27], v10 offset:256
  v_exp_f32 v121, v121
  v_mfma_f32_16x16x32_bf16 v[108:111], v[28:31], v[84:87], v[108:111]
  v_cvt_pk_bf16_f32 v157, v118, v119
  s_waitcnt lgkmcnt(1)
  v_mfma_f32_16x16x32_bf16 v[96:99], v[16:19], v[56:59], v[96:99]
  ds_read_b128 v[28:31], v10 offset:2304
  v_exp_f32 v124, v124
  v_mfma_f32_16x16x32_bf16 v[100:103], v[16:19], v[60:63], v[100:103]
  v_exp_f32 v125, v125
  v_cvt_pk_bf16_f32 v154, v120, v121
  s_and_b32 s50, s68, 15
  s_lshr_b64 s[68:69], s[68:69], 4
  s_lshl_b32 s50, s50, 14
  v_add_u32 v8, s50, v6
  v_mfma_f32_16x16x32_bf16 v[104:107], v[20:23], v[56:59], v[104:107]
  v_exp_f32 v122, v122
  v_mfma_f32_16x16x32_bf16 v[108:111], v[20:23], v[60:63], v[108:111]
  v_exp_f32 v123, v123
  s_waitcnt lgkmcnt(0)
  s_barrier
  ds_read_b128 v[16:19], v8 offset:0
  v_mfma_f32_16x16x32_bf16 v[96:99], v[24:27], v[88:91], v[96:99]
  ds_read_b128 v[20:23], v8 offset:2048
  v_cvt_pk_bf16_f32 v158, v124, v125
  v_mfma_f32_16x16x32_bf16 v[100:103], v[24:27], v[92:95], v[100:103]
  v_exp_f32 v126, v126
  v_mfma_f32_16x16x32_bf16 v[104:107], v[28:31], v[88:91], v[104:107]
  ds_read_b128 v[24:27], v8 offset:256
  v_exp_f32 v127, v127
  v_mfma_f32_16x16x32_bf16 v[108:111], v[28:31], v[92:95], v[108:111]
  v_cvt_pk_bf16_f32 v155, v122, v123
  v_cvt_pk_bf16_f32 v159, v126, v127
  s_waitcnt lgkmcnt(2)
  v_mfma_f32_16x16x32_bf16 v[112:115], v[16:19], v[32:35], v[248:251]
  ds_read_b128 v[28:31], v8 offset:2304
  v_mfma_f32_16x16x32_bf16 v[116:119], v[16:19], v[36:39], v[252:255]
  s_waitcnt lgkmcnt(2)
  v_mfma_f32_16x16x32_bf16 v[120:123], v[20:23], v[32:35], v[248:251]
  v_xor_b32 v10, 64, v8
  v_mfma_f32_16x16x32_bf16 v[124:127], v[20:23], v[36:39], v[252:255]
  ds_read_b128 v[16:19], v10 offset:0
  s_waitcnt lgkmcnt(1)
  v_mfma_f32_16x16x32_bf16 v[112:115], v[24:27], v[64:67], v[112:115]
  ds_read_b128 v[20:23], v10 offset:2048
  v_max3_f32 v12, v96, v97, v98
  v_max3_f32 v7, v99, v100, v101
  v_mfma_f32_16x16x32_bf16 v[116:119], v[24:27], v[68:71], v[116:119]
  v_max3_f32 v12, v12, v102, v103
  v_max3_f32 v7, v7, v104, v105
  v_mfma_f32_16x16x32_bf16 v[120:123], v[28:31], v[64:67], v[120:123]
  ds_read_b128 v[24:27], v10 offset:256
  v_max3_f32 v12, v12, v106, v107
  v_max3_f32 v7, v7, v108, v109
  v_mfma_f32_16x16x32_bf16 v[124:127], v[28:31], v[68:71], v[124:127]
  v_max3_f32 v12, v12, v110, v111
  s_waitcnt lgkmcnt(1)
  v_mfma_f32_16x16x32_bf16 v[112:115], v[16:19], v[40:43], v[112:115]
  ds_read_b128 v[28:31], v10 offset:2304
  v_mfma_f32_16x16x32_bf16 v[116:119], v[16:19], v[44:47], v[116:119]
  v_max_f32 v3, v12, v7
  v_cmp_lt_f32 vcc, 0x41a00000, v3
  s_mov_b32 s82, 0
  s_nop 0
  s_cbranch_vccz L_ok_4
  s_call_b64 s[60:61], L_rescue
L_ok_4:
  v_mfma_f32_16x16x32_bf16 v[120:123], v[20:23], v[40:43], v[120:123]
  v_xor_b32 v9, 128, v8
  v_exp_f32 v96, v96
  v_mfma_f32_16x16x32_bf16 v[124:127], v[20:23], v[44:47], v[124:127]
  ds_read_b128 v[16:19], v9 offset:0
  s_waitcnt lgkmcnt(1)
  v_mfma_f32_16x16x32_bf16 v[112:115], v[24:27], v[72:75], v[112:115]
  ds_read_b128 v[20:23], v9 offset:2048
  v_exp_f32 v97, v97
  v_mfma_f32_16x16x32_bf16 v[116:119], v[24:27], v[76:79], v[116:119]
  v_exp_f32 v100, v100
  v_mfma_f32_16x16x32_bf16 v[120:123], v[28:31], v[72:75], v[120:123]
  ds_read_b128 v[24:27], v9 offset:256
  v_exp_f32 v101, v101
  v_mfma_f32_16x16x32_bf16 v[124:127], v[28:31], v[76:79], v[124:127]
  v_cvt_pk_bf16_f32 v160, v96, v97
  v_exp_f32 v98, v98
  s_waitcnt lgkmcnt(1)
  v_mfma_f32_16x16x32_bf16 v[112:115], v[16:19], v[48:51], v[112:115]
  ds_read_b128 v[28:31], v9 offset:2304
  v_mfma_f32_16x16x32_bf16 v[116:119], v[16:19], v[52:55], v[116:119]
  v_exp_f32 v99, v99
  v_cvt_pk_bf16_f32 v164, v100, v101
  v_mfma_f32_16x16x32_bf16 v[120:123], v[20:23], v[48:51], v[120:123]
  v_xor_b32 v10, 192, v8
  v_exp_f32 v102, v102
  v_mfma_f32_16x16x32_bf16 v[124:127], v[20:23], v[52:55], v[124:127]
  ds_read_b128 v[16:19], v10 offset:0
  s_waitcnt lgkmcnt(1)
  v_mfma_f32_16x16x32_bf16 v[112:115], v[24:27], v[80:83], v[112:115]
  ds_read_b128 v[20:23], v10 offset:2048
  v_exp_f32 v103, v103
  v_cvt_pk_bf16_f32 v161, v98, v99
  v_mfma_f32_16x16x32_bf16 v[116:119], v[24:27], v[84:87], v[116:119]
  v_exp_f32 v104, v104
  v_mfma_f32_16x16x32_bf16 v[120:123], v[28:31], v[80:83], v[120:123]
  ds_read_b128 v[24:27], v10 offset:256
  v_exp_f32 v105, v105
  v_mfma_f32_16x16x32_bf16 v[124:127], v[28:31], v[84:87], v[124:127]
  v_cvt_pk_bf16_f32 v165, v102, v103
  s_waitcnt lgkmcnt(1)
  v_mfma_f32_16x16x32_bf16 v[112:115], v[16:19], v[56:59], v[112:115]
  ds_read_b128 v[28:31], v10 offset:2304
  v_exp_f32 v108, v108
  v_mfma_f32_16x16x32_bf16 v[116:119], v[16:19], v[60:63], v[116:119]
  v_exp_f32 v109, v109
  v_cvt_pk_bf16_f32 v162, v104, v105
  s_and_b32 s50, s68, 15
  s_lshr_b64 s[68:69], s[68:69], 4
  s_lshl_b32 s50, s50, 14
  v_add_u32 v8, s50, v6
  v_mfma_f32_16x16x32_bf16 v[120:123], v[20:23], v[56:59], v[120:123]
  v_exp_f32 v106, v106
  v_mfma_f32_16x16x32_bf16 v[124:127], v[20:23], v[60:63], v[124:127]
  v_exp_f32 v107, v107
  s_waitcnt lgkmcnt(0)
  s_barrier
  ds_read_b128 v[16:19], v8 offset:0
  v_mfma_f32_16x16x32_bf16 v[112:115], v[24:27], v[88:91], v[112:115]
  ds_read_b128 v[20:23], v8 offset:2048
  v_cvt_pk_bf16_f32 v166, v108, v109
  v_mfma_f32_16x16x32_bf16 v[116:119], v[24:27], v[92:95], v[116:119]
  v_exp_f32 v110, v110
  v_mfma_f32_16x16x32_bf16 v[120:123], v[28:31], v[88:91], v[120:123]
  ds_read_b128 v[24:27], v8 offset:256
  v_exp_f32 v111, v111
  v_mfma_f32_16x16x32_bf16 v[124:127], v[28:31], v[92:95], v[124:127]
  v_cvt_pk_bf16_f32 v163, v106, v107
  v_cvt_pk_bf16_f32 v167, v110, v111
  s_waitcnt lgkmcnt(2)
  v_mfma_f32_16x16x32_bf16 v[96:99], v[16:19], v[32:35], v[248:251]
  ds_read_b128 v[28:31], v8 offset:2304
  v_mfma_f32_16x16x32_bf16 v[100:103], v[16:19], v[36:39], v[252:255]
  s_waitcnt lgkmcnt(2)
  v_mfma_f32_16x16x32_bf16 v[104:107], v[20:23], v[32:35], v[248:251]
  v_xor_b32 v10, 64, v8
  v_mfma_f32_16x16x32_bf16 v[108:111], v[20:23], v[36:39], v[252:255]
  ds_read_b128 v[16:19], v10 offset:0
  s_waitcnt lgkmcnt(1)
  v_mfma_f32_16x16x32_bf16 v[96:99], v[24:27], v[64:67], v[96:99]
  ds_read_b128 v[20:23], v10 offset:2048
  v_max3_f32 v12, v112, v113, v114
  v_max3_f32 v7, v115, v116, v117
  v_mfma_f32_16x16x32_bf16 v[100:103], v[24:27], v[68:71], v[100:103]
  v_max3_f32 v12, v12, v118, v119
  v_max3_f32 v7, v7, v120, v121
  v_mfma_f32_16x16x32_bf16 v[104:107], v[28:31], v[64:67], v[104:107]
  ds_read_b128 v[24:27], v10 offset:256
  v_max3_f32 v12, v12, v122, v123
  v_max3_f32 v7, v7, v124, v125
  v_mfma_f32_16x16x32_bf16 v[108:111], v[28:31], v[68:71], v[108:111]
  v_max3_f32 v12, v12, v126, v127
  s_waitcnt lgkmcnt(1)
  v_mfma_f32_16x16x32_bf16 v[96:99], v[16:19], v[40:43], v[96:99]
  ds_read_b128 v[28:31], v10 offset:2304
  v_mfma_f32_16x16x32_bf16 v[100:103], v[16:19], v[44:47], v[100:103]
  v_max_f32 v3, v12, v7
  v_cmp_lt_f32 vcc, 0x41a00000, v3
  s_mov_b32 s82, 1
  s_nop 0
  s_cbranch_vccz L_ok_5
  s_call_b64 s[60:61], L_rescue
L_ok_5:
  v_mfma_f32_16x16x32_bf16 v[104:107], v[20:23], v[40:43], v[104:107]
  v_xor_b32 v9, 128, v8
  v_exp_f32 v112, v112
  v_mfma_f32_16x16x32_bf16 v[108:111], v[20:23], v[44:47], v[108:111]
  ds_read_b128 v[16:19], v9 offset:0
  s_waitcnt lgkmcnt(1)
  v_mfma_f32_16x16x32_bf16 v[96:99], v[24:27], v[72:75], v[96:99]
  ds_read_b128 v[20:23], v9 offset:2048
  v_exp_f32 v113, v113
  v_mfma_f32_16x16x32_bf16 v[100:103], v[24:27], v[76:79], v[100:103]
  v_exp_f32 v116, v116
  v_mfma_f32_16x16x32_bf16 v[104:107], v[28:31], v[72:75], v[104:107]
  ds_read_b128 v[24:27], v9 offset:256
  v_exp_f32 v117, v117
  v_mfma_f32_16x16x32_bf16 v[108:111], v[28:31], v[76:79], v[108:111]
  v_cvt_pk_bf16_f32 v168, v112, v113
  v_exp_f32 v114, v114
  s_waitcnt lgkmcnt(1)
  v_mfma_f32_16x16x32_bf16 v[96:99], v[16:19], v[48:51], v[96:99]
  ds_read_b128 v[28:31], v9 offset:2304
  v_mfma_f32_16x16x32_bf16 v[100:103], v[16:19], v[52:55], v[100:103]
  v_exp_f32 v115, v115
  v_cvt_pk_bf16_f32 v172, v116, v117
  v_mfma_f32_16x16x32_bf16 v[104:107], v[20:23], v[48:51], v[104:107]
  v_xor_b32 v10, 192, v8
  v_exp_f32 v118, v118
  v_mfma_f32_16x16x32_bf16 v[108:111], v[20:23], v[52:55], v[108:111]
  ds_read_b128 v[16:19], v10 offset:0
  s_waitcnt lgkmcnt(1)
  v_mfma_f32_16x16x32_bf16 v[96:99], v[24:27], v[80:83], v[96:99]
  ds_read_b128 v[20:23], v10 offset:2048
  v_exp_f32 v119, v119
  v_cvt_pk_bf16_f32 v169, v114, v115
  v_mfma_f32_16x16x32_bf16 v[100:103], v[24:27], v[84:87], v[100:103]
  v_exp_f32 v120, v120
  v_mfma_f32_16x16x32_bf16 v[104:107], v[28:31], v[80:83], v[104:107]
  ds_read_b128 v[24:27], v10 offset:256
  v_exp_f32 v121, v121
  v_mfma_f32_16x16x32_bf16 v[108:111], v[28:31], v[84:87], v[108:111]
  v_cvt_pk_bf16_f32 v173, v118, v119
  s_waitcnt lgkmcnt(1)
  v_mfma_f32_16x16x32_bf16 v[96:99], v[16:19], v[56:59], v[96:99]
  ds_read_b128 v[28:31], v10 offset:2304
  v_exp_f32 v124, v124
  v_mfma_f32_16x16x32_bf16 v[100:103], v[16:19], v[60:63], v[100:103]
  v_exp_f32 v125, v125
  v_cvt_pk_bf16_f32 v170, v120, v121
  s_and_b32 s50, s68, 15
  s_lshr_b64 s[68:69], s[68:69], 4
  s_lshl_b32 s50, s50, 14
  v_add_u32 v8, s50, v6
  v_mfma_f32_16x16x32_bf16 v[104:107], v[20:23], v[56:59], v[104:107]
  v_exp_f32 v122, v122
  v_mfma_f32_16x16x32_bf16 v[108:111], v[20:23], v[60:63], v[108:111]
  v_exp_f32 v123, v123
  s_waitcnt lgkmcnt(0)
  s_barrier
  ds_read_b128 v[16:19], v8 offset:0
  v_mfma_f32_16x16x32_bf16 v[96:99], v[24:27], v[88:91], v[96:99]
  ds_read_b128 v[20:23], v8 offset:2048
  v_cvt_pk_bf16_f32 v174, v124, v125
  v_mfma_f32_16x16x32_bf16 v[100:103], v[24:27], v[92:95], v[100:103]
  v_exp_f32 v126, v126
  v_mfma_f32_16x16x32_bf16 v[104:107], v[28:31], v[88:91], v[104:107]
  ds_read_b128 v[24:27], v8 offset:256
  v_exp_f32 v127, v127
  v_mfma_f32_16x16x32_bf16 v[108:111], v[28:31], v[92:95], v[108:111]
  v_cvt_pk_bf16_f32 v171, v122, v123
  v_cvt_pk_bf16_f32 v175, v126, v127
  s_waitcnt lgkmcnt(2)
  v_mfma_f32_16x16x32_bf16 v[112:115], v[16:19], v[32:35], v[248:251]
  ds_read_b128 v[28:31], v8 offset:2304
  v_mfma_f32_16x16x32_bf16 v[116:119], v[16:19], v[36:39], v[252:255]
  s_waitcnt lgkmcnt(2)
  v_mfma_f32_16x16x32_bf16 v[120:123], v[20:23], v[32:35], v[248:251]
  v_xor_b32 v10, 64, v8
  v_mfma_f32_16x16x32_bf16 v[124:127], v[20:23], v[36:39], v[252:255]
  ds_read_b128 v[16:19], v10 offset:0
  s_waitcnt lgkmcnt(1)
  v_mfma_f32_16x16x32_bf16 v[112:115], v[24:27], v[64:67], v[112:115]
  ds_read_b128 v[20:23], v10 offset:2048
  v_max3_f32 v12, v96, v97, v98
  v_max3_f32 v7, v99, v100, v101
  v_mfma_f32_16x16x32_bf16 v[116:119], v[24:27], v[68:71], v[116:119]
  v_max3_f32 v12, v12, v102, v103
  v_max3_f32 v7, v7, v104, v105
  v_mfma_f32_16x16x32_bf16 v[120:123], v[28:31], v[64:67], v[120:123]
  ds_read_b128 v[24:27], v10 offset:256
  v_max3_f32 v12, v12, v106, v107
  v_max3_f32 v7, v7, v108, v109
  v_mfma_f32_16x16x32_bf16 v[124:127], v[28:31], v[68:71], v[124:127]
  v_max3_f32 v12, v12, v110, v111
  s_waitcnt lgkmcnt(1)
  v_mfma_f32_16x16x32_bf16 v[112:115], v[16:19], v[40:43], v[112:115]
  ds_read_b128 v[28:31], v10 offset:2304
  v_mfma_f32_16x16x32_bf16 v[116:119], v[16:19], v[44:47], v[116:119]
  v_max_f32 v3, v12, v7
  v_cmp_lt_f32 vcc, 0x41a00000, v3
  s_mov_b32 s82, 0
  s_nop 0
  s_cbranch_vccz L_ok_6
  s_call_b64 s[60:61], L_rescue
L_ok_6:
  v_mfma_f32_16x16x32_bf16 v[120:123], v[20:23], v[40:43], v[120:123]
  v_xor_b32 v9, 128, v8
  v_exp_f32 v96, v96
  v_mfma_f32_16x16x32_bf16 v[124:127], v[20:23], v[44:47], v[124:127]
  ds_read_b128 v[16:19], v9 offset:0
  s_waitcnt lgkmcnt(1)
  v_mfma_f32_16x16x32_bf16 v[112:115], v[24:27], v[72:75], v[112:115]
  ds_read_b128 v[20:23], v9 offset:2048
  v_exp_f32 v97, v97
  v_mfma_f32_16x16x32_bf16 v[116:119], v[24:27], v[76:79], v[116:119]
  v_exp_f32 v100, v100
  v_mfma_f32_16x16x32_bf16 v[120:123], v[28:31], v[72:75], v[120:123]
  ds_read_b128 v[24:27], v9 offset:256
  v_exp_f32 v101, v101
  v_mfma_f32_16x16x32_bf16 v[124:127], v[28:31], v[76:79], v[124:127]
  v_cvt_pk_bf16_f32 v176, v96, v97
  v_exp_f32 v98, v98
  s_waitcnt lgkmcnt(1)
  v_mfma_f32_16x16x32_bf16 v[112:115], v[16:19], v[48:51], v[112:115]
  ds_read_b128 v[28:31], v9 offset:2304
  v_mfma_f32_16x16x32_bf16 v[116:119], v[16:19], v[52:55], v[116:119]
  v_exp_f32 v99, v99
  v_cvt_pk_bf16_f32 v180, v100, v101
  v_mfma_f32_16x16x32_bf16 v[120:123], v[20:23], v[48:51], v[120:123]
  v_xor_b32 v10, 192, v8
  v_exp_f32 v102, v102
  v_mfma_f32_16x16x32_bf16 v[124:127], v[20:23], v[52:55], v[124:127]
  ds_read_b128 v[16:19], v10 offset:0
  s_waitcnt lgkmcnt(1)
  v_mfma_f32_16x16x32_bf16 v[112:115], v[24:27], v[80:83], v[112:115]
  ds_read_b128 v[20:23], v10 offset:2048
  v_exp_f32 v103, v103
  v_cvt_pk_bf16_f32 v177, v98, v99
  v_mfma_f32_16x16x32_bf16 v[116:119], v[24:27], v[84:87], v[116:119]
  v_exp_f32 v104, v104
  v_mfma_f32_16x16x32_bf16 v[120:123], v[28:31], v[80:83], v[120:123]
  ds_read_b128 v[24:27], v10 offset:256
  v_exp_f32 v105, v105
  v_mfma_f32_16x16x32_bf16 v[124:127], v[28:31], v[84:87], v[124:127]
  v_cvt_pk_bf16_f32 v181, v102, v103
  s_waitcnt lgkmcnt(1)
  v_mfma_f32_16x16x32_bf16 v[112:115], v[16:19], v[56:59], v[112:115]
  ds_read_b128 v[28:31], v10 offset:2304
  v_exp_f32 v108, v108
  v_mfma_f32_16x16x32_bf16 v[116:119], v[16:19], v[60:63], v[116:119]
  v_exp_f32 v109, v109
  v_cvt_pk_bf16_f32 v178, v104, v105
  s_and_b32 s50, s68, 15
  s_lshr_b64 s[68:69], s[68:69], 4
  s_lshl_b32 s50, s50, 14
  v_add_u32 v8, s50, v6
  v_mfma_f32_16x16x32_bf16 v[120:123], v[20:23], v[56:59], v[120:123]
  v_exp_f32 v106, v106
  v_mfma_f32_16x16x32_bf16 v[124:127], v[20:23], v[60:63], v[124:127]
  v_exp_f32 v107, v107
  s_waitcnt lgkmcnt(0)
  s_barrier
  ds_read_b128 v[16:19], v8 offset:0
  v_mfma_f32_16x16x32_bf16 v[112:115], v[24:27], v[88:91], v[112:115]
  ds_read_b128 v[20:23], v8 offset:2048
  v_cvt_pk_bf16_f32 v182, v108, v109
  v_mfma_f32_16x16x32_bf16 v[116:119], v[24:27], v[92:95], v[116:119]
  v_exp_f32 v110, v110
  v_mfma_f32_16x16x32_bf16 v[120:123], v[28:31], v[88:91], v[120:123]
  ds_read_b128 v[24:27], v8 offset:256
  v_exp_f32 v111, v111
  v_mfma_f32_16x16x32_bf16 v[124:127], v[28:31], v[92:95], v[124:127]
  v_cvt_pk_bf16_f32 v179, v106, v107
  v_cvt_pk_bf16_f32 v183, v110, v111
  s_waitcnt lgkmcnt(2)
  v_mfma_f32_16x16x32_bf16 v[96:99], v[16:19], v[32:35], v[248:251]
  ds_read_b128 v[28:31], v8 offset:2304
  v_mfma_f32_16x16x32_bf16 v[100:103], v[16:19], v[36:39], v[252:255]
  s_waitcnt lgkmcnt(2)
  v_mfma_f32_16x16x32_bf16 v[104:107], v[20:23], v[32:35], v[248:251]
  v_xor_b32 v10, 64, v8
  v_mfma_f32_16x16x32_bf16 v[108:111], v[20:23], v[36:39], v[252:255]
  ds_read_b128 v[16:19], v10 offset:0
  s_waitcnt lgkmcnt(1)
  v_mfma_f32_16x16x32_bf16 v[96:99], v[24:27], v[64:67], v[96:99]
  ds_read_b128 v[20:23], v10 offset:2048
  v_max3_f32 v12, v112, v113, v114
  v_max3_f32 v7, v115, v116, v117
  v_mfma_f32_16x16x32_bf16 v[100:103], v[24:27], v[68:71], v[100:103]
  v_max3_f32 v12, v12, v118, v119
  v_max3_f32 v7, v7, v120, v121
  v_mfma_f32_16x16x32_bf16 v[104:107], v[28:31], v[64:67], v[104:107]
  ds_read_b128 v[24:27], v10 offset:256
  v_max3_f32 v12, v12, v122, v123
  v_max3_f32 v7, v7, v124, v125
  v_mfma_f32_16x16x32_bf16 v[108:111], v[28:31], v[68:71], v[108:111]
  v_max3_f32 v12, v12, v126, v127
  s_waitcnt lgkmcnt(1)
  v_mfma_f32_16x16x32_bf16 v[96:99], v[16:19], v[40:43], v[96:99]
  ds_read_b128 v[28:31], v10 offset:2304
  v_mfma_f32_16x16x32_bf16 v[100:103], v[16:19], v[44:47], v[100:103]
  v_max_f32 v3, v12, v7
  v_cmp_lt_f32 vcc, 0x41a00000, v3
  s_mov_b32 s82, 1
  s_nop 0
  s_cbranch_vccz L_ok_7
  s_call_b64 s[60:61], L_rescue
L_ok_7:
  v_mfma_f32_16x16x32_bf16 v[104:107], v[20:23], v[40:43], v[104:107]
  v_xor_b32 v9, 128, v8
  v_exp_f32 v112, v112
  v_mfma_f32_16x16x32_bf16 v[108:111], v[20:23], v[44:47], v[108:111]
  ds_read_b128 v[16:19], v9 offset:0
  s_waitcnt lgkmcnt(1)
  v_mfma_f32_16x16x32_bf16 v[96:99], v[24:27], v[72:75], v[96:99]
  ds_read_b128 v[20:23], v9 offset:2048
  v_exp_f32 v113, v113
  v_mfma_f32_16x16x32_bf16 v[100:103], v[24:27], v[76:79], v[100:103]
  v_exp_f32 v116, v116
  v_mfma_f32_16x16x32_bf16 v[104:107], v[28:31], v[72:75], v[104:107]
  ds_read_b128 v[24:27], v9 offset:256
  v_exp_f32 v117, v117
  v_mfma_f32_16x16x32_bf16 v[108:111], v[28:31], v[76:79], v[108:111]
  v_cvt_pk_bf16_f32 v184, v112, v113
  v_exp_f32 v114, v114
  s_waitcnt lgkmcnt(1)
  v_mfma_f32_16x16x32_bf16 v[96:99], v[16:19], v[48:51], v[96:99]
  ds_read_b128 v[28:31], v9 offset:2304
  v_mfma_f32_16x16x32_bf16 v[100:103], v[16:19], v[52:55], v[100:103]
  v_exp_f32 v115, v115
  v_cvt_pk_bf16_f32 v188, v116, v117
  v_mfma_f32_16x16x32_bf16 v[104:107], v[20:23], v[48:51], v[104:107]
  v_xor_b32 v10, 192, v8
  v_exp_f32 v118, v118
  v_mfma_f32_16x16x32_bf16 v[108:111], v[20:23], v[52:55], v[108:111]
  ds_read_b128 v[16:19], v10 offset:0
  s_waitcnt lgkmcnt(1)
  v_mfma_f32_16x16x32_bf16 v[96:99], v[24:27], v[80:83], v[96:99]
  ds_read_b128 v[20:23], v10 offset:2048
  v_exp_f32 v119, v119
  v_cvt_pk_bf16_f32 v185, v114, v115
  v_mfma_f32_16x16x32_bf16 v[100:103], v[24:27], v[84:87], v[100:103]
  v_exp_f32 v120, v120
  v_mfma_f32_16x16x32_bf16 v[104:107], v[28:31], v[80:83], v[104:107]
  ds_read_b128 v[24:27], v10 offset:256
  v_exp_f32 v121, v121
  v_mfma_f32_16x16x32_bf16 v[108:111], v[28:31], v[84:87], v[108:111]
  v_cvt_pk_bf16_f32 v189, v118, v119
  s_waitcnt lgkmcnt(1)
  v_mfma_f32_16x16x32_bf16 v[96:99], v[16:19], v[56:59], v[96:99]
  ds_read_b128 v[28:31], v10 offset:2304
  v_exp_f32 v124, v124
  v_mfma_f32_16x16x32_bf16 v[100:103], v[16:19], v[60:63], v[100:103]
  v_exp_f32 v125, v125
  v_cvt_pk_bf16_f32 v186, v120, v121
  s_and_b32 s50, s68, 15
  s_lshr_b64 s[68:69], s[68:69], 4
  s_lshl_b32 s50, s50, 14
  v_add_u32 v8, s50, v6
  v_mfma_f32_16x16x32_bf16 v[104:107], v[20:23], v[56:59], v[104:107]
  v_exp_f32 v122, v122
  v_mfma_f32_16x16x32_bf16 v[108:111], v[20:23], v[60:63], v[108:111]
  v_exp_f32 v123, v123
  s_waitcnt lgkmcnt(0)
  s_barrier
  ds_read_b128 v[16:19], v8 offset:0
  v_mfma_f32_16x16x32_bf16 v[96:99], v[24:27], v[88:91], v[96:99]
  ds_read_b128 v[20:23], v8 offset:2048
  v_cvt_pk_bf16_f32 v190, v124, v125
  v_mfma_f32_16x16x32_bf16 v[100:103], v[24:27], v[92:95], v[100:103]
  v_exp_f32 v126, v126
  v_mfma_f32_16x16x32_bf16 v[104:107], v[28:31], v[88:91], v[104:107]
  ds_read_b128 v[24:27], v8 offset:256
  v_exp_f32 v127, v127
  v_mfma_f32_16x16x32_bf16 v[108:111], v[28:31], v[92:95], v[108:111]
  v_cvt_pk_bf16_f32 v187, v122, v123
  v_cvt_pk_bf16_f32 v191, v126, v127
  s_waitcnt lgkmcnt(2)
  v_mfma_f32_16x16x32_bf16 v[112:115], v[16:19], v[32:35], v[248:251]
  ds_read_b128 v[28:31], v8 offset:2304
  v_mfma_f32_16x16x32_bf16 v[116:119], v[16:19], v[36:39], v[252:255]
  s_waitcnt lgkmcnt(2)
  v_mfma_f32_16x16x32_bf16 v[120:123], v[20:23], v[32:35], v[248:251]
  v_xor_b32 v10, 64, v8
  v_mfma_f32_16x16x32_bf16 v[124:127], v[20:23], v[36:39], v[252:255]
  ds_read_b128 v[16:19], v10 offset:0
  s_waitcnt lgkmcnt(1)
  v_mfma_f32_16x16x32_bf16 v[112:115], v[24:27], v[64:67], v[112:115]
  ds_read_b128 v[20:23], v10 offset:2048
  v_max3_f32 v12, v96, v97, v98
  v_max3_f32 v7, v99, v100, v101
  v_mfma_f32_16x16x32_bf16 v[116:119], v[24:27], v[68:71], v[116:119]
  v_max3_f32 v12, v12, v102, v103
  v_max3_f32 v7, v7, v104, v105
  v_mfma_f32_16x16x32_bf16 v[120:123], v[28:31], v[64:67], v[120:123]
  ds_read_b128 v[24:27], v10 offset:256
  v_max3_f32 v12, v12, v106, v107
  v_max3_f32 v7, v7, v108, v109
  v_mfma_f32_16x16x32_bf16 v[124:127], v[28:31], v[68:71], v[124:127]
  v_max3_f32 v12, v12, v110, v111
  s_waitcnt lgkmcnt(1)
  v_mfma_f32_16x16x32_bf16 v[112:115], v[16:19], v[40:43], v[112:115]
  ds_read_b128 v[28:31], v10 offset:2304
  v_mfma_f32_16x16x32_bf16 v[116:119], v[16:19], v[44:47], v[116:119]
  v_max_f32 v3, v12, v7
  v_cmp_lt_f32 vcc, 0x41a00000, v3
  s_mov_b32 s82, 0
  s_nop 0
  s_cbranch_vccz L_ok_8
  s_call_b64 s[60:61], L_rescue
L_ok_8:
  v_mfma_f32_16x16x32_bf16 v[120:123], v[20:23], v[40:43], v[120:123]
  v_xor_b32 v9, 128, v8
  v_exp_f32 v96, v96
  v_mfma_f32_16x16x32_bf16 v[124:127], v[20:23], v[44:47], v[124:127]
  ds_read_b128 v[16:19], v9 offset:0
  s_waitcnt lgkmcnt(1)
  v_mfma_f32_16x16x32_bf16 v[112:115], v[24:27], v[72:75], v[112:115]
  ds_read_b128 v[20:23], v9 offset:2048
  v_exp_f32 v97, v97
  v_mfma_f32_16x16x32_bf16 v[116:119], v[24:27], v[76:79], v[116:119]
  v_exp_f32 v100, v100
  v_mfma_f32_16x16x32_bf16 v[120:123], v[28:31], v[72:75], v[120:123]
  ds_read_b128 v[24:27], v9 offset:256
  v_exp_f32 v101, v101
  v_mfma_f32_16x16x32_bf16 v[124:127], v[28:31], v[76:79], v[124:127]
  v_cvt_pk_bf16_f32 v192, v96, v97
  v_exp_f32 v98, v98
  s_waitcnt lgkmcnt(1)
  v_mfma_f32_16x16x32_bf16 v[112:115], v[16:19], v[48:51], v[112:115]
  ds_read_b128 v[28:31], v9 offset:2304
  v_mfma_f32_16x16x32_bf16 v[116:119], v[16:19], v[52:55], v[116:119]
  v_exp_f32 v99, v99
  v_cvt_pk_bf16_f32 v196, v100, v101
  v_mfma_f32_16x16x32_bf16 v[120:123], v[20:23], v[48:51], v[120:123]
  v_xor_b32 v10, 192, v8
  v_exp_f32 v102, v102
  v_mfma_f32_16x16x32_bf16 v[124:127], v[20:23], v[52:55], v[124:127]
  ds_read_b128 v[16:19], v10 offset:0
  s_waitcnt lgkmcnt(1)
  v_mfma_f32_16x16x32_bf16 v[112:115], v[24:27], v[80:83], v[112:115]
  ds_read_b128 v[20:23], v10 offset:2048
  v_exp_f32 v103, v103
  v_cvt_pk_bf16_f32 v193, v98, v99
  v_mfma_f32_16x16x32_bf16 v[116:119], v[24:27], v[84:87], v[116:119]
  v_exp_f32 v104, v104
  v_mfma_f32_16x16x32_bf16 v[120:123], v[28:31], v[80:83], v[120:123]
  ds_read_b128 v[24:27], v10 offset:256
  v_exp_f32 v105, v105
  v_mfma_f32_16x16x32_bf16 v[124:127], v[28:31], v[84:87], v[124:127]
  v_cvt_pk_bf16_f32 v197, v102, v103
  s_waitcnt lgkmcnt(1)
  v_mfma_f32_16x16x32_bf16 v[112:115], v[16:19], v[56:59], v[112:115]
  ds_read_b128 v[28:31], v10 offset:2304
  v_exp_f32 v108, v108
  v_mfma_f32_16x16x32_bf16 v[116:119], v[16:19], v[60:63], v[116:119]
  v_exp_f32 v109, v109
  v_cvt_pk_bf16_f32 v194, v104, v105
  s_and_b32 s50, s68, 15
  s_lshr_b64 s[68:69], s[68:69], 4
  s_lshl_b32 s50, s50, 14
  v_add_u32 v8, s50, v6
  v_mfma_f32_16x16x32_bf16 v[120:123], v[20:23], v[56:59], v[120:123]
  v_exp_f32 v106, v106
  v_mfma_f32_16x16x32_bf16 v[124:127], v[20:23], v[60:63], v[124:127]
  v_exp_f32 v107, v107
  s_waitcnt lgkmcnt(0)
  s_barrier
  ds_read_b128 v[16:19], v8 offset:0
  v_mfma_f32_16x16x32_bf16 v[112:115], v[24:27], v[88:91], v[112:115]
  ds_read_b128 v[20:23], v8 offset:2048
  v_cvt_pk_bf16_f32 v198, v108, v109
  v_mfma_f32_16x16x32_bf16 v[116:119], v[24:27], v[92:95], v[116:119]
  v_exp_f32 v110, v110
  v_mfma_f32_16x16x32_bf16 v[120:123], v[28:31], v[88:91], v[120:123]
  ds_read_b128 v[24:27], v8 offset:256
  v_exp_f32 v111, v111
  v_mfma_f32_16x16x32_bf16 v[124:127], v[28:31], v[92:95], v[124:127]
  v_cvt_pk_bf16_f32 v195, v106, v107
  v_cvt_pk_bf16_f32 v199, v110, v111
  s_waitcnt lgkmcnt(2)
  v_mfma_f32_16x16x32_bf16 v[96:99], v[16:19], v[32:35], v[248:251]
  ds_read_b128 v[28:31], v8 offset:2304
  v_mfma_f32_16x16x32_bf16 v[100:103], v[16:19], v[36:39], v[252:255]
  s_waitcnt lgkmcnt(2)
  v_mfma_f32_16x16x32_bf16 v[104:107], v[20:23], v[32:35], v[248:251]
  v_xor_b32 v10, 64, v8
  v_mfma_f32_16x16x32_bf16 v[108:111], v[20:23], v[36:39], v[252:255]
  ds_read_b128 v[16:19], v10 offset:0
  s_waitcnt lgkmcnt(1)
  v_mfma_f32_16x16x32_bf16 v[96:99], v[24:27], v[64:67], v[96:99]
  ds_read_b128 v[20:23], v10 offset:2048
  v_max3_f32 v12, v112, v113, v114
  v_max3_f32 v7, v115, v116, v117
  v_mfma_f32_16x16x32_bf16 v[100:103], v[24:27], v[68:71], v[100:103]
  v_max3_f32 v12, v12, v118, v119
  v_max3_f32 v7, v7, v120, v121
  v_mfma_f32_16x16x32_bf16 v[104:107], v[28:31], v[64:67], v[104:107]
  ds_read_b128 v[24:27], v10 offset:256
  v_max3_f32 v12, v12, v122, v123
  v_max3_f32 v7, v7, v124, v125
  v_mfma_f32_16x16x32_bf16 v[108:111], v[28:31], v[68:71], v[108:111]
  v_max3_f32 v12, v12, v126, v127
  s_waitcnt lgkmcnt(1)
  v_mfma_f32_16x16x32_bf16 v[96:99], v[16:19], v[40:43], v[96:99]
  ds_read_b128 v[28:31], v10 offset:2304
  v_mfma_f32_16x16x32_bf16 v[100:103], v[16:19], v[44:47], v[100:103]
  v_max_f32 v3, v12, v7
  v_cmp_lt_f32 vcc, 0x41a00000, v3
  s_mov_b32 s82, 1
  s_nop 0
  s_cbranch_vccz L_ok_9
  s_call_b64 s[60:61], L_rescue
L_ok_9:
  v_mfma_f32_16x16x32_bf16 v[104:107], v[20:23], v[40:43], v[104:107]
  v_xor_b32 v9, 128, v8
  v_exp_f32 v112, v112
  v_mfma_f32_16x16x32_bf16 v[108:111], v[20:23], v[44:47], v[108:111]
  ds_read_b128 v[16:19], v9 offset:0
  s_waitcnt lgkmcnt(1)
  v_mfma_f32_16x16x32_bf16 v[96:99], v[24:27], v[72:75], v[96:99]
  ds_read_b128 v[20:23], v9 offset:2048
  v_exp_f32 v113, v113
  v_mfma_f32_16x16x32_bf16 v[100:103], v[24:27], v[76:79], v[100:103]
  v_exp_f32 v116, v116
  v_mfma_f32_16x16x32_bf16 v[104:107], v[28:31], v[72:75], v[104:107]
  ds_read_b128 v[24:27], v9 offset:256
  v_exp_f32 v117, v117
  v_mfma_f32_16x16x32_bf16 v[108:111], v[28:31], v[76:79], v[108:111]
  v_cvt_pk_bf16_f32 v200, v112, v113
  v_exp_f32 v114, v114
  s_waitcnt lgkmcnt(1)
  v_mfma_f32_16x16x32_bf16 v[96:99], v[16:19], v[48:51], v[96:99]
  ds_read_b128 v[28:31], v9 offset:2304
  v_mfma_f32_16x16x32_bf16 v[100:103], v[16:19], v[52:55], v[100:103]
  v_exp_f32 v115, v115
  v_cvt_pk_bf16_f32 v204, v116, v117
  s_branch L_pads7
L_pad7:
  s_setpc_b64 s[60:61]
L_pads7:
  v_mfma_f32_16x16x32_bf16 v[104:107], v[20:23], v[48:51], v[104:107]
  v_xor_b32 v10, 192, v8
  v_exp_f32 v118, v118
  v_mfma_f32_16x16x32_bf16 v[108:111], v[20:23], v[52:55], v[108:111]
  ds_read_b128 v[16:19], v10 offset:0
  s_waitcnt lgkmcnt(1)
  v_mfma_f32_16x16x32_bf16 v[96:99], v[24:27], v[80:83], v[96:99]
  ds_read_b128 v[20:23], v10 offset:2048
  v_exp_f32 v119, v119
  v_cvt_pk_bf16_f32 v201, v114, v115
  v_mfma_f32_16x16x32_bf16 v[100:103], v[24:27], v[84:87], v[100:103]
  v_exp_f32 v120, v120
  v_mfma_f32_16x16x32_bf16 v[104:107], v[28:31], v[80:83], v[104:107]
  ds_read_b128 v[24:27], v10 offset:256
  v_exp_f32 v121, v121
  v_mfma_f32_16x16x32_bf16 v[108:111], v[28:31], v[84:87], v[108:111]
  v_cvt_pk_bf16_f32 v205, v118, v119
  s_waitcnt lgkmcnt(1)
  v_mfma_f32_16x16x32_bf16 v[96:99], v[16:19], v[56:59], v[96:99]
  ds_read_b128 v[28:31], v10 offset:2304
  v_exp_f32 v124, v124
  v_mfma_f32_16x16x32_bf16 v[100:103], v[16:19], v[60:63], v[100:103]
  v_exp_f32 v125, v125
  v_cvt_pk_bf16_f32 v202, v120, v121
  s_and_b32 s50, s68, 15
  s_lshr_b64 s[68:69], s[68:69], 4
  s_lshl_b32 s50, s50, 14
  v_add_u32 v8, s50, v6
  v_mfma_f32_16x16x32_bf16 v[104:107], v[20:23], v[56:59], v[104:107]
  v_exp_f32 v122, v122
  v_mfma_f32_16x16x32_bf16 v[108:111], v[20:23], v[60:63], v[108:111]
  v_exp_f32 v123, v123
  s_waitcnt lgkmcnt(0)
  s_barrier
  ds_read_b128 v[16:19], v8 offset:0
  v_mfma_f32_16x16x32_bf16 v[96:99], v[24:27], v[88:91], v[96:99]
  ds_read_b128 v[20:23], v8 offset:2048
  v_cvt_pk_bf16_f32 v206, v124, v125
  v_mfma_f32_16x16x32_bf16 v[100:103], v[24:27], v[92:95], v[100:103]
  v_exp_f32 v126, v126
  v_mfma_f32_16x16x32_bf16 v[104:107], v[28:31], v[88:91], v[104:107]
  ds_read_b128 v[24:27], v8 offset:256
  v_exp_f32 v127, v127
  v_mfma_f32_16x16x32_bf16 v[108:111], v[28:31], v[92:95], v[108:111]
  v_cvt_pk_bf16_f32 v203, v122, v123
  v_cvt_pk_bf16_f32 v207, v126, v127
  s_waitcnt lgkmcnt(2)
  v_mfma_f32_16x16x32_bf16 v[112:115], v[16:19], v[32:35], v[248:251]
  ds_read_b128 v[28:31], v8 offset:2304
  v_mfma_f32_16x16x32_bf16 v[116:119], v[16:19], v[36:39], v[252:255]
  s_waitcnt lgkmcnt(2)
  v_mfma_f32_16x16x32_bf16 v[120:123], v[20:23], v[32:35], v[248:251]
  v_xor_b32 v10, 64, v8
  v_mfma_f32_16x16x32_bf16 v[124:127], v[20:23], v[36:39], v[252:255]
  ds_read_b128 v[16:19], v10 offset:0
  s_waitcnt lgkmcnt(1)
  v_mfma_f32_16x16x32_bf16 v[112:115], v[24:27], v[64:67], v[112:115]
  ds_read_b128 v[20:23], v10 offset:2048
  v_max3_f32 v12, v96, v97, v98
  v_max3_f32 v7, v99, v100, v101
  v_mfma_f32_16x16x32_bf16 v[116:119], v[24:27], v[68:71], v[116:119]
  v_max3_f32 v12, v12, v102, v103
  v_max3_f32 v7, v7, v104, v105
  v_mfma_f32_16x16x32_bf16 v[120:123], v[28:31], v[64:67], v[120:123]
  ds_read_b128 v[24:27], v10 offset:256
  v_max3_f32 v12, v12, v106, v107
  v_max3_f32 v7, v7, v108, v109
  v_mfma_f32_16x16x32_bf16 v[124:127], v[28:31], v[68:71], v[124:127]
  v_max3_f32 v12, v12, v110, v111
  s_waitcnt lgkmcnt(1)
  v_mfma_f32_16x16x32_bf16 v[112:115], v[16:19], v[40:43], v[112:115]
  ds_read_b128 v[28:31], v10 offset:2304
  v_mfma_f32_16x16x32_bf16 v[116:119], v[16:19], v[44:47], v[116:119]
  v_max_f32 v3, v12, v7
  v_cmp_lt_f32 vcc, 0x41a00000, v3
  s_mov_b32 s82, 0
  s_nop 0
  s_cbranch_vccz L_ok_10
  s_call_b64 s[60:61], L_rescue
L_ok_10:
  v_mfma_f32_16x16x32_bf16 v[120:123], v[20:23], v[40:43], v[120:123]
  v_xor_b32 v9, 128, v8
  v_exp_f32 v96, v96
  v_mfma_f32_16x16x32_bf16 v[124:127], v[20:23], v[44:47], v[124:127]
  ds_read_b128 v[16:19], v9 offset:0
  s_waitcnt lgkmcnt(1)
  v_mfma_f32_16x16x32_bf16 v[112:115], v[24:27], v[72:75], v[112:115]
  ds_read_b128 v[20:23], v9 offset:2048
  v_exp_f32 v97, v97
  v_mfma_f32_16x16x32_bf16 v[116:119], v[24:27], v[76:79], v[116:119]
  v_exp_f32 v100, v100
  v_mfma_f32_16x16x32_bf16 v[120:123], v[28:31], v[72:75], v[120:123]
  ds_read_b128 v[24:27], v9 offset:256
  v_exp_f32 v101, v101
  v_mfma_f32_16x16x32_bf16 v[124:127], v[28:31], v[76:79], v[124:127]
  v_cvt_pk_bf16_f32 v208, v96, v97
  v_exp_f32 v98, v98
  s_waitcnt lgkmcnt(1)
  v_mfma_f32_16x16x32_bf16 v[112:115], v[16:19], v[48:51], v[112:115]
  ds_read_b128 v[28:31], v9 offset:2304
  v_mfma_f32_16x16x32_bf16 v[116:119], v[16:19], v[52:55], v[116:119]
  v_exp_f32 v99, v99
  v_cvt_pk_bf16_f32 v212, v100, v101
  v_mfma_f32_16x16x32_bf16 v[120:123], v[20:23], v[48:51], v[120:123]
  v_xor_b32 v10, 192, v8
  v_exp_f32 v102, v102
  v_mfma_f32_16x16x32_bf16 v[124:127], v[20:23], v[52:55], v[124:127]
  ds_read_b128 v[16:19], v10 offset:0
  s_waitcnt lgkmcnt(1)
  v_mfma_f32_16x16x32_bf16 v[112:115], v[24:27], v[80:83], v[112:115]
  ds_read_b128 v[20:23], v10 offset:2048
  v_exp_f32 v103, v103
  v_cvt_pk_bf16_f32 v209, v98, v99
  v_mfma_f32_16x16x32_bf16 v[116:119], v[24:27], v[84:87], v[116:119]
  v_exp_f32 v104, v104
  v_mfma_f32_16x16x32_bf16 v[120:123], v[28:31], v[80:83], v[120:123]
  ds_read_b128 v[24:27], v10 offset:256
  v_exp_f32 v105, v105
  v_mfma_f32_16x16x32_bf16 v[124:127], v[28:31], v[84:87], v[124:127]
  v_cvt_pk_bf16_f32 v213, v102, v103
  s_waitcnt lgkmcnt(1)
  v_mfma_f32_16x16x32_bf16 v[112:115], v[16:19], v[56:59], v[112:115]
  ds_read_b128 v[28:31], v10 offset:2304
  v_exp_f32 v108, v108
  v_mfma_f32_16x16x32_bf16 v[116:119], v[16:19], v[60:63], v[116:119]
  v_exp_f32 v109, v109
  v_cvt_pk_bf16_f32 v210, v104, v105
  s_and_b32 s50, s68, 15
  s_lshr_b64 s[68:69], s[68:69], 4
  s_lshl_b32 s50, s50, 14
  v_add_u32 v8, s50, v6
  v_mfma_f32_16x16x32_bf16 v[120:123], v[20:23], v[56:59], v[120:123]
  v_exp_f32 v106, v106
  v_mfma_f32_16x16x32_bf16 v[124:127], v[20:23], v[60:63], v[124:127]
  v_exp_f32 v107, v107
  s_waitcnt lgkmcnt(0)
  s_barrier
  ds_read_b128 v[16:19], v8 offset:0
  v_mfma_f32_16x16x32_bf16 v[112:115], v[24:27], v[88:91], v[112:115]
  ds_read_b128 v[20:23], v8 offset:2048
  v_cvt_pk_bf16_f32 v214, v108, v109
  v_mfma_f32_16x16x32_bf16 v[116:119], v[24:27], v[92:95], v[116:119]
  v_exp_f32 v110, v110
  v_mfma_f32_16x16x32_bf16 v[120:123], v[28:31], v[88:91], v[120:123]
  ds_read_b128 v[24:27], v8 offset:256
  v_exp_f32 v111, v111
  v_mfma_f32_16x16x32_bf16 v[124:127], v[28:31], v[92:95], v[124:127]
  v_cvt_pk_bf16_f32 v211, v106, v107
  v_cvt_pk_bf16_f32 v215, v110, v111
  s_waitcnt lgkmcnt(2)
  v_mfma_f32_16x16x32_bf16 v[96:99], v[16:19], v[32:35], v[248:251]
  ds_read_b128 v[28:31], v8 offset:2304
  v_mfma_f32_16x16x32_bf16 v[100:103], v[16:19], v[36:39], v[252:255]
  s_waitcnt lgkmcnt(2)
  v_mfma_f32_16x16x32_bf16 v[104:107], v[20:23], v[32:35], v[248:251]
  v_xor_b32 v10, 64, v8
  v_mfma_f32_16x16x32_bf16 v[108:111], v[20:23], v[36:39], v[252:255]
  ds_read_b128 v[16:19], v10 offset:0
  s_waitcnt lgkmcnt(1)
  v_mfma_f32_16x16x32_bf16 v[96:99], v[24:27], v[64:67], v[96:99]
  ds_read_b128 v[20:23], v10 offset:2048
  v_max3_f32 v12, v112, v113, v114
  v_max3_f32 v7, v115, v116, v117
  v_mfma_f32_16x16x32_bf16 v[100:103], v[24:27], v[68:71], v[100:103]
  v_max3_f32 v12, v12, v118, v119
  v_max3_f32 v7, v7, v120, v121
  v_mfma_f32_16x16x32_bf16 v[104:107], v[28:31], v[64:67], v[104:107]
  ds_read_b128 v[24:27], v10 offset:256
  v_max3_f32 v12, v12, v122, v123
  v_max3_f32 v7, v7, v124, v125
  v_mfma_f32_16x16x32_bf16 v[108:111], v[28:31], v[68:71], v[108:111]
  v_max3_f32 v12, v12, v126, v127
  s_waitcnt lgkmcnt(1)
  v_mfma_f32_16x16x32_bf16 v[96:99], v[16:19], v[40:43], v[96:99]
  ds_read_b128 v[28:31], v10 offset:2304
  v_mfma_f32_16x16x32_bf16 v[100:103], v[16:19], v[44:47], v[100:103]
  v_max_f32 v3, v12, v7
  v_cmp_lt_f32 vcc, 0x41a00000, v3
  s_mov_b32 s82, 1
  s_nop 0
  s_cbranch_vccz L_ok_11
  s_call_b64 s[60:61], L_rescue
L_ok_11:
  v_mfma_f32_16x16x32_bf16 v[104:107], v[20:23], v[40:43], v[104:107]
  v_xor_b32 v9, 128, v8
  v_exp_f32 v112, v112
  v_mfma_f32_16x16x32_bf16 v[108:111], v[20:23], v[44:47], v[108:111]
  ds_read_b128 v[16:19], v9 offset:0
  s_waitcnt lgkmcnt(1)
  v_mfma_f32_16x16x32_bf16 v[96:99], v[24:27], v[72:75], v[96:99]
  ds_read_b128 v[20:23], v9 offset:2048
  v_exp_f32 v113, v113
  v_mfma_f32_16x16x32_bf16 v[100:103], v[24:27], v[76:79], v[100:103]
  v_exp_f32 v116, v116
  v_mfma_f32_16x16x32_bf16 v[104:107], v[28:31], v[72:75], v[104:107]
  ds_read_b128 v[24:27], v9 offset:256
  v_exp_f32 v117, v117
  v_mfma_f32_16x16x32_bf16 v[108:111], v[28:31], v[76:79], v[108:111]
  v_cvt_pk_bf16_f32 v216, v112, v113
  v_exp_f32 v114, v114
  s_waitcnt lgkmcnt(1)
  v_mfma_f32_16x16x32_bf16 v[96:99], v[16:19], v[48:51], v[96:99]
  ds_read_b128 v[28:31], v9 offset:2304
  v_mfma_f32_16x16x32_bf16 v[100:103], v[16:19], v[52:55], v[100:103]
  v_exp_f32 v115, v115
  v_cvt_pk_bf16_f32 v220, v116, v117
  v_mfma_f32_16x16x32_bf16 v[104:107], v[20:23], v[48:51], v[104:107]
  v_xor_b32 v10, 192, v8
  v_exp_f32 v118, v118
  v_mfma_f32_16x16x32_bf16 v[108:111], v[20:23], v[52:55], v[108:111]
  ds_read_b128 v[16:19], v10 offset:0
  s_waitcnt lgkmcnt(1)
  v_mfma_f32_16x16x32_bf16 v[96:99], v[24:27], v[80:83], v[96:99]
  ds_read_b128 v[20:23], v10 offset:2048
  v_exp_f32 v119, v119
  v_cvt_pk_bf16_f32 v217, v114, v115
  v_mfma_f32_16x16x32_bf16 v[100:103], v[24:27], v[84:87], v[100:103]
  v_exp_f32 v120, v120
  v_mfma_f32_16x16x32_bf16 v[104:107], v[28:31], v[80:83], v[104:107]
  ds_read_b128 v[24:27], v10 offset:256
  v_exp_f32 v121, v121
  v_mfma_f32_16x16x32_bf16 v[108:111], v[28:31], v[84:87], v[108:111]
  v_cvt_pk_bf16_f32 v221, v118, v119
  s_waitcnt lgkmcnt(1)
  v_mfma_f32_16x16x32_bf16 v[96:99], v[16:19], v[56:59], v[96:99]
  ds_read_b128 v[28:31], v10 offset:2304
  v_exp_f32 v124, v124
  v_mfma_f32_16x16x32_bf16 v[100:103], v[16:19], v[60:63], v[100:103]
  v_exp_f32 v125, v125
  v_cvt_pk_bf16_f32 v218, v120, v121
  s_and_b32 s50, s68, 15
  s_lshr_b64 s[68:69], s[68:69], 4
  s_lshl_b32 s50, s50, 14
  v_add_u32 v8, s50, v6
  v_mfma_f32_16x16x32_bf16 v[104:107], v[20:23], v[56:59], v[104:107]
  v_exp_f32 v122, v122
  v_mfma_f32_16x16x32_bf16 v[108:111], v[20:23], v[60:63], v[108:111]
  v_exp_f32 v123, v123
  s_waitcnt lgkmcnt(0)
  s_barrier
  ds_read_b128 v[16:19], v8 offset:0
  v_mfma_f32_16x16x32_bf16 v[96:99], v[24:27], v[88:91], v[96:99]
  ds_read_b128 v[20:23], v8 offset:2048
  v_cvt_pk_bf16_f32 v222, v124, v125
  v_mfma_f32_16x16x32_bf16 v[100:103], v[24:27], v[92:95], v[100:103]
  v_exp_f32 v126, v126
  v_mfma_f32_16x16x32_bf16 v[104:107], v[28:31], v[88:91], v[104:107]
  ds_read_b128 v[24:27], v8 offset:256
  v_exp_f32 v127, v127
  v_mfma_f32_16x16x32_bf16 v[108:111], v[28:31], v[92:95], v[108:111]
  v_cvt_pk_bf16_f32 v219, v122, v123
  v_cvt_pk_bf16_f32 v223, v126, v127
  s_waitcnt lgkmcnt(2)
  v_mfma_f32_16x16x32_bf16 v[112:115], v[16:19], v[32:35], v[248:251]
  ds_read_b128 v[28:31], v8 offset:2304
  v_mfma_f32_16x16x32_bf16 v[116:119], v[16:19], v[36:39], v[252:255]
  s_waitcnt lgkmcnt(2)
  v_mfma_f32_16x16x32_bf16 v[120:123], v[20:23], v[32:35], v[248:251]
  v_xor_b32 v10, 64, v8
  v_mfma_f32_16x16x32_bf16 v[124:127], v[20:23], v[36:39], v[252:255]
  ds_read_b128 v[16:19], v10 offset:0
  s_waitcnt lgkmcnt(1)
  v_mfma_f32_16x16x32_bf16 v[112:115], v[24:27], v[64:67], v[112:115]
  ds_read_b128 v[20:23], v10 offset:2048
  v_max3_f32 v12, v96, v97, v98
  v_max3_f32 v7, v99, v100, v101
  v_mfma_f32_16x16x32_bf16 v[116:119], v[24:27], v[68:71], v[116:119]
  v_max3_f32 v12, v12, v102, v103
  v_max3_f32 v7, v7, v104, v105
  v_mfma_f32_16x16x32_bf16 v[120:123], v[28:31], v[64:67], v[120:123]
  ds_read_b128 v[24:27], v10 offset:256
  v_max3_f32 v12, v12, v106, v107
  v_max3_f32 v7, v7, v108, v109
  v_mfma_f32_16x16x32_bf16 v[124:127], v[28:31], v[68:71], v[124:127]
  v_max3_f32 v12, v12, v110, v111
  s_waitcnt lgkmcnt(1)
  v_mfma_f32_16x16x32_bf16 v[112:115], v[16:19], v[40:43], v[112:115]
  ds_read_b128 v[28:31], v10 offset:2304
  v_mfma_f32_16x16x32_bf16 v[116:119], v[16:19], v[44:47], v[116:119]
  v_max_f32 v3, v12, v7
  v_cmp_lt_f32 vcc, 0x41a00000, v3
  s_mov_b32 s82, 0
  s_nop 0
  s_cbranch_vccz L_ok_12
  s_call_b64 s[60:61], L_rescue
L_ok_12:
  v_mfma_f32_16x16x32_bf16 v[120:123], v[20:23], v[40:43], v[120:123]
  v_xor_b32 v9, 128, v8
  v_exp_f32 v96, v96
  v_mfma_f32_16x16x32_bf16 v[124:127], v[20:23], v[44:47], v[124:127]
  ds_read_b128 v[16:19], v9 offset:0
  s_waitcnt lgkmcnt(1)
  v_mfma_f32_16x16x32_bf16 v[112:115], v[24:27], v[72:75], v[112:115]
  ds_read_b128 v[20:23], v9 offset:2048
  v_exp_f32 v97, v97
  v_mfma_f32_16x16x32_bf16 v[116:119], v[24:27], v[76:79], v[116:119]
  v_exp_f32 v100, v100
  v_mfma_f32_16x16x32_bf16 v[120:123], v[28:31], v[72:75], v[120:123]
  ds_read_b128 v[24:27], v9 offset:256
  v_exp_f32 v101, v101
  v_mfma_f32_16x16x32_bf16 v[124:127], v[28:31], v[76:79], v[124:127]
  v_cvt_pk_bf16_f32 v224, v96, v97
  v_exp_f32 v98, v98
  s_waitcnt lgkmcnt(1)
  v_mfma_f32_16x16x32_bf16 v[112:115], v[16:19], v[48:51], v[112:115]
  ds_read_b128 v[28:31], v9 offset:2304
  v_mfma_f32_16x16x32_bf16 v[116:119], v[16:19], v[52:55], v[116:119]
  v_exp_f32 v99, v99
  v_cvt_pk_bf16_f32 v228, v100, v101
  v_mfma_f32_16x16x32_bf16 v[120:123], v[20:23], v[48:51], v[120:123]
  v_xor_b32 v10, 192, v8
  v_exp_f32 v102, v102
  v_mfma_f32_16x16x32_bf16 v[124:127], v[20:23], v[52:55], v[124:127]
  ds_read_b128 v[16:19], v10 offset:0
  s_waitcnt lgkmcnt(1)
  v_mfma_f32_16x16x32_bf16 v[112:115], v[24:27], v[80:83], v[112:115]
  ds_read_b128 v[20:23], v10 offset:2048
  v_exp_f32 v103, v103
  v_cvt_pk_bf16_f32 v225, v98, v99
  v_mfma_f32_16x16x32_bf16 v[116:119], v[24:27], v[84:87], v[116:119]
  v_exp_f32 v104, v104
  v_mfma_f32_16x16x32_bf16 v[120:123], v[28:31], v[80:83], v[120:123]
  ds_read_b128 v[24:27], v10 offset:256
  v_exp_f32 v105, v105
  v_mfma_f32_16x16x32_bf16 v[124:127], v[28:31], v[84:87], v[124:127]
  v_cvt_pk_bf16_f32 v229, v102, v103
  s_waitcnt lgkmcnt(1)
  v_mfma_f32_16x16x32_bf16 v[112:115], v[16:19], v[56:59], v[112:115]
  ds_read_b128 v[28:31], v10 offset:2304
  v_exp_f32 v108, v108
  v_mfma_f32_16x16x32_bf16 v[116:119], v[16:19], v[60:63], v[116:119]
  v_exp_f32 v109, v109
  v_cvt_pk_bf16_f32 v226, v104, v105
  s_and_b32 s50, s68, 15
  s_lshr_b64 s[68:69], s[68:69], 4
  s_lshl_b32 s50, s50, 14
  v_add_u32 v8, s50, v6
  v_mfma_f32_16x16x32_bf16 v[120:123], v[20:23], v[56:59], v[120:123]
  v_exp_f32 v106, v106
  v_mfma_f32_16x16x32_bf16 v[124:127], v[20:23], v[60:63], v[124:127]
  v_exp_f32 v107, v107
  s_waitcnt lgkmcnt(0)
  s_barrier
  ds_read_b128 v[16:19], v8 offset:0
  v_mfma_f32_16x16x32_bf16 v[112:115], v[24:27], v[88:91], v[112:115]
  ds_read_b128 v[20:23], v8 offset:2048
  v_cvt_pk_bf16_f32 v230, v108, v109
  v_mfma_f32_16x16x32_bf16 v[116:119], v[24:27], v[92:95], v[116:119]
  v_exp_f32 v110, v110
  v_mfma_f32_16x16x32_bf16 v[120:123], v[28:31], v[88:91], v[120:123]
  ds_read_b128 v[24:27], v8 offset:256
  v_exp_f32 v111, v111
  v_mfma_f32_16x16x32_bf16 v[124:127], v[28:31], v[92:95], v[124:127]
  v_cvt_pk_bf16_f32 v227, v106, v107
  v_cvt_pk_bf16_f32 v231, v110, v111
  s_waitcnt lgkmcnt(2)
  v_mfma_f32_16x16x32_bf16 v[96:99], v[16:19], v[32:35], v[248:251]
  ds_read_b128 v[28:31], v8 offset:2304
  v_mfma_f32_16x16x32_bf16 v[100:103], v[16:19], v[36:39], v[252:255]
  s_waitcnt lgkmcnt(2)
  v_mfma_f32_16x16x32_bf16 v[104:107], v[20:23], v[32:35], v[248:251]
  v_xor_b32 v10, 64, v8
  v_mfma_f32_16x16x32_bf16 v[108:111], v[20:23], v[36:39], v[252:255]
  ds_read_b128 v[16:19], v10 offset:0
  s_waitcnt lgkmcnt(1)
  v_mfma_f32_16x16x32_bf16 v[96:99], v[24:27], v[64:67], v[96:99]
  ds_read_b128 v[20:23], v10 offset:2048
  v_max3_f32 v12, v112, v113, v114
  v_max3_f32 v7, v115, v116, v117
  v_mfma_f32_16x16x32_bf16 v[100:103], v[24:27], v[68:71], v[100:103]
  v_max3_f32 v12, v12, v118, v119
  v_max3_f32 v7, v7, v120, v121
  v_mfma_f32_16x16x32_bf16 v[104:107], v[28:31], v[64:67], v[104:107]
  ds_read_b128 v[24:27], v10 offset:256
  v_max3_f32 v12, v12, v122, v123
  v_max3_f32 v7, v7, v124, v125
  v_mfma_f32_16x16x32_bf16 v[108:111], v[28:31], v[68:71], v[108:111]
  v_max3_f32 v12, v12, v126, v127
  s_waitcnt lgkmcnt(1)
  v_mfma_f32_16x16x32_bf16 v[96:99], v[16:19], v[40:43], v[96:99]
  ds_read_b128 v[28:31], v10 offset:2304
  v_mfma_f32_16x16x32_bf16 v[100:103], v[16:19], v[44:47], v[100:103]
  v_max_f32 v3, v12, v7
  v_cmp_lt_f32 vcc, 0x41a00000, v3
  s_mov_b32 s82, 1
  s_nop 0
  s_cbranch_vccz L_ok_13
  s_call_b64 s[60:61], L_rescue
L_ok_13:
  v_mfma_f32_16x16x32_bf16 v[104:107], v[20:23], v[40:43], v[104:107]
  v_xor_b32 v9, 128, v8
  v_exp_f32 v112, v112
  v_mfma_f32_16x16x32_bf16 v[108:111], v[20:23], v[44:47], v[108:111]
  ds_read_b128 v[16:19], v9 offset:0
  s_waitcnt lgkmcnt(1)
  v_mfma_f32_16x16x32_bf16 v[96:99], v[24:27], v[72:75], v[96:99]
  ds_read_b128 v[20:23], v9 offset:2048
  v_exp_f32 v113, v113
  v_mfma_f32_16x16x32_bf16 v[100:103], v[24:27], v[76:79], v[100:103]
  v_exp_f32 v116, v116
  v_mfma_f32_16x16x32_bf16 v[104:107], v[28:31], v[72:75], v[104:107]
  ds_read_b128 v[24:27], v9 offset:256
  v_exp_f32 v117, v117
  v_mfma_f32_16x16x32_bf16 v[108:111], v[28:31], v[76:79], v[108:111]
  v_cvt_pk_bf16_f32 v232, v112, v113
  v_exp_f32 v114, v114
  s_waitcnt lgkmcnt(1)
  v_mfma_f32_16x16x32_bf16 v[96:99], v[16:19], v[48:51], v[96:99]
  ds_read_b128 v[28:31], v9 offset:2304
  v_mfma_f32_16x16x32_bf16 v[100:103], v[16:19], v[52:55], v[100:103]
  v_exp_f32 v115, v115
  v_cvt_pk_bf16_f32 v236, v116, v117
  v_mfma_f32_16x16x32_bf16 v[104:107], v[20:23], v[48:51], v[104:107]
  v_xor_b32 v10, 192, v8
  v_exp_f32 v118, v118
  v_mfma_f32_16x16x32_bf16 v[108:111], v[20:23], v[52:55], v[108:111]
  ds_read_b128 v[16:19], v10 offset:0
  s_waitcnt lgkmcnt(1)
  v_mfma_f32_16x16x32_bf16 v[96:99], v[24:27], v[80:83], v[96:99]
  ds_read_b128 v[20:23], v10 offset:2048
  v_exp_f32 v119, v119
  v_cvt_pk_bf16_f32 v233, v114, v115
  v_mfma_f32_16x16x32_bf16 v[100:103], v[24:27], v[84:87], v[100:103]
  v_exp_f32 v120, v120
  v_mfma_f32_16x16x32_bf16 v[104:107], v[28:31], v[80:83], v[104:107]
  ds_read_b128 v[24:27], v10 offset:256
  v_exp_f32 v121, v121
  v_mfma_f32_16x16x32_bf16 v[108:111], v[28:31], v[84:87], v[108:111]
  v_cvt_pk_bf16_f32 v237, v118, v119
  s_waitcnt lgkmcnt(1)
  v_mfma_f32_16x16x32_bf16 v[96:99], v[16:19], v[56:59], v[96:99]
  ds_read_b128 v[28:31], v10 offset:2304
  v_exp_f32 v124, v124
  v_mfma_f32_16x16x32_bf16 v[100:103], v[16:19], v[60:63], v[100:103]
  v_exp_f32 v125, v125
  v_cvt_pk_bf16_f32 v234, v120, v121
  s_and_b32 s50, s68, 15
  s_lshr_b64 s[68:69], s[68:69], 4
  s_lshl_b32 s50, s50, 14
  v_add_u32 v8, s50, v6
  v_mfma_f32_16x16x32_bf16 v[104:107], v[20:23], v[56:59], v[104:107]
  v_exp_f32 v122, v122
  v_mfma_f32_16x16x32_bf16 v[108:111], v[20:23], v[60:63], v[108:111]
  v_exp_f32 v123, v123
  s_waitcnt lgkmcnt(0)
  s_barrier
  ds_read_b128 v[16:19], v8 offset:0
  v_mfma_f32_16x16x32_bf16 v[96:99], v[24:27], v[88:91], v[96:99]
  ds_read_b128 v[20:23], v8 offset:2048
  v_cvt_pk_bf16_f32 v238, v124, v125
  v_mfma_f32_16x16x32_bf16 v[100:103], v[24:27], v[92:95], v[100:103]
  v_exp_f32 v126, v126
  v_mfma_f32_16x16x32_bf16 v[104:107], v[28:31], v[88:91], v[104:107]
  ds_read_b128 v[24:27], v8 offset:256
  v_exp_f32 v127, v127
  v_mfma_f32_16x16x32_bf16 v[108:111], v[28:31], v[92:95], v[108:111]
  v_cvt_pk_bf16_f32 v235, v122, v123
  v_cvt_pk_bf16_f32 v239, v126, v127
  s_waitcnt lgkmcnt(2)
  v_mfma_f32_16x16x32_bf16 v[112:115], v[16:19], v[32:35], v[248:251]
  ds_read_b128 v[28:31], v8 offset:2304
  v_mfma_f32_16x16x32_bf16 v[116:119], v[16:19], v[36:39], v[252:255]
  s_waitcnt lgkmcnt(2)
  v_mfma_f32_16x16x32_bf16 v[120:123], v[20:23], v[32:35], v[248:251]
  v_xor_b32 v10, 64, v8
  v_mfma_f32_16x16x32_bf16 v[124:127], v[20:23], v[36:39], v[252:255]
  ds_read_b128 v[16:19], v10 offset:0
  s_waitcnt lgkmcnt(1)
  v_mfma_f32_16x16x32_bf16 v[112:115], v[24:27], v[64:67], v[112:115]
  ds_read_b128 v[20:23], v10 offset:2048
  v_max3_f32 v12, v96, v97, v98
  v_max3_f32 v7, v99, v100, v101
  v_mfma_f32_16x16x32_bf16 v[116:119], v[24:27], v[68:71], v[116:119]
  v_max3_f32 v12, v12, v102, v103
  v_max3_f32 v7, v7, v104, v105
  v_mfma_f32_16x16x32_bf16 v[120:123], v[28:31], v[64:67], v[120:123]
  ds_read_b128 v[24:27], v10 offset:256
  v_max3_f32 v12, v12, v106, v107
  v_max3_f32 v7, v7, v108, v109
  v_mfma_f32_16x16x32_bf16 v[124:127], v[28:31], v[68:71], v[124:127]
  v_max3_f32 v12, v12, v110, v111
  s_waitcnt lgkmcnt(1)
  v_mfma_f32_16x16x32_bf16 v[112:115], v[16:19], v[40:43], v[112:115]
  ds_read_b128 v[28:31], v10 offset:2304
  v_mfma_f32_16x16x32_bf16 v[116:119], v[16:19], v[44:47], v[116:119]
  v_max_f32 v3, v12, v7
  v_cmp_lt_f32 vcc, 0x41a00000, v3
  s_mov_b32 s82, 0
  s_nop 0
  s_cbranch_vccz L_ok_14
  s_call_b64 s[60:61], L_rescue
L_ok_14:
  v_mfma_f32_16x16x32_bf16 v[120:123], v[20:23], v[40:43], v[120:123]
  v_xor_b32 v9, 128, v8
  v_exp_f32 v96, v96
  v_mfma_f32_16x16x32_bf16 v[124:127], v[20:23], v[44:47], v[124:127]
  ds_read_b128 v[16:19], v9 offset:0
  s_waitcnt lgkmcnt(1)
  v_mfma_f32_16x16x32_bf16 v[112:115], v[24:27], v[72:75], v[112:115]
  ds_read_b128 v[20:23], v9 offset:2048
  v_exp_f32 v97, v97
  v_mfma_f32_16x16x32_bf16 v[116:119], v[24:27], v[76:79], v[116:119]
  v_exp_f32 v100, v100
  v_mfma_f32_16x16x32_bf16 v[120:123], v[28:31], v[72:75], v[120:123]
  ds_read_b128 v[24:27], v9 offset:256
  v_exp_f32 v101, v101
  v_mfma_f32_16x16x32_bf16 v[124:127], v[28:31], v[76:79], v[124:127]
  v_cvt_pk_bf16_f32 v240, v96, v97
  v_exp_f32 v98, v98
  s_waitcnt lgkmcnt(1)
  v_mfma_f32_16x16x32_bf16 v[112:115], v[16:19], v[48:51], v[112:115]
  ds_read_b128 v[28:31], v9 offset:2304
  v_mfma_f32_16x16x32_bf16 v[116:119], v[16:19], v[52:55], v[116:119]
  v_exp_f32 v99, v99
  v_cvt_pk_bf16_f32 v244, v100, v101
  v_mfma_f32_16x16x32_bf16 v[120:123], v[20:23], v[48:51], v[120:123]
  v_xor_b32 v10, 192, v8
  v_exp_f32 v102, v102
  v_mfma_f32_16x16x32_bf16 v[124:127], v[20:23], v[52:55], v[124:127]
  ds_read_b128 v[16:19], v10 offset:0
  s_waitcnt lgkmcnt(1)
  v_mfma_f32_16x16x32_bf16 v[112:115], v[24:27], v[80:83], v[112:115]
  ds_read_b128 v[20:23], v10 offset:2048
  v_exp_f32 v103, v103
  v_cvt_pk_bf16_f32 v241, v98, v99
  v_mfma_f32_16x16x32_bf16 v[116:119], v[24:27], v[84:87], v[116:119]
  v_exp_f32 v104, v104
  v_mfma_f32_16x16x32_bf16 v[120:123], v[28:31], v[80:83], v[120:123]
  ds_read_b128 v[24:27], v10 offset:256
  v_exp_f32 v105, v105
  v_mfma_f32_16x16x32_bf16 v[124:127], v[28:31], v[84:87], v[124:127]
  v_cvt_pk_bf16_f32 v245, v102, v103
  s_waitcnt lgkmcnt(1)
  v_mfma_f32_16x16x32_bf16 v[112:115], v[16:19], v[56:59], v[112:115]
  ds_read_b128 v[28:31], v10 offset:2304
  v_exp_f32 v108, v108
  v_mfma_f32_16x16x32_bf16 v[116:119], v[16:19], v[60:63], v[116:119]
  v_exp_f32 v109, v109
  v_cvt_pk_bf16_f32 v242, v104, v105
  s_and_b32 s50, s70, 15
  s_lshr_b64 s[70:71], s[70:71], 4
  s_lshl_b32 s50, s50, 14
  v_add_u32 v8, s50, v5
  v_mfma_f32_16x16x32_bf16 v[120:123], v[20:23], v[56:59], v[120:123]
  v_exp_f32 v106, v106
  v_mfma_f32_16x16x32_bf16 v[124:127], v[20:23], v[60:63], v[124:127]
  v_exp_f32 v107, v107
  s_waitcnt lgkmcnt(0)
  s_barrier
  ds_read_b64_tr_b16 v[16:17], v8 offset:0
  ds_read_b64_tr_b16 v[18:19], v8 offset:1024
  v_mfma_f32_16x16x32_bf16 v[112:115], v[24:27], v[88:91], v[112:115]
  ds_read_b64_tr_b16 v[20:21], v8 offset:8192
  v_cvt_pk_bf16_f32 v246, v108, v109
  v_mfma_f32_16x16x32_bf16 v[116:119], v[24:27], v[92:95], v[116:119]
  ds_read_b64_tr_b16 v[22:23], v8 offset:9216
  v_exp_f32 v110, v110
  v_mfma_f32_16x16x32_bf16 v[120:123], v[28:31], v[88:91], v[120:123]
  v_xor_b32 v10, 32, v8
  ds_read_b64_tr_b16 v[24:25], v10 offset:0
  v_exp_f32 v111, v111
  v_mfma_f32_16x16x32_bf16 v[124:127], v[28:31], v[92:95], v[124:127]
  ds_read_b64_tr_b16 v[26:27], v10 offset:1024
  v_cvt_pk_bf16_f32 v243, v106, v107
  v_cvt_pk_bf16_f32 v247, v110, v111
  s_waitcnt lgkmcnt(4)
  v_mfma_f32_16x16x32_bf16 v[32:35], v[16:19], v[128:131], 0
  ds_read_b64_tr_b16 v[28:29], v10 offset:8192
  v_mfma_f32_16x16x32_bf16 v[36:39], v[16:19], v[132:135], 0
  ds_read_b64_tr_b16 v[30:31], v10 offset:9216
  s_waitcnt lgkmcnt(4)
  v_mfma_f32_16x16x32_bf16 v[32:35], v[20:23], v[136:139], v[32:35]
  v_xor_b32 v9, 64, v8
  ds_read_b64_tr_b16 v[16:17], v9 offset:0
  v_mfma_f32_16x16x32_bf16 v[36:39], v[20:23], v[140:143], v[36:39]
  ds_read_b64_tr_b16 v[18:19], v9 offset:1024
  s_waitcnt lgkmcnt(4)
  v_mfma_f32_16x16x32_bf16 v[40:43], v[24:27], v[128:131], 0
  ds_read_b64_tr_b16 v[20:21], v9 offset:8192
  v_max3_f32 v12, v112, v113, v114
  v_max3_f32 v7, v115, v116, v117
  v_max3_f32 v12, v12, v118, v119
  v_mfma_f32_16x16x32_bf16 v[44:47], v[24:27], v[132:135], 0
  ds_read_b64_tr_b16 v[22:23], v9 offset:9216
  v_max3_f32 v7, v7, v120, v121
  s_waitcnt lgkmcnt(4)
  v_mfma_f32_16x16x32_bf16 v[40:43], v[28:31], v[136:139], v[40:43]
  v_xor_b32 v10, 96, v8
  ds_read_b64_tr_b16 v[24:25], v10 offset:0
  v_max3_f32 v12, v12, v122, v123
  v_max3_f32 v7, v7, v124, v125
  v_mfma_f32_16x16x32_bf16 v[44:47], v[28:31], v[140:143], v[44:47]
  ds_read_b64_tr_b16 v[26:27], v10 offset:1024
  v_max3_f32 v12, v12, v126, v127
  s_waitcnt lgkmcnt(4)
  v_mfma_f32_16x16x32_bf16 v[48:51], v[16:19], v[128:131], 0
  ds_read_b64_tr_b16 v[28:29], v10 offset:8192
  v_max_f32 v3, v12, v7
  v_cmp_lt_f32 vcc, 0x41a00000, v3
  s_mov_b32 s82, 3
  s_nop 0
  s_cbranch_vccz L_ok_15
  s_call_b64 s[60:61], L_rescue
L_ok_15:
  v_mfma_f32_16x16x32_bf16 v[52:55], v[16:19], v[132:135], 0
  ds_read_b64_tr_b16 v[30:31], v10 offset:9216
  s_waitcnt lgkmcnt(4)
  v_mfma_f32_16x16x32_bf16 v[48:51], v[20:23], v[136:139], v[48:51]
  v_xor_b32 v9, 128, v8
  ds_read_b64_tr_b16 v[16:17], v9 offset:0
  v_exp_f32 v112, v112
  v_mfma_f32_16x16x32_bf16 v[52:55], v[20:23], v[140:143], v[52:55]
  ds_read_b64_tr_b16 v[18:19], v9 offset:1024
  s_waitcnt lgkmcnt(4)
  v_mfma_f32_16x16x32_bf16 v[56:59], v[24:27], v[128:131], 0
  ds_read_b64_tr_b16 v[20:21], v9 offset:8192
  v_exp_f32 v113, v113
  v_exp_f32 v116, v116
  v_mfma_f32_16x16x32_bf16 v[60:63], v[24:27], v[132:135], 0
  ds_read_b64_tr_b16 v[22:23], v9 offset:9216
  s_waitcnt lgkmcnt(4)
  v_mfma_f32_16x16x32_bf16 v[56:59], v[28:31], v[136:139], v[56:59]
  v_xor_b32 v10, 160, v8
  ds_read_b64_tr_b16 v[24:25], v10 offset:0
  v_exp_f32 v117, v117
  v_mfma_f32_16x16x32_bf16 v[60:63], v[28:31], v[140:143], v[60:63]
  s_branch L_pads8
L_pad8:
  s_setpc_b64 s[60:61]
L_pads8:
  ds_read_b64_tr_b16 v[26:27], v10 offset:1024
  v_cvt_pk_bf16_f32 v248, v112, v113
  s_waitcnt lgkmcnt(4)
  v_mfma_f32_16x16x32_bf16 v[64:67], v[16:19], v[128:131], 0
  ds_read_b64_tr_b16 v[28:29], v10 offset:8192
  v_exp_f32 v114, v114
  v_exp_f32 v115, v115
  v_mfma_f32_16x16x32_bf16 v[68:71], v[16:19], v[132:135], 0
  ds_read_b64_tr_b16 v[30:31], v10 offset:9216
  v_cvt_pk_bf16_f32 v252, v116, v117
  s_waitcnt lgkmcnt(4)
  v_mfma_f32_16x16x32_bf16 v[64:67], v[20:23], v[136:139], v[64:67]
  v_xor_b32 v9, 192, v8
  ds_read_b64_tr_b16 v[16:17], v9 offset:0
  v_exp_f32 v118, v118
  v_mfma_f32_16x16x32_bf16 v[68:71], v[20:23], v[140:143], v[68:71]
  ds_read_b64_tr_b16 v[18:19], v9 offset:1024
  v_exp_f32 v119, v119
  s_waitcnt lgkmcnt(4)
  v_mfma_f32_16x16x32_bf16 v[72:75], v[24:27], v[128:131], 0
  ds_read_b64_tr_b16 v[20:21], v9 offset:8192
  v_cvt_pk_bf16_f32 v249, v114, v115
  v_mfma_f32_16x16x32_bf16 v[76:79], v[24:27], v[132:135], 0
  ds_read_b64_tr_b16 v[22:23], v9 offset:9216
  v_exp_f32 v120, v120
  s_waitcnt lgkmcnt(4)
  v_mfma_f32_16x16x32_bf16 v[72:75], v[28:31], v[136:139], v[72:75]
  v_xor_b32 v10, 224, v8
  ds_read_b64_tr_b16 v[24:25], v10 offset:0
  v_exp_f32 v121, v121
  v_mfma_f32_16x16x32_bf16 v[76:79], v[28:31], v[140:143], v[76:79]
  ds_read_b64_tr_b16 v[26:27], v10 offset:1024
  v_cvt_pk_bf16_f32 v253, v118, v119
  s_waitcnt lgkmcnt(4)
  v_mfma_f32_16x16x32_bf16 v[80:83], v[16:19], v[128:131], 0
  ds_read_b64_tr_b16 v[28:29], v10 offset:8192
  v_exp_f32 v124, v124
  v_exp_f32 v125, v125
  v_mfma_f32_16x16x32_bf16 v[84:87], v[16:19], v[132:135], 0
  ds_read_b64_tr_b16 v[30:31], v10 offset:9216
  v_cvt_pk_bf16_f32 v250, v120, v121
  v_mov_b32 v96, v14
  v_mov_b32 v97, v14
  s_and_b32 s50, s70, 15
  s_lshr_b64 s[70:71], s[70:71], 4
  s_lshl_b32 s50, s50, 14
  v_add_u32 v8, s50, v5
  s_waitcnt lgkmcnt(4)
  v_mfma_f32_16x16x32_bf16 v[80:83], v[20:23], v[136:139], v[80:83]
  v_exp_f32 v122, v122
  v_mov_b32 v98, v14
  v_mfma_f32_16x16x32_bf16 v[84:87], v[20:23], v[140:143], v[84:87]
  v_exp_f32 v123, v123
  v_mov_b32 v99, v14
  s_waitcnt lgkmcnt(0)
  s_barrier
  ds_read_b64_tr_b16 v[16:17], v8 offset:0
  ds_read_b64_tr_b16 v[18:19], v8 offset:1024
  v_mfma_f32_16x16x32_bf16 v[88:91], v[24:27], v[128:131], 0
  v_xor_b32 v9, 32, v8
  ds_read_b64_tr_b16 v[20:21], v9 offset:0
  v_cvt_pk_bf16_f32 v254, v124, v125
  v_exp_f32 v126, v126
  v_mfma_f32_16x16x32_bf16 v[92:95], v[24:27], v[132:135], 0
  ds_read_b64_tr_b16 v[22:23], v9 offset:1024
  v_mfma_f32_16x16x32_bf16 v[88:91], v[28:31], v[136:139], v[88:91]
  v_xor_b32 v10, 64, v8
  ds_read_b64_tr_b16 v[24:25], v10 offset:0
  v_exp_f32 v127, v127
  v_mfma_f32_16x16x32_bf16 v[92:95], v[28:31], v[140:143], v[92:95]
  ds_read_b64_tr_b16 v[26:27], v10 offset:1024
  v_cvt_pk_bf16_f32 v251, v122, v123
  v_cvt_pk_bf16_f32 v255, v126, v127
  s_waitcnt lgkmcnt(4)
  v_mfma_f32_16x16x32_bf16 v[32:35], v[16:19], v[144:147], v[32:35]
  v_xor_b32 v11, 96, v8
  ds_read_b64_tr_b16 v[28:29], v11 offset:0
  v_mfma_f32_16x16x32_bf16 v[36:39], v[16:19], v[148:151], v[36:39]
  ds_read_b64_tr_b16 v[30:31], v11 offset:1024
  s_waitcnt lgkmcnt(4)
  v_mfma_f32_16x16x32_bf16 v[40:43], v[20:23], v[144:147], v[40:43]
  v_xor_b32 v108, 128, v8
  ds_read_b64_tr_b16 v[16:17], v108 offset:0
  v_mfma_f32_16x16x32_bf16 v[44:47], v[20:23], v[148:151], v[44:47]
  ds_read_b64_tr_b16 v[18:19], v108 offset:1024
  s_waitcnt lgkmcnt(4)
  v_mfma_f32_16x16x32_bf16 v[48:51], v[24:27], v[144:147], v[48:51]
  v_xor_b32 v109, 160, v8
  ds_read_b64_tr_b16 v[20:21], v109 offset:0
  v_mfma_f32_16x16x32_bf16 v[52:55], v[24:27], v[148:151], v[52:55]
  ds_read_b64_tr_b16 v[22:23], v109 offset:1024
  s_waitcnt lgkmcnt(4)
  v_mfma_f32_16x16x32_bf16 v[56:59], v[28:31], v[144:147], v[56:59]
  v_xor_b32 v110, 192, v8
  ds_read_b64_tr_b16 v[24:25], v110 offset:0
  v_mfma_f32_16x16x32_bf16 v[60:63], v[28:31], v[148:151], v[60:63]
  ds_read_b64_tr_b16 v[26:27], v110 offset:1024
  s_waitcnt lgkmcnt(4)
  v_mfma_f32_16x16x32_bf16 v[64:67], v[16:19], v[144:147], v[64:67]
  v_xor_b32 v111, 224, v8
  ds_read_b64_tr_b16 v[28:29], v111 offset:0
  v_mfma_f32_16x16x32_bf16 v[68:71], v[16:19], v[148:151], v[68:71]
  ds_read_b64_tr_b16 v[30:31], v111 offset:1024
  s_waitcnt lgkmcnt(4)
  v_mfma_f32_16x16x32_bf16 v[72:75], v[20:23], v[144:147], v[72:75]
  ds_read_b64_tr_b16 v[16:17], v8 offset:8192
  v_mfma_f32_16x16x32_bf16 v[100:103], v[96:99], v[128:131], 0
  v_mfma_f32_16x16x32_bf16 v[76:79], v[20:23], v[148:151], v[76:79]
  ds_read_b64_tr_b16 v[18:19], v8 offset:9216
  s_waitcnt lgkmcnt(4)
  v_mfma_f32_16x16x32_bf16 v[80:83], v[24:27], v[144:147], v[80:83]
  ds_read_b64_tr_b16 v[20:21], v9 offset:8192
  v_mfma_f32_16x16x32_bf16 v[84:87], v[24:27], v[148:151], v[84:87]
  ds_read_b64_tr_b16 v[22:23], v9 offset:9216
  s_waitcnt lgkmcnt(4)
  v_mfma_f32_16x16x32_bf16 v[88:91], v[28:31], v[144:147], v[88:91]
  ds_read_b64_tr_b16 v[24:25], v10 offset:8192
  v_mfma_f32_16x16x32_bf16 v[104:107], v[96:99], v[132:135], 0
  v_mfma_f32_16x16x32_bf16 v[92:95], v[28:31], v[148:151], v[92:95]
  ds_read_b64_tr_b16 v[26:27], v10 offset:9216
  s_waitcnt lgkmcnt(4)
  v_mfma_f32_16x16x32_bf16 v[32:35], v[16:19], v[152:155], v[32:35]
  ds_read_b64_tr_b16 v[28:29], v11 offset:8192
  v_mfma_f32_16x16x32_bf16 v[36:39], v[16:19], v[156:159], v[36:39]
  ds_read_b64_tr_b16 v[30:31], v11 offset:9216
  s_waitcnt lgkmcnt(4)
  v_mfma_f32_16x16x32_bf16 v[40:43], v[20:23], v[152:155], v[40:43]
  ds_read_b64_tr_b16 v[16:17], v108 offset:8192
  v_mfma_f32_16x16x32_bf16 v[100:103], v[96:99], v[136:139], v[100:103]
  v_mfma_f32_16x16x32_bf16 v[44:47], v[20:23], v[156:159], v[44:47]
  ds_read_b64_tr_b16 v[18:19], v108 offset:9216
  s_waitcnt lgkmcnt(4)
  v_mfma_f32_16x16x32_bf16 v[48:51], v[24:27], v[152:155], v[48:51]
  ds_read_b64_tr_b16 v[20:21], v109 offset:8192
  v_mfma_f32_16x16x32_bf16 v[52:55], v[24:27], v[156:159], v[52:55]
  ds_read_b64_tr_b16 v[22:23], v109 offset:9216
  s_waitcnt lgkmcnt(4)
  v_mfma_f32_16x16x32_bf16 v[56:59], v[28:31], v[152:155], v[56:59]
  ds_read_b64_tr_b16 v[24:25], v110 offset:8192
  v_mfma_f32_16x16x32_bf16 v[104:107], v[96:99], v[140:143], v[104:107]
  v_mfma_f32_16x16x32_bf16 v[60:63], v[28:31], v[156:159], v[60:63]
  ds_read_b64_tr_b16 v[26:27], v110 offset:9216
  s_waitcnt lgkmcnt(4)
  v_mfma_f32_16x16x32_bf16 v[64:67], v[16:19], v[152:155], v[64:67]
  ds_read_b64_tr_b16 v[28:29], v111 offset:8192
  v_mfma_f32_16x16x32_bf16 v[68:71], v[16:19], v[156:159], v[68:71]
  ds_read_b64_tr_b16 v[30:31], v111 offset:9216
  s_and_b32 s50, s70, 15
  s_lshr_b64 s[70:71], s[70:71], 4
  s_lshl_b32 s50, s50, 14
  v_add_u32 v8, s50, v5
  s_waitcnt lgkmcnt(4)
  v_mfma_f32_16x16x32_bf16 v[72:75], v[20:23], v[152:155], v[72:75]
  v_mfma_f32_16x16x32_bf16 v[100:103], v[96:99], v[144:147], v[100:103]
  v_mfma_f32_16x16x32_bf16 v[76:79], v[20:23], v[156:159], v[76:79]
  s_waitcnt lgkmcnt(0)
  s_barrier
  ds_read_b64_tr_b16 v[16:17], v8 offset:0
  ds_read_b64_tr_b16 v[18:19], v8 offset:1024
  v_mfma_f32_16x16x32_bf16 v[80:83], v[24:27], v[152:155], v[80:83]
  v_xor_b32 v9, 32, v8
  ds_read_b64_tr_b16 v[20:21], v9 offset:0
  v_mfma_f32_16x16x32_bf16 v[84:87], v[24:27], v[156:159], v[84:87]
  ds_read_b64_tr_b16 v[22:23], v9 offset:1024
  v_mfma_f32_16x16x32_bf16 v[88:91], v[28:31], v[152:155], v[88:91]
  v_xor_b32 v10, 64, v8
  ds_read_b64_tr_b16 v[24:25], v10 offset:0
  v_mfma_f32_16x16x32_bf16 v[92:95], v[28:31], v[156:159], v[92:95]
  ds_read_b64_tr_b16 v[26:27], v10 offset:1024
  s_waitcnt lgkmcnt(4)
  v_mfma_f32_16x16x32_bf16 v[32:35], v[16:19], v[160:163], v[32:35]
  v_xor_b32 v11, 96, v8
  ds_read_b64_tr_b16 v[28:29], v11 offset:0
  v_mfma_f32_16x16x32_bf16 v[36:39], v[16:19], v[164:167], v[36:39]
  ds_read_b64_tr_b16 v[30:31], v11 offset:1024
  s_waitcnt lgkmcnt(4)
  v_mfma_f32_16x16x32_bf16 v[40:43], v[20:23], v[160:163], v[40:43]
  v_xor_b32 v108, 128, v8
  ds_read_b64_tr_b16 v[16:17], v108 offset:0
  v_mfma_f32_16x16x32_bf16 v[44:47], v[20:23], v[164:167], v[44:47]
  ds_read_b64_tr_b16 v[18:19], v108 offset:1024
  s_waitcnt lgkmcnt(4)
  v_mfma_f32_16x16x32_bf16 v[48:51], v[24:27], v[160:163], v[48:51]
  v_xor_b32 v109, 160, v8
  ds_read_b64_tr_b16 v[20:21], v109 offset:0
  v_mfma_f32_16x16x32_bf16 v[52:55], v[24:27], v[164:167], v[52:55]
  ds_read_b64_tr_b16 v[22:23], v109 offset:1024
  s_waitcnt lgkmcnt(4)
  v_mfma_f32_16x16x32_bf16 v[56:59], v[28:31], v[160:163], v[56:59]
  v_xor_b32 v110, 192, v8
  ds_read_b64_tr_b16 v[24:25], v110 offset:0
  v_mfma_f32_16x16x32_bf16 v[60:63], v[28:31], v[164:167], v[60:63]
  ds_read_b64_tr_b16 v[26:27], v110 offset:1024
  s_waitcnt lgkmcnt(4)
  v_mfma_f32_16x16x32_bf16 v[64:67], v[16:19], v[160:163], v[64:67]
  v_xor_b32 v111, 224, v8
  ds_read_b64_tr_b16 v[28:29], v111 offset:0
  v_mfma_f32_16x16x32_bf16 v[68:71], v[16:19], v[164:167], v[68:71]
  ds_read_b64_tr_b16 v[30:31], v111 offset:1024
  s_waitcnt lgkmcnt(4)
  v_mfma_f32_16x16x32_bf16 v[72:75], v[20:23], v[160:163], v[72:75]
  ds_read_b64_tr_b16 v[16:17], v8 offset:8192
  v_mfma_f32_16x16x32_bf16 v[104:107], v[96:99], v[148:151], v[104:107]
  v_mfma_f32_16x16x32_bf16 v[76:79], v[20:23], v[164:167], v[76:79]
  ds_read_b64_tr_b16 v[18:19], v8 offset:9216
  s_waitcnt lgkmcnt(4)
  v_mfma_f32_16x16x32_bf16 v[80:83], v[24:27], v[160:163], v[80:83]
  ds_read_b64_tr_b16 v[20:21], v9 offset:8192
  v_mfma_f32_16x16x32_bf16 v[84:87], v[24:27], v[164:167], v[84:87]
  ds_read_b64_tr_b16 v[22:23], v9 offset:9216
  s_waitcnt lgkmcnt(4)
  v_mfma_f32_16x16x32_bf16 v[88:91], v[28:31], v[160:163], v[88:91]
  ds_read_b64_tr_b16 v[24:25], v10 offset:8192
  v_mfma_f32_16x16x32_bf16 v[100:103], v[96:99], v[152:155], v[100:103]
  v_mfma_f32_16x16x32_bf16 v[92:95], v[28:31], v[164:167], v[92:95]
  ds_read_b64_tr_b16 v[26:27], v10 offset:9216
  s_waitcnt lgkmcnt(4)
  v_mfma_f32_16x16x32_bf16 v[32:35], v[16:19], v[168:171], v[32:35]
  ds_read_b64_tr_b16 v[28:29], v11 offset:8192
  v_mfma_f32_16x16x32_bf16 v[36:39], v[16:19], v[172:175], v[36:39]
  ds_read_b64_tr_b16 v[30:31], v11 offset:9216
  s_waitcnt lgkmcnt(4)
  v_mfma_f32_16x16x32_bf16 v[40:43], v[20:23], v[168:171], v[40:43]
  ds_read_b64_tr_b16 v[16:17], v108 offset:8192
  v_mfma_f32_16x16x32_bf16 v[104:107], v[96:99], v[156:159], v[104:107]
  v_mfma_f32_16x16x32_bf16 v[44:47], v[20:23], v[172:175], v[44:47]
  ds_read_b64_tr_b16 v[18:19], v108 offset:9216
  s_waitcnt lgkmcnt(4)
  v_mfma_f32_16x16x32_bf16 v[48:51], v[24:27], v[168:171], v[48:51]
  ds_read_b64_tr_b16 v[20:21], v109 offset:8192
  v_mfma_f32_16x16x32_bf16 v[52:55], v[24:27], v[172:175], v[52:55]
  ds_read_b64_tr_b16 v[22:23], v109 offset:9216
  s_waitcnt lgkmcnt(4)
  v_mfma_f32_16x16x32_bf16 v[56:59], v[28:31], v[168:171], v[56:59]
  ds_read_b64_tr_b16 v[24:25], v110 offset:8192
  v_mfma_f32_16x16x32_bf16 v[100:103], v[96:99], v[160:163], v[100:103]
  v_mfma_f32_16x16x32_bf16 v[60:63], v[28:31], v[172:175], v[60:63]
  ds_read_b64_tr_b16 v[26:27], v110 offset:9216
  s_waitcnt lgkmcnt(4)
  v_mfma_f32_16x16x32_bf16 v[64:67], v[16:19], v[168:171], v[64:67]
  ds_read_b64_tr_b16 v[28:29], v111 offset:8192
  v_mfma_f32_16x16x32_bf16 v[68:71], v[16:19], v[172:175], v[68:71]
  ds_read_b64_tr_b16 v[30:31], v111 offset:9216
  s_and_b32 s50, s70, 15
  s_lshr_b64 s[70:71], s[70:71], 4
  s_lshl_b32 s50, s50, 14
  v_add_u32 v8, s50, v5
  s_waitcnt lgkmcnt(4)
  v_mfma_f32_16x16x32_bf16 v[72:75], v[20:23], v[168:171], v[72:75]
  v_mfma_f32_16x16x32_bf16 v[104:107], v[96:99], v[164:167], v[104:107]
  v_mfma_f32_16x16x32_bf16 v[76:79], v[20:23], v[172:175], v[76:79]
  s_waitcnt lgkmcnt(0)
  s_barrier
  ds_read_b64_tr_b16 v[16:17], v8 offset:0
  ds_read_b64_tr_b16 v[18:19], v8 offset:1024
  v_mfma_f32_16x16x32_bf16 v[80:83], v[24:27], v[168:171], v[80:83]
  v_xor_b32 v9, 32, v8
  ds_read_b64_tr_b16 v[20:21], v9 offset:0
  v_mfma_f32_16x16x32_bf16 v[84:87], v[24:27], v[172:175], v[84:87]
  ds_read_b64_tr_b16 v[22:23], v9 offset:1024
  v_mfma_f32_16x16x32_bf16 v[88:91], v[28:31], v[168:171], v[88:91]
  v_xor_b32 v10, 64, v8
  ds_read_b64_tr_b16 v[24:25], v10 offset:0
  v_mfma_f32_16x16x32_bf16 v[92:95], v[28:31], v[172:175], v[92:95]
  ds_read_b64_tr_b16 v[26:27], v10 offset:1024
  s_waitcnt lgkmcnt(4)
  v_mfma_f32_16x16x32_bf16 v[32:35], v[16:19], v[176:179], v[32:35]
  v_xor_b32 v11, 96, v8
  ds_read_b64_tr_b16 v[28:29], v11 offset:0
  v_mfma_f32_16x16x32_bf16 v[36:39], v[16:19], v[180:183], v[36:39]
  ds_read_b64_tr_b16 v[30:31], v11 offset:1024
  s_waitcnt lgkmcnt(4)
  v_mfma_f32_16x16x32_bf16 v[40:43], v[20:23], v[176:179], v[40:43]
  v_xor_b32 v108, 128, v8
  ds_read_b64_tr_b16 v[16:17], v108 offset:0
  v_mfma_f32_16x16x32_bf16 v[44:47], v[20:23], v[180:183], v[44:47]
  ds_read_b64_tr_b16 v[18:19], v108 offset:1024
  s_waitcnt lgkmcnt(4)
  v_mfma_f32_16x16x32_bf16 v[48:51], v[24:27], v[176:179], v[48:51]
  v_xor_b32 v109, 160, v8
  ds_read_b64_tr_b16 v[20:21], v109 offset:0
  v_mfma_f32_16x16x32_bf16 v[52:55], v[24:27], v[180:183], v[52:55]
  ds_read_b64_tr_b16 v[22:23], v109 offset:1024
  s_waitcnt lgkmcnt(4)
  v_mfma_f32_16x16x32_bf16 v[56:59], v[28:31], v[176:179], v[56:59]
  v_xor_b32 v110, 192, v8
  ds_read_b64_tr_b16 v[24:25], v110 offset:0
  v_mfma_f32_16x16x32_bf16 v[60:63], v[28:31], v[180:183], v[60:63]
  ds_read_b64_tr_b16 v[26:27], v110 offset:1024
  s_waitcnt lgkmcnt(4)
  v_mfma_f32_16x16x32_bf16 v[64:67], v[16:19], v[176:179], v[64:67]
  v_xor_b32 v111, 224, v8
  ds_read_b64_tr_b16 v[28:29], v111 offset:0
  v_mfma_f32_16x16x32_bf16 v[68:71], v[16:19], v[180:183], v[68:71]
  ds_read_b64_tr_b16 v[30:31], v111 offset:1024
  s_waitcnt lgkmcnt(4)
  v_mfma_f32_16x16x32_bf16 v[72:75], v[20:23], v[176:179], v[72:75]
  ds_read_b64_tr_b16 v[16:17], v8 offset:8192
  v_mfma_f32_16x16x32_bf16 v[100:103], v[96:99], v[168:171], v[100:103]
  v_mfma_f32_16x16x32_bf16 v[76:79], v[20:23], v[180:183], v[76:79]
  ds_read_b64_tr_b16 v[18:19], v8 offset:9216
  s_waitcnt lgkmcnt(4)
  v_mfma_f32_16x16x32_bf16 v[80:83], v[24:27], v[176:179], v[80:83]
  ds_read_b64_tr_b16 v[20:21], v9 offset:8192
  v_mfma_f32_16x16x32_bf16 v[104:107], v[96:99], v[172:175], v[104:107]
  v_mfma_f32_16x16x32_bf16 v[84:87], v[24:27], v[180:183], v[84:87]
  ds_read_b64_tr_b16 v[22:23], v9 offset:9216
  s_waitcnt lgkmcnt(4)
  v_mfma_f32_16x16x32_bf16 v[88:91], v[28:31], v[176:179], v[88:91]
  ds_read_b64_tr_b16 v[24:25], v10 offset:8192
  v_mfma_f32_16x16x32_bf16 v[92:95], v[28:31], v[180:183], v[92:95]
  ds_read_b64_tr_b16 v[26:27], v10 offset:9216
  s_waitcnt lgkmcnt(4)
  v_mfma_f32_16x16x32_bf16 v[32:35], v[16:19], v[184:187], v[32:35]
  ds_read_b64_tr_b16 v[28:29], v11 offset:8192
  v_mfma_f32_16x16x32_bf16 v[100:103], v[96:99], v[176:179], v[100:103]
  v_mfma_f32_16x16x32_bf16 v[36:39], v[16:19], v[188:191], v[36:39]
  ds_read_b64_tr_b16 v[30:31], v11 offset:9216
  s_waitcnt lgkmcnt(4)
  v_mfma_f32_16x16x32_bf16 v[40:43], v[20:23], v[184:187], v[40:43]
  ds_read_b64_tr_b16 v[16:17], v108 offset:8192
  v_mfma_f32_16x16x32_bf16 v[44:47], v[20:23], v[188:191], v[44:47]
  ds_read_b64_tr_b16 v[18:19], v108 offset:9216
  s_waitcnt lgkmcnt(4)
  v_mfma_f32_16x16x32_bf16 v[48:51], v[24:27], v[184:187], v[48:51]
  ds_read_b64_tr_b16 v[20:21], v109 offset:8192
  v_mfma_f32_16x16x32_bf16 v[104:107], v[96:99], v[180:183], v[104:107]
  v_mfma_f32_16x16x32_bf16 v[52:55], v[24:27], v[188:191], v[52:55]
  ds_read_b64_tr_b16 v[22:23], v109 offset:9216
  s_waitcnt lgkmcnt(4)
  v_mfma_f32_16x16x32_bf16 v[56:59], v[28:31], v[184:187], v[56:59]
  ds_read_b64_tr_b16 v[24:25], v110 offset:8192
  v_mfma_f32_16x16x32_bf16 v[100:103], v[96:99], v[184:187], v[100:103]
  v_mfma_f32_16x16x32_bf16 v[60:63], v[28:31], v[188:191], v[60:63]
  ds_read_b64_tr_b16 v[26:27], v110 offset:9216
  s_waitcnt lgkmcnt(4)
  v_mfma_f32_16x16x32_bf16 v[64:67], v[16:19], v[184:187], v[64:67]
  ds_read_b64_tr_b16 v[28:29], v111 offset:8192
  v_mfma_f32_16x16x32_bf16 v[68:71], v[16:19], v[188:191], v[68:71]
  ds_read_b64_tr_b16 v[30:31], v111 offset:9216
  s_and_b32 s50, s70, 15
  s_lshr_b64 s[70:71], s[70:71], 4
  s_lshl_b32 s50, s50, 14
  v_add_u32 v8, s50, v5
  s_waitcnt lgkmcnt(4)
  v_mfma_f32_16x16x32_bf16 v[72:75], v[20:23], v[184:187], v[72:75]
  v_mfma_f32_16x16x32_bf16 v[104:107], v[96:99], v[188:191], v[104:107]
  v_mfma_f32_16x16x32_bf16 v[76:79], v[20:23], v[188:191], v[76:79]
  s_waitcnt lgkmcnt(0)
  s_barrier
  ds_read_b64_tr_b16 v[16:17], v8 offset:0
  ds_read_b64_tr_b16 v[18:19], v8 offset:1024
  v_mfma_f32_16x16x32_bf16 v[80:83], v[24:27], v[184:187], v[80:83]
  v_xor_b32 v9, 32, v8
  ds_read_b64_tr_b16 v[20:21], v9 offset:0
  v_mfma_f32_16x16x32_bf16 v[84:87], v[24:27], v[188:191], v[84:87]
  ds_read_b64_tr_b16 v[22:23], v9 offset:1024
  v_mfma_f32_16x16x32_bf16 v[88:91], v[28:31], v[184:187], v[88:91]
  v_xor_b32 v10, 64, v8
  ds_read_b64_tr_b16 v[24:25], v10 offset:0
  v_mfma_f32_16x16x32_bf16 v[92:95], v[28:31], v[188:191], v[92:95]
  ds_read_b64_tr_b16 v[26:27], v10 offset:1024
  s_waitcnt lgkmcnt(4)
  v_mfma_f32_16x16x32_bf16 v[32:35], v[16:19], v[192:195], v[32:35]
  v_xor_b32 v11, 96, v8
  ds_read_b64_tr_b16 v[28:29], v11 offset:0
  v_mfma_f32_16x16x32_bf16 v[36:39], v[16:19], v[196:199], v[36:39]
  ds_read_b64_tr_b16 v[30:31], v11 offset:1024
  s_waitcnt lgkmcnt(4)
  v_mfma_f32_16x16x32_bf16 v[40:43], v[20:23], v[192:195], v[40:43]
  v_xor_b32 v108, 128, v8
  ds_read_b64_tr_b16 v[16:17], v108 offset:0
  v_mfma_f32_16x16x32_bf16 v[44:47], v[20:23], v[196:199], v[44:47]
  ds_read_b64_tr_b16 v[18:19], v108 offset:1024
  s_waitcnt lgkmcnt(4)
  v_mfma_f32_16x16x32_bf16 v[48:51], v[24:27], v[192:195], v[48:51]
  v_xor_b32 v109, 160, v8
  ds_read_b64_tr_b16 v[20:21], v109 offset:0
  v_mfma_f32_16x16x32_bf16 v[52:55], v[24:27], v[196:199], v[52:55]
  ds_read_b64_tr_b16 v[22:23], v109 offset:1024
  s_waitcnt lgkmcnt(4)
  v_mfma_f32_16x16x32_bf16 v[56:59], v[28:31], v[192:195], v[56:59]
  v_xor_b32 v110, 192, v8
  ds_read_b64_tr_b16 v[24:25], v110 offset:0
  v_mfma_f32_16x16x32_bf16 v[60:63], v[28:31], v[196:199], v[60:63]
  ds_read_b64_tr_b16 v[26:27], v110 offset:1024
  s_waitcnt lgkmcnt(4)
  v_mfma_f32_16x16x32_bf16 v[64:67], v[16:19], v[192:195], v[64:67]
  v_xor_b32 v111, 224, v8
  ds_read_b64_tr_b16 v[28:29], v111 offset:0
  v_mfma_f32_16x16x32_bf16 v[68:71], v[16:19], v[196:199], v[68:71]
  ds_read_b64_tr_b16 v[30:31], v111 offset:1024
  s_waitcnt lgkmcnt(4)
  v_mfma_f32_16x16x32_bf16 v[72:75], v[20:23], v[192:195], v[72:75]
  ds_read_b64_tr_b16 v[16:17], v8 offset:8192
  v_mfma_f32_16x16x32_bf16 v[100:103], v[96:99], v[192:195], v[100:103]
  v_mfma_f32_16x16x32_bf16 v[76:79], v[20:23], v[196:199], v[76:79]
  ds_read_b64_tr_b16 v[18:19], v8 offset:9216
  s_waitcnt lgkmcnt(4)
  v_mfma_f32_16x16x32_bf16 v[80:83], v[24:27], v[192:195], v[80:83]
  ds_read_b64_tr_b16 v[20:21], v9 offset:8192
  v_mfma_f32_16x16x32_bf16 v[84:87], v[24:27], v[196:199], v[84:87]
  ds_read_b64_tr_b16 v[22:23], v9 offset:9216
  s_waitcnt lgkmcnt(4)
  v_mfma_f32_16x16x32_bf16 v[88:91], v[28:31], v[192:195], v[88:91]
  ds_read_b64_tr_b16 v[24:25], v10 offset:8192
  v_mfma_f32_16x16x32_bf16 v[104:107], v[96:99], v[196:199], v[104:107]
  v_mfma_f32_16x16x32_bf16 v[92:95], v[28:31], v[196:199], v[92:95]
  ds_read_b64_tr_b16 v[26:27], v10 offset:9216
  s_waitcnt lgkmcnt(4)
  v_mfma_f32_16x16x32_bf16 v[32:35], v[16:19], v[200:203], v[32:35]
  ds_read_b64_tr_b16 v[28:29], v11 offset:8192
  v_mfma_f32_16x16x32_bf16 v[36:39], v[16:19], v[204:207], v[36:39]
  ds_read_b64_tr_b16 v[30:31], v11 offset:9216
  s_waitcnt lgkmcnt(4)
  v_mfma_f32_16x16x32_bf16 v[40:43], v[20:23], v[200:203], v[40:43]
  ds_read_b64_tr_b16 v[16:17], v108 offset:8192
  v_mfma_f32_16x16x32_bf16 v[100:103], v[96:99], v[200:203], v[100:103]
  v_mfma_f32_16x16x32_bf16 v[44:47], v[20:23], v[204:207], v[44:47]
  ds_read_b64_tr_b16 v[18:19], v108 offset:9216
  s_waitcnt lgkmcnt(4)
  v_mfma_f32_16x16x32_bf16 v[48:51], v[24:27], v[200:203], v[48:51]
  ds_read_b64_tr_b16 v[20:21], v109 offset:8192
  v_mfma_f32_16x16x32_bf16 v[52:55], v[24:27], v[204:207], v[52:55]
  ds_read_b64_tr_b16 v[22:23], v109 offset:9216
  s_waitcnt lgkmcnt(4)
  v_mfma_f32_16x16x32_bf16 v[56:59], v[28:31], v[200:203], v[56:59]
  ds_read_b64_tr_b16 v[24:25], v110 offset:8192
  v_mfma_f32_16x16x32_bf16 v[104:107], v[96:99], v[204:207], v[104:107]
  v_mfma_f32_16x16x32_bf16 v[60:63], v[28:31], v[204:207], v[60:63]
  ds_read_b64_tr_b16 v[26:27], v110 offset:9216
  s_waitcnt lgkmcnt(4)
  v_mfma_f32_16x16x32_bf16 v[64:67], v[16:19], v[200:203], v[64:67]
  ds_read_b64_tr_b16 v[28:29], v111 offset:8192
  v_mfma_f32_16x16x32_bf16 v[68:71], v[16:19], v[204:207], v[68:71]
  ds_read_b64_tr_b16 v[30:31], v111 offset:9216
  s_and_b32 s50, s70, 15
  s_lshr_b64 s[70:71], s[70:71], 4
  s_lshl_b32 s50, s50, 14
  v_add_u32 v8, s50, v5
  s_waitcnt lgkmcnt(4)
  v_mfma_f32_16x16x32_bf16 v[72:75], v[20:23], v[200:203], v[72:75]
  v_mfma_f32_16x16x32_bf16 v[100:103], v[96:99], v[208:211], v[100:103]
  v_mfma_f32_16x16x32_bf16 v[76:79], v[20:23], v[204:207], v[76:79]
  s_waitcnt lgkmcnt(0)
  s_barrier
  ds_read_b64_tr_b16 v[16:17], v8 offset:0
  ds_read_b64_tr_b16 v[18:19], v8 offset:1024
  v_mfma_f32_16x16x32_bf16 v[80:83], v[24:27], v[200:203], v[80:83]
  v_xor_b32 v9, 32, v8
  ds_read_b64_tr_b16 v[20:21], v9 offset:0
  v_mfma_f32_16x16x32_bf16 v[84:87], v[24:27], v[204:207], v[84:87]
  ds_read_b64_tr_b16 v[22:23], v9 offset:1024
  v_mfma_f32_16x16x32_bf16 v[88:91], v[28:31], v[200:203], v[88:91]
  v_xor_b32 v10, 64, v8
  ds_read_b64_tr_b16 v[24:25], v10 offset:0
  v_mfma_f32_16x16x32_bf16 v[92:95], v[28:31], v[204:207], v[92:95]
  ds_read_b64_tr_b16 v[26:27], v10 offset:1024
  s_waitcnt lgkmcnt(4)
  v_mfma_f32_16x16x32_bf16 v[32:35], v[16:19], v[208:211], v[32:35]
  v_xor_b32 v11, 96, v8
  ds_read_b64_tr_b16 v[28:29], v11 offset:0
  v_mfma_f32_16x16x32_bf16 v[36:39], v[16:19], v[212:215], v[36:39]
  ds_read_b64_tr_b16 v[30:31], v11 offset:1024
  s_waitcnt lgkmcnt(4)
  v_mfma_f32_16x16x32_bf16 v[40:43], v[20:23], v[208:211], v[40:43]
  v_xor_b32 v108, 128, v8
  ds_read_b64_tr_b16 v[16:17], v108 offset:0
  v_mfma_f32_16x16x32_bf16 v[44:47], v[20:23], v[212:215], v[44:47]
  ds_read_b64_tr_b16 v[18:19], v108 offset:1024
  s_waitcnt lgkmcnt(4)
  v_mfma_f32_16x16x32_bf16 v[48:51], v[24:27], v[208:211], v[48:51]
  v_xor_b32 v109, 160, v8
  ds_read_b64_tr_b16 v[20:21], v109 offset:0
  v_mfma_f32_16x16x32_bf16 v[52:55], v[24:27], v[212:215], v[52:55]
  ds_read_b64_tr_b16 v[22:23], v109 offset:1024
  s_waitcnt lgkmcnt(4)
  v_mfma_f32_16x16x32_bf16 v[56:59], v[28:31], v[208:211], v[56:59]
  v_xor_b32 v110, 192, v8
  ds_read_b64_tr_b16 v[24:25], v110 offset:0
  v_mfma_f32_16x16x32_bf16 v[60:63], v[28:31], v[212:215], v[60:63]
  ds_read_b64_tr_b16 v[26:27], v110 offset:1024
  s_waitcnt lgkmcnt(4)
  v_mfma_f32_16x16x32_bf16 v[64:67], v[16:19], v[208:211], v[64:67]
  v_xor_b32 v111, 224, v8
  ds_read_b64_tr_b16 v[28:29], v111 offset:0
  v_mfma_f32_16x16x32_bf16 v[68:71], v[16:19], v[212:215], v[68:71]
  ds_read_b64_tr_b16 v[30:31], v111 offset:1024
  s_waitcnt lgkmcnt(4)
  v_mfma_f32_16x16x32_bf16 v[72:75], v[20:23], v[208:211], v[72:75]
  ds_read_b64_tr_b16 v[16:17], v8 offset:8192
  v_mfma_f32_16x16x32_bf16 v[104:107], v[96:99], v[212:215], v[104:107]
  v_mfma_f32_16x16x32_bf16 v[76:79], v[20:23], v[212:215], v[76:79]
  ds_read_b64_tr_b16 v[18:19], v8 offset:9216
  s_waitcnt lgkmcnt(4)
  v_mfma_f32_16x16x32_bf16 v[80:83], v[24:27], v[208:211], v[80:83]
  ds_read_b64_tr_b16 v[20:21], v9 offset:8192
  v_mfma_f32_16x16x32_bf16 v[84:87], v[24:27], v[212:215], v[84:87]
  ds_read_b64_tr_b16 v[22:23], v9 offset:9216
  s_waitcnt lgkmcnt(4)
  v_mfma_f32_16x16x32_bf16 v[88:91], v[28:31], v[208:211], v[88:91]
  ds_read_b64_tr_b16 v[24:25], v10 offset:8192
  v_mfma_f32_16x16x32_bf16 v[100:103], v[96:99], v[216:219], v[100:103]
  v_mfma_f32_16x16x32_bf16 v[92:95], v[28:31], v[212:215], v[92:95]
  ds_read_b64_tr_b16 v[26:27], v10 offset:9216
  s_waitcnt lgkmcnt(4)
  v_mfma_f32_16x16x32_bf16 v[32:35], v[16:19], v[216:219], v[32:35]
  ds_read_b64_tr_b16 v[28:29], v11 offset:8192
  v_mfma_f32_16x16x32_bf16 v[36:39], v[16:19], v[220:223], v[36:39]
  ds_read_b64_tr_b16 v[30:31], v11 offset:9216
  s_waitcnt lgkmcnt(4)
  v_mfma_f32_16x16x32_bf16 v[40:43], v[20:23], v[216:219], v[40:43]
  ds_read_b64_tr_b16 v[16:17], v108 offset:8192
  v_mfma_f32_16x16x32_bf16 v[104:107], v[96:99], v[220:223], v[104:107]
  v_mfma_f32_16x16x32_bf16 v[44:47], v[20:23], v[220:223], v[44:47]
  ds_read_b64_tr_b16 v[18:19], v108 offset:9216
  s_waitcnt lgkmcnt(4)
  v_mfma_f32_16x16x32_bf16 v[48:51], v[24:27], v[216:219], v[48:51]
  ds_read_b64_tr_b16 v[20:21], v109 offset:8192
  v_mfma_f32_16x16x32_bf16 v[52:55], v[24:27], v[220:223], v[52:55]
  ds_read_b64_tr_b16 v[22:23], v109 offset:9216
  s_waitcnt lgkmcnt(4)
  v_mfma_f32_16x16x32_bf16 v[56:59], v[28:31], v[216:219], v[56:59]
  ds_read_b64_tr_b16 v[24:25], v110 offset:8192
  v_mfma_f32_16x16x32_bf16 v[100:103], v[96:99], v[224:227], v[100:103]
  v_mfma_f32_16x16x32_bf16 v[60:63], v[28:31], v[220:223], v[60:63]
  ds_read_b64_tr_b16 v[26:27], v110 offset:9216
  s_waitcnt lgkmcnt(4)
  v_mfma_f32_16x16x32_bf16 v[64:67], v[16:19], v[216:219], v[64:67]
  ds_read_b64_tr_b16 v[28:29], v111 offset:8192
  v_mfma_f32_16x16x32_bf16 v[68:71], v[16:19], v[220:223], v[68:71]
  ds_read_b64_tr_b16 v[30:31], v111 offset:9216
  s_and_b32 s50, s70, 15
  s_lshr_b64 s[70:71], s[70:71], 4
  s_lshl_b32 s50, s50, 14
  v_add_u32 v8, s50, v5
  s_waitcnt lgkmcnt(4)
  v_mfma_f32_16x16x32_bf16 v[72:75], v[20:23], v[216:219], v[72:75]
  v_mfma_f32_16x16x32_bf16 v[104:107], v[96:99], v[228:231], v[104:107]
  v_mfma_f32_16x16x32_bf16 v[76:79], v[20:23], v[220:223], v[76:79]
  s_waitcnt lgkmcnt(0)
  s_barrier
  ds_read_b64_tr_b16 v[16:17], v8 offset:0
  ds_read_b64_tr_b16 v[18:19], v8 offset:1024
  v_mfma_f32_16x16x32_bf16 v[80:83], v[24:27], v[216:219], v[80:83]
  v_xor_b32 v9, 32, v8
  ds_read_b64_tr_b16 v[20:21], v9 offset:0
  v_mfma_f32_16x16x32_bf16 v[84:87], v[24:27], v[220:223], v[84:87]
  ds_read_b64_tr_b16 v[22:23], v9 offset:1024
  v_mfma_f32_16x16x32_bf16 v[88:91], v[28:31], v[216:219], v[88:91]
  v_xor_b32 v10, 64, v8
  ds_read_b64_tr_b16 v[24:25], v10 offset:0
  v_mfma_f32_16x16x32_bf16 v[92:95], v[28:31], v[220:223], v[92:95]
  ds_read_b64_tr_b16 v[26:27], v10 offset:1024
  s_waitcnt lgkmcnt(4)
  v_mfma_f32_16x16x32_bf16 v[32:35], v[16:19], v[224:227], v[32:35]
  v_xor_b32 v11, 96, v8
  ds_read_b64_tr_b16 v[28:29], v11 offset:0
  v_mfma_f32_16x16x32_bf16 v[36:39], v[16:19], v[228:231], v[36:39]
  ds_read_b64_tr_b16 v[30:31], v11 offset:1024
  s_waitcnt lgkmcnt(4)
  v_mfma_f32_16x16x32_bf16 v[40:43], v[20:23], v[224:227], v[40:43]
  v_xor_b32 v108, 128, v8
  ds_read_b64_tr_b16 v[16:17], v108 offset:0
  v_mfma_f32_16x16x32_bf16 v[44:47], v[20:23], v[228:231], v[44:47]
  ds_read_b64_tr_b16 v[18:19], v108 offset:1024
  s_waitcnt lgkmcnt(4)
  v_mfma_f32_16x16x32_bf16 v[48:51], v[24:27], v[224:227], v[48:51]
  v_xor_b32 v109, 160, v8
  ds_read_b64_tr_b16 v[20:21], v109 offset:0
  v_mfma_f32_16x16x32_bf16 v[52:55], v[24:27], v[228:231], v[52:55]
  ds_read_b64_tr_b16 v[22:23], v109 offset:1024
  s_waitcnt lgkmcnt(4)
  v_mfma_f32_16x16x32_bf16 v[56:59], v[28:31], v[224:227], v[56:59]
  v_xor_b32 v110, 192, v8
  ds_read_b64_tr_b16 v[24:25], v110 offset:0
  v_mfma_f32_16x16x32_bf16 v[60:63], v[28:31], v[228:231], v[60:63]
  ds_read_b64_tr_b16 v[26:27], v110 offset:1024
  s_waitcnt lgkmcnt(4)
  v_mfma_f32_16x16x32_bf16 v[64:67], v[16:19], v[224:227], v[64:67]
  v_xor_b32 v111, 224, v8
  ds_read_b64_tr_b16 v[28:29], v111 offset:0
  v_mfma_f32_16x16x32_bf16 v[68:71], v[16:19], v[228:231], v[68:71]
  s_branch L_pads9
L_pad9:
  s_setpc_b64 s[60:61]
L_pads9:
  ds_read_b64_tr_b16 v[30:31], v111 offset:1024
  s_waitcnt lgkmcnt(4)
  v_mfma_f32_16x16x32_bf16 v[72:75], v[20:23], v[224:227], v[72:75]
  ds_read_b64_tr_b16 v[16:17], v8 offset:8192
  v_mfma_f32_16x16x32_bf16 v[100:103], v[96:99], v[232:235], v[100:103]
  v_mfma_f32_16x16x32_bf16 v[76:79], v[20:23], v[228:231], v[76:79]
  ds_read_b64_tr_b16 v[18:19], v8 offset:9216
  s_waitcnt lgkmcnt(4)
  v_mfma_f32_16x16x32_bf16 v[80:83], v[24:27], v[224:227], v[80:83]
  ds_read_b64_tr_b16 v[20:21], v9 offset:8192
  v_mfma_f32_16x16x32_bf16 v[104:107], v[96:99], v[236:239], v[104:107]
  v_mfma_f32_16x16x32_bf16 v[84:87], v[24:27], v[228:231], v[84:87]
  ds_read_b64_tr_b16 v[22:23], v9 offset:9216
  s_waitcnt lgkmcnt(4)
  v_mfma_f32_16x16x32_bf16 v[88:91], v[28:31], v[224:227], v[88:91]
  ds_read_b64_tr_b16 v[24:25], v10 offset:8192
  v_mfma_f32_16x16x32_bf16 v[92:95], v[28:31], v[228:231], v[92:95]
  ds_read_b64_tr_b16 v[26:27], v10 offset:9216
  s_waitcnt lgkmcnt(4)
  v_mfma_f32_16x16x32_bf16 v[32:35], v[16:19], v[232:235], v[32:35]
  ds_read_b64_tr_b16 v[28:29], v11 offset:8192
  v_mfma_f32_16x16x32_bf16 v[100:103], v[96:99], v[240:243], v[100:103]
  v_mfma_f32_16x16x32_bf16 v[36:39], v[16:19], v[236:239], v[36:39]
  ds_read_b64_tr_b16 v[30:31], v11 offset:9216
  s_waitcnt lgkmcnt(4)
  v_mfma_f32_16x16x32_bf16 v[40:43], v[20:23], v[232:235], v[40:43]
  ds_read_b64_tr_b16 v[16:17], v108 offset:8192
  v_mfma_f32_16x16x32_bf16 v[44:47], v[20:23], v[236:239], v[44:47]
  ds_read_b64_tr_b16 v[18:19], v108 offset:9216
  s_waitcnt lgkmcnt(4)
  v_mfma_f32_16x16x32_bf16 v[48:51], v[24:27], v[232:235], v[48:51]
  ds_read_b64_tr_b16 v[20:21], v109 offset:8192
  v_mfma_f32_16x16x32_bf16 v[104:107], v[96:99], v[244:247], v[104:107]
  v_mfma_f32_16x16x32_bf16 v[52:55], v[24:27], v[236:239], v[52:55]
  ds_read_b64_tr_b16 v[22:23], v109 offset:9216
  s_waitcnt lgkmcnt(4)
  v_mfma_f32_16x16x32_bf16 v[56:59], v[28:31], v[232:235], v[56:59]
  ds_read_b64_tr_b16 v[24:25], v110 offset:8192
  v_mfma_f32_16x16x32_bf16 v[100:103], v[96:99], v[248:251], v[100:103]
  v_mfma_f32_16x16x32_bf16 v[60:63], v[28:31], v[236:239], v[60:63]
  ds_read_b64_tr_b16 v[26:27], v110 offset:9216
  s_waitcnt lgkmcnt(4)
  v_mfma_f32_16x16x32_bf16 v[64:67], v[16:19], v[232:235], v[64:67]
  ds_read_b64_tr_b16 v[28:29], v111 offset:8192
  v_mfma_f32_16x16x32_bf16 v[68:71], v[16:19], v[236:239], v[68:71]
  ds_read_b64_tr_b16 v[30:31], v111 offset:9216
  s_and_b32 s50, s70, 15
  s_lshr_b64 s[70:71], s[70:71], 4
  s_lshl_b32 s50, s50, 14
  v_add_u32 v8, s50, v5
  s_waitcnt lgkmcnt(4)
  v_mfma_f32_16x16x32_bf16 v[72:75], v[20:23], v[232:235], v[72:75]
  v_mfma_f32_16x16x32_bf16 v[104:107], v[96:99], v[252:255], v[104:107]
  v_mfma_f32_16x16x32_bf16 v[76:79], v[20:23], v[236:239], v[76:79]
  s_waitcnt lgkmcnt(0)
  s_barrier
  ds_read_b64_tr_b16 v[16:17], v8 offset:0
  ds_read_b64_tr_b16 v[18:19], v8 offset:1024
  v_mfma_f32_16x16x32_bf16 v[80:83], v[24:27], v[232:235], v[80:83]
  ds_read_b64_tr_b16 v[20:21], v8 offset:8192
  v_mfma_f32_16x16x32_bf16 v[84:87], v[24:27], v[236:239], v[84:87]
  ds_read_b64_tr_b16 v[22:23], v8 offset:9216
  v_mfma_f32_16x16x32_bf16 v[88:91], v[28:31], v[232:235], v[88:91]
  v_xor_b32 v10, 32, v8
  ds_read_b64_tr_b16 v[24:25], v10 offset:0
  v_mfma_f32_16x16x32_bf16 v[92:95], v[28:31], v[236:239], v[92:95]
  ds_read_b64_tr_b16 v[26:27], v10 offset:1024
  s_waitcnt lgkmcnt(4)
  v_mfma_f32_16x16x32_bf16 v[32:35], v[16:19], v[240:243], v[32:35]
  ds_read_b64_tr_b16 v[28:29], v10 offset:8192
  v_mfma_f32_16x16x32_bf16 v[36:39], v[16:19], v[244:247], v[36:39]
  ds_read_b64_tr_b16 v[30:31], v10 offset:9216
  s_waitcnt lgkmcnt(4)
  v_mfma_f32_16x16x32_bf16 v[32:35], v[20:23], v[248:251], v[32:35]
  v_xor_b32 v9, 64, v8
  ds_read_b64_tr_b16 v[16:17], v9 offset:0
  v_mfma_f32_16x16x32_bf16 v[36:39], v[20:23], v[252:255], v[36:39]
  ds_read_b64_tr_b16 v[18:19], v9 offset:1024
  s_waitcnt lgkmcnt(4)
  v_mfma_f32_16x16x32_bf16 v[40:43], v[24:27], v[240:243], v[40:43]
  ds_read_b64_tr_b16 v[20:21], v9 offset:8192
  v_rcp_f32 v13, v100
  v_mfma_f32_16x16x32_bf16 v[44:47], v[24:27], v[244:247], v[44:47]
  ds_read_b64_tr_b16 v[22:23], v9 offset:9216
  v_rcp_f32 v14, v104
  s_waitcnt lgkmcnt(4)
  v_mfma_f32_16x16x32_bf16 v[40:43], v[28:31], v[248:251], v[40:43]
  v_xor_b32 v10, 96, v8
  ds_read_b64_tr_b16 v[24:25], v10 offset:0
  v_mfma_f32_16x16x32_bf16 v[44:47], v[28:31], v[252:255], v[44:47]
  ds_read_b64_tr_b16 v[26:27], v10 offset:1024
  s_waitcnt lgkmcnt(4)
  v_mfma_f32_16x16x32_bf16 v[48:51], v[16:19], v[240:243], v[48:51]
  ds_read_b64_tr_b16 v[28:29], v10 offset:8192
  v_mfma_f32_16x16x32_bf16 v[52:55], v[16:19], v[244:247], v[52:55]
  ds_read_b64_tr_b16 v[30:31], v10 offset:9216
  s_waitcnt lgkmcnt(4)
  v_mfma_f32_16x16x32_bf16 v[48:51], v[20:23], v[248:251], v[48:51]
  v_xor_b32 v9, 128, v8
  ds_read_b64_tr_b16 v[16:17], v9 offset:0
  v_mfma_f32_16x16x32_bf16 v[52:55], v[20:23], v[252:255], v[52:55]
  ds_read_b64_tr_b16 v[18:19], v9 offset:1024
  v_mul_f32 v32, v13, v32
  v_mul_f32 v33, v13, v33
  s_waitcnt lgkmcnt(4)
  v_mfma_f32_16x16x32_bf16 v[56:59], v[24:27], v[240:243], v[56:59]
  ds_read_b64_tr_b16 v[20:21], v9 offset:8192
  v_mul_f32 v34, v13, v34
  v_mul_f32 v35, v13, v35
  v_mul_f32 v36, v14, v36
  v_mfma_f32_16x16x32_bf16 v[60:63], v[24:27], v[244:247], v[60:63]
  ds_read_b64_tr_b16 v[22:23], v9 offset:9216
  v_mul_f32 v37, v14, v37
  v_mul_f32 v38, v14, v38
  s_waitcnt lgkmcnt(4)
  v_mfma_f32_16x16x32_bf16 v[56:59], v[28:31], v[248:251], v[56:59]
  v_xor_b32 v10, 160, v8
  ds_read_b64_tr_b16 v[24:25], v10 offset:0
  v_mul_f32 v39, v14, v39
  v_mul_f32 v40, v13, v40
  v_mfma_f32_16x16x32_bf16 v[60:63], v[28:31], v[252:255], v[60:63]
  ds_read_b64_tr_b16 v[26:27], v10 offset:1024
  v_mul_f32 v41, v13, v41
  v_mul_f32 v42, v13, v42
  s_waitcnt lgkmcnt(4)
  v_mfma_f32_16x16x32_bf16 v[64:67], v[16:19], v[240:243], v[64:67]
  ds_read_b64_tr_b16 v[28:29], v10 offset:8192
  v_mul_f32 v43, v13, v43
  v_mul_f32 v44, v14, v44
  v_mul_f32 v45, v14, v45
  v_mul_f32 v46, v14, v46
  v_mfma_f32_16x16x32_bf16 v[68:71], v[16:19], v[244:247], v[68:71]
  ds_read_b64_tr_b16 v[30:31], v10 offset:9216
  v_mul_f32 v47, v14, v47
  v_cvt_pk_bf16_f32 v96, v32, v33
  s_waitcnt lgkmcnt(4)
  v_mfma_f32_16x16x32_bf16 v[64:67], v[20:23], v[248:251], v[64:67]
  v_xor_b32 v9, 192, v8
  ds_read_b64_tr_b16 v[16:17], v9 offset:0
  v_cvt_pk_bf16_f32 v97, v34, v35
  v_cvt_pk_bf16_f32 v98, v40, v41
  v_mfma_f32_16x16x32_bf16 v[68:71], v[20:23], v[252:255], v[68:71]
  ds_read_b64_tr_b16 v[18:19], v9 offset:1024
  v_cvt_pk_bf16_f32 v99, v42, v43
  ds_write_b128 v15, v[96:99] offset:0
  s_waitcnt lgkmcnt(5)
  v_mfma_f32_16x16x32_bf16 v[72:75], v[24:27], v[240:243], v[72:75]
  ds_read_b64_tr_b16 v[20:21], v9 offset:8192
  v_cvt_pk_bf16_f32 v100, v36, v37
  v_cvt_pk_bf16_f32 v101, v38, v39
  v_cvt_pk_bf16_f32 v102, v44, v45
  v_mfma_f32_16x16x32_bf16 v[76:79], v[24:27], v[244:247], v[76:79]
  ds_read_b64_tr_b16 v[22:23], v9 offset:9216
  v_cvt_pk_bf16_f32 v103, v46, v47
  ds_write_b128 v15, v[100:103] offset:1024
  s_waitcnt lgkmcnt(6)
  v_mfma_f32_16x16x32_bf16 v[72:75], v[28:31], v[248:251], v[72:75]
  v_xor_b32 v10, 224, v8
  ds_read_b64_tr_b16 v[24:25], v10 offset:0
  v_mul_f32 v48, v13, v48
  v_mul_f32 v49, v13, v49
  v_mfma_f32_16x16x32_bf16 v[76:79], v[28:31], v[252:255], v[76:79]
  ds_read_b64_tr_b16 v[26:27], v10 offset:1024
  v_mul_f32 v50, v13, v50
  v_mul_f32 v51, v13, v51
  s_waitcnt lgkmcnt(6)
  v_mfma_f32_16x16x32_bf16 v[80:83], v[16:19], v[240:243], v[80:83]
  ds_read_b64_tr_b16 v[28:29], v10 offset:8192
  v_mul_f32 v52, v14, v52
  v_mul_f32 v53, v14, v53
  v_mul_f32 v54, v14, v54
  v_mfma_f32_16x16x32_bf16 v[84:87], v[16:19], v[244:247], v[84:87]
  ds_read_b64_tr_b16 v[30:31], v10 offset:9216
  v_mul_f32 v55, v14, v55
  v_mul_f32 v56, v13, v56
  s_and_b32 s50, s70, 15
  s_lshr_b64 s[70:71], s[70:71], 4
  s_lshl_b32 s50, s50, 14
  v_add_u32 v8, s50, v5
  s_waitcnt lgkmcnt(5)
  v_mfma_f32_16x16x32_bf16 v[80:83], v[20:23], v[248:251], v[80:83]
  v_mul_f32 v57, v13, v57
  v_mul_f32 v58, v13, v58
  v_mul_f32 v59, v13, v59
  v_mfma_f32_16x16x32_bf16 v[84:87], v[20:23], v[252:255], v[84:87]
  v_mul_f32 v60, v14, v60
  v_mul_f32 v61, v14, v61
  s_waitcnt lgkmcnt(0)
  s_barrier
  ds_read_b64_tr_b16 v[16:17], v8 offset:0
  ds_read_b64_tr_b16 v[18:19], v8 offset:1024
  v_mfma_f32_16x16x32_bf16 v[88:91], v[24:27], v[240:243], v[88:91]
  ds_read_b64_tr_b16 v[20:21], v8 offset:8192
  v_mul_f32 v62, v14, v62
  v_mul_f32 v63, v14, v63
  v_cvt_pk_bf16_f32 v104, v48, v49
  v_mfma_f32_16x16x32_bf16 v[92:95], v[24:27], v[244:247], v[92:95]
  ds_read_b64_tr_b16 v[22:23], v8 offset:9216
  v_cvt_pk_bf16_f32 v105, v50, v51
  v_cvt_pk_bf16_f32 v106, v56, v57
  v_mfma_f32_16x16x32_bf16 v[88:91], v[28:31], v[248:251], v[88:91]
  v_xor_b32 v10, 32, v8
  ds_read_b64_tr_b16 v[24:25], v10 offset:0
  v_cvt_pk_bf16_f32 v107, v58, v59
  ds_write_b128 v15, v[104:107] offset:6144
  v_mfma_f32_16x16x32_bf16 v[92:95], v[28:31], v[252:255], v[92:95]
  ds_read_b64_tr_b16 v[26:27], v10 offset:1024
  v_cvt_pk_bf16_f32 v108, v52, v53
  v_cvt_pk_bf16_f32 v109, v54, v55
  s_waitcnt lgkmcnt(5)
  v_mfma_f32_16x16x32_bf16 v[32:35], v[16:19], v[128:131], 0
  ds_read_b64_tr_b16 v[28:29], v10 offset:8192
  v_cvt_pk_bf16_f32 v110, v60, v61
  v_cvt_pk_bf16_f32 v111, v62, v63
  ds_write_b128 v15, v[108:111] offset:7168
  v_mfma_f32_16x16x32_bf16 v[36:39], v[16:19], v[132:135], 0
  ds_read_b64_tr_b16 v[30:31], v10 offset:9216
  v_mul_f32 v64, v13, v64
  v_mul_f32 v65, v13, v65
  s_waitcnt lgkmcnt(6)
  v_mfma_f32_16x16x32_bf16 v[32:35], v[20:23], v[136:139], v[32:35]
  v_xor_b32 v9, 64, v8
  ds_read_b64_tr_b16 v[16:17], v9 offset:0
  v_mul_f32 v66, v13, v66
  v_mul_f32 v67, v13, v67
  v_mfma_f32_16x16x32_bf16 v[36:39], v[20:23], v[140:143], v[36:39]
  ds_read_b64_tr_b16 v[18:19], v9 offset:1024
  v_mul_f32 v68, v14, v68
  v_mul_f32 v69, v14, v69
  v_mul_f32 v70, v14, v70
  s_waitcnt lgkmcnt(5)
  v_mfma_f32_16x16x32_bf16 v[40:43], v[24:27], v[128:131], 0
  ds_read_b64_tr_b16 v[20:21], v9 offset:8192
  v_mul_f32 v71, v14, v71
  v_mul_f32 v72, v13, v72
  v_mul_f32 v73, v13, v73
  v_mfma_f32_16x16x32_bf16 v[44:47], v[24:27], v[132:135], 0
  ds_read_b64_tr_b16 v[22:23], v9 offset:9216
  v_mul_f32 v74, v13, v74
  v_mul_f32 v75, v13, v75
  s_waitcnt lgkmcnt(4)
  v_mfma_f32_16x16x32_bf16 v[40:43], v[28:31], v[136:139], v[40:43]
  v_xor_b32 v10, 96, v8
  ds_read_b64_tr_b16 v[24:25], v10 offset:0
  v_mul_f32 v76, v14, v76
  v_mul_f32 v77, v14, v77
  v_mfma_f32_16x16x32_bf16 v[44:47], v[28:31], v[140:143], v[44:47]
  ds_read_b64_tr_b16 v[26:27], v10 offset:1024
  v_mul_f32 v78, v14, v78
  v_mul_f32 v79, v14, v79
  s_waitcnt lgkmcnt(4)
  v_mfma_f32_16x16x32_bf16 v[48:51], v[16:19], v[128:131], 0
  ds_read_b64_tr_b16 v[28:29], v10 offset:8192
  v_cvt_pk_bf16_f32 v112, v64, v65
  v_cvt_pk_bf16_f32 v113, v66, v67
  v_cvt_pk_bf16_f32 v114, v72, v73
  v_mfma_f32_16x16x32_bf16 v[52:55], v[16:19], v[132:135], 0
  ds_read_b64_tr_b16 v[30:31], v10 offset:9216
  v_cvt_pk_bf16_f32 v115, v74, v75
  ds_write_b128 v15, v[112:115] offset:12288
  v_cvt_pk_bf16_f32 v116, v68, v69
  s_waitcnt lgkmcnt(5)
  v_mfma_f32_16x16x32_bf16 v[48:51], v[20:23], v[136:139], v[48:51]
  v_xor_b32 v9, 128, v8
  ds_read_b64_tr_b16 v[16:17], v9 offset:0
  v_cvt_pk_bf16_f32 v117, v70, v71
  v_cvt_pk_bf16_f32 v118, v76, v77
  v_mfma_f32_16x16x32_bf16 v[52:55], v[20:23], v[140:143], v[52:55]
  ds_read_b64_tr_b16 v[18:19], v9 offset:1024
  v_cvt_pk_bf16_f32 v119, v78, v79
  ds_write_b128 v15, v[116:119] offset:13312
  s_waitcnt lgkmcnt(6)
  v_mfma_f32_16x16x32_bf16 v[56:59], v[24:27], v[128:131], 0
  ds_read_b64_tr_b16 v[20:21], v9 offset:8192
  v_mul_f32 v80, v13, v80
  v_mul_f32 v81, v13, v81
  v_mul_f32 v82, v13, v82
  v_mfma_f32_16x16x32_bf16 v[60:63], v[24:27], v[132:135], 0
  ds_read_b64_tr_b16 v[22:23], v9 offset:9216
  v_mul_f32 v83, v13, v83
  v_mul_f32 v84, v14, v84
  s_waitcnt lgkmcnt(6)
  v_mfma_f32_16x16x32_bf16 v[56:59], v[28:31], v[136:139], v[56:59]
  v_xor_b32 v10, 160, v8
  ds_read_b64_tr_b16 v[24:25], v10 offset:0
  v_mul_f32 v85, v14, v85
  v_mul_f32 v86, v14, v86
  v_mfma_f32_16x16x32_bf16 v[60:63], v[28:31], v[140:143], v[60:63]
  ds_read_b64_tr_b16 v[26:27], v10 offset:1024
  v_mul_f32 v87, v14, v87
  v_mul_f32 v88, v13, v88
  s_waitcnt lgkmcnt(5)
  v_mfma_f32_16x16x32_bf16 v[64:67], v[16:19], v[128:131], 0
  ds_read_b64_tr_b16 v[28:29], v10 offset:8192
  v_mul_f32 v89, v13, v89
  v_mul_f32 v90, v13, v90
  v_mul_f32 v91, v13, v91
  v_mfma_f32_16x16x32_bf16 v[68:71], v[16:19], v[132:135], 0
  ds_read_b64_tr_b16 v[30:31], v10 offset:9216
  v_mul_f32 v92, v14, v92
  v_mul_f32 v93, v14, v93
  v_mul_f32 v94, v14, v94
  s_waitcnt lgkmcnt(4)
  v_mfma_f32_16x16x32_bf16 v[64:67], v[20:23], v[136:139], v[64:67]
  v_xor_b32 v9, 192, v8
  ds_read_b64_tr_b16 v[16:17], v9 offset:0
  v_mul_f32 v95, v14, v95
  v_cvt_pk_bf16_f32 v120, v80, v81
  v_mfma_f32_16x16x32_bf16 v[68:71], v[20:23], v[140:143], v[68:71]
  ds_read_b64_tr_b16 v[18:19], v9 offset:1024
  v_cvt_pk_bf16_f32 v121, v82, v83
  v_cvt_pk_bf16_f32 v122, v88, v89
  s_waitcnt lgkmcnt(4)
  v_mfma_f32_16x16x32_bf16 v[72:75], v[24:27], v[128:131], 0
  ds_read_b64_tr_b16 v[20:21], v9 offset:8192
  v_cvt_pk_bf16_f32 v123, v90, v91
  ds_write_b128 v15, v[120:123] offset:18432
  v_cvt_pk_bf16_f32 v124, v84, v85
  v_mfma_f32_16x16x32_bf16 v[76:79], v[24:27], v[132:135], 0
  ds_read_b64_tr_b16 v[22:23], v9 offset:9216
  v_cvt_pk_bf16_f32 v125, v86, v87
  v_cvt_pk_bf16_f32 v126, v92, v93
  s_waitcnt lgkmcnt(5)
  v_mfma_f32_16x16x32_bf16 v[72:75], v[28:31], v[136:139], v[72:75]
  v_xor_b32 v10, 224, v8
  ds_read_b64_tr_b16 v[24:25], v10 offset:0
  v_cvt_pk_bf16_f32 v127, v94, v95
  ds_write_b128 v15, v[124:127] offset:19456
  v_mfma_f32_16x16x32_bf16 v[76:79], v[28:31], v[140:143], v[76:79]
  ds_read_b64_tr_b16 v[26:27], v10 offset:1024
  s_waitcnt lgkmcnt(6)
  v_mfma_f32_16x16x32_bf16 v[80:83], v[16:19], v[128:131], 0
  ds_read_b64_tr_b16 v[28:29], v10 offset:8192
  v_mfma_f32_16x16x32_bf16 v[84:87], v[16:19], v[132:135], 0
  ds_read_b64_tr_b16 v[30:31], v10 offset:9216
  s_and_b32 s50, s70, 15
  s_lshr_b64 s[70:71], s[70:71], 4
  s_lshl_b32 s50, s50, 14
  v_add_u32 v8, s50, v5
  s_waitcnt lgkmcnt(5)
  v_mfma_f32_16x16x32_bf16 v[80:83], v[20:23], v[136:139], v[80:83]
  v_mfma_f32_16x16x32_bf16 v[84:87], v[20:23], v[140:143], v[84:87]
  s_waitcnt lgkmcnt(0)
  s_barrier
  ds_read_b64_tr_b16 v[16:17], v8 offset:0
  ds_read_b64_tr_b16 v[18:19], v8 offset:1024
  v_mfma_f32_16x16x32_bf16 v[88:91], v[24:27], v[128:131], 0
  v_xor_b32 v9, 32, v8
  ds_read_b64_tr_b16 v[20:21], v9 offset:0
  v_mfma_f32_16x16x32_bf16 v[92:95], v[24:27], v[132:135], 0
  ds_read_b64_tr_b16 v[22:23], v9 offset:1024
  v_mfma_f32_16x16x32_bf16 v[88:91], v[28:31], v[136:139], v[88:91]
  v_xor_b32 v10, 64, v8
  ds_read_b64_tr_b16 v[24:25], v10 offset:0
  v_mfma_f32_16x16x32_bf16 v[92:95], v[28:31], v[140:143], v[92:95]
  ds_read_b64_tr_b16 v[26:27], v10 offset:1024
  s_waitcnt lgkmcnt(4)
  v_mfma_f32_16x16x32_bf16 v[32:35], v[16:19], v[144:147], v[32:35]
  v_xor_b32 v11, 96, v8
  ds_read_b64_tr_b16 v[28:29], v11 offset:0
  v_mfma_f32_16x16x32_bf16 v[36:39], v[16:19], v[148:151], v[36:39]
  ds_read_b64_tr_b16 v[30:31], v11 offset:1024
  s_waitcnt lgkmcnt(4)
  v_mfma_f32_16x16x32_bf16 v[40:43], v[20:23], v[144:147], v[40:43]
  v_xor_b32 v108, 128, v8
  ds_read_b64_tr_b16 v[16:17], v108 offset:0
  v_mfma_f32_16x16x32_bf16 v[44:47], v[20:23], v[148:151], v[44:47]
  ds_read_b64_tr_b16 v[18:19], v108 offset:1024
  s_waitcnt lgkmcnt(4)
  v_mfma_f32_16x16x32_bf16 v[48:51], v[24:27], v[144:147], v[48:51]
  v_xor_b32 v109, 160, v8
  ds_read_b64_tr_b16 v[20:21], v109 offset:0
  v_mfma_f32_16x16x32_bf16 v[52:55], v[24:27], v[148:151], v[52:55]
  ds_read_b64_tr_b16 v[22:23], v109 offset:1024
  s_waitcnt lgkmcnt(4)
  v_mfma_f32_16x16x32_bf16 v[56:59], v[28:31], v[144:147], v[56:59]
  v_xor_b32 v110, 192, v8
  ds_read_b64_tr_b16 v[24:25], v110 offset:0
  v_mfma_f32_16x16x32_bf16 v[60:63], v[28:31], v[148:151], v[60:63]
  ds_read_b64_tr_b16 v[26:27], v110 offset:1024
  s_waitcnt lgkmcnt(4)
  v_mfma_f32_16x16x32_bf16 v[64:67], v[16:19], v[144:147], v[64:67]
  v_xor_b32 v111, 224, v8
  ds_read_b64_tr_b16 v[28:29], v111 offset:0
  v_mfma_f32_16x16x32_bf16 v[68:71], v[16:19], v[148:151], v[68:71]
  ds_read_b64_tr_b16 v[30:31], v111 offset:1024
  s_waitcnt lgkmcnt(4)
  v_mfma_f32_16x16x32_bf16 v[72:75], v[20:23], v[144:147], v[72:75]
  ds_read_b64_tr_b16 v[16:17], v8 offset:8192
  v_mfma_f32_16x16x32_bf16 v[76:79], v[20:23], v[148:151], v[76:79]
  ds_read_b64_tr_b16 v[18:19], v8 offset:9216
  s_waitcnt lgkmcnt(4)
  v_mfma_f32_16x16x32_bf16 v[80:83], v[24:27], v[144:147], v[80:83]
  ds_read_b64_tr_b16 v[20:21], v9 offset:8192
  v_mfma_f32_16x16x32_bf16 v[84:87], v[24:27], v[148:151], v[84:87]
  ds_read_b64_tr_b16 v[22:23], v9 offset:9216
  s_waitcnt lgkmcnt(4)
  v_mfma_f32_16x16x32_bf16 v[88:91], v[28:31], v[144:147], v[88:91]
  ds_read_b64_tr_b16 v[24:25], v10 offset:8192
  v_mfma_f32_16x16x32_bf16 v[92:95], v[28:31], v[148:151], v[92:95]
  ds_read_b64_tr_b16 v[26:27], v10 offset:9216
  s_waitcnt lgkmcnt(4)
  v_mfma_f32_16x16x32_bf16 v[32:35], v[16:19], v[152:155], v[32:35]
  ds_read_b64_tr_b16 v[28:29], v11 offset:8192
  v_mfma_f32_16x16x32_bf16 v[36:39], v[16:19], v[156:159], v[36:39]
  ds_read_b64_tr_b16 v[30:31], v11 offset:9216
  s_waitcnt lgkmcnt(4)
  v_mfma_f32_16x16x32_bf16 v[40:43], v[20:23], v[152:155], v[40:43]
  ds_read_b64_tr_b16 v[16:17], v108 offset:8192
  v_mfma_f32_16x16x32_bf16 v[44:47], v[20:23], v[156:159], v[44:47]
  ds_read_b64_tr_b16 v[18:19], v108 offset:9216
  s_waitcnt lgkmcnt(4)
  v_mfma_f32_16x16x32_bf16 v[48:51], v[24:27], v[152:155], v[48:51]
  ds_read_b64_tr_b16 v[20:21], v109 offset:8192
  v_mfma_f32_16x16x32_bf16 v[52:55], v[24:27], v[156:159], v[52:55]
  ds_read_b64_tr_b16 v[22:23], v109 offset:9216
  s_waitcnt lgkmcnt(4)
  v_mfma_f32_16x16x32_bf16 v[56:59], v[28:31], v[152:155], v[56:59]
  ds_read_b64_tr_b16 v[24:25], v110 offset:8192
  v_mfma_f32_16x16x32_bf16 v[60:63], v[28:31], v[156:159], v[60:63]
  ds_read_b64_tr_b16 v[26:27], v110 offset:9216
  s_waitcnt lgkmcnt(4)
  v_mfma_f32_16x16x32_bf16 v[64:67], v[16:19], v[152:155], v[64:67]
  ds_read_b64_tr_b16 v[28:29], v111 offset:8192
  v_mfma_f32_16x16x32_bf16 v[68:71], v[16:19], v[156:159], v[68:71]
  ds_read_b64_tr_b16 v[30:31], v111 offset:9216
  s_and_b32 s50, s70, 15
  s_lshr_b64 s[70:71], s[70:71], 4
  s_lshl_b32 s50, s50, 14
  v_add_u32 v8, s50, v5
  s_waitcnt lgkmcnt(4)
  v_mfma_f32_16x16x32_bf16 v[72:75], v[20:23], v[152:155], v[72:75]
  v_mfma_f32_16x16x32_bf16 v[76:79], v[20:23], v[156:159], v[76:79]
  s_waitcnt lgkmcnt(0)
  s_barrier
  ds_read_b64_tr_b16 v[16:17], v8 offset:0
  ds_read_b64_tr_b16 v[18:19], v8 offset:1024
  v_mfma_f32_16x16x32_bf16 v[80:83], v[24:27], v[152:155], v[80:83]
  v_xor_b32 v9, 32, v8
  ds_read_b64_tr_b16 v[20:21], v9 offset:0
  v_mfma_f32_16x16x32_bf16 v[84:87], v[24:27], v[156:159], v[84:87]
  ds_read_b64_tr_b16 v[22:23], v9 offset:1024
  v_mfma_f32_16x16x32_bf16 v[88:91], v[28:31], v[152:155], v[88:91]
  v_xor_b32 v10, 64, v8
  ds_read_b64_tr_b16 v[24:25], v10 offset:0
  v_mfma_f32_16x16x32_bf16 v[92:95], v[28:31], v[156:159], v[92:95]
  ds_read_b64_tr_b16 v[26:27], v10 offset:1024
  s_waitcnt lgkmcnt(4)
  v_mfma_f32_16x16x32_bf16 v[32:35], v[16:19], v[160:163], v[32:35]
  v_xor_b32 v11, 96, v8
  ds_read_b64_tr_b16 v[28:29], v11 offset:0
  v_mfma_f32_16x16x32_bf16 v[36:39], v[16:19], v[164:167], v[36:39]
  ds_read_b64_tr_b16 v[30:31], v11 offset:1024
  s_waitcnt lgkmcnt(4)
  v_mfma_f32_16x16x32_bf16 v[40:43], v[20:23], v[160:163], v[40:43]
  v_xor_b32 v108, 128, v8
  ds_read_b64_tr_b16 v[16:17], v108 offset:0
  v_mfma_f32_16x16x32_bf16 v[44:47], v[20:23], v[164:167], v[44:47]
  ds_read_b64_tr_b16 v[18:19], v108 offset:1024
  s_waitcnt lgkmcnt(4)
  v_mfma_f32_16x16x32_bf16 v[48:51], v[24:27], v[160:163], v[48:51]
  v_xor_b32 v109, 160, v8
  ds_read_b64_tr_b16 v[20:21], v109 offset:0
  v_mfma_f32_16x16x32_bf16 v[52:55], v[24:27], v[164:167], v[52:55]
  ds_read_b64_tr_b16 v[22:23], v109 offset:1024
  s_waitcnt lgkmcnt(4)
  v_mfma_f32_16x16x32_bf16 v[56:59], v[28:31], v[160:163], v[56:59]
  v_xor_b32 v110, 192, v8
  ds_read_b64_tr_b16 v[24:25], v110 offset:0
  v_mfma_f32_16x16x32_bf16 v[60:63], v[28:31], v[164:167], v[60:63]
  ds_read_b64_tr_b16 v[26:27], v110 offset:1024
  s_waitcnt lgkmcnt(4)
  v_mfma_f32_16x16x32_bf16 v[64:67], v[16:19], v[160:163], v[64:67]
  v_xor_b32 v111, 224, v8
  ds_read_b64_tr_b16 v[28:29], v111 offset:0
  v_mfma_f32_16x16x32_bf16 v[68:71], v[16:19], v[164:167], v[68:71]
  ds_read_b64_tr_b16 v[30:31], v111 offset:1024
  s_waitcnt lgkmcnt(4)
  v_mfma_f32_16x16x32_bf16 v[72:75], v[20:23], v[160:163], v[72:75]
  ds_read_b64_tr_b16 v[16:17], v8 offset:8192
  v_mfma_f32_16x16x32_bf16 v[76:79], v[20:23], v[164:167], v[76:79]
  ds_read_b64_tr_b16 v[18:19], v8 offset:9216
  s_waitcnt lgkmcnt(4)
  v_mfma_f32_16x16x32_bf16 v[80:83], v[24:27], v[160:163], v[80:83]
  ds_read_b64_tr_b16 v[20:21], v9 offset:8192
  v_mfma_f32_16x16x32_bf16 v[84:87], v[24:27], v[164:167], v[84:87]
  ds_read_b64_tr_b16 v[22:23], v9 offset:9216
  s_waitcnt lgkmcnt(4)
  v_mfma_f32_16x16x32_bf16 v[88:91], v[28:31], v[160:163], v[88:91]
  ds_read_b64_tr_b16 v[24:25], v10 offset:8192
  v_mfma_f32_16x16x32_bf16 v[92:95], v[28:31], v[164:167], v[92:95]
  ds_read_b64_tr_b16 v[26:27], v10 offset:9216
  s_waitcnt lgkmcnt(4)
  v_mfma_f32_16x16x32_bf16 v[32:35], v[16:19], v[168:171], v[32:35]
  ds_read_b64_tr_b16 v[28:29], v11 offset:8192
  v_mfma_f32_16x16x32_bf16 v[36:39], v[16:19], v[172:175], v[36:39]
  ds_read_b64_tr_b16 v[30:31], v11 offset:9216
  s_waitcnt lgkmcnt(4)
  v_mfma_f32_16x16x32_bf16 v[40:43], v[20:23], v[168:171], v[40:43]
  ds_read_b64_tr_b16 v[16:17], v108 offset:8192
  v_mfma_f32_16x16x32_bf16 v[44:47], v[20:23], v[172:175], v[44:47]
  ds_read_b64_tr_b16 v[18:19], v108 offset:9216
  s_waitcnt lgkmcnt(4)
  v_mfma_f32_16x16x32_bf16 v[48:51], v[24:27], v[168:171], v[48:51]
  ds_read_b64_tr_b16 v[20:21], v109 offset:8192
  v_mfma_f32_16x16x32_bf16 v[52:55], v[24:27], v[172:175], v[52:55]
  ds_read_b64_tr_b16 v[22:23], v109 offset:9216
  s_waitcnt lgkmcnt(4)
  v_mfma_f32_16x16x32_bf16 v[56:59], v[28:31], v[168:171], v[56:59]
  ds_read_b64_tr_b16 v[24:25], v110 offset:8192
  v_mfma_f32_16x16x32_bf16 v[60:63], v[28:31], v[172:175], v[60:63]
  ds_read_b64_tr_b16 v[26:27], v110 offset:9216
  s_waitcnt lgkmcnt(4)
  v_mfma_f32_16x16x32_bf16 v[64:67], v[16:19], v[168:171], v[64:67]
  ds_read_b64_tr_b16 v[28:29], v111 offset:8192
  v_mfma_f32_16x16x32_bf16 v[68:71], v[16:19], v[172:175], v[68:71]
  ds_read_b64_tr_b16 v[30:31], v111 offset:9216
  s_and_b32 s50, s70, 15
  s_lshr_b64 s[70:71], s[70:71], 4
  s_lshl_b32 s50, s50, 14
  v_add_u32 v8, s50, v5
  s_waitcnt lgkmcnt(4)
  v_mfma_f32_16x16x32_bf16 v[72:75], v[20:23], v[168:171], v[72:75]
  v_mfma_f32_16x16x32_bf16 v[76:79], v[20:23], v[172:175], v[76:79]
  s_waitcnt lgkmcnt(0)
  s_barrier
  ds_read_b64_tr_b16 v[16:17], v8 offset:0
  ds_read_b64_tr_b16 v[18:19], v8 offset:1024
  v_mfma_f32_16x16x32_bf16 v[80:83], v[24:27], v[168:171], v[80:83]
  v_xor_b32 v9, 32, v8
  ds_read_b64_tr_b16 v[20:21], v9 offset:0
  v_mfma_f32_16x16x32_bf16 v[84:87], v[24:27], v[172:175], v[84:87]
  ds_read_b64_tr_b16 v[22:23], v9 offset:1024
  v_mfma_f32_16x16x32_bf16 v[88:91], v[28:31], v[168:171], v[88:91]
  v_xor_b32 v10, 64, v8
  ds_read_b64_tr_b16 v[24:25], v10 offset:0
  v_mfma_f32_16x16x32_bf16 v[92:95], v[28:31], v[172:175], v[92:95]
  ds_read_b64_tr_b16 v[26:27], v10 offset:1024
  s_waitcnt lgkmcnt(4)
  v_mfma_f32_16x16x32_bf16 v[32:35], v[16:19], v[176:179], v[32:35]
  v_xor_b32 v11, 96, v8
  ds_read_b64_tr_b16 v[28:29], v11 offset:0
  v_mfma_f32_16x16x32_bf16 v[36:39], v[16:19], v[180:183], v[36:39]
  ds_read_b64_tr_b16 v[30:31], v11 offset:1024
  s_waitcnt lgkmcnt(4)
  v_mfma_f32_16x16x32_bf16 v[40:43], v[20:23], v[176:179], v[40:43]
  v_xor_b32 v108, 128, v8
  ds_read_b64_tr_b16 v[16:17], v108 offset:0
  v_mfma_f32_16x16x32_bf16 v[44:47], v[20:23], v[180:183], v[44:47]
  ds_read_b64_tr_b16 v[18:19], v108 offset:1024
  s_waitcnt lgkmcnt(4)
  v_mfma_f32_16x16x32_bf16 v[48:51], v[24:27], v[176:179], v[48:51]
  v_xor_b32 v109, 160, v8
  ds_read_b64_tr_b16 v[20:21], v109 offset:0
  v_mfma_f32_16x16x32_bf16 v[52:55], v[24:27], v[180:183], v[52:55]
  ds_read_b64_tr_b16 v[22:23], v109 offset:1024
  s_waitcnt lgkmcnt(4)
  v_mfma_f32_16x16x32_bf16 v[56:59], v[28:31], v[176:179], v[56:59]
  v_xor_b32 v110, 192, v8
  ds_read_b64_tr_b16 v[24:25], v110 offset:0
  v_mfma_f32_16x16x32_bf16 v[60:63], v[28:31], v[180:183], v[60:63]
  ds_read_b64_tr_b16 v[26:27], v110 offset:1024
  s_waitcnt lgkmcnt(4)
  v_mfma_f32_16x16x32_bf16 v[64:67], v[16:19], v[176:179], v[64:67]
  v_xor_b32 v111, 224, v8
  ds_read_b64_tr_b16 v[28:29], v111 offset:0
  v_mfma_f32_16x16x32_bf16 v[68:71], v[16:19], v[180:183], v[68:71]
  ds_read_b64_tr_b16 v[30:31], v111 offset:1024
  s_waitcnt lgkmcnt(4)
  v_mfma_f32_16x16x32_bf16 v[72:75], v[20:23], v[176:179], v[72:75]
  ds_read_b64_tr_b16 v[16:17], v8 offset:8192
  v_mfma_f32_16x16x32_bf16 v[76:79], v[20:23], v[180:183], v[76:79]
  ds_read_b64_tr_b16 v[18:19], v8 offset:9216
  s_waitcnt lgkmcnt(4)
  v_mfma_f32_16x16x32_bf16 v[80:83], v[24:27], v[176:179], v[80:83]
  ds_read_b64_tr_b16 v[20:21], v9 offset:8192
  v_mfma_f32_16x16x32_bf16 v[84:87], v[24:27], v[180:183], v[84:87]
  ds_read_b64_tr_b16 v[22:23], v9 offset:9216
  s_waitcnt lgkmcnt(4)
  v_mfma_f32_16x16x32_bf16 v[88:91], v[28:31], v[176:179], v[88:91]
  ds_read_b64_tr_b16 v[24:25], v10 offset:8192
  v_mfma_f32_16x16x32_bf16 v[92:95], v[28:31], v[180:183], v[92:95]
  ds_read_b64_tr_b16 v[26:27], v10 offset:9216
  s_waitcnt lgkmcnt(4)
  v_mfma_f32_16x16x32_bf16 v[32:35], v[16:19], v[184:187], v[32:35]
  ds_read_b64_tr_b16 v[28:29], v11 offset:8192
  v_mfma_f32_16x16x32_bf16 v[36:39], v[16:19], v[188:191], v[36:39]
  ds_read_b64_tr_b16 v[30:31], v11 offset:9216
  s_waitcnt lgkmcnt(4)
  v_mfma_f32_16x16x32_bf16 v[40:43], v[20:23], v[184:187], v[40:43]
  ds_read_b64_tr_b16 v[16:17], v108 offset:8192
  v_mfma_f32_16x16x32_bf16 v[44:47], v[20:23], v[188:191], v[44:47]
  ds_read_b64_tr_b16 v[18:19], v108 offset:9216
  s_waitcnt lgkmcnt(4)
  v_mfma_f32_16x16x32_bf16 v[48:51], v[24:27], v[184:187], v[48:51]
  ds_read_b64_tr_b16 v[20:21], v109 offset:8192
  v_mfma_f32_16x16x32_bf16 v[52:55], v[24:27], v[188:191], v[52:55]
  ds_read_b64_tr_b16 v[22:23], v109 offset:9216
  s_waitcnt lgkmcnt(4)
  v_mfma_f32_16x16x32_bf16 v[56:59], v[28:31], v[184:187], v[56:59]
  ds_read_b64_tr_b16 v[24:25], v110 offset:8192
  v_mfma_f32_16x16x32_bf16 v[60:63], v[28:31], v[188:191], v[60:63]
  ds_read_b64_tr_b16 v[26:27], v110 offset:9216
  s_branch L_pads10
L_pad10:
  s_setpc_b64 s[60:61]
L_pads10:
  s_waitcnt lgkmcnt(4)
  v_mfma_f32_16x16x32_bf16 v[64:67], v[16:19], v[184:187], v[64:67]
  ds_read_b64_tr_b16 v[28:29], v111 offset:8192
  v_mfma_f32_16x16x32_bf16 v[68:71], v[16:19], v[188:191], v[68:71]
  ds_read_b64_tr_b16 v[30:31], v111 offset:9216
  s_and_b32 s50, s70, 15
  s_lshr_b64 s[70:71], s[70:71], 4
  s_lshl_b32 s50, s50, 14
  v_add_u32 v8, s50, v5
  s_waitcnt lgkmcnt(4)
  v_mfma_f32_16x16x32_bf16 v[72:75], v[20:23], v[184:187], v[72:75]
  v_mfma_f32_16x16x32_bf16 v[76:79], v[20:23], v[188:191], v[76:79]
  s_waitcnt lgkmcnt(0)
  s_barrier
  ds_read_b64_tr_b16 v[16:17], v8 offset:0
  ds_read_b64_tr_b16 v[18:19], v8 offset:1024
  v_mfma_f32_16x16x32_bf16 v[80:83], v[24:27], v[184:187], v[80:83]
  v_xor_b32 v9, 32, v8
  ds_read_b64_tr_b16 v[20:21], v9 offset:0
  v_mfma_f32_16x16x32_bf16 v[84:87], v[24:27], v[188:191], v[84:87]
  ds_read_b64_tr_b16 v[22:23], v9 offset:1024
  v_mfma_f32_16x16x32_bf16 v[88:91], v[28:31], v[184:187], v[88:91]
  v_xor_b32 v10, 64, v8
  ds_read_b64_tr_b16 v[24:25], v10 offset:0
  v_mfma_f32_16x16x32_bf16 v[92:95], v[28:31], v[188:191], v[92:95]
  ds_read_b64_tr_b16 v[26:27], v10 offset:1024
  s_waitcnt lgkmcnt(4)
  v_mfma_f32_16x16x32_bf16 v[32:35], v[16:19], v[192:195], v[32:35]
  v_xor_b32 v11, 96, v8
  ds_read_b64_tr_b16 v[28:29], v11 offset:0
  v_mfma_f32_16x16x32_bf16 v[36:39], v[16:19], v[196:199], v[36:39]
  ds_read_b64_tr_b16 v[30:31], v11 offset:1024
  s_waitcnt lgkmcnt(4)
  v_mfma_f32_16x16x32_bf16 v[40:43], v[20:23], v[192:195], v[40:43]
  v_xor_b32 v108, 128, v8
  ds_read_b64_tr_b16 v[16:17], v108 offset:0
  v_mfma_f32_16x16x32_bf16 v[44:47], v[20:23], v[196:199], v[44:47]
  ds_read_b64_tr_b16 v[18:19], v108 offset:1024
  s_waitcnt lgkmcnt(4)
  v_mfma_f32_16x16x32_bf16 v[48:51], v[24:27], v[192:195], v[48:51]
  v_xor_b32 v109, 160, v8
  ds_read_b64_tr_b16 v[20:21], v109 offset:0
  v_mfma_f32_16x16x32_bf16 v[52:55], v[24:27], v[196:199], v[52:55]
  ds_read_b64_tr_b16 v[22:23], v109 offset:1024
  s_waitcnt lgkmcnt(4)
  v_mfma_f32_16x16x32_bf16 v[56:59], v[28:31], v[192:195], v[56:59]
  v_xor_b32 v110, 192, v8
  ds_read_b64_tr_b16 v[24:25], v110 offset:0
  v_mfma_f32_16x16x32_bf16 v[60:63], v[28:31], v[196:199], v[60:63]
  ds_read_b64_tr_b16 v[26:27], v110 offset:1024
  s_waitcnt lgkmcnt(4)
  v_mfma_f32_16x16x32_bf16 v[64:67], v[16:19], v[192:195], v[64:67]
  v_xor_b32 v111, 224, v8
  ds_read_b64_tr_b16 v[28:29], v111 offset:0
  v_mfma_f32_16x16x32_bf16 v[68:71], v[16:19], v[196:199], v[68:71]
  ds_read_b64_tr_b16 v[30:31], v111 offset:1024
  s_waitcnt lgkmcnt(4)
  v_mfma_f32_16x16x32_bf16 v[72:75], v[20:23], v[192:195], v[72:75]
  ds_read_b64_tr_b16 v[16:17], v8 offset:8192
  v_mfma_f32_16x16x32_bf16 v[76:79], v[20:23], v[196:199], v[76:79]
  ds_read_b64_tr_b16 v[18:19], v8 offset:9216
  s_waitcnt lgkmcnt(4)
  v_mfma_f32_16x16x32_bf16 v[80:83], v[24:27], v[192:195], v[80:83]
  ds_read_b64_tr_b16 v[20:21], v9 offset:8192
  v_mfma_f32_16x16x32_bf16 v[84:87], v[24:27], v[196:199], v[84:87]
  ds_read_b64_tr_b16 v[22:23], v9 offset:9216
  s_waitcnt lgkmcnt(4)
  v_mfma_f32_16x16x32_bf16 v[88:91], v[28:31], v[192:195], v[88:91]
  ds_read_b64_tr_b16 v[24:25], v10 offset:8192
  v_mfma_f32_16x16x32_bf16 v[92:95], v[28:31], v[196:199], v[92:95]
  ds_read_b64_tr_b16 v[26:27], v10 offset:9216
  s_waitcnt lgkmcnt(4)
  v_mfma_f32_16x16x32_bf16 v[32:35], v[16:19], v[200:203], v[32:35]
  ds_read_b64_tr_b16 v[28:29], v11 offset:8192
  v_mfma_f32_16x16x32_bf16 v[36:39], v[16:19], v[204:207], v[36:39]
  ds_read_b64_tr_b16 v[30:31], v11 offset:9216
  s_waitcnt lgkmcnt(4)
  v_mfma_f32_16x16x32_bf16 v[40:43], v[20:23], v[200:203], v[40:43]
  ds_read_b64_tr_b16 v[16:17], v108 offset:8192
  v_mfma_f32_16x16x32_bf16 v[44:47], v[20:23], v[204:207], v[44:47]
  ds_read_b64_tr_b16 v[18:19], v108 offset:9216
  s_waitcnt lgkmcnt(4)
  v_mfma_f32_16x16x32_bf16 v[48:51], v[24:27], v[200:203], v[48:51]
  ds_read_b64_tr_b16 v[20:21], v109 offset:8192
  v_mfma_f32_16x16x32_bf16 v[52:55], v[24:27], v[204:207], v[52:55]
  ds_read_b64_tr_b16 v[22:23], v109 offset:9216
  s_waitcnt lgkmcnt(4)
  v_mfma_f32_16x16x32_bf16 v[56:59], v[28:31], v[200:203], v[56:59]
  ds_read_b64_tr_b16 v[24:25], v110 offset:8192
  v_mfma_f32_16x16x32_bf16 v[60:63], v[28:31], v[204:207], v[60:63]
  ds_read_b64_tr_b16 v[26:27], v110 offset:9216
  s_waitcnt lgkmcnt(4)
  v_mfma_f32_16x16x32_bf16 v[64:67], v[16:19], v[200:203], v[64:67]
  ds_read_b64_tr_b16 v[28:29], v111 offset:8192
  v_mfma_f32_16x16x32_bf16 v[68:71], v[16:19], v[204:207], v[68:71]
  ds_read_b64_tr_b16 v[30:31], v111 offset:9216
  s_and_b32 s50, s70, 15
  s_lshr_b64 s[70:71], s[70:71], 4
  s_lshl_b32 s50, s50, 14
  v_add_u32 v8, s50, v5
  s_waitcnt lgkmcnt(4)
  v_mfma_f32_16x16x32_bf16 v[72:75], v[20:23], v[200:203], v[72:75]
  v_mfma_f32_16x16x32_bf16 v[76:79], v[20:23], v[204:207], v[76:79]
  s_waitcnt lgkmcnt(0)
  s_barrier
  ds_read_b64_tr_b16 v[16:17], v8 offset:0
  ds_read_b64_tr_b16 v[18:19], v8 offset:1024
  v_mfma_f32_16x16x32_bf16 v[80:83], v[24:27], v[200:203], v[80:83]
  v_xor_b32 v9, 32, v8
  ds_read_b64_tr_b16 v[20:21], v9 offset:0
  v_mfma_f32_16x16x32_bf16 v[84:87], v[24:27], v[204:207], v[84:87]
  ds_read_b64_tr_b16 v[22:23], v9 offset:1024
  v_mfma_f32_16x16x32_bf16 v[88:91], v[28:31], v[200:203], v[88:91]
  v_xor_b32 v10, 64, v8
  ds_read_b64_tr_b16 v[24:25], v10 offset:0
  v_mfma_f32_16x16x32_bf16 v[92:95], v[28:31], v[204:207], v[92:95]
  ds_read_b64_tr_b16 v[26:27], v10 offset:1024
  s_waitcnt lgkmcnt(4)
  v_mfma_f32_16x16x32_bf16 v[32:35], v[16:19], v[208:211], v[32:35]
  v_xor_b32 v11, 96, v8
  ds_read_b64_tr_b16 v[28:29], v11 offset:0
  v_mfma_f32_16x16x32_bf16 v[36:39], v[16:19], v[212:215], v[36:39]
  ds_read_b64_tr_b16 v[30:31], v11 offset:1024
  s_waitcnt lgkmcnt(4)
  v_mfma_f32_16x16x32_bf16 v[40:43], v[20:23], v[208:211], v[40:43]
  v_xor_b32 v108, 128, v8
  ds_read_b64_tr_b16 v[16:17], v108 offset:0
  v_mfma_f32_16x16x32_bf16 v[44:47], v[20:23], v[212:215], v[44:47]
  ds_read_b64_tr_b16 v[18:19], v108 offset:1024
  s_waitcnt lgkmcnt(4)
  v_mfma_f32_16x16x32_bf16 v[48:51], v[24:27], v[208:211], v[48:51]
  v_xor_b32 v109, 160, v8
  ds_read_b64_tr_b16 v[20:21], v109 offset:0
  v_mfma_f32_16x16x32_bf16 v[52:55], v[24:27], v[212:215], v[52:55]
  ds_read_b64_tr_b16 v[22:23], v109 offset:1024
  s_waitcnt lgkmcnt(4)
  v_mfma_f32_16x16x32_bf16 v[56:59], v[28:31], v[208:211], v[56:59]
  v_xor_b32 v110, 192, v8
  ds_read_b64_tr_b16 v[24:25], v110 offset:0
  v_mfma_f32_16x16x32_bf16 v[60:63], v[28:31], v[212:215], v[60:63]
  ds_read_b64_tr_b16 v[26:27], v110 offset:1024
  s_waitcnt lgkmcnt(4)
  v_mfma_f32_16x16x32_bf16 v[64:67], v[16:19], v[208:211], v[64:67]
  v_xor_b32 v111, 224, v8
  ds_read_b64_tr_b16 v[28:29], v111 offset:0
  v_mfma_f32_16x16x32_bf16 v[68:71], v[16:19], v[212:215], v[68:71]
  ds_read_b64_tr_b16 v[30:31], v111 offset:1024
  s_waitcnt lgkmcnt(4)
  v_mfma_f32_16x16x32_bf16 v[72:75], v[20:23], v[208:211], v[72:75]
  ds_read_b64_tr_b16 v[16:17], v8 offset:8192
  v_mfma_f32_16x16x32_bf16 v[76:79], v[20:23], v[212:215], v[76:79]
  ds_read_b64_tr_b16 v[18:19], v8 offset:9216
  s_waitcnt lgkmcnt(4)
  v_mfma_f32_16x16x32_bf16 v[80:83], v[24:27], v[208:211], v[80:83]
  ds_read_b64_tr_b16 v[20:21], v9 offset:8192
  v_mfma_f32_16x16x32_bf16 v[84:87], v[24:27], v[212:215], v[84:87]
  ds_read_b64_tr_b16 v[22:23], v9 offset:9216
  s_waitcnt lgkmcnt(4)
  v_mfma_f32_16x16x32_bf16 v[88:91], v[28:31], v[208:211], v[88:91]
  ds_read_b64_tr_b16 v[24:25], v10 offset:8192
  v_mfma_f32_16x16x32_bf16 v[92:95], v[28:31], v[212:215], v[92:95]
  ds_read_b64_tr_b16 v[26:27], v10 offset:9216
  s_waitcnt lgkmcnt(4)
  v_mfma_f32_16x16x32_bf16 v[32:35], v[16:19], v[216:219], v[32:35]
  ds_read_b64_tr_b16 v[28:29], v11 offset:8192
  v_mfma_f32_16x16x32_bf16 v[36:39], v[16:19], v[220:223], v[36:39]
  ds_read_b64_tr_b16 v[30:31], v11 offset:9216
  s_waitcnt lgkmcnt(4)
  v_mfma_f32_16x16x32_bf16 v[40:43], v[20:23], v[216:219], v[40:43]
  ds_read_b64_tr_b16 v[16:17], v108 offset:8192
  v_mfma_f32_16x16x32_bf16 v[44:47], v[20:23], v[220:223], v[44:47]
  ds_read_b64_tr_b16 v[18:19], v108 offset:9216
  s_waitcnt lgkmcnt(4)
  v_mfma_f32_16x16x32_bf16 v[48:51], v[24:27], v[216:219], v[48:51]
  ds_read_b64_tr_b16 v[20:21], v109 offset:8192
  v_mfma_f32_16x16x32_bf16 v[52:55], v[24:27], v[220:223], v[52:55]
  ds_read_b64_tr_b16 v[22:23], v109 offset:9216
  s_waitcnt lgkmcnt(4)
  v_mfma_f32_16x16x32_bf16 v[56:59], v[28:31], v[216:219], v[56:59]
  ds_read_b64_tr_b16 v[24:25], v110 offset:8192
  v_mfma_f32_16x16x32_bf16 v[60:63], v[28:31], v[220:223], v[60:63]
  ds_read_b64_tr_b16 v[26:27], v110 offset:9216
  s_waitcnt lgkmcnt(4)
  v_mfma_f32_16x16x32_bf16 v[64:67], v[16:19], v[216:219], v[64:67]
  ds_read_b64_tr_b16 v[28:29], v111 offset:8192
  v_mfma_f32_16x16x32_bf16 v[68:71], v[16:19], v[220:223], v[68:71]
  ds_read_b64_tr_b16 v[30:31], v111 offset:9216
  s_and_b32 s50, s70, 15
  s_lshr_b64 s[70:71], s[70:71], 4
  s_lshl_b32 s50, s50, 14
  v_add_u32 v8, s50, v5
  s_waitcnt lgkmcnt(4)
  v_mfma_f32_16x16x32_bf16 v[72:75], v[20:23], v[216:219], v[72:75]
  v_mfma_f32_16x16x32_bf16 v[76:79], v[20:23], v[220:223], v[76:79]
  s_waitcnt lgkmcnt(0)
  s_barrier
  ds_read_b64_tr_b16 v[16:17], v8 offset:0
  ds_read_b64_tr_b16 v[18:19], v8 offset:1024
  v_mfma_f32_16x16x32_bf16 v[80:83], v[24:27], v[216:219], v[80:83]
  v_xor_b32 v9, 32, v8
  ds_read_b64_tr_b16 v[20:21], v9 offset:0
  v_mfma_f32_16x16x32_bf16 v[84:87], v[24:27], v[220:223], v[84:87]
  ds_read_b64_tr_b16 v[22:23], v9 offset:1024
  v_mfma_f32_16x16x32_bf16 v[88:91], v[28:31], v[216:219], v[88:91]
  v_xor_b32 v10, 64, v8
  ds_read_b64_tr_b16 v[24:25], v10 offset:0
  v_mfma_f32_16x16x32_bf16 v[92:95], v[28:31], v[220:223], v[92:95]
  ds_read_b64_tr_b16 v[26:27], v10 offset:1024
  s_waitcnt lgkmcnt(4)
  v_mfma_f32_16x16x32_bf16 v[32:35], v[16:19], v[224:227], v[32:35]
  v_xor_b32 v11, 96, v8
  ds_read_b64_tr_b16 v[28:29], v11 offset:0
  v_mfma_f32_16x16x32_bf16 v[36:39], v[16:19], v[228:231], v[36:39]
  ds_read_b64_tr_b16 v[30:31], v11 offset:1024
  s_waitcnt lgkmcnt(4)
  v_mfma_f32_16x16x32_bf16 v[40:43], v[20:23], v[224:227], v[40:43]
  v_xor_b32 v108, 128, v8
  ds_read_b64_tr_b16 v[16:17], v108 offset:0
  v_mfma_f32_16x16x32_bf16 v[44:47], v[20:23], v[228:231], v[44:47]
  ds_read_b64_tr_b16 v[18:19], v108 offset:1024
  s_waitcnt lgkmcnt(4)
  v_mfma_f32_16x16x32_bf16 v[48:51], v[24:27], v[224:227], v[48:51]
  v_xor_b32 v109, 160, v8
  ds_read_b64_tr_b16 v[20:21], v109 offset:0
  v_mfma_f32_16x16x32_bf16 v[52:55], v[24:27], v[228:231], v[52:55]
  ds_read_b64_tr_b16 v[22:23], v109 offset:1024
  s_waitcnt lgkmcnt(4)
  v_mfma_f32_16x16x32_bf16 v[56:59], v[28:31], v[224:227], v[56:59]
  v_xor_b32 v110, 192, v8
  ds_read_b64_tr_b16 v[24:25], v110 offset:0
  v_mfma_f32_16x16x32_bf16 v[60:63], v[28:31], v[228:231], v[60:63]
  ds_read_b64_tr_b16 v[26:27], v110 offset:1024
  s_waitcnt lgkmcnt(4)
  v_mfma_f32_16x16x32_bf16 v[64:67], v[16:19], v[224:227], v[64:67]
  v_xor_b32 v111, 224, v8
  ds_read_b64_tr_b16 v[28:29], v111 offset:0
  v_mfma_f32_16x16x32_bf16 v[68:71], v[16:19], v[228:231], v[68:71]
  ds_read_b64_tr_b16 v[30:31], v111 offset:1024
  s_waitcnt lgkmcnt(4)
  v_mfma_f32_16x16x32_bf16 v[72:75], v[20:23], v[224:227], v[72:75]
  ds_read_b64_tr_b16 v[16:17], v8 offset:8192
  v_mfma_f32_16x16x32_bf16 v[76:79], v[20:23], v[228:231], v[76:79]
  ds_read_b64_tr_b16 v[18:19], v8 offset:9216
  s_waitcnt lgkmcnt(4)
  v_mfma_f32_16x16x32_bf16 v[80:83], v[24:27], v[224:227], v[80:83]
  ds_read_b64_tr_b16 v[20:21], v9 offset:8192
  v_mfma_f32_16x16x32_bf16 v[84:87], v[24:27], v[228:231], v[84:87]
  ds_read_b64_tr_b16 v[22:23], v9 offset:9216
  s_waitcnt lgkmcnt(4)
  v_mfma_f32_16x16x32_bf16 v[88:91], v[28:31], v[224:227], v[88:91]
  ds_read_b64_tr_b16 v[24:25], v10 offset:8192
  v_mfma_f32_16x16x32_bf16 v[92:95], v[28:31], v[228:231], v[92:95]
  ds_read_b64_tr_b16 v[26:27], v10 offset:9216
  s_waitcnt lgkmcnt(4)
  v_mfma_f32_16x16x32_bf16 v[32:35], v[16:19], v[232:235], v[32:35]
  ds_read_b64_tr_b16 v[28:29], v11 offset:8192
  v_mfma_f32_16x16x32_bf16 v[36:39], v[16:19], v[236:239], v[36:39]
  ds_read_b64_tr_b16 v[30:31], v11 offset:9216
  s_waitcnt lgkmcnt(4)
  v_mfma_f32_16x16x32_bf16 v[40:43], v[20:23], v[232:235], v[40:43]
  ds_read_b64_tr_b16 v[16:17], v108 offset:8192
  v_mfma_f32_16x16x32_bf16 v[44:47], v[20:23], v[236:239], v[44:47]
  ds_read_b64_tr_b16 v[18:19], v108 offset:9216
  s_waitcnt lgkmcnt(4)
  v_mfma_f32_16x16x32_bf16 v[48:51], v[24:27], v[232:235], v[48:51]
  ds_read_b64_tr_b16 v[20:21], v109 offset:8192
  v_mfma_f32_16x16x32_bf16 v[52:55], v[24:27], v[236:239], v[52:55]
  ds_read_b64_tr_b16 v[22:23], v109 offset:9216
  s_waitcnt lgkmcnt(4)
  v_mfma_f32_16x16x32_bf16 v[56:59], v[28:31], v[232:235], v[56:59]
  ds_read_b64_tr_b16 v[24:25], v110 offset:8192
  v_mfma_f32_16x16x32_bf16 v[60:63], v[28:31], v[236:239], v[60:63]
  ds_read_b64_tr_b16 v[26:27], v110 offset:9216
  s_waitcnt lgkmcnt(4)
  v_mfma_f32_16x16x32_bf16 v[64:67], v[16:19], v[232:235], v[64:67]
  ds_read_b64_tr_b16 v[28:29], v111 offset:8192
  v_mfma_f32_16x16x32_bf16 v[68:71], v[16:19], v[236:239], v[68:71]
  ds_read_b64_tr_b16 v[30:31], v111 offset:9216
  s_and_b32 s50, s70, 15
  s_lshr_b64 s[70:71], s[70:71], 4
  s_lshl_b32 s50, s50, 14
  v_add_u32 v8, s50, v5
  s_waitcnt lgkmcnt(4)
  v_mfma_f32_16x16x32_bf16 v[72:75], v[20:23], v[232:235], v[72:75]
  v_mfma_f32_16x16x32_bf16 v[76:79], v[20:23], v[236:239], v[76:79]
  s_waitcnt lgkmcnt(0)
  s_barrier
  ds_read_b64_tr_b16 v[16:17], v8 offset:0
  ds_read_b64_tr_b16 v[18:19], v8 offset:1024
  v_mfma_f32_16x16x32_bf16 v[80:83], v[24:27], v[232:235], v[80:83]
  ds_read_b64_tr_b16 v[20:21], v8 offset:8192
  v_mfma_f32_16x16x32_bf16 v[84:87], v[24:27], v[236:239], v[84:87]
  ds_read_b64_tr_b16 v[22:23], v8 offset:9216
  v_mfma_f32_16x16x32_bf16 v[88:91], v[28:31], v[232:235], v[88:91]
  v_xor_b32 v10, 32, v8
  ds_read_b64_tr_b16 v[24:25], v10 offset:0
  v_mfma_f32_16x16x32_bf16 v[92:95], v[28:31], v[236:239], v[92:95]
  ds_read_b64_tr_b16 v[26:27], v10 offset:1024
  s_waitcnt lgkmcnt(4)
  v_mfma_f32_16x16x32_bf16 v[32:35], v[16:19], v[240:243], v[32:35]
  ds_read_b64_tr_b16 v[28:29], v10 offset:8192
  v_mfma_f32_16x16x32_bf16 v[36:39], v[16:19], v[244:247], v[36:39]
  ds_read_b64_tr_b16 v[30:31], v10 offset:9216
  s_waitcnt lgkmcnt(4)
  v_mfma_f32_16x16x32_bf16 v[32:35], v[20:23], v[248:251], v[32:35]
  v_xor_b32 v9, 64, v8
  ds_read_b64_tr_b16 v[16:17], v9 offset:0
  v_mfma_f32_16x16x32_bf16 v[36:39], v[20:23], v[252:255], v[36:39]
  ds_read_b64_tr_b16 v[18:19], v9 offset:1024
  s_waitcnt lgkmcnt(4)
  v_mfma_f32_16x16x32_bf16 v[40:43], v[24:27], v[240:243], v[40:43]
  ds_read_b64_tr_b16 v[20:21], v9 offset:8192
  v_mfma_f32_16x16x32_bf16 v[44:47], v[24:27], v[244:247], v[44:47]
  ds_read_b64_tr_b16 v[22:23], v9 offset:9216
  s_waitcnt lgkmcnt(4)
  v_mfma_f32_16x16x32_bf16 v[40:43], v[28:31], v[248:251], v[40:43]
  v_xor_b32 v10, 96, v8
  ds_read_b64_tr_b16 v[24:25], v10 offset:0
  v_mfma_f32_16x16x32_bf16 v[44:47], v[28:31], v[252:255], v[44:47]
  ds_read_b64_tr_b16 v[26:27], v10 offset:1024
  s_waitcnt lgkmcnt(4)
  v_mfma_f32_16x16x32_bf16 v[48:51], v[16:19], v[240:243], v[48:51]
  ds_read_b64_tr_b16 v[28:29], v10 offset:8192
  v_mfma_f32_16x16x32_bf16 v[52:55], v[16:19], v[244:247], v[52:55]
  ds_read_b64_tr_b16 v[30:31], v10 offset:9216
  s_waitcnt lgkmcnt(4)
  v_mfma_f32_16x16x32_bf16 v[48:51], v[20:23], v[248:251], v[48:51]
  v_xor_b32 v9, 128, v8
  ds_read_b64_tr_b16 v[16:17], v9 offset:0
  v_mfma_f32_16x16x32_bf16 v[52:55], v[20:23], v[252:255], v[52:55]
  ds_read_b64_tr_b16 v[18:19], v9 offset:1024
  v_mul_f32 v32, v13, v32
  v_mul_f32 v33, v13, v33
  s_waitcnt lgkmcnt(4)
  v_mfma_f32_16x16x32_bf16 v[56:59], v[24:27], v[240:243], v[56:59]
  ds_read_b64_tr_b16 v[20:21], v9 offset:8192
  v_mul_f32 v34, v13, v34
  v_mul_f32 v35, v13, v35
  v_mul_f32 v36, v14, v36
  v_mul_f32 v37, v14, v37
  v_mfma_f32_16x16x32_bf16 v[60:63], v[24:27], v[244:247], v[60:63]
  ds_read_b64_tr_b16 v[22:23], v9 offset:9216
  v_mul_f32 v38, v14, v38
  v_mul_f32 v39, v14, v39
  s_waitcnt lgkmcnt(4)
  v_mfma_f32_16x16x32_bf16 v[56:59], v[28:31], v[248:251], v[56:59]
  v_xor_b32 v10, 160, v8
  ds_read_b64_tr_b16 v[24:25], v10 offset:0
  v_mul_f32 v40, v13, v40
  v_mul_f32 v41, v13, v41
  v_mfma_f32_16x16x32_bf16 v[60:63], v[28:31], v[252:255], v[60:63]
  ds_read_b64_tr_b16 v[26:27], v10 offset:1024
  v_mul_f32 v42, v13, v42
  v_mul_f32 v43, v13, v43
  v_mul_f32 v44, v14, v44
  s_waitcnt lgkmcnt(4)
  v_mfma_f32_16x16x32_bf16 v[64:67], v[16:19], v[240:243], v[64:67]
  ds_read_b64_tr_b16 v[28:29], v10 offset:8192
  v_mul_f32 v45, v14, v45
  v_mul_f32 v46, v14, v46
  v_mul_f32 v47, v14, v47
  v_mfma_f32_16x16x32_bf16 v[68:71], v[16:19], v[244:247], v[68:71]
  ds_read_b64_tr_b16 v[30:31], v10 offset:9216
  v_cvt_pk_bf16_f32 v96, v32, v33
  v_cvt_pk_bf16_f32 v97, v34, v35
  s_waitcnt lgkmcnt(4)
  v_mfma_f32_16x16x32_bf16 v[64:67], v[20:23], v[248:251], v[64:67]
  v_xor_b32 v9, 192, v8
  ds_read_b64_tr_b16 v[16:17], v9 offset:0
  v_cvt_pk_bf16_f32 v98, v40, v41
  v_cvt_pk_bf16_f32 v99, v42, v43
  v_mfma_f32_16x16x32_bf16 v[68:71], v[20:23], v[252:255], v[68:71]
  ds_read_b64_tr_b16 v[18:19], v9 offset:1024
  ds_write_b128 v15, v[96:99] offset:24576
  v_cvt_pk_bf16_f32 v100, v36, v37
  v_cvt_pk_bf16_f32 v101, v38, v39
  s_waitcnt lgkmcnt(5)
  v_mfma_f32_16x16x32_bf16 v[72:75], v[24:27], v[240:243], v[72:75]
  ds_read_b64_tr_b16 v[20:21], v9 offset:8192
  v_cvt_pk_bf16_f32 v102, v44, v45
  v_cvt_pk_bf16_f32 v103, v46, v47
  ds_write_b128 v15, v[100:103] offset:25600
  v_mfma_f32_16x16x32_bf16 v[76:79], v[24:27], v[244:247], v[76:79]
  ds_read_b64_tr_b16 v[22:23], v9 offset:9216
  v_mul_f32 v48, v13, v48
  v_mul_f32 v49, v13, v49
  v_mul_f32 v50, v13, v50
  s_waitcnt lgkmcnt(6)
  v_mfma_f32_16x16x32_bf16 v[72:75], v[28:31], v[248:251], v[72:75]
  v_xor_b32 v10, 224, v8
  ds_read_b64_tr_b16 v[24:25], v10 offset:0
  v_mul_f32 v51, v13, v51
  v_mul_f32 v52, v14, v52
  v_mul_f32 v53, v14, v53
  v_mul_f32 v54, v14, v54
  v_mfma_f32_16x16x32_bf16 v[76:79], v[28:31], v[252:255], v[76:79]
  ds_read_b64_tr_b16 v[26:27], v10 offset:1024
  v_mul_f32 v55, v14, v55
  v_mul_f32 v56, v13, v56
  v_mul_f32 v57, v13, v57
  s_waitcnt lgkmcnt(6)
  v_mfma_f32_16x16x32_bf16 v[80:83], v[16:19], v[240:243], v[80:83]
  ds_read_b64_tr_b16 v[28:29], v10 offset:8192
  v_mul_f32 v58, v13, v58
  v_mul_f32 v59, v13, v59
  v_mul_f32 v60, v14, v60
  v_mul_f32 v61, v14, v61
  v_mul_f32 v62, v14, v62
  v_mfma_f32_16x16x32_bf16 v[84:87], v[16:19], v[244:247], v[84:87]
  ds_read_b64_tr_b16 v[30:31], v10 offset:9216
  v_mul_f32 v63, v14, v63
  v_cvt_pk_bf16_f32 v104, v48, v49
  v_cvt_pk_bf16_f32 v105, v50, v51
  s_waitcnt lgkmcnt(4)
  v_mfma_f32_16x16x32_bf16 v[80:83], v[20:23], v[248:251], v[80:83]
  v_cvt_pk_bf16_f32 v106, v56, v57
  v_cvt_pk_bf16_f32 v107, v58, v59
  ds_write_b128 v15, v[104:107] offset:30720
  v_cvt_pk_bf16_f32 v108, v52, v53
  v_cvt_pk_bf16_f32 v109, v54, v55
  v_mfma_f32_16x16x32_bf16 v[84:87], v[20:23], v[252:255], v[84:87]
  v_cvt_pk_bf16_f32 v110, v60, v61
  v_cvt_pk_bf16_f32 v111, v62, v63
  ds_write_b128 v15, v[108:111] offset:31744
  s_waitcnt lgkmcnt(0)
  s_barrier
  v_mfma_f32_16x16x32_bf16 v[88:91], v[24:27], v[240:243], v[88:91]
  v_mul_f32 v64, v13, v64
  v_mul_f32 v65, v13, v65
  v_mul_f32 v66, v13, v66
  v_mul_f32 v67, v13, v67
  v_mul_f32 v68, v14, v68
  v_mul_f32 v69, v14, v69
  v_mul_f32 v70, v14, v70
  v_mfma_f32_16x16x32_bf16 v[92:95], v[24:27], v[244:247], v[92:95]
  v_mul_f32 v71, v14, v71
  v_mul_f32 v72, v13, v72
  v_mul_f32 v73, v13, v73
  v_mul_f32 v74, v13, v74
  v_mul_f32 v75, v13, v75
  v_mul_f32 v76, v14, v76
  v_mul_f32 v77, v14, v77
  v_mfma_f32_16x16x32_bf16 v[88:91], v[28:31], v[248:251], v[88:91]
  v_mul_f32 v78, v14, v78
  v_mul_f32 v79, v14, v79
  v_cvt_pk_bf16_f32 v112, v64, v65
  v_cvt_pk_bf16_f32 v113, v66, v67
  v_cvt_pk_bf16_f32 v114, v72, v73
  v_cvt_pk_bf16_f32 v115, v74, v75
  v_mfma_f32_16x16x32_bf16 v[92:95], v[28:31], v[252:255], v[92:95]
  ds_write_b128 v15, v[112:115] offset:36864
  v_cvt_pk_bf16_f32 v116, v68, v69
  v_cvt_pk_bf16_f32 v117, v70, v71
  v_cvt_pk_bf16_f32 v118, v76, v77
  v_cvt_pk_bf16_f32 v119, v78, v79
  ds_write_b128 v15, v[116:119] offset:37888
  v_mul_f32 v80, v13, v80
  v_mul_f32 v81, v13, v81
  v_mul_f32 v82, v13, v82
  v_mul_f32 v83, v13, v83
  v_mul_f32 v84, v14, v84
  v_mul_f32 v85, v14, v85
  v_mul_f32 v86, v14, v86
  v_mul_f32 v87, v14, v87
  v_mul_f32 v88, v13, v88
  v_mul_f32 v89, v13, v89
  v_mul_f32 v90, v13, v90
  v_mul_f32 v91, v13, v91
  v_mul_f32 v92, v14, v92
  v_mul_f32 v93, v14, v93
  v_mul_f32 v94, v14, v94
  v_mul_f32 v95, v14, v95
  v_cvt_pk_bf16_f32 v120, v80, v81
  v_cvt_pk_bf16_f32 v121, v82, v83
  v_cvt_pk_bf16_f32 v122, v88, v89
  v_cvt_pk_bf16_f32 v123, v90, v91
  ds_write_b128 v15, v[120:123] offset:43008
  v_cvt_pk_bf16_f32 v124, v84, v85
  v_cvt_pk_bf16_f32 v125, v86, v87
  v_cvt_pk_bf16_f32 v126, v92, v93
  v_cvt_pk_bf16_f32 v127, v94, v95
  ds_write_b128 v15, v[124:127] offset:44032
  s_waitcnt lgkmcnt(0)
  s_setprio 0
  s_cmp_eq_u32 s65, 0
  s_cbranch_scc1 L_opA
  s_barrier
  s_barrier
  s_barrier
  s_barrier
  s_barrier
  s_barrier
  s_branch L_red
L_qpB:
  s_and_b32 s50, s66, 15
  s_lshr_b64 s[66:67], s[66:67], 4
  s_lshl_b32 s50, s50, 14
  v_add_u32 v8, s50, v5
  s_barrier
  ds_read_b64_tr_b16 v[16:17], v8 offset:0
  ds_read_b64_tr_b16 v[18:19], v8 offset:1024
  v_xor_b32 v9, 32, v8
  ds_read_b64_tr_b16 v[20:21], v9 offset:0
  ds_read_b64_tr_b16 v[22:23], v9 offset:1024
  v_xor_b32 v10, 64, v8
  ds_read_b64_tr_b16 v[24:25], v10 offset:0
  ds_read_b64_tr_b16 v[26:27], v10 offset:1024
  s_waitcnt lgkmcnt(4)
  v_mfma_f32_16x16x32_bf16 v[64:67], v[16:19], v[144:147], 0
  v_xor_b32 v11, 96, v8
  ds_read_b64_tr_b16 v[28:29], v11 offset:0
  v_mfma_f32_16x16x32_bf16 v[68:71], v[16:19], v[148:151], 0
  ds_read_b64_tr_b16 v[30:31], v11 offset:1024
  s_waitcnt lgkmcnt(4)
  v_mfma_f32_16x16x32_bf16 v[72:75], v[20:23], v[144:147], 0
  v_xor_b32 v136, 128, v8
  ds_read_b64_tr_b16 v[16:17], v136 offset:0
  v_mfma_f32_16x16x32_bf16 v[76:79], v[20:23], v[148:151], 0
  ds_read_b64_tr_b16 v[18:19], v136 offset:1024
  s_waitcnt lgkmcnt(4)
  v_mfma_f32_16x16x32_bf16 v[80:83], v[24:27], v[144:147], 0
  v_xor_b32 v137, 160, v8
  ds_read_b64_tr_b16 v[20:21], v137 offset:0
  v_mfma_f32_16x16x32_bf16 v[84:87], v[24:27], v[148:151], 0
  ds_read_b64_tr_b16 v[22:23], v137 offset:1024
  s_waitcnt lgkmcnt(4)
  v_mfma_f32_16x16x32_bf16 v[88:91], v[28:31], v[144:147], 0
  v_xor_b32 v138, 192, v8
  ds_read_b64_tr_b16 v[24:25], v138 offset:0
  v_mfma_f32_16x16x32_bf16 v[92:95], v[28:31], v[148:151], 0
  ds_read_b64_tr_b16 v[26:27], v138 offset:1024
  s_waitcnt lgkmcnt(4)
  v_mfma_f32_16x16x32_bf16 v[96:99], v[16:19], v[144:147], 0
  v_xor_b32 v139, 224, v8
  ds_read_b64_tr_b16 v[28:29], v139 offset:0
  v_mfma_f32_16x16x32_bf16 v[100:103], v[16:19], v[148:151], 0
  ds_read_b64_tr_b16 v[30:31], v139 offset:1024
  s_waitcnt lgkmcnt(4)
  v_mfma_f32_16x16x32_bf16 v[104:107], v[20:23], v[144:147], 0
  ds_read_b64_tr_b16 v[16:17], v8 offset:8192
  v_mfma_f32_16x16x32_bf16 v[108:111], v[20:23], v[148:151], 0
  ds_read_b64_tr_b16 v[18:19], v8 offset:9216
  s_waitcnt lgkmcnt(4)
  v_mfma_f32_16x16x32_bf16 v[112:115], v[24:27], v[144:147], 0
  ds_read_b64_tr_b16 v[20:21], v9 offset:8192
  v_mfma_f32_16x16x32_bf16 v[116:119], v[24:27], v[148:151], 0
  ds_read_b64_tr_b16 v[22:23], v9 offset:9216
  s_waitcnt lgkmcnt(4)
  v_mfma_f32_16x16x32_bf16 v[120:123], v[28:31], v[144:147], 0
  ds_read_b64_tr_b16 v[24:25], v10 offset:8192
  v_mfma_f32_16x16x32_bf16 v[124:127], v[28:31], v[148:151], 0
  ds_read_b64_tr_b16 v[26:27], v10 offset:9216
  s_barrier
  s_waitcnt lgkmcnt(4)
  v_mfma_f32_16x16x32_bf16 v[64:67], v[16:19], v[152:155], v[64:67]
  ds_read_b64_tr_b16 v[28:29], v11 offset:8192
  v_mfma_f32_16x16x32_bf16 v[68:71], v[16:19], v[156:159], v[68:71]
  ds_read_b64_tr_b16 v[30:31], v11 offset:9216
  s_waitcnt lgkmcnt(4)
  v_mfma_f32_16x16x32_bf16 v[72:75], v[20:23], v[152:155], v[72:75]
  ds_read_b64_tr_b16 v[16:17], v136 offset:8192
  v_mfma_f32_16x16x32_bf16 v[76:79], v[20:23], v[156:159], v[76:79]
  ds_read_b64_tr_b16 v[18:19], v136 offset:9216
  s_waitcnt lgkmcnt(4)
  v_mfma_f32_16x16x32_bf16 v[80:83], v[24:27], v[152:155], v[80:83]
  ds_read_b64_tr_b16 v[20:21], v137 offset:8192
  v_mfma_f32_16x16x32_bf16 v[84:87], v[24:27], v[156:159], v[84:87]
  ds_read_b64_tr_b16 v[22:23], v137 offset:9216
  s_waitcnt lgkmcnt(4)
  v_mfma_f32_16x16x32_bf16 v[88:91], v[28:31], v[152:155], v[88:91]
  ds_read_b64_tr_b16 v[24:25], v138 offset:8192
  v_mfma_f32_16x16x32_bf16 v[92:95], v[28:31], v[156:159], v[92:95]
  ds_read_b64_tr_b16 v[26:27], v138 offset:9216
  s_waitcnt lgkmcnt(4)
  v_mfma_f32_16x16x32_bf16 v[96:99], v[16:19], v[152:155], v[96:99]
  ds_read_b64_tr_b16 v[28:29], v139 offset:8192
  v_mfma_f32_16x16x32_bf16 v[100:103], v[16:19], v[156:159], v[100:103]
  ds_read_b64_tr_b16 v[30:31], v139 offset:9216
  s_and_b32 s50, s66, 15
  s_lshr_b64 s[66:67], s[66:67], 4
  s_lshl_b32 s50, s50, 14
  v_add_u32 v8, s50, v5
  s_waitcnt lgkmcnt(4)
  v_mfma_f32_16x16x32_bf16 v[104:107], v[20:23], v[152:155], v[104:107]
  v_mfma_f32_16x16x32_bf16 v[108:111], v[20:23], v[156:159], v[108:111]
  s_waitcnt lgkmcnt(0)
  s_barrier
  ds_read_b64_tr_b16 v[16:17], v8 offset:0
  ds_read_b64_tr_b16 v[18:19], v8 offset:1024
  v_mfma_f32_16x16x32_bf16 v[112:115], v[24:27], v[152:155], v[112:115]
  v_xor_b32 v9, 32, v8
  ds_read_b64_tr_b16 v[20:21], v9 offset:0
  v_mfma_f32_16x16x32_bf16 v[116:119], v[24:27], v[156:159], v[116:119]
  ds_read_b64_tr_b16 v[22:23], v9 offset:1024
  v_mfma_f32_16x16x32_bf16 v[120:123], v[28:31], v[152:155], v[120:123]
  v_xor_b32 v10, 64, v8
  ds_read_b64_tr_b16 v[24:25], v10 offset:0
  v_mfma_f32_16x16x32_bf16 v[124:127], v[28:31], v[156:159], v[124:127]
  ds_read_b64_tr_b16 v[26:27], v10 offset:1024
  s_waitcnt lgkmcnt(4)
  v_mfma_f32_16x16x32_bf16 v[64:67], v[16:19], v[160:163], v[64:67]
  v_xor_b32 v11, 96, v8
  ds_read_b64_tr_b16 v[28:29], v11 offset:0
  v_mfma_f32_16x16x32_bf16 v[68:71], v[16:19], v[164:167], v[68:71]
  ds_read_b64_tr_b16 v[30:31], v11 offset:1024
  s_waitcnt lgkmcnt(4)
  v_mfma_f32_16x16x32_bf16 v[72:75], v[20:23], v[160:163], v[72:75]
  v_xor_b32 v136, 128, v8
  ds_read_b64_tr_b16 v[16:17], v136 offset:0
  v_mfma_f32_16x16x32_bf16 v[76:79], v[20:23], v[164:167], v[76:79]
  ds_read_b64_tr_b16 v[18:19], v136 offset:1024
  s_branch L_pads11
L_pad11:
  s_setpc_b64 s[60:61]
L_pads11:
  s_waitcnt lgkmcnt(4)
  v_mfma_f32_16x16x32_bf16 v[80:83], v[24:27], v[160:163], v[80:83]
  v_xor_b32 v137, 160, v8
  ds_read_b64_tr_b16 v[20:21], v137 offset:0
  v_mfma_f32_16x16x32_bf16 v[84:87], v[24:27], v[164:167], v[84:87]
  ds_read_b64_tr_b16 v[22:23], v137 offset:1024
  s_waitcnt lgkmcnt(4)
  v_mfma_f32_16x16x32_bf16 v[88:91], v[28:31], v[160:163], v[88:91]
  v_xor_b32 v138, 192, v8
  ds_read_b64_tr_b16 v[24:25], v138 offset:0
  v_mfma_f32_16x16x32_bf16 v[92:95], v[28:31], v[164:167], v[92:95]
  ds_read_b64_tr_b16 v[26:27], v138 offset:1024
  s_waitcnt lgkmcnt(4)
  v_mfma_f32_16x16x32_bf16 v[96:99], v[16:19], v[160:163], v[96:99]
  v_xor_b32 v139, 224, v8
  ds_read_b64_tr_b16 v[28:29], v139 offset:0
  v_mfma_f32_16x16x32_bf16 v[100:103], v[16:19], v[164:167], v[100:103]
  ds_read_b64_tr_b16 v[30:31], v139 offset:1024
  s_waitcnt lgkmcnt(4)
  v_mfma_f32_16x16x32_bf16 v[104:107], v[20:23], v[160:163], v[104:107]
  ds_read_b64_tr_b16 v[16:17], v8 offset:8192
  v_mfma_f32_16x16x32_bf16 v[108:111], v[20:23], v[164:167], v[108:111]
  ds_read_b64_tr_b16 v[18:19], v8 offset:9216
  s_waitcnt lgkmcnt(4)
  v_mfma_f32_16x16x32_bf16 v[112:115], v[24:27], v[160:163], v[112:115]
  ds_read_b64_tr_b16 v[20:21], v9 offset:8192
  v_mfma_f32_16x16x32_bf16 v[116:119], v[24:27], v[164:167], v[116:119]
  ds_read_b64_tr_b16 v[22:23], v9 offset:9216
  s_waitcnt lgkmcnt(4)
  v_mfma_f32_16x16x32_bf16 v[120:123], v[28:31], v[160:163], v[120:123]
  ds_read_b64_tr_b16 v[24:25], v10 offset:8192
  v_mfma_f32_16x16x32_bf16 v[124:127], v[28:31], v[164:167], v[124:127]
  ds_read_b64_tr_b16 v[26:27], v10 offset:9216
  s_barrier
  s_waitcnt lgkmcnt(4)
  v_mfma_f32_16x16x32_bf16 v[64:67], v[16:19], v[168:171], v[64:67]
  ds_read_b64_tr_b16 v[28:29], v11 offset:8192
  v_mfma_f32_16x16x32_bf16 v[68:71], v[16:19], v[172:175], v[68:71]
  ds_read_b64_tr_b16 v[30:31], v11 offset:9216
  s_waitcnt lgkmcnt(4)
  v_mfma_f32_16x16x32_bf16 v[72:75], v[20:23], v[168:171], v[72:75]
  ds_read_b64_tr_b16 v[16:17], v136 offset:8192
  v_mfma_f32_16x16x32_bf16 v[76:79], v[20:23], v[172:175], v[76:79]
  ds_read_b64_tr_b16 v[18:19], v136 offset:9216
  s_waitcnt lgkmcnt(4)
  v_mfma_f32_16x16x32_bf16 v[80:83], v[24:27], v[168:171], v[80:83]
  ds_read_b64_tr_b16 v[20:21], v137 offset:8192
  v_mfma_f32_16x16x32_bf16 v[84:87], v[24:27], v[172:175], v[84:87]
  ds_read_b64_tr_b16 v[22:23], v137 offset:9216
  s_waitcnt lgkmcnt(4)
  v_mfma_f32_16x16x32_bf16 v[88:91], v[28:31], v[168:171], v[88:91]
  ds_read_b64_tr_b16 v[24:25], v138 offset:8192
  v_mfma_f32_16x16x32_bf16 v[92:95], v[28:31], v[172:175], v[92:95]
  ds_read_b64_tr_b16 v[26:27], v138 offset:9216
  s_waitcnt lgkmcnt(4)
  v_mfma_f32_16x16x32_bf16 v[96:99], v[16:19], v[168:171], v[96:99]
  ds_read_b64_tr_b16 v[28:29], v139 offset:8192
  v_mfma_f32_16x16x32_bf16 v[100:103], v[16:19], v[172:175], v[100:103]
  ds_read_b64_tr_b16 v[30:31], v139 offset:9216
  s_and_b32 s50, s66, 15
  s_lshr_b64 s[66:67], s[66:67], 4
  s_lshl_b32 s50, s50, 14
  v_add_u32 v8, s50, v5
  s_waitcnt lgkmcnt(4)
  v_mfma_f32_16x16x32_bf16 v[104:107], v[20:23], v[168:171], v[104:107]
  v_mfma_f32_16x16x32_bf16 v[108:111], v[20:23], v[172:175], v[108:111]
  s_waitcnt lgkmcnt(0)
  s_barrier
  ds_read_b64_tr_b16 v[16:17], v8 offset:0
  ds_read_b64_tr_b16 v[18:19], v8 offset:1024
  v_mfma_f32_16x16x32_bf16 v[112:115], v[24:27], v[168:171], v[112:115]
  v_xor_b32 v9, 32, v8
  ds_read_b64_tr_b16 v[20:21], v9 offset:0
  v_mfma_f32_16x16x32_bf16 v[116:119], v[24:27], v[172:175], v[116:119]
  ds_read_b64_tr_b16 v[22:23], v9 offset:1024
  v_mfma_f32_16x16x32_bf16 v[120:123], v[28:31], v[168:171], v[120:123]
  v_xor_b32 v10, 64, v8
  ds_read_b64_tr_b16 v[24:25], v10 offset:0
  v_mfma_f32_16x16x32_bf16 v[124:127], v[28:31], v[172:175], v[124:127]
  ds_read_b64_tr_b16 v[26:27], v10 offset:1024
  s_waitcnt lgkmcnt(4)
  v_mfma_f32_16x16x32_bf16 v[64:67], v[16:19], v[176:179], v[64:67]
  v_xor_b32 v11, 96, v8
  ds_read_b64_tr_b16 v[28:29], v11 offset:0
  v_mfma_f32_16x16x32_bf16 v[68:71], v[16:19], v[180:183], v[68:71]
  ds_read_b64_tr_b16 v[30:31], v11 offset:1024
  s_waitcnt lgkmcnt(4)
  v_mfma_f32_16x16x32_bf16 v[72:75], v[20:23], v[176:179], v[72:75]
  v_xor_b32 v136, 128, v8
  ds_read_b64_tr_b16 v[16:17], v136 offset:0
  v_mfma_f32_16x16x32_bf16 v[76:79], v[20:23], v[180:183], v[76:79]
  ds_read_b64_tr_b16 v[18:19], v136 offset:1024
  s_waitcnt lgkmcnt(4)
  v_mfma_f32_16x16x32_bf16 v[80:83], v[24:27], v[176:179], v[80:83]
  v_xor_b32 v137, 160, v8
  ds_read_b64_tr_b16 v[20:21], v137 offset:0
  v_mfma_f32_16x16x32_bf16 v[84:87], v[24:27], v[180:183], v[84:87]
  ds_read_b64_tr_b16 v[22:23], v137 offset:1024
  s_waitcnt lgkmcnt(4)
  v_mfma_f32_16x16x32_bf16 v[88:91], v[28:31], v[176:179], v[88:91]
  v_xor_b32 v138, 192, v8
  ds_read_b64_tr_b16 v[24:25], v138 offset:0
  v_mfma_f32_16x16x32_bf16 v[92:95], v[28:31], v[180:183], v[92:95]
  ds_read_b64_tr_b16 v[26:27], v138 offset:1024
  s_waitcnt lgkmcnt(4)
  v_mfma_f32_16x16x32_bf16 v[96:99], v[16:19], v[176:179], v[96:99]
  v_xor_b32 v139, 224, v8
  ds_read_b64_tr_b16 v[28:29], v139 offset:0
  v_mfma_f32_16x16x32_bf16 v[100:103], v[16:19], v[180:183], v[100:103]
  ds_read_b64_tr_b16 v[30:31], v139 offset:1024
  s_waitcnt lgkmcnt(4)
  v_mfma_f32_16x16x32_bf16 v[104:107], v[20:23], v[176:179], v[104:107]
  ds_read_b64_tr_b16 v[16:17], v8 offset:8192
  v_mfma_f32_16x16x32_bf16 v[108:111], v[20:23], v[180:183], v[108:111]
  ds_read_b64_tr_b16 v[18:19], v8 offset:9216
  s_waitcnt lgkmcnt(4)
  v_mfma_f32_16x16x32_bf16 v[112:115], v[24:27], v[176:179], v[112:115]
  ds_read_b64_tr_b16 v[20:21], v9 offset:8192
  v_mfma_f32_16x16x32_bf16 v[116:119], v[24:27], v[180:183], v[116:119]
  ds_read_b64_tr_b16 v[22:23], v9 offset:9216
  s_waitcnt lgkmcnt(4)
  v_mfma_f32_16x16x32_bf16 v[120:123], v[28:31], v[176:179], v[120:123]
  ds_read_b64_tr_b16 v[24:25], v10 offset:8192
  v_mfma_f32_16x16x32_bf16 v[124:127], v[28:31], v[180:183], v[124:127]
  ds_read_b64_tr_b16 v[26:27], v10 offset:9216
  s_barrier
  s_waitcnt lgkmcnt(4)
  v_mfma_f32_16x16x32_bf16 v[64:67], v[16:19], v[184:187], v[64:67]
  ds_read_b64_tr_b16 v[28:29], v11 offset:8192
  v_mfma_f32_16x16x32_bf16 v[68:71], v[16:19], v[188:191], v[68:71]
  ds_read_b64_tr_b16 v[30:31], v11 offset:9216
  s_waitcnt lgkmcnt(4)
  v_mfma_f32_16x16x32_bf16 v[72:75], v[20:23], v[184:187], v[72:75]
  ds_read_b64_tr_b16 v[16:17], v136 offset:8192
  v_mfma_f32_16x16x32_bf16 v[76:79], v[20:23], v[188:191], v[76:79]
  ds_read_b64_tr_b16 v[18:19], v136 offset:9216
  s_waitcnt lgkmcnt(4)
  v_mfma_f32_16x16x32_bf16 v[80:83], v[24:27], v[184:187], v[80:83]
  ds_read_b64_tr_b16 v[20:21], v137 offset:8192
  v_mfma_f32_16x16x32_bf16 v[84:87], v[24:27], v[188:191], v[84:87]
  ds_read_b64_tr_b16 v[22:23], v137 offset:9216
  s_waitcnt lgkmcnt(4)
  v_mfma_f32_16x16x32_bf16 v[88:91], v[28:31], v[184:187], v[88:91]
  ds_read_b64_tr_b16 v[24:25], v138 offset:8192
  v_mfma_f32_16x16x32_bf16 v[92:95], v[28:31], v[188:191], v[92:95]
  ds_read_b64_tr_b16 v[26:27], v138 offset:9216
  s_waitcnt lgkmcnt(4)
  v_mfma_f32_16x16x32_bf16 v[96:99], v[16:19], v[184:187], v[96:99]
  ds_read_b64_tr_b16 v[28:29], v139 offset:8192
  v_mfma_f32_16x16x32_bf16 v[100:103], v[16:19], v[188:191], v[100:103]
  ds_read_b64_tr_b16 v[30:31], v139 offset:9216
  s_and_b32 s50, s66, 15
  s_lshr_b64 s[66:67], s[66:67], 4
  s_lshl_b32 s50, s50, 14
  v_add_u32 v8, s50, v5
  s_waitcnt lgkmcnt(4)
  v_mfma_f32_16x16x32_bf16 v[104:107], v[20:23], v[184:187], v[104:107]
  v_mfma_f32_16x16x32_bf16 v[108:111], v[20:23], v[188:191], v[108:111]
  s_waitcnt lgkmcnt(0)
  s_barrier
  ds_read_b64_tr_b16 v[16:17], v8 offset:0
  ds_read_b64_tr_b16 v[18:19], v8 offset:1024
  v_mfma_f32_16x16x32_bf16 v[112:115], v[24:27], v[184:187], v[112:115]
  v_xor_b32 v9, 32, v8
  ds_read_b64_tr_b16 v[20:21], v9 offset:0
  v_mfma_f32_16x16x32_bf16 v[116:119], v[24:27], v[188:191], v[116:119]
  ds_read_b64_tr_b16 v[22:23], v9 offset:1024
  v_mfma_f32_16x16x32_bf16 v[120:123], v[28:31], v[184:187], v[120:123]
  v_xor_b32 v10, 64, v8
  ds_read_b64_tr_b16 v[24:25], v10 offset:0
  v_mfma_f32_16x16x32_bf16 v[124:127], v[28:31], v[188:191], v[124:127]
  ds_read_b64_tr_b16 v[26:27], v10 offset:1024
  s_waitcnt lgkmcnt(4)
  v_mfma_f32_16x16x32_bf16 v[64:67], v[16:19], v[192:195], v[64:67]
  v_xor_b32 v11, 96, v8
  ds_read_b64_tr_b16 v[28:29], v11 offset:0
  v_mfma_f32_16x16x32_bf16 v[68:71], v[16:19], v[196:199], v[68:71]
  ds_read_b64_tr_b16 v[30:31], v11 offset:1024
  s_waitcnt lgkmcnt(4)
  v_mfma_f32_16x16x32_bf16 v[72:75], v[20:23], v[192:195], v[72:75]
  v_xor_b32 v136, 128, v8
  ds_read_b64_tr_b16 v[16:17], v136 offset:0
  v_mfma_f32_16x16x32_bf16 v[76:79], v[20:23], v[196:199], v[76:79]
  ds_read_b64_tr_b16 v[18:19], v136 offset:1024
  s_waitcnt lgkmcnt(4)
  v_mfma_f32_16x16x32_bf16 v[80:83], v[24:27], v[192:195], v[80:83]
  v_xor_b32 v137, 160, v8
  ds_read_b64_tr_b16 v[20:21], v137 offset:0
  v_mfma_f32_16x16x32_bf16 v[84:87], v[24:27], v[196:199], v[84:87]
  ds_read_b64_tr_b16 v[22:23], v137 offset:1024
  s_waitcnt lgkmcnt(4)
  v_mfma_f32_16x16x32_bf16 v[88:91], v[28:31], v[192:195], v[88:91]
  v_xor_b32 v138, 192, v8
  ds_read_b64_tr_b16 v[24:25], v138 offset:0
  v_mfma_f32_16x16x32_bf16 v[92:95], v[28:31], v[196:199], v[92:95]
  ds_read_b64_tr_b16 v[26:27], v138 offset:1024
  s_waitcnt lgkmcnt(4)
  v_mfma_f32_16x16x32_bf16 v[96:99], v[16:19], v[192:195], v[96:99]
  v_xor_b32 v139, 224, v8
  ds_read_b64_tr_b16 v[28:29], v139 offset:0
  v_mfma_f32_16x16x32_bf16 v[100:103], v[16:19], v[196:199], v[100:103]
  ds_read_b64_tr_b16 v[30:31], v139 offset:1024
  s_waitcnt lgkmcnt(4)
  v_mfma_f32_16x16x32_bf16 v[104:107], v[20:23], v[192:195], v[104:107]
  ds_read_b64_tr_b16 v[16:17], v8 offset:8192
  v_mfma_f32_16x16x32_bf16 v[108:111], v[20:23], v[196:199], v[108:111]
  ds_read_b64_tr_b16 v[18:19], v8 offset:9216
  s_waitcnt lgkmcnt(4)
  v_mfma_f32_16x16x32_bf16 v[112:115], v[24:27], v[192:195], v[112:115]
  ds_read_b64_tr_b16 v[20:21], v9 offset:8192
  v_mfma_f32_16x16x32_bf16 v[116:119], v[24:27], v[196:199], v[116:119]
  ds_read_b64_tr_b16 v[22:23], v9 offset:9216
  s_waitcnt lgkmcnt(4)
  v_mfma_f32_16x16x32_bf16 v[120:123], v[28:31], v[192:195], v[120:123]
  ds_read_b64_tr_b16 v[24:25], v10 offset:8192
  v_mfma_f32_16x16x32_bf16 v[124:127], v[28:31], v[196:199], v[124:127]
  ds_read_b64_tr_b16 v[26:27], v10 offset:9216
  s_barrier
  s_waitcnt lgkmcnt(4)
  v_mfma_f32_16x16x32_bf16 v[64:67], v[16:19], v[200:203], v[64:67]
  ds_read_b64_tr_b16 v[28:29], v11 offset:8192
  v_mfma_f32_16x16x32_bf16 v[68:71], v[16:19], v[204:207], v[68:71]
  ds_read_b64_tr_b16 v[30:31], v11 offset:9216
  s_waitcnt lgkmcnt(4)
  v_mfma_f32_16x16x32_bf16 v[72:75], v[20:23], v[200:203], v[72:75]
  ds_read_b64_tr_b16 v[16:17], v136 offset:8192
  v_mfma_f32_16x16x32_bf16 v[76:79], v[20:23], v[204:207], v[76:79]
  ds_read_b64_tr_b16 v[18:19], v136 offset:9216
  s_waitcnt lgkmcnt(4)
  v_mfma_f32_16x16x32_bf16 v[80:83], v[24:27], v[200:203], v[80:83]
  ds_read_b64_tr_b16 v[20:21], v137 offset:8192
  v_mfma_f32_16x16x32_bf16 v[84:87], v[24:27], v[204:207], v[84:87]
  ds_read_b64_tr_b16 v[22:23], v137 offset:9216
  s_waitcnt lgkmcnt(4)
  v_mfma_f32_16x16x32_bf16 v[88:91], v[28:31], v[200:203], v[88:91]
  ds_read_b64_tr_b16 v[24:25], v138 offset:8192
  v_mfma_f32_16x16x32_bf16 v[92:95], v[28:31], v[204:207], v[92:95]
  ds_read_b64_tr_b16 v[26:27], v138 offset:9216
  s_waitcnt lgkmcnt(4)
  v_mfma_f32_16x16x32_bf16 v[96:99], v[16:19], v[200:203], v[96:99]
  ds_read_b64_tr_b16 v[28:29], v139 offset:8192
  v_mfma_f32_16x16x32_bf16 v[100:103], v[16:19], v[204:207], v[100:103]
  ds_read_b64_tr_b16 v[30:31], v139 offset:9216
  s_and_b32 s50, s66, 15
  s_lshr_b64 s[66:67], s[66:67], 4
  s_lshl_b32 s50, s50, 14
  v_add_u32 v8, s50, v5
  s_waitcnt lgkmcnt(4)
  v_mfma_f32_16x16x32_bf16 v[104:107], v[20:23], v[200:203], v[104:107]
  v_mfma_f32_16x16x32_bf16 v[108:111], v[20:23], v[204:207], v[108:111]
  s_waitcnt lgkmcnt(0)
  s_barrier
  ds_read_b64_tr_b16 v[16:17], v8 offset:0
  ds_read_b64_tr_b16 v[18:19], v8 offset:1024
  v_mfma_f32_16x16x32_bf16 v[112:115], v[24:27], v[200:203], v[112:115]
  v_xor_b32 v9, 32, v8
  ds_read_b64_tr_b16 v[20:21], v9 offset:0
  v_mfma_f32_16x16x32_bf16 v[116:119], v[24:27], v[204:207], v[116:119]
  ds_read_b64_tr_b16 v[22:23], v9 offset:1024
  v_mfma_f32_16x16x32_bf16 v[120:123], v[28:31], v[200:203], v[120:123]
  v_xor_b32 v10, 64, v8
  ds_read_b64_tr_b16 v[24:25], v10 offset:0
  v_mfma_f32_16x16x32_bf16 v[124:127], v[28:31], v[204:207], v[124:127]
  ds_read_b64_tr_b16 v[26:27], v10 offset:1024
  s_waitcnt lgkmcnt(4)
  v_mfma_f32_16x16x32_bf16 v[64:67], v[16:19], v[208:211], v[64:67]
  v_xor_b32 v11, 96, v8
  ds_read_b64_tr_b16 v[28:29], v11 offset:0
  v_mfma_f32_16x16x32_bf16 v[68:71], v[16:19], v[212:215], v[68:71]
  ds_read_b64_tr_b16 v[30:31], v11 offset:1024
  s_waitcnt lgkmcnt(4)
  v_mfma_f32_16x16x32_bf16 v[72:75], v[20:23], v[208:211], v[72:75]
  v_xor_b32 v136, 128, v8
  ds_read_b64_tr_b16 v[16:17], v136 offset:0
  v_mfma_f32_16x16x32_bf16 v[76:79], v[20:23], v[212:215], v[76:79]
  ds_read_b64_tr_b16 v[18:19], v136 offset:1024
  s_waitcnt lgkmcnt(4)
  v_mfma_f32_16x16x32_bf16 v[80:83], v[24:27], v[208:211], v[80:83]
  v_xor_b32 v137, 160, v8
  ds_read_b64_tr_b16 v[20:21], v137 offset:0
  v_mfma_f32_16x16x32_bf16 v[84:87], v[24:27], v[212:215], v[84:87]
  ds_read_b64_tr_b16 v[22:23], v137 offset:1024
  s_waitcnt lgkmcnt(4)
  v_mfma_f32_16x16x32_bf16 v[88:91], v[28:31], v[208:211], v[88:91]
  v_xor_b32 v138, 192, v8
  ds_read_b64_tr_b16 v[24:25], v138 offset:0
  v_mfma_f32_16x16x32_bf16 v[92:95], v[28:31], v[212:215], v[92:95]
  ds_read_b64_tr_b16 v[26:27], v138 offset:1024
  s_waitcnt lgkmcnt(4)
  v_mfma_f32_16x16x32_bf16 v[96:99], v[16:19], v[208:211], v[96:99]
  v_xor_b32 v139, 224, v8
  ds_read_b64_tr_b16 v[28:29], v139 offset:0
  v_mfma_f32_16x16x32_bf16 v[100:103], v[16:19], v[212:215], v[100:103]
  ds_read_b64_tr_b16 v[30:31], v139 offset:1024
  s_waitcnt lgkmcnt(4)
  v_mfma_f32_16x16x32_bf16 v[104:107], v[20:23], v[208:211], v[104:107]
  ds_read_b64_tr_b16 v[16:17], v8 offset:8192
  v_mfma_f32_16x16x32_bf16 v[108:111], v[20:23], v[212:215], v[108:111]
  ds_read_b64_tr_b16 v[18:19], v8 offset:9216
  s_waitcnt lgkmcnt(4)
  v_mfma_f32_16x16x32_bf16 v[112:115], v[24:27], v[208:211], v[112:115]
  ds_read_b64_tr_b16 v[20:21], v9 offset:8192
  v_mfma_f32_16x16x32_bf16 v[116:119], v[24:27], v[212:215], v[116:119]
  ds_read_b64_tr_b16 v[22:23], v9 offset:9216
  s_waitcnt lgkmcnt(4)
  v_mfma_f32_16x16x32_bf16 v[120:123], v[28:31], v[208:211], v[120:123]
  ds_read_b64_tr_b16 v[24:25], v10 offset:8192
  v_mfma_f32_16x16x32_bf16 v[124:127], v[28:31], v[212:215], v[124:127]
  ds_read_b64_tr_b16 v[26:27], v10 offset:9216
  s_barrier
  s_waitcnt lgkmcnt(4)
  v_mfma_f32_16x16x32_bf16 v[64:67], v[16:19], v[216:219], v[64:67]
  ds_read_b64_tr_b16 v[28:29], v11 offset:8192
  v_mfma_f32_16x16x32_bf16 v[68:71], v[16:19], v[220:223], v[68:71]
  ds_read_b64_tr_b16 v[30:31], v11 offset:9216
  s_waitcnt lgkmcnt(4)
  v_mfma_f32_16x16x32_bf16 v[72:75], v[20:23], v[216:219], v[72:75]
  ds_read_b64_tr_b16 v[16:17], v136 offset:8192
  v_mfma_f32_16x16x32_bf16 v[76:79], v[20:23], v[220:223], v[76:79]
  ds_read_b64_tr_b16 v[18:19], v136 offset:9216
  s_waitcnt lgkmcnt(4)
  v_mfma_f32_16x16x32_bf16 v[80:83], v[24:27], v[216:219], v[80:83]
  ds_read_b64_tr_b16 v[20:21], v137 offset:8192
  v_mfma_f32_16x16x32_bf16 v[84:87], v[24:27], v[220:223], v[84:87]
  ds_read_b64_tr_b16 v[22:23], v137 offset:9216
  s_waitcnt lgkmcnt(4)
  v_mfma_f32_16x16x32_bf16 v[88:91], v[28:31], v[216:219], v[88:91]
  ds_read_b64_tr_b16 v[24:25], v138 offset:8192
  v_mfma_f32_16x16x32_bf16 v[92:95], v[28:31], v[220:223], v[92:95]
  ds_read_b64_tr_b16 v[26:27], v138 offset:9216
  s_waitcnt lgkmcnt(4)
  v_mfma_f32_16x16x32_bf16 v[96:99], v[16:19], v[216:219], v[96:99]
  ds_read_b64_tr_b16 v[28:29], v139 offset:8192
  v_mfma_f32_16x16x32_bf16 v[100:103], v[16:19], v[220:223], v[100:103]
  ds_read_b64_tr_b16 v[30:31], v139 offset:9216
  s_and_b32 s50, s66, 15
  s_lshr_b64 s[66:67], s[66:67], 4
  s_lshl_b32 s50, s50, 14
  v_add_u32 v8, s50, v5
  s_waitcnt lgkmcnt(4)
  v_mfma_f32_16x16x32_bf16 v[104:107], v[20:23], v[216:219], v[104:107]
  v_mfma_f32_16x16x32_bf16 v[108:111], v[20:23], v[220:223], v[108:111]
  s_waitcnt lgkmcnt(0)
  s_barrier
  ds_read_b64_tr_b16 v[16:17], v8 offset:0
  ds_read_b64_tr_b16 v[18:19], v8 offset:1024
  v_mfma_f32_16x16x32_bf16 v[112:115], v[24:27], v[216:219], v[112:115]
  v_xor_b32 v9, 32, v8
  ds_read_b64_tr_b16 v[20:21], v9 offset:0
  v_mfma_f32_16x16x32_bf16 v[116:119], v[24:27], v[220:223], v[116:119]
  ds_read_b64_tr_b16 v[22:23], v9 offset:1024
  v_mfma_f32_16x16x32_bf16 v[120:123], v[28:31], v[216:219], v[120:123]
  v_xor_b32 v10, 64, v8
  ds_read_b64_tr_b16 v[24:25], v10 offset:0
  v_mfma_f32_16x16x32_bf16 v[124:127], v[28:31], v[220:223], v[124:127]
  ds_read_b64_tr_b16 v[26:27], v10 offset:1024
  s_waitcnt lgkmcnt(4)
  v_mfma_f32_16x16x32_bf16 v[64:67], v[16:19], v[224:227], v[64:67]
  v_xor_b32 v11, 96, v8
  ds_read_b64_tr_b16 v[28:29], v11 offset:0
  v_mfma_f32_16x16x32_bf16 v[68:71], v[16:19], v[228:231], v[68:71]
  ds_read_b64_tr_b16 v[30:31], v11 offset:1024
  s_waitcnt lgkmcnt(4)
  v_mfma_f32_16x16x32_bf16 v[72:75], v[20:23], v[224:227], v[72:75]
  v_xor_b32 v136, 128, v8
  ds_read_b64_tr_b16 v[16:17], v136 offset:0
  v_mfma_f32_16x16x32_bf16 v[76:79], v[20:23], v[228:231], v[76:79]
  ds_read_b64_tr_b16 v[18:19], v136 offset:1024
  s_waitcnt lgkmcnt(4)
  v_mfma_f32_16x16x32_bf16 v[80:83], v[24:27], v[224:227], v[80:83]
  v_xor_b32 v137, 160, v8
  ds_read_b64_tr_b16 v[20:21], v137 offset:0
  v_mfma_f32_16x16x32_bf16 v[84:87], v[24:27], v[228:231], v[84:87]
  ds_read_b64_tr_b16 v[22:23], v137 offset:1024
  s_waitcnt lgkmcnt(4)
  v_mfma_f32_16x16x32_bf16 v[88:91], v[28:31], v[224:227], v[88:91]
  v_xor_b32 v138, 192, v8
  ds_read_b64_tr_b16 v[24:25], v138 offset:0
  v_mfma_f32_16x16x32_bf16 v[92:95], v[28:31], v[228:231], v[92:95]
  ds_read_b64_tr_b16 v[26:27], v138 offset:1024
  s_waitcnt lgkmcnt(4)
  v_mfma_f32_16x16x32_bf16 v[96:99], v[16:19], v[224:227], v[96:99]
  v_xor_b32 v139, 224, v8
  ds_read_b64_tr_b16 v[28:29], v139 offset:0
  v_mfma_f32_16x16x32_bf16 v[100:103], v[16:19], v[228:231], v[100:103]
  ds_read_b64_tr_b16 v[30:31], v139 offset:1024
  s_waitcnt lgkmcnt(4)
  v_mfma_f32_16x16x32_bf16 v[104:107], v[20:23], v[224:227], v[104:107]
  ds_read_b64_tr_b16 v[16:17], v8 offset:8192
  v_mfma_f32_16x16x32_bf16 v[108:111], v[20:23], v[228:231], v[108:111]
  ds_read_b64_tr_b16 v[18:19], v8 offset:9216
  s_waitcnt lgkmcnt(4)
  v_mfma_f32_16x16x32_bf16 v[112:115], v[24:27], v[224:227], v[112:115]
  ds_read_b64_tr_b16 v[20:21], v9 offset:8192
  v_mfma_f32_16x16x32_bf16 v[116:119], v[24:27], v[228:231], v[116:119]
  ds_read_b64_tr_b16 v[22:23], v9 offset:9216
  s_waitcnt lgkmcnt(4)
  v_mfma_f32_16x16x32_bf16 v[120:123], v[28:31], v[224:227], v[120:123]
  ds_read_b64_tr_b16 v[24:25], v10 offset:8192
  v_mfma_f32_16x16x32_bf16 v[124:127], v[28:31], v[228:231], v[124:127]
  ds_read_b64_tr_b16 v[26:27], v10 offset:9216
  s_barrier
  s_waitcnt lgkmcnt(4)
  v_mfma_f32_16x16x32_bf16 v[64:67], v[16:19], v[232:235], v[64:67]
  ds_read_b64_tr_b16 v[28:29], v11 offset:8192
  v_mfma_f32_16x16x32_bf16 v[68:71], v[16:19], v[236:239], v[68:71]
  ds_read_b64_tr_b16 v[30:31], v11 offset:9216
  s_waitcnt lgkmcnt(4)
  v_mfma_f32_16x16x32_bf16 v[72:75], v[20:23], v[232:235], v[72:75]
  ds_read_b64_tr_b16 v[16:17], v136 offset:8192
  v_mfma_f32_16x16x32_bf16 v[76:79], v[20:23], v[236:239], v[76:79]
  ds_read_b64_tr_b16 v[18:19], v136 offset:9216
  s_waitcnt lgkmcnt(4)
  v_mfma_f32_16x16x32_bf16 v[80:83], v[24:27], v[232:235], v[80:83]
  ds_read_b64_tr_b16 v[20:21], v137 offset:8192
  v_mfma_f32_16x16x32_bf16 v[84:87], v[24:27], v[236:239], v[84:87]
  ds_read_b64_tr_b16 v[22:23], v137 offset:9216
  s_waitcnt lgkmcnt(4)
  v_mfma_f32_16x16x32_bf16 v[88:91], v[28:31], v[232:235], v[88:91]
  ds_read_b64_tr_b16 v[24:25], v138 offset:8192
  v_mfma_f32_16x16x32_bf16 v[92:95], v[28:31], v[236:239], v[92:95]
  ds_read_b64_tr_b16 v[26:27], v138 offset:9216
  s_waitcnt lgkmcnt(4)
  v_mfma_f32_16x16x32_bf16 v[96:99], v[16:19], v[232:235], v[96:99]
  ds_read_b64_tr_b16 v[28:29], v139 offset:8192
  v_mfma_f32_16x16x32_bf16 v[100:103], v[16:19], v[236:239], v[100:103]
  ds_read_b64_tr_b16 v[30:31], v139 offset:9216
  s_and_b32 s50, s66, 15
  s_lshr_b64 s[66:67], s[66:67], 4
  s_lshl_b32 s50, s50, 14
  v_add_u32 v8, s50, v5
  s_waitcnt lgkmcnt(4)
  v_mfma_f32_16x16x32_bf16 v[104:107], v[20:23], v[232:235], v[104:107]
  v_mfma_f32_16x16x32_bf16 v[108:111], v[20:23], v[236:239], v[108:111]
  s_waitcnt lgkmcnt(0)
  s_barrier
  ds_read_b64_tr_b16 v[16:17], v8 offset:0
  ds_read_b64_tr_b16 v[18:19], v8 offset:1024
  v_mfma_f32_16x16x32_bf16 v[112:115], v[24:27], v[232:235], v[112:115]
  ds_read_b64_tr_b16 v[20:21], v8 offset:8192
  v_mfma_f32_16x16x32_bf16 v[116:119], v[24:27], v[236:239], v[116:119]
  ds_read_b64_tr_b16 v[22:23], v8 offset:9216
  v_mfma_f32_16x16x32_bf16 v[120:123], v[28:31], v[232:235], v[120:123]
  v_xor_b32 v10, 32, v8
  ds_read_b64_tr_b16 v[24:25], v10 offset:0
  v_mfma_f32_16x16x32_bf16 v[124:127], v[28:31], v[236:239], v[124:127]
  ds_read_b64_tr_b16 v[26:27], v10 offset:1024
  s_waitcnt lgkmcnt(4)
  v_mfma_f32_16x16x32_bf16 v[64:67], v[16:19], v[240:243], v[64:67]
  ds_read_b64_tr_b16 v[28:29], v10 offset:8192
  v_mfma_f32_16x16x32_bf16 v[68:71], v[16:19], v[244:247], v[68:71]
  ds_read_b64_tr_b16 v[30:31], v10 offset:9216
  s_waitcnt lgkmcnt(4)
  v_mfma_f32_16x16x32_bf16 v[64:67], v[20:23], v[248:251], v[64:67]
  v_xor_b32 v9, 64, v8
  ds_read_b64_tr_b16 v[16:17], v9 offset:0
  v_mfma_f32_16x16x32_bf16 v[68:71], v[20:23], v[252:255], v[68:71]
  ds_read_b64_tr_b16 v[18:19], v9 offset:1024
  s_waitcnt lgkmcnt(4)
  v_mfma_f32_16x16x32_bf16 v[72:75], v[24:27], v[240:243], v[72:75]
  ds_read_b64_tr_b16 v[20:21], v9 offset:8192
  v_mfma_f32_16x16x32_bf16 v[76:79], v[24:27], v[244:247], v[76:79]
  ds_read_b64_tr_b16 v[22:23], v9 offset:9216
  s_waitcnt lgkmcnt(4)
  v_mfma_f32_16x16x32_bf16 v[72:75], v[28:31], v[248:251], v[72:75]
  v_xor_b32 v10, 96, v8
  ds_read_b64_tr_b16 v[24:25], v10 offset:0
  v_mfma_f32_16x16x32_bf16 v[76:79], v[28:31], v[252:255], v[76:79]
  ds_read_b64_tr_b16 v[26:27], v10 offset:1024
  s_waitcnt lgkmcnt(4)
  v_mfma_f32_16x16x32_bf16 v[80:83], v[16:19], v[240:243], v[80:83]
  ds_read_b64_tr_b16 v[28:29], v10 offset:8192
  v_mfma_f32_16x16x32_bf16 v[84:87], v[16:19], v[244:247], v[84:87]
  ds_read_b64_tr_b16 v[30:31], v10 offset:9216
  s_waitcnt lgkmcnt(4)
  v_mfma_f32_16x16x32_bf16 v[80:83], v[20:23], v[248:251], v[80:83]
  v_xor_b32 v9, 128, v8
  ds_read_b64_tr_b16 v[16:17], v9 offset:0
  v_mfma_f32_16x16x32_bf16 v[84:87], v[20:23], v[252:255], v[84:87]
  ds_read_b64_tr_b16 v[18:19], v9 offset:1024
  s_waitcnt lgkmcnt(4)
  v_mfma_f32_16x16x32_bf16 v[88:91], v[24:27], v[240:243], v[88:91]
  ds_read_b64_tr_b16 v[20:21], v9 offset:8192
  v_mfma_f32_16x16x32_bf16 v[92:95], v[24:27], v[244:247], v[92:95]
  ds_read_b64_tr_b16 v[22:23], v9 offset:9216
  s_waitcnt lgkmcnt(4)
  v_mfma_f32_16x16x32_bf16 v[88:91], v[28:31], v[248:251], v[88:91]
  v_xor_b32 v10, 160, v8
  ds_read_b64_tr_b16 v[24:25], v10 offset:0
  v_mul_f32 v64, s72, v64
  v_mul_f32 v65, s72, v65
  v_mul_f32 v66, s72, v66
  v_mfma_f32_16x16x32_bf16 v[92:95], v[28:31], v[252:255], v[92:95]
  ds_read_b64_tr_b16 v[26:27], v10 offset:1024
  v_mul_f32 v67, s72, v67
  v_mul_f32 v68, s72, v68
  s_barrier
  s_waitcnt lgkmcnt(4)
  v_mfma_f32_16x16x32_bf16 v[96:99], v[16:19], v[240:243], v[96:99]
  ds_read_b64_tr_b16 v[28:29], v10 offset:8192
  v_mul_f32 v69, s72, v69
  v_mul_f32 v70, s72, v70
  v_mul_f32 v71, s72, v71
  v_mul_f32 v72, s72, v72
  v_mfma_f32_16x16x32_bf16 v[100:103], v[16:19], v[244:247], v[100:103]
  ds_read_b64_tr_b16 v[30:31], v10 offset:9216
  v_mul_f32 v73, s72, v73
  v_mul_f32 v74, s72, v74
  s_waitcnt lgkmcnt(4)
  v_mfma_f32_16x16x32_bf16 v[96:99], v[20:23], v[248:251], v[96:99]
  v_xor_b32 v9, 192, v8
  ds_read_b64_tr_b16 v[16:17], v9 offset:0
  v_mul_f32 v75, s72, v75
  v_mul_f32 v76, s72, v76
  v_mul_f32 v77, s72, v77
  v_mfma_f32_16x16x32_bf16 v[100:103], v[20:23], v[252:255], v[100:103]
  ds_read_b64_tr_b16 v[18:19], v9 offset:1024
  v_mul_f32 v78, s72, v78
  v_mul_f32 v79, s72, v79
  v_cvt_pk_bf16_f32 v32, v64, v65
  s_waitcnt lgkmcnt(4)
  v_mfma_f32_16x16x32_bf16 v[104:107], v[24:27], v[240:243], v[104:107]
  ds_read_b64_tr_b16 v[20:21], v9 offset:8192
  v_cvt_pk_bf16_f32 v33, v66, v67
  v_cvt_pk_bf16_f32 v34, v72, v73
  v_cvt_pk_bf16_f32 v35, v74, v75
  v_mfma_f32_16x16x32_bf16 v[108:111], v[24:27], v[244:247], v[108:111]
  ds_read_b64_tr_b16 v[22:23], v9 offset:9216
  v_cvt_pk_bf16_f32 v36, v68, v69
  v_cvt_pk_bf16_f32 v37, v70, v71
  v_cvt_pk_bf16_f32 v38, v76, v77
  s_waitcnt lgkmcnt(4)
  v_mfma_f32_16x16x32_bf16 v[104:107], v[28:31], v[248:251], v[104:107]
  v_xor_b32 v10, 224, v8
  ds_read_b64_tr_b16 v[24:25], v10 offset:0
  v_cvt_pk_bf16_f32 v39, v78, v79
  v_permlane16_swap_b32 v32, v34
  v_mfma_f32_16x16x32_bf16 v[108:111], v[28:31], v[252:255], v[108:111]
  ds_read_b64_tr_b16 v[26:27], v10 offset:1024
  v_permlane16_swap_b32 v33, v35
  v_permlane16_swap_b32 v36, v38
  v_permlane16_swap_b32 v37, v39
  s_waitcnt lgkmcnt(4)
  v_mfma_f32_16x16x32_bf16 v[112:115], v[16:19], v[240:243], v[112:115]
  ds_read_b64_tr_b16 v[28:29], v10 offset:8192
  v_mul_f32 v80, s72, v80
  v_mul_f32 v81, s72, v81
  v_mul_f32 v82, s72, v82
  v_mfma_f32_16x16x32_bf16 v[116:119], v[16:19], v[244:247], v[116:119]
  ds_read_b64_tr_b16 v[30:31], v10 offset:9216
  v_mul_f32 v83, s72, v83
  v_mul_f32 v84, s72, v84
  v_mul_f32 v85, s72, v85
  s_and_b32 s50, s66, 15
  s_lshr_b64 s[66:67], s[66:67], 4
  s_lshl_b32 s50, s50, 14
  v_add_u32 v8, s50, v5
  s_waitcnt lgkmcnt(4)
  v_mfma_f32_16x16x32_bf16 v[112:115], v[20:23], v[248:251], v[112:115]
  v_mul_f32 v86, s72, v86
  v_mul_f32 v87, s72, v87
  v_mul_f32 v88, s72, v88
  v_mfma_f32_16x16x32_bf16 v[116:119], v[20:23], v[252:255], v[116:119]
  v_mul_f32 v89, s72, v89
  v_mul_f32 v90, s72, v90
  v_mul_f32 v91, s72, v91
  s_waitcnt lgkmcnt(0)
  s_barrier
  ds_read_b64_tr_b16 v[16:17], v8 offset:0
  ds_read_b64_tr_b16 v[18:19], v8 offset:1024
  v_mfma_f32_16x16x32_bf16 v[120:123], v[24:27], v[240:243], v[120:123]
  ds_read_b64_tr_b16 v[20:21], v8 offset:8192
  v_mul_f32 v92, s72, v92
  v_mul_f32 v93, s72, v93
  v_mul_f32 v94, s72, v94
  v_mfma_f32_16x16x32_bf16 v[124:127], v[24:27], v[244:247], v[124:127]
  ds_read_b64_tr_b16 v[22:23], v8 offset:9216
  v_mul_f32 v95, s72, v95
  v_cvt_pk_bf16_f32 v40, v80, v81
  v_mfma_f32_16x16x32_bf16 v[120:123], v[28:31], v[248:251], v[120:123]
  v_xor_b32 v10, 32, v8
  ds_read_b64_tr_b16 v[24:25], v10 offset:0
  v_cvt_pk_bf16_f32 v41, v82, v83
  v_cvt_pk_bf16_f32 v42, v88, v89
  v_cvt_pk_bf16_f32 v43, v90, v91
  v_mfma_f32_16x16x32_bf16 v[124:127], v[28:31], v[252:255], v[124:127]
  ds_read_b64_tr_b16 v[26:27], v10 offset:1024
  v_cvt_pk_bf16_f32 v44, v84, v85
  v_cvt_pk_bf16_f32 v45, v86, v87
  s_waitcnt lgkmcnt(4)
  v_mfma_f32_16x16x32_bf16 v[64:67], v[16:19], v[144:147], 0
  ds_read_b64_tr_b16 v[28:29], v10 offset:8192
  v_cvt_pk_bf16_f32 v46, v92, v93
  v_cvt_pk_bf16_f32 v47, v94, v95
  v_permlane16_swap_b32 v40, v42
  v_permlane16_swap_b32 v41, v43
  v_mfma_f32_16x16x32_bf16 v[68:71], v[16:19], v[148:151], 0
  ds_read_b64_tr_b16 v[30:31], v10 offset:9216
  s_branch L_pads12
L_pad12:
  s_setpc_b64 s[60:61]
L_pads12:
  v_permlane16_swap_b32 v44, v46
  v_permlane16_swap_b32 v45, v47
  s_waitcnt lgkmcnt(4)
  v_mfma_f32_16x16x32_bf16 v[64:67], v[20:23], v[152:155], v[64:67]
  v_xor_b32 v9, 64, v8
  ds_read_b64_tr_b16 v[16:17], v9 offset:0
  v_mul_f32 v96, s72, v96
  v_mul_f32 v97, s72, v97
  v_mul_f32 v98, s72, v98
  v_mfma_f32_16x16x32_bf16 v[68:71], v[20:23], v[156:159], v[68:71]
  ds_read_b64_tr_b16 v[18:19], v9 offset:1024
  v_mul_f32 v99, s72, v99
  v_mul_f32 v100, s72, v100
  s_waitcnt lgkmcnt(4)
  v_mfma_f32_16x16x32_bf16 v[72:75], v[24:27], v[144:147], 0
  ds_read_b64_tr_b16 v[20:21], v9 offset:8192
  v_mul_f32 v101, s72, v101
  v_mul_f32 v102, s72, v102
  v_mul_f32 v103, s72, v103
  v_mul_f32 v104, s72, v104
  v_mfma_f32_16x16x32_bf16 v[76:79], v[24:27], v[148:151], 0
  ds_read_b64_tr_b16 v[22:23], v9 offset:9216
  v_mul_f32 v105, s72, v105
  v_mul_f32 v106, s72, v106
  s_waitcnt lgkmcnt(4)
  v_mfma_f32_16x16x32_bf16 v[72:75], v[28:31], v[152:155], v[72:75]
  v_xor_b32 v10, 96, v8
  ds_read_b64_tr_b16 v[24:25], v10 offset:0
  v_mul_f32 v107, s72, v107
  v_mul_f32 v108, s72, v108
  v_mul_f32 v109, s72, v109
  v_mfma_f32_16x16x32_bf16 v[76:79], v[28:31], v[156:159], v[76:79]
  ds_read_b64_tr_b16 v[26:27], v10 offset:1024
  v_mul_f32 v110, s72, v110
  v_mul_f32 v111, s72, v111
  v_cvt_pk_bf16_f32 v48, v96, v97
  s_waitcnt lgkmcnt(4)
  v_mfma_f32_16x16x32_bf16 v[80:83], v[16:19], v[144:147], 0
  ds_read_b64_tr_b16 v[28:29], v10 offset:8192
  v_cvt_pk_bf16_f32 v49, v98, v99
  v_cvt_pk_bf16_f32 v50, v104, v105
  v_cvt_pk_bf16_f32 v51, v106, v107
  v_mfma_f32_16x16x32_bf16 v[84:87], v[16:19], v[148:151], 0
  ds_read_b64_tr_b16 v[30:31], v10 offset:9216
  v_cvt_pk_bf16_f32 v52, v100, v101
  v_cvt_pk_bf16_f32 v53, v102, v103
  v_cvt_pk_bf16_f32 v54, v108, v109
  s_waitcnt lgkmcnt(4)
  v_mfma_f32_16x16x32_bf16 v[80:83], v[20:23], v[152:155], v[80:83]
  v_xor_b32 v9, 128, v8
  ds_read_b64_tr_b16 v[16:17], v9 offset:0
  v_cvt_pk_bf16_f32 v55, v110, v111
  v_permlane16_swap_b32 v48, v50
  v_mfma_f32_16x16x32_bf16 v[84:87], v[20:23], v[156:159], v[84:87]
  ds_read_b64_tr_b16 v[18:19], v9 offset:1024
  v_permlane16_swap_b32 v49, v51
  v_permlane16_swap_b32 v52, v54
  v_permlane16_swap_b32 v53, v55
  s_waitcnt lgkmcnt(4)
  v_mfma_f32_16x16x32_bf16 v[88:91], v[24:27], v[144:147], 0
  ds_read_b64_tr_b16 v[20:21], v9 offset:8192
  v_mul_f32 v112, s72, v112
  v_mul_f32 v113, s72, v113
  v_mul_f32 v114, s72, v114
  v_mul_f32 v115, s72, v115
  v_mfma_f32_16x16x32_bf16 v[92:95], v[24:27], v[148:151], 0
  ds_read_b64_tr_b16 v[22:23], v9 offset:9216
  v_mul_f32 v116, s72, v116
  v_mul_f32 v117, s72, v117
  s_waitcnt lgkmcnt(4)
  v_mfma_f32_16x16x32_bf16 v[88:91], v[28:31], v[152:155], v[88:91]
  v_xor_b32 v10, 160, v8
  ds_read_b64_tr_b16 v[24:25], v10 offset:0
  v_mul_f32 v118, s72, v118
  v_mul_f32 v119, s72, v119
  v_mul_f32 v120, s72, v120
  v_mfma_f32_16x16x32_bf16 v[92:95], v[28:31], v[156:159], v[92:95]
  ds_read_b64_tr_b16 v[26:27], v10 offset:1024
  v_mul_f32 v121, s72, v121
  v_mul_f32 v122, s72, v122
  s_barrier
  s_waitcnt lgkmcnt(4)
  v_mfma_f32_16x16x32_bf16 v[96:99], v[16:19], v[144:147], 0
  ds_read_b64_tr_b16 v[28:29], v10 offset:8192
  v_mul_f32 v123, s72, v123
  v_mul_f32 v124, s72, v124
  v_mul_f32 v125, s72, v125
  v_mul_f32 v126, s72, v126
  v_mfma_f32_16x16x32_bf16 v[100:103], v[16:19], v[148:151], 0
  ds_read_b64_tr_b16 v[30:31], v10 offset:9216
  v_mul_f32 v127, s72, v127
  v_cvt_pk_bf16_f32 v56, v112, v113
  s_waitcnt lgkmcnt(4)
  v_mfma_f32_16x16x32_bf16 v[96:99], v[20:23], v[152:155], v[96:99]
  v_xor_b32 v9, 192, v8
  ds_read_b64_tr_b16 v[16:17], v9 offset:0
  v_cvt_pk_bf16_f32 v57, v114, v115
  v_cvt_pk_bf16_f32 v58, v120, v121
  v_cvt_pk_bf16_f32 v59, v122, v123
  v_mfma_f32_16x16x32_bf16 v[100:103], v[20:23], v[156:159], v[100:103]
  ds_read_b64_tr_b16 v[18:19], v9 offset:1024
  v_cvt_pk_bf16_f32 v60, v116, v117
  v_cvt_pk_bf16_f32 v61, v118, v119
  s_waitcnt lgkmcnt(4)
  v_mfma_f32_16x16x32_bf16 v[104:107], v[24:27], v[144:147], 0
  ds_read_b64_tr_b16 v[20:21], v9 offset:8192
  v_cvt_pk_bf16_f32 v62, v124, v125
  v_cvt_pk_bf16_f32 v63, v126, v127
  v_permlane16_swap_b32 v56, v58
  v_permlane16_swap_b32 v57, v59
  v_mfma_f32_16x16x32_bf16 v[108:111], v[24:27], v[148:151], 0
  ds_read_b64_tr_b16 v[22:23], v9 offset:9216
  v_permlane16_swap_b32 v60, v62
  v_permlane16_swap_b32 v61, v63
  s_waitcnt lgkmcnt(4)
  v_mfma_f32_16x16x32_bf16 v[104:107], v[28:31], v[152:155], v[104:107]
  v_xor_b32 v10, 224, v8
  ds_read_b64_tr_b16 v[24:25], v10 offset:0
  v_mfma_f32_16x16x32_bf16 v[108:111], v[28:31], v[156:159], v[108:111]
  ds_read_b64_tr_b16 v[26:27], v10 offset:1024
  s_waitcnt lgkmcnt(4)
  v_mfma_f32_16x16x32_bf16 v[112:115], v[16:19], v[144:147], 0
  ds_read_b64_tr_b16 v[28:29], v10 offset:8192
  v_mfma_f32_16x16x32_bf16 v[116:119], v[16:19], v[148:151], 0
  ds_read_b64_tr_b16 v[30:31], v10 offset:9216
  s_and_b32 s50, s66, 15
  s_lshr_b64 s[66:67], s[66:67], 4
  s_lshl_b32 s50, s50, 14
  v_add_u32 v8, s50, v5
  s_waitcnt lgkmcnt(4)
  v_mfma_f32_16x16x32_bf16 v[112:115], v[20:23], v[152:155], v[112:115]
  v_mfma_f32_16x16x32_bf16 v[116:119], v[20:23], v[156:159], v[116:119]
  s_waitcnt lgkmcnt(0)
  s_barrier
  ds_read_b64_tr_b16 v[16:17], v8 offset:0
  ds_read_b64_tr_b16 v[18:19], v8 offset:1024
  v_mfma_f32_16x16x32_bf16 v[120:123], v[24:27], v[144:147], 0
  v_xor_b32 v9, 32, v8
  ds_read_b64_tr_b16 v[20:21], v9 offset:0
  v_mfma_f32_16x16x32_bf16 v[124:127], v[24:27], v[148:151], 0
  ds_read_b64_tr_b16 v[22:23], v9 offset:1024
  v_mfma_f32_16x16x32_bf16 v[120:123], v[28:31], v[152:155], v[120:123]
  v_xor_b32 v10, 64, v8
  ds_read_b64_tr_b16 v[24:25], v10 offset:0
  v_mfma_f32_16x16x32_bf16 v[124:127], v[28:31], v[156:159], v[124:127]
  ds_read_b64_tr_b16 v[26:27], v10 offset:1024
  s_waitcnt lgkmcnt(4)
  v_mfma_f32_16x16x32_bf16 v[64:67], v[16:19], v[160:163], v[64:67]
  v_xor_b32 v11, 96, v8
  ds_read_b64_tr_b16 v[28:29], v11 offset:0
  v_mfma_f32_16x16x32_bf16 v[68:71], v[16:19], v[164:167], v[68:71]
  ds_read_b64_tr_b16 v[30:31], v11 offset:1024
  s_waitcnt lgkmcnt(4)
  v_mfma_f32_16x16x32_bf16 v[72:75], v[20:23], v[160:163], v[72:75]
  v_xor_b32 v136, 128, v8
  ds_read_b64_tr_b16 v[16:17], v136 offset:0
  v_mfma_f32_16x16x32_bf16 v[76:79], v[20:23], v[164:167], v[76:79]
  ds_read_b64_tr_b16 v[18:19], v136 offset:1024
  s_waitcnt lgkmcnt(4)
  v_mfma_f32_16x16x32_bf16 v[80:83], v[24:27], v[160:163], v[80:83]
  v_xor_b32 v137, 160, v8
  ds_read_b64_tr_b16 v[20:21], v137 offset:0
  v_mfma_f32_16x16x32_bf16 v[84:87], v[24:27], v[164:167], v[84:87]
  ds_read_b64_tr_b16 v[22:23], v137 offset:1024
  s_waitcnt lgkmcnt(4)
  v_mfma_f32_16x16x32_bf16 v[88:91], v[28:31], v[160:163], v[88:91]
  v_xor_b32 v138, 192, v8
  ds_read_b64_tr_b16 v[24:25], v138 offset:0
  v_mfma_f32_16x16x32_bf16 v[92:95], v[28:31], v[164:167], v[92:95]
  ds_read_b64_tr_b16 v[26:27], v138 offset:1024
  s_waitcnt lgkmcnt(4)
  v_mfma_f32_16x16x32_bf16 v[96:99], v[16:19], v[160:163], v[96:99]
  v_xor_b32 v139, 224, v8
  ds_read_b64_tr_b16 v[28:29], v139 offset:0
  v_mfma_f32_16x16x32_bf16 v[100:103], v[16:19], v[164:167], v[100:103]
  ds_read_b64_tr_b16 v[30:31], v139 offset:1024
  s_waitcnt lgkmcnt(4)
  v_mfma_f32_16x16x32_bf16 v[104:107], v[20:23], v[160:163], v[104:107]
  ds_read_b64_tr_b16 v[16:17], v8 offset:8192
  v_mfma_f32_16x16x32_bf16 v[108:111], v[20:23], v[164:167], v[108:111]
  ds_read_b64_tr_b16 v[18:19], v8 offset:9216
  s_waitcnt lgkmcnt(4)
  v_mfma_f32_16x16x32_bf16 v[112:115], v[24:27], v[160:163], v[112:115]
  ds_read_b64_tr_b16 v[20:21], v9 offset:8192
  v_mfma_f32_16x16x32_bf16 v[116:119], v[24:27], v[164:167], v[116:119]
  ds_read_b64_tr_b16 v[22:23], v9 offset:9216
  s_waitcnt lgkmcnt(4)
  v_mfma_f32_16x16x32_bf16 v[120:123], v[28:31], v[160:163], v[120:123]
  ds_read_b64_tr_b16 v[24:25], v10 offset:8192
  v_mfma_f32_16x16x32_bf16 v[124:127], v[28:31], v[164:167], v[124:127]
  ds_read_b64_tr_b16 v[26:27], v10 offset:9216
  s_barrier
  s_waitcnt lgkmcnt(4)
  v_mfma_f32_16x16x32_bf16 v[64:67], v[16:19], v[168:171], v[64:67]
  ds_read_b64_tr_b16 v[28:29], v11 offset:8192
  v_mfma_f32_16x16x32_bf16 v[68:71], v[16:19], v[172:175], v[68:71]
  ds_read_b64_tr_b16 v[30:31], v11 offset:9216
  s_waitcnt lgkmcnt(4)
  v_mfma_f32_16x16x32_bf16 v[72:75], v[20:23], v[168:171], v[72:75]
  ds_read_b64_tr_b16 v[16:17], v136 offset:8192
  v_mfma_f32_16x16x32_bf16 v[76:79], v[20:23], v[172:175], v[76:79]
  ds_read_b64_tr_b16 v[18:19], v136 offset:9216
  s_waitcnt lgkmcnt(4)
  v_mfma_f32_16x16x32_bf16 v[80:83], v[24:27], v[168:171], v[80:83]
  ds_read_b64_tr_b16 v[20:21], v137 offset:8192
  v_mfma_f32_16x16x32_bf16 v[84:87], v[24:27], v[172:175], v[84:87]
  ds_read_b64_tr_b16 v[22:23], v137 offset:9216
  s_waitcnt lgkmcnt(4)
  v_mfma_f32_16x16x32_bf16 v[88:91], v[28:31], v[168:171], v[88:91]
  ds_read_b64_tr_b16 v[24:25], v138 offset:8192
  v_mfma_f32_16x16x32_bf16 v[92:95], v[28:31], v[172:175], v[92:95]
  ds_read_b64_tr_b16 v[26:27], v138 offset:9216
  s_waitcnt lgkmcnt(4)
  v_mfma_f32_16x16x32_bf16 v[96:99], v[16:19], v[168:171], v[96:99]
  ds_read_b64_tr_b16 v[28:29], v139 offset:8192
  v_mfma_f32_16x16x32_bf16 v[100:103], v[16:19], v[172:175], v[100:103]
  ds_read_b64_tr_b16 v[30:31], v139 offset:9216
  s_and_b32 s50, s66, 15
  s_lshr_b64 s[66:67], s[66:67], 4
  s_lshl_b32 s50, s50, 14
  v_add_u32 v8, s50, v5
  s_waitcnt lgkmcnt(4)
  v_mfma_f32_16x16x32_bf16 v[104:107], v[20:23], v[168:171], v[104:107]
  v_mfma_f32_16x16x32_bf16 v[108:111], v[20:23], v[172:175], v[108:111]
  s_waitcnt lgkmcnt(0)
  s_barrier
  ds_read_b64_tr_b16 v[16:17], v8 offset:0
  ds_read_b64_tr_b16 v[18:19], v8 offset:1024
  v_mfma_f32_16x16x32_bf16 v[112:115], v[24:27], v[168:171], v[112:115]
  v_xor_b32 v9, 32, v8
  ds_read_b64_tr_b16 v[20:21], v9 offset:0
  v_mfma_f32_16x16x32_bf16 v[116:119], v[24:27], v[172:175], v[116:119]
  ds_read_b64_tr_b16 v[22:23], v9 offset:1024
  v_mfma_f32_16x16x32_bf16 v[120:123], v[28:31], v[168:171], v[120:123]
  v_xor_b32 v10, 64, v8
  ds_read_b64_tr_b16 v[24:25], v10 offset:0
  v_mfma_f32_16x16x32_bf16 v[124:127], v[28:31], v[172:175], v[124:127]
  ds_read_b64_tr_b16 v[26:27], v10 offset:1024
  s_waitcnt lgkmcnt(4)
  v_mfma_f32_16x16x32_bf16 v[64:67], v[16:19], v[176:179], v[64:67]
  v_xor_b32 v11, 96, v8
  ds_read_b64_tr_b16 v[28:29], v11 offset:0
  v_mfma_f32_16x16x32_bf16 v[68:71], v[16:19], v[180:183], v[68:71]
  ds_read_b64_tr_b16 v[30:31], v11 offset:1024
  s_waitcnt lgkmcnt(4)
  v_mfma_f32_16x16x32_bf16 v[72:75], v[20:23], v[176:179], v[72:75]
  v_xor_b32 v136, 128, v8
  ds_read_b64_tr_b16 v[16:17], v136 offset:0
  v_mfma_f32_16x16x32_bf16 v[76:79], v[20:23], v[180:183], v[76:79]
  ds_read_b64_tr_b16 v[18:19], v136 offset:1024
  s_waitcnt lgkmcnt(4)
  v_mfma_f32_16x16x32_bf16 v[80:83], v[24:27], v[176:179], v[80:83]
  v_xor_b32 v137, 160, v8
  ds_read_b64_tr_b16 v[20:21], v137 offset:0
  v_mfma_f32_16x16x32_bf16 v[84:87], v[24:27], v[180:183], v[84:87]
  ds_read_b64_tr_b16 v[22:23], v137 offset:1024
  s_waitcnt lgkmcnt(4)
  v_mfma_f32_16x16x32_bf16 v[88:91], v[28:31], v[176:179], v[88:91]
  v_xor_b32 v138, 192, v8
  ds_read_b64_tr_b16 v[24:25], v138 offset:0
  v_mfma_f32_16x16x32_bf16 v[92:95], v[28:31], v[180:183], v[92:95]
  ds_read_b64_tr_b16 v[26:27], v138 offset:1024
  s_waitcnt lgkmcnt(4)
  v_mfma_f32_16x16x32_bf16 v[96:99], v[16:19], v[176:179], v[96:99]
  v_xor_b32 v139, 224, v8
  ds_read_b64_tr_b16 v[28:29], v139 offset:0
  v_mfma_f32_16x16x32_bf16 v[100:103], v[16:19], v[180:183], v[100:103]
  ds_read_b64_tr_b16 v[30:31], v139 offset:1024
  s_waitcnt lgkmcnt(4)
  v_mfma_f32_16x16x32_bf16 v[104:107], v[20:23], v[176:179], v[104:107]
  ds_read_b64_tr_b16 v[16:17], v8 offset:8192
  v_mfma_f32_16x16x32_bf16 v[108:111], v[20:23], v[180:183], v[108:111]
  ds_read_b64_tr_b16 v[18:19], v8 offset:9216
  s_waitcnt lgkmcnt(4)
  v_mfma_f32_16x16x32_bf16 v[112:115], v[24:27], v[176:179], v[112:115]
  ds_read_b64_tr_b16 v[20:21], v9 offset:8192
  v_mfma_f32_16x16x32_bf16 v[116:119], v[24:27], v[180:183], v[116:119]
  ds_read_b64_tr_b16 v[22:23], v9 offset:9216
  s_waitcnt lgkmcnt(4)
  v_mfma_f32_16x16x32_bf16 v[120:123], v[28:31], v[176:179], v[120:123]
  ds_read_b64_tr_b16 v[24:25], v10 offset:8192
  v_mfma_f32_16x16x32_bf16 v[124:127], v[28:31], v[180:183], v[124:127]
  ds_read_b64_tr_b16 v[26:27], v10 offset:9216
  s_barrier
  s_waitcnt lgkmcnt(4)
  v_mfma_f32_16x16x32_bf16 v[64:67], v[16:19], v[184:187], v[64:67]
  ds_read_b64_tr_b16 v[28:29], v11 offset:8192
  v_mfma_f32_16x16x32_bf16 v[68:71], v[16:19], v[188:191], v[68:71]
  ds_read_b64_tr_b16 v[30:31], v11 offset:9216
  s_waitcnt lgkmcnt(4)
  v_mfma_f32_16x16x32_bf16 v[72:75], v[20:23], v[184:187], v[72:75]
  ds_read_b64_tr_b16 v[16:17], v136 offset:8192
  v_mfma_f32_16x16x32_bf16 v[76:79], v[20:23], v[188:191], v[76:79]
  ds_read_b64_tr_b16 v[18:19], v136 offset:9216
  s_waitcnt lgkmcnt(4)
  v_mfma_f32_16x16x32_bf16 v[80:83], v[24:27], v[184:187], v[80:83]
  ds_read_b64_tr_b16 v[20:21], v137 offset:8192
  v_mfma_f32_16x16x32_bf16 v[84:87], v[24:27], v[188:191], v[84:87]
  ds_read_b64_tr_b16 v[22:23], v137 offset:9216
  s_waitcnt lgkmcnt(4)
  v_mfma_f32_16x16x32_bf16 v[88:91], v[28:31], v[184:187], v[88:91]
  ds_read_b64_tr_b16 v[24:25], v138 offset:8192
  v_mfma_f32_16x16x32_bf16 v[92:95], v[28:31], v[188:191], v[92:95]
  ds_read_b64_tr_b16 v[26:27], v138 offset:9216
  s_waitcnt lgkmcnt(4)
  v_mfma_f32_16x16x32_bf16 v[96:99], v[16:19], v[184:187], v[96:99]
  ds_read_b64_tr_b16 v[28:29], v139 offset:8192
  v_mfma_f32_16x16x32_bf16 v[100:103], v[16:19], v[188:191], v[100:103]
  ds_read_b64_tr_b16 v[30:31], v139 offset:9216
  s_and_b32 s50, s66, 15
  s_lshr_b64 s[66:67], s[66:67], 4
  s_lshl_b32 s50, s50, 14
  v_add_u32 v8, s50, v5
  s_waitcnt lgkmcnt(4)
  v_mfma_f32_16x16x32_bf16 v[104:107], v[20:23], v[184:187], v[104:107]
  v_mfma_f32_16x16x32_bf16 v[108:111], v[20:23], v[188:191], v[108:111]
  s_waitcnt lgkmcnt(0)
  s_barrier
  ds_read_b64_tr_b16 v[16:17], v8 offset:0
  ds_read_b64_tr_b16 v[18:19], v8 offset:1024
  v_mfma_f32_16x16x32_bf16 v[112:115], v[24:27], v[184:187], v[112:115]
  v_xor_b32 v9, 32, v8
  ds_read_b64_tr_b16 v[20:21], v9 offset:0
  v_mfma_f32_16x16x32_bf16 v[116:119], v[24:27], v[188:191], v[116:119]
  ds_read_b64_tr_b16 v[22:23], v9 offset:1024
  v_mfma_f32_16x16x32_bf16 v[120:123], v[28:31], v[184:187], v[120:123]
  v_xor_b32 v10, 64, v8
  ds_read_b64_tr_b16 v[24:25], v10 offset:0
  v_mfma_f32_16x16x32_bf16 v[124:127], v[28:31], v[188:191], v[124:127]
  ds_read_b64_tr_b16 v[26:27], v10 offset:1024
  s_waitcnt lgkmcnt(4)
  v_mfma_f32_16x16x32_bf16 v[64:67], v[16:19], v[192:195], v[64:67]
  v_xor_b32 v11, 96, v8
  ds_read_b64_tr_b16 v[28:29], v11 offset:0
  v_mfma_f32_16x16x32_bf16 v[68:71], v[16:19], v[196:199], v[68:71]
  ds_read_b64_tr_b16 v[30:31], v11 offset:1024
  s_waitcnt lgkmcnt(4)
  v_mfma_f32_16x16x32_bf16 v[72:75], v[20:23], v[192:195], v[72:75]
  v_xor_b32 v136, 128, v8
  ds_read_b64_tr_b16 v[16:17], v136 offset:0
  v_mfma_f32_16x16x32_bf16 v[76:79], v[20:23], v[196:199], v[76:79]
  ds_read_b64_tr_b16 v[18:19], v136 offset:1024
  s_waitcnt lgkmcnt(4)
  v_mfma_f32_16x16x32_bf16 v[80:83], v[24:27], v[192:195], v[80:83]
  v_xor_b32 v137, 160, v8
  ds_read_b64_tr_b16 v[20:21], v137 offset:0
  v_mfma_f32_16x16x32_bf16 v[84:87], v[24:27], v[196:199], v[84:87]
  ds_read_b64_tr_b16 v[22:23], v137 offset:1024
  s_waitcnt lgkmcnt(4)
  v_mfma_f32_16x16x32_bf16 v[88:91], v[28:31], v[192:195], v[88:91]
  v_xor_b32 v138, 192, v8
  ds_read_b64_tr_b16 v[24:25], v138 offset:0
  v_mfma_f32_16x16x32_bf16 v[92:95], v[28:31], v[196:199], v[92:95]
  ds_read_b64_tr_b16 v[26:27], v138 offset:1024
  s_waitcnt lgkmcnt(4)
  v_mfma_f32_16x16x32_bf16 v[96:99], v[16:19], v[192:195], v[96:99]
  v_xor_b32 v139, 224, v8
  ds_read_b64_tr_b16 v[28:29], v139 offset:0
  v_mfma_f32_16x16x32_bf16 v[100:103], v[16:19], v[196:199], v[100:103]
  ds_read_b64_tr_b16 v[30:31], v139 offset:1024
  s_waitcnt lgkmcnt(4)
  v_mfma_f32_16x16x32_bf16 v[104:107], v[20:23], v[192:195], v[104:107]
  ds_read_b64_tr_b16 v[16:17], v8 offset:8192
  v_mfma_f32_16x16x32_bf16 v[108:111], v[20:23], v[196:199], v[108:111]
  ds_read_b64_tr_b16 v[18:19], v8 offset:9216
  s_waitcnt lgkmcnt(4)
  v_mfma_f32_16x16x32_bf16 v[112:115], v[24:27], v[192:195], v[112:115]
  ds_read_b64_tr_b16 v[20:21], v9 offset:8192
  v_mfma_f32_16x16x32_bf16 v[116:119], v[24:27], v[196:199], v[116:119]
  ds_read_b64_tr_b16 v[22:23], v9 offset:9216
  s_waitcnt lgkmcnt(4)
  v_mfma_f32_16x16x32_bf16 v[120:123], v[28:31], v[192:195], v[120:123]
  ds_read_b64_tr_b16 v[24:25], v10 offset:8192
  v_mfma_f32_16x16x32_bf16 v[124:127], v[28:31], v[196:199], v[124:127]
  ds_read_b64_tr_b16 v[26:27], v10 offset:9216
  s_barrier
  s_waitcnt lgkmcnt(4)
  v_mfma_f32_16x16x32_bf16 v[64:67], v[16:19], v[200:203], v[64:67]
  ds_read_b64_tr_b16 v[28:29], v11 offset:8192
  v_mfma_f32_16x16x32_bf16 v[68:71], v[16:19], v[204:207], v[68:71]
  ds_read_b64_tr_b16 v[30:31], v11 offset:9216
  s_waitcnt lgkmcnt(4)
  v_mfma_f32_16x16x32_bf16 v[72:75], v[20:23], v[200:203], v[72:75]
  ds_read_b64_tr_b16 v[16:17], v136 offset:8192
  v_mfma_f32_16x16x32_bf16 v[76:79], v[20:23], v[204:207], v[76:79]
  ds_read_b64_tr_b16 v[18:19], v136 offset:9216
  s_waitcnt lgkmcnt(4)
  v_mfma_f32_16x16x32_bf16 v[80:83], v[24:27], v[200:203], v[80:83]
  ds_read_b64_tr_b16 v[20:21], v137 offset:8192
  v_mfma_f32_16x16x32_bf16 v[84:87], v[24:27], v[204:207], v[84:87]
  ds_read_b64_tr_b16 v[22:23], v137 offset:9216
  s_waitcnt lgkmcnt(4)
  v_mfma_f32_16x16x32_bf16 v[88:91], v[28:31], v[200:203], v[88:91]
  ds_read_b64_tr_b16 v[24:25], v138 offset:8192
  v_mfma_f32_16x16x32_bf16 v[92:95], v[28:31], v[204:207], v[92:95]
  ds_read_b64_tr_b16 v[26:27], v138 offset:9216
  s_waitcnt lgkmcnt(4)
  v_mfma_f32_16x16x32_bf16 v[96:99], v[16:19], v[200:203], v[96:99]
  ds_read_b64_tr_b16 v[28:29], v139 offset:8192
  v_mfma_f32_16x16x32_bf16 v[100:103], v[16:19], v[204:207], v[100:103]
  ds_read_b64_tr_b16 v[30:31], v139 offset:9216
  s_and_b32 s50, s66, 15
  s_lshr_b64 s[66:67], s[66:67], 4
  s_lshl_b32 s50, s50, 14
  v_add_u32 v8, s50, v5
  s_waitcnt lgkmcnt(4)
  v_mfma_f32_16x16x32_bf16 v[104:107], v[20:23], v[200:203], v[104:107]
  v_mfma_f32_16x16x32_bf16 v[108:111], v[20:23], v[204:207], v[108:111]
  s_waitcnt lgkmcnt(0)
  s_barrier
  ds_read_b64_tr_b16 v[16:17], v8 offset:0
  ds_read_b64_tr_b16 v[18:19], v8 offset:1024
  v_mfma_f32_16x16x32_bf16 v[112:115], v[24:27], v[200:203], v[112:115]
  v_xor_b32 v9, 32, v8
  ds_read_b64_tr_b16 v[20:21], v9 offset:0
  v_mfma_f32_16x16x32_bf16 v[116:119], v[24:27], v[204:207], v[116:119]
  ds_read_b64_tr_b16 v[22:23], v9 offset:1024
  v_mfma_f32_16x16x32_bf16 v[120:123], v[28:31], v[200:203], v[120:123]
  v_xor_b32 v10, 64, v8
  ds_read_b64_tr_b16 v[24:25], v10 offset:0
  v_mfma_f32_16x16x32_bf16 v[124:127], v[28:31], v[204:207], v[124:127]
  ds_read_b64_tr_b16 v[26:27], v10 offset:1024
  s_waitcnt lgkmcnt(4)
  v_mfma_f32_16x16x32_bf16 v[64:67], v[16:19], v[208:211], v[64:67]
  v_xor_b32 v11, 96, v8
  ds_read_b64_tr_b16 v[28:29], v11 offset:0
  v_mfma_f32_16x16x32_bf16 v[68:71], v[16:19], v[212:215], v[68:71]
  ds_read_b64_tr_b16 v[30:31], v11 offset:1024
  s_waitcnt lgkmcnt(4)
  v_mfma_f32_16x16x32_bf16 v[72:75], v[20:23], v[208:211], v[72:75]
  v_xor_b32 v136, 128, v8
  ds_read_b64_tr_b16 v[16:17], v136 offset:0
  v_mfma_f32_16x16x32_bf16 v[76:79], v[20:23], v[212:215], v[76:79]
  ds_read_b64_tr_b16 v[18:19], v136 offset:1024
  s_waitcnt lgkmcnt(4)
  v_mfma_f32_16x16x32_bf16 v[80:83], v[24:27], v[208:211], v[80:83]
  v_xor_b32 v137, 160, v8
  ds_read_b64_tr_b16 v[20:21], v137 offset:0
  v_mfma_f32_16x16x32_bf16 v[84:87], v[24:27], v[212:215], v[84:87]
  ds_read_b64_tr_b16 v[22:23], v137 offset:1024
  s_waitcnt lgkmcnt(4)
  v_mfma_f32_16x16x32_bf16 v[88:91], v[28:31], v[208:211], v[88:91]
  v_xor_b32 v138, 192, v8
  ds_read_b64_tr_b16 v[24:25], v138 offset:0
  v_mfma_f32_16x16x32_bf16 v[92:95], v[28:31], v[212:215], v[92:95]
  ds_read_b64_tr_b16 v[26:27], v138 offset:1024
  s_waitcnt lgkmcnt(4)
  v_mfma_f32_16x16x32_bf16 v[96:99], v[16:19], v[208:211], v[96:99]
  v_xor_b32 v139, 224, v8
  ds_read_b64_tr_b16 v[28:29], v139 offset:0
  v_mfma_f32_16x16x32_bf16 v[100:103], v[16:19], v[212:215], v[100:103]
  ds_read_b64_tr_b16 v[30:31], v139 offset:1024
  s_waitcnt lgkmcnt(4)
  v_mfma_f32_16x16x32_bf16 v[104:107], v[20:23], v[208:211], v[104:107]
  ds_read_b64_tr_b16 v[16:17], v8 offset:8192
  v_mfma_f32_16x16x32_bf16 v[108:111], v[20:23], v[212:215], v[108:111]
  ds_read_b64_tr_b16 v[18:19], v8 offset:9216
  s_waitcnt lgkmcnt(4)
  v_mfma_f32_16x16x32_bf16 v[112:115], v[24:27], v[208:211], v[112:115]
  ds_read_b64_tr_b16 v[20:21], v9 offset:8192
  v_mfma_f32_16x16x32_bf16 v[116:119], v[24:27], v[212:215], v[116:119]
  ds_read_b64_tr_b16 v[22:23], v9 offset:9216
  s_waitcnt lgkmcnt(4)
  v_mfma_f32_16x16x32_bf16 v[120:123], v[28:31], v[208:211], v[120:123]
  ds_read_b64_tr_b16 v[24:25], v10 offset:8192
  v_mfma_f32_16x16x32_bf16 v[124:127], v[28:31], v[212:215], v[124:127]
  ds_read_b64_tr_b16 v[26:27], v10 offset:9216
  s_barrier
  s_waitcnt lgkmcnt(4)
  v_mfma_f32_16x16x32_bf16 v[64:67], v[16:19], v[216:219], v[64:67]
  ds_read_b64_tr_b16 v[28:29], v11 offset:8192
  v_mfma_f32_16x16x32_bf16 v[68:71], v[16:19], v[220:223], v[68:71]
  ds_read_b64_tr_b16 v[30:31], v11 offset:9216
  s_waitcnt lgkmcnt(4)
  v_mfma_f32_16x16x32_bf16 v[72:75], v[20:23], v[216:219], v[72:75]
  ds_read_b64_tr_b16 v[16:17], v136 offset:8192
  v_mfma_f32_16x16x32_bf16 v[76:79], v[20:23], v[220:223], v[76:79]
  ds_read_b64_tr_b16 v[18:19], v136 offset:9216
  s_waitcnt lgkmcnt(4)
  v_mfma_f32_16x16x32_bf16 v[80:83], v[24:27], v[216:219], v[80:83]
  ds_read_b64_tr_b16 v[20:21], v137 offset:8192
  v_mfma_f32_16x16x32_bf16 v[84:87], v[24:27], v[220:223], v[84:87]
  ds_read_b64_tr_b16 v[22:23], v137 offset:9216
  s_waitcnt lgkmcnt(4)
  v_mfma_f32_16x16x32_bf16 v[88:91], v[28:31], v[216:219], v[88:91]
  ds_read_b64_tr_b16 v[24:25], v138 offset:8192
  v_mfma_f32_16x16x32_bf16 v[92:95], v[28:31], v[220:223], v[92:95]
  ds_read_b64_tr_b16 v[26:27], v138 offset:9216
  s_waitcnt lgkmcnt(4)
  v_mfma_f32_16x16x32_bf16 v[96:99], v[16:19], v[216:219], v[96:99]
  ds_read_b64_tr_b16 v[28:29], v139 offset:8192
  v_mfma_f32_16x16x32_bf16 v[100:103], v[16:19], v[220:223], v[100:103]
  ds_read_b64_tr_b16 v[30:31], v139 offset:9216
  s_and_b32 s50, s66, 15
  s_lshr_b64 s[66:67], s[66:67], 4
  s_lshl_b32 s50, s50, 14
  v_add_u32 v8, s50, v5
  s_waitcnt lgkmcnt(4)
  v_mfma_f32_16x16x32_bf16 v[104:107], v[20:23], v[216:219], v[104:107]
  v_mfma_f32_16x16x32_bf16 v[108:111], v[20:23], v[220:223], v[108:111]
  s_waitcnt lgkmcnt(0)
  s_barrier
  ds_read_b64_tr_b16 v[16:17], v8 offset:0
  ds_read_b64_tr_b16 v[18:19], v8 offset:1024
  v_mfma_f32_16x16x32_bf16 v[112:115], v[24:27], v[216:219], v[112:115]
  v_xor_b32 v9, 32, v8
  ds_read_b64_tr_b16 v[20:21], v9 offset:0
  v_mfma_f32_16x16x32_bf16 v[116:119], v[24:27], v[220:223], v[116:119]
  ds_read_b64_tr_b16 v[22:23], v9 offset:1024
  v_mfma_f32_16x16x32_bf16 v[120:123], v[28:31], v[216:219], v[120:123]
  v_xor_b32 v10, 64, v8
  ds_read_b64_tr_b16 v[24:25], v10 offset:0
  v_mfma_f32_16x16x32_bf16 v[124:127], v[28:31], v[220:223], v[124:127]
  ds_read_b64_tr_b16 v[26:27], v10 offset:1024
  s_waitcnt lgkmcnt(4)
  v_mfma_f32_16x16x32_bf16 v[64:67], v[16:19], v[224:227], v[64:67]
  v_xor_b32 v11, 96, v8
  ds_read_b64_tr_b16 v[28:29], v11 offset:0
  v_mfma_f32_16x16x32_bf16 v[68:71], v[16:19], v[228:231], v[68:71]
  ds_read_b64_tr_b16 v[30:31], v11 offset:1024
  s_waitcnt lgkmcnt(4)
  v_mfma_f32_16x16x32_bf16 v[72:75], v[20:23], v[224:227], v[72:75]
  v_xor_b32 v136, 128, v8
  ds_read_b64_tr_b16 v[16:17], v136 offset:0
  v_mfma_f32_16x16x32_bf16 v[76:79], v[20:23], v[228:231], v[76:79]
  ds_read_b64_tr_b16 v[18:19], v136 offset:1024
  s_waitcnt lgkmcnt(4)
  v_mfma_f32_16x16x32_bf16 v[80:83], v[24:27], v[224:227], v[80:83]
  v_xor_b32 v137, 160, v8
  ds_read_b64_tr_b16 v[20:21], v137 offset:0
  v_mfma_f32_16x16x32_bf16 v[84:87], v[24:27], v[228:231], v[84:87]
  ds_read_b64_tr_b16 v[22:23], v137 offset:1024
  s_waitcnt lgkmcnt(4)
  v_mfma_f32_16x16x32_bf16 v[88:91], v[28:31], v[224:227], v[88:91]
  v_xor_b32 v138, 192, v8
  ds_read_b64_tr_b16 v[24:25], v138 offset:0
  v_mfma_f32_16x16x32_bf16 v[92:95], v[28:31], v[228:231], v[92:95]
  ds_read_b64_tr_b16 v[26:27], v138 offset:1024
  s_waitcnt lgkmcnt(4)
  v_mfma_f32_16x16x32_bf16 v[96:99], v[16:19], v[224:227], v[96:99]
  v_xor_b32 v139, 224, v8
  ds_read_b64_tr_b16 v[28:29], v139 offset:0
  v_mfma_f32_16x16x32_bf16 v[100:103], v[16:19], v[228:231], v[100:103]
  ds_read_b64_tr_b16 v[30:31], v139 offset:1024
  s_waitcnt lgkmcnt(4)
  v_mfma_f32_16x16x32_bf16 v[104:107], v[20:23], v[224:227], v[104:107]
  ds_read_b64_tr_b16 v[16:17], v8 offset:8192
  v_mfma_f32_16x16x32_bf16 v[108:111], v[20:23], v[228:231], v[108:111]
  ds_read_b64_tr_b16 v[18:19], v8 offset:9216
  s_waitcnt lgkmcnt(4)
  v_mfma_f32_16x16x32_bf16 v[112:115], v[24:27], v[224:227], v[112:115]
  ds_read_b64_tr_b16 v[20:21], v9 offset:8192
  v_mfma_f32_16x16x32_bf16 v[116:119], v[24:27], v[228:231], v[116:119]
  ds_read_b64_tr_b16 v[22:23], v9 offset:9216
  s_waitcnt lgkmcnt(4)
  v_mfma_f32_16x16x32_bf16 v[120:123], v[28:31], v[224:227], v[120:123]
  ds_read_b64_tr_b16 v[24:25], v10 offset:8192
  v_mfma_f32_16x16x32_bf16 v[124:127], v[28:31], v[228:231], v[124:127]
  ds_read_b64_tr_b16 v[26:27], v10 offset:9216
  s_barrier
  s_waitcnt lgkmcnt(4)
  v_mfma_f32_16x16x32_bf16 v[64:67], v[16:19], v[232:235], v[64:67]
  ds_read_b64_tr_b16 v[28:29], v11 offset:8192
  v_mfma_f32_16x16x32_bf16 v[68:71], v[16:19], v[236:239], v[68:71]
  ds_read_b64_tr_b16 v[30:31], v11 offset:9216
  s_waitcnt lgkmcnt(4)
  v_mfma_f32_16x16x32_bf16 v[72:75], v[20:23], v[232:235], v[72:75]
  ds_read_b64_tr_b16 v[16:17], v136 offset:8192
  v_mfma_f32_16x16x32_bf16 v[76:79], v[20:23], v[236:239], v[76:79]
  ds_read_b64_tr_b16 v[18:19], v136 offset:9216
  s_waitcnt lgkmcnt(4)
  v_mfma_f32_16x16x32_bf16 v[80:83], v[24:27], v[232:235], v[80:83]
  ds_read_b64_tr_b16 v[20:21], v137 offset:8192
  v_mfma_f32_16x16x32_bf16 v[84:87], v[24:27], v[236:239], v[84:87]
  ds_read_b64_tr_b16 v[22:23], v137 offset:9216
  s_waitcnt lgkmcnt(4)
  v_mfma_f32_16x16x32_bf16 v[88:91], v[28:31], v[232:235], v[88:91]
  ds_read_b64_tr_b16 v[24:25], v138 offset:8192
  v_mfma_f32_16x16x32_bf16 v[92:95], v[28:31], v[236:239], v[92:95]
  ds_read_b64_tr_b16 v[26:27], v138 offset:9216
  s_waitcnt lgkmcnt(4)
  v_mfma_f32_16x16x32_bf16 v[96:99], v[16:19], v[232:235], v[96:99]
  ds_read_b64_tr_b16 v[28:29], v139 offset:8192
  v_mfma_f32_16x16x32_bf16 v[100:103], v[16:19], v[236:239], v[100:103]
  ds_read_b64_tr_b16 v[30:31], v139 offset:9216
  s_and_b32 s50, s66, 15
  s_lshr_b64 s[66:67], s[66:67], 4
  s_lshl_b32 s50, s50, 14
  v_add_u32 v8, s50, v5
  s_waitcnt lgkmcnt(4)
  v_mfma_f32_16x16x32_bf16 v[104:107], v[20:23], v[232:235], v[104:107]
  v_mfma_f32_16x16x32_bf16 v[108:111], v[20:23], v[236:239], v[108:111]
  s_waitcnt lgkmcnt(0)
  s_barrier
  ds_read_b64_tr_b16 v[16:17], v8 offset:0
  ds_read_b64_tr_b16 v[18:19], v8 offset:1024
  v_mfma_f32_16x16x32_bf16 v[112:115], v[24:27], v[232:235], v[112:115]
  ds_read_b64_tr_b16 v[20:21], v8 offset:8192
  v_mfma_f32_16x16x32_bf16 v[116:119], v[24:27], v[236:239], v[116:119]
  ds_read_b64_tr_b16 v[22:23], v8 offset:9216
  s_branch L_pads13
L_pad13:
  s_setpc_b64 s[60:61]
L_pads13:
  v_mfma_f32_16x16x32_bf16 v[120:123], v[28:31], v[232:235], v[120:123]
  v_xor_b32 v10, 32, v8
  ds_read_b64_tr_b16 v[24:25], v10 offset:0
  v_mfma_f32_16x16x32_bf16 v[124:127], v[28:31], v[236:239], v[124:127]
  ds_read_b64_tr_b16 v[26:27], v10 offset:1024
  s_waitcnt lgkmcnt(4)
  v_mfma_f32_16x16x32_bf16 v[64:67], v[16:19], v[240:243], v[64:67]
  ds_read_b64_tr_b16 v[28:29], v10 offset:8192
  v_mfma_f32_16x16x32_bf16 v[68:71], v[16:19], v[244:247], v[68:71]
  ds_read_b64_tr_b16 v[30:31], v10 offset:9216
  s_waitcnt lgkmcnt(4)
  v_mfma_f32_16x16x32_bf16 v[64:67], v[20:23], v[248:251], v[64:67]
  v_xor_b32 v9, 64, v8
  ds_read_b64_tr_b16 v[16:17], v9 offset:0
  v_mfma_f32_16x16x32_bf16 v[68:71], v[20:23], v[252:255], v[68:71]
  ds_read_b64_tr_b16 v[18:19], v9 offset:1024
  s_waitcnt lgkmcnt(4)
  v_mfma_f32_16x16x32_bf16 v[72:75], v[24:27], v[240:243], v[72:75]
  ds_read_b64_tr_b16 v[20:21], v9 offset:8192
  v_mfma_f32_16x16x32_bf16 v[76:79], v[24:27], v[244:247], v[76:79]
  ds_read_b64_tr_b16 v[22:23], v9 offset:9216
  s_waitcnt lgkmcnt(4)
  v_mfma_f32_16x16x32_bf16 v[72:75], v[28:31], v[248:251], v[72:75]
  v_xor_b32 v10, 96, v8
  ds_read_b64_tr_b16 v[24:25], v10 offset:0
  v_mfma_f32_16x16x32_bf16 v[76:79], v[28:31], v[252:255], v[76:79]
  ds_read_b64_tr_b16 v[26:27], v10 offset:1024
  s_waitcnt lgkmcnt(4)
  v_mfma_f32_16x16x32_bf16 v[80:83], v[16:19], v[240:243], v[80:83]
  ds_read_b64_tr_b16 v[28:29], v10 offset:8192
  v_mfma_f32_16x16x32_bf16 v[84:87], v[16:19], v[244:247], v[84:87]
  ds_read_b64_tr_b16 v[30:31], v10 offset:9216
  s_waitcnt lgkmcnt(4)
  v_mfma_f32_16x16x32_bf16 v[80:83], v[20:23], v[248:251], v[80:83]
  v_xor_b32 v9, 128, v8
  ds_read_b64_tr_b16 v[16:17], v9 offset:0
  v_mfma_f32_16x16x32_bf16 v[84:87], v[20:23], v[252:255], v[84:87]
  ds_read_b64_tr_b16 v[18:19], v9 offset:1024
  s_waitcnt lgkmcnt(4)
  v_mfma_f32_16x16x32_bf16 v[88:91], v[24:27], v[240:243], v[88:91]
  ds_read_b64_tr_b16 v[20:21], v9 offset:8192
  v_mfma_f32_16x16x32_bf16 v[92:95], v[24:27], v[244:247], v[92:95]
  ds_read_b64_tr_b16 v[22:23], v9 offset:9216
  s_waitcnt lgkmcnt(4)
  v_mfma_f32_16x16x32_bf16 v[88:91], v[28:31], v[248:251], v[88:91]
  v_xor_b32 v10, 160, v8
  ds_read_b64_tr_b16 v[24:25], v10 offset:0
  v_mul_f32 v64, s72, v64
  v_mul_f32 v65, s72, v65
  v_mul_f32 v66, s72, v66
  v_mfma_f32_16x16x32_bf16 v[92:95], v[28:31], v[252:255], v[92:95]
  ds_read_b64_tr_b16 v[26:27], v10 offset:1024
  v_mul_f32 v67, s72, v67
  v_mul_f32 v68, s72, v68
  v_mul_f32 v69, s72, v69
  v_mul_f32 v70, s72, v70
  s_barrier
  s_waitcnt lgkmcnt(4)
  v_mfma_f32_16x16x32_bf16 v[96:99], v[16:19], v[240:243], v[96:99]
  ds_read_b64_tr_b16 v[28:29], v10 offset:8192
  v_mul_f32 v71, s72, v71
  v_mul_f32 v72, s72, v72
  v_mul_f32 v73, s72, v73
  v_mul_f32 v74, s72, v74
  v_mfma_f32_16x16x32_bf16 v[100:103], v[16:19], v[244:247], v[100:103]
  ds_read_b64_tr_b16 v[30:31], v10 offset:9216
  v_mul_f32 v75, s72, v75
  v_mul_f32 v76, s72, v76
  v_mul_f32 v77, s72, v77
  s_waitcnt lgkmcnt(4)
  v_mfma_f32_16x16x32_bf16 v[96:99], v[20:23], v[248:251], v[96:99]
  v_xor_b32 v9, 192, v8
  ds_read_b64_tr_b16 v[16:17], v9 offset:0
  v_mul_f32 v78, s72, v78
  v_mul_f32 v79, s72, v79
  v_cvt_pk_bf16_f32 v64, v64, v65
  v_mfma_f32_16x16x32_bf16 v[100:103], v[20:23], v[252:255], v[100:103]
  ds_read_b64_tr_b16 v[18:19], v9 offset:1024
  v_cvt_pk_bf16_f32 v65, v66, v67
  v_cvt_pk_bf16_f32 v66, v72, v73
  v_cvt_pk_bf16_f32 v67, v74, v75
  v_cvt_pk_bf16_f32 v68, v68, v69
  s_waitcnt lgkmcnt(4)
  v_mfma_f32_16x16x32_bf16 v[104:107], v[24:27], v[240:243], v[104:107]
  ds_read_b64_tr_b16 v[20:21], v9 offset:8192
  v_cvt_pk_bf16_f32 v69, v70, v71
  v_cvt_pk_bf16_f32 v70, v76, v77
  v_cvt_pk_bf16_f32 v71, v78, v79
  v_permlane16_swap_b32 v64, v66
  v_mfma_f32_16x16x32_bf16 v[108:111], v[24:27], v[244:247], v[108:111]
  ds_read_b64_tr_b16 v[22:23], v9 offset:9216
  v_permlane16_swap_b32 v65, v67
  v_permlane16_swap_b32 v68, v70
  v_permlane16_swap_b32 v69, v71
  s_waitcnt lgkmcnt(4)
  v_mfma_f32_16x16x32_bf16 v[104:107], v[28:31], v[248:251], v[104:107]
  v_xor_b32 v10, 224, v8
  ds_read_b64_tr_b16 v[24:25], v10 offset:0
  v_mul_f32 v80, s72, v80
  v_mul_f32 v81, s72, v81
  v_mul_f32 v82, s72, v82
  v_mul_f32 v83, s72, v83
  v_mfma_f32_16x16x32_bf16 v[108:111], v[28:31], v[252:255], v[108:111]
  ds_read_b64_tr_b16 v[26:27], v10 offset:1024
  v_mul_f32 v84, s72, v84
  v_mul_f32 v85, s72, v85
  v_mul_f32 v86, s72, v86
  v_mul_f32 v87, s72, v87
  v_mul_f32 v88, s72, v88
  s_waitcnt lgkmcnt(4)
  v_mfma_f32_16x16x32_bf16 v[112:115], v[16:19], v[240:243], v[112:115]
  ds_read_b64_tr_b16 v[28:29], v10 offset:8192
  v_mul_f32 v89, s72, v89
  v_mul_f32 v90, s72, v90
  v_mul_f32 v91, s72, v91
  v_mul_f32 v92, s72, v92
  v_mul_f32 v93, s72, v93
  v_mfma_f32_16x16x32_bf16 v[116:119], v[16:19], v[244:247], v[116:119]
  ds_read_b64_tr_b16 v[30:31], v10 offset:9216
  v_mul_f32 v94, s72, v94
  v_mul_f32 v95, s72, v95
  v_cvt_pk_bf16_f32 v72, v80, v81
  v_cvt_pk_bf16_f32 v73, v82, v83
  s_and_b32 s50, s68, 15
  s_lshr_b64 s[68:69], s[68:69], 4
  s_lshl_b32 s50, s50, 14
  v_add_u32 v8, s50, v6
  s_waitcnt lgkmcnt(4)
  v_mfma_f32_16x16x32_bf16 v[112:115], v[20:23], v[248:251], v[112:115]
  v_cvt_pk_bf16_f32 v74, v88, v89
  v_cvt_pk_bf16_f32 v75, v90, v91
  v_cvt_pk_bf16_f32 v76, v84, v85
  v_cvt_pk_bf16_f32 v77, v86, v87
  v_cvt_pk_bf16_f32 v78, v92, v93
  v_cvt_pk_bf16_f32 v79, v94, v95
  v_mfma_f32_16x16x32_bf16 v[116:119], v[20:23], v[252:255], v[116:119]
  v_permlane16_swap_b32 v72, v74
  v_permlane16_swap_b32 v73, v75
  v_permlane16_swap_b32 v76, v78
  v_permlane16_swap_b32 v77, v79
  s_waitcnt lgkmcnt(0)
  s_barrier
  v_mfma_f32_16x16x32_bf16 v[120:123], v[24:27], v[240:243], v[120:123]
  v_mul_f32 v96, s72, v96
  v_mul_f32 v97, s72, v97
  v_mul_f32 v98, s72, v98
  v_mul_f32 v99, s72, v99
  v_mul_f32 v100, s72, v100
  v_mul_f32 v101, s72, v101
  v_mul_f32 v102, s72, v102
  v_mul_f32 v103, s72, v103
  v_mfma_f32_16x16x32_bf16 v[124:127], v[24:27], v[244:247], v[124:127]
  v_mul_f32 v104, s72, v104
  v_mul_f32 v105, s72, v105
  v_mul_f32 v106, s72, v106
  v_mul_f32 v107, s72, v107
  v_mul_f32 v108, s72, v108
  v_mul_f32 v109, s72, v109
  v_mul_f32 v110, s72, v110
  v_mfma_f32_16x16x32_bf16 v[120:123], v[28:31], v[248:251], v[120:123]
  v_mul_f32 v111, s72, v111
  v_cvt_pk_bf16_f32 v80, v96, v97
  v_cvt_pk_bf16_f32 v81, v98, v99
  v_cvt_pk_bf16_f32 v82, v104, v105
  v_cvt_pk_bf16_f32 v83, v106, v107
  v_cvt_pk_bf16_f32 v84, v100, v101
  v_mfma_f32_16x16x32_bf16 v[124:127], v[28:31], v[252:255], v[124:127]
  v_cvt_pk_bf16_f32 v85, v102, v103
  v_cvt_pk_bf16_f32 v86, v108, v109
  v_cvt_pk_bf16_f32 v87, v110, v111
  v_permlane16_swap_b32 v80, v82
  v_permlane16_swap_b32 v81, v83
  v_permlane16_swap_b32 v84, v86
  v_permlane16_swap_b32 v85, v87
  v_mul_f32 v112, s72, v112
  v_mul_f32 v113, s72, v113
  v_mul_f32 v114, s72, v114
  v_mul_f32 v115, s72, v115
  v_mul_f32 v116, s72, v116
  v_mul_f32 v117, s72, v117
  v_mul_f32 v118, s72, v118
  v_mul_f32 v119, s72, v119
  v_mul_f32 v120, s72, v120
  v_mul_f32 v121, s72, v121
  v_mul_f32 v122, s72, v122
  v_mul_f32 v123, s72, v123
  v_mul_f32 v124, s72, v124
  v_mul_f32 v125, s72, v125
  v_mul_f32 v126, s72, v126
  v_mul_f32 v127, s72, v127
  v_cvt_pk_bf16_f32 v88, v112, v113
  v_cvt_pk_bf16_f32 v89, v114, v115
  v_cvt_pk_bf16_f32 v90, v120, v121
  v_cvt_pk_bf16_f32 v91, v122, v123
  v_cvt_pk_bf16_f32 v92, v116, v117
  v_cvt_pk_bf16_f32 v93, v118, v119
  v_cvt_pk_bf16_f32 v94, v124, v125
  v_cvt_pk_bf16_f32 v95, v126, v127
  v_permlane16_swap_b32 v88, v90
  v_permlane16_swap_b32 v89, v91
  v_permlane16_swap_b32 v92, v94
  v_permlane16_swap_b32 v93, v95
  s_waitcnt vmcnt(0)
  s_setprio 2
  s_barrier
  ds_read_b128 v[16:19], v8 offset:0
  ds_read_b128 v[20:23], v8 offset:2048
  v_xor_b32 v10, 64, v8
  ds_read_b128 v[24:27], v10 offset:0
  s_waitcnt lgkmcnt(2)
  v_mfma_f32_16x16x32_bf16 v[144:147], v[16:19], v[32:35], 0
  ds_read_b128 v[28:31], v10 offset:2048
  v_mfma_f32_16x16x32_bf16 v[148:151], v[16:19], v[36:39], 0
  s_waitcnt lgkmcnt(2)
  v_mfma_f32_16x16x32_bf16 v[152:155], v[20:23], v[32:35], 0
  v_xor_b32 v9, 128, v8
  v_mfma_f32_16x16x32_bf16 v[156:159], v[20:23], v[36:39], 0
  ds_read_b128 v[16:19], v9 offset:0
  s_waitcnt lgkmcnt(1)
  v_mfma_f32_16x16x32_bf16 v[144:147], v[24:27], v[40:43], v[144:147]
  ds_read_b128 v[20:23], v9 offset:2048
  v_mfma_f32_16x16x32_bf16 v[148:151], v[24:27], v[44:47], v[148:151]
  v_mfma_f32_16x16x32_bf16 v[152:155], v[28:31], v[40:43], v[152:155]
  v_xor_b32 v10, 192, v8
  v_mfma_f32_16x16x32_bf16 v[156:159], v[28:31], v[44:47], v[156:159]
  ds_read_b128 v[24:27], v10 offset:0
  s_waitcnt lgkmcnt(1)
  v_mfma_f32_16x16x32_bf16 v[144:147], v[16:19], v[48:51], v[144:147]
  ds_read_b128 v[28:31], v10 offset:2048
  v_mfma_f32_16x16x32_bf16 v[148:151], v[16:19], v[52:55], v[148:151]
  v_mfma_f32_16x16x32_bf16 v[152:155], v[20:23], v[48:51], v[152:155]
  ds_read_b128 v[16:19], v8 offset:256
  v_mfma_f32_16x16x32_bf16 v[156:159], v[20:23], v[52:55], v[156:159]
  s_waitcnt lgkmcnt(1)
  v_mfma_f32_16x16x32_bf16 v[144:147], v[24:27], v[56:59], v[144:147]
  ds_read_b128 v[20:23], v8 offset:2304
  v_mfma_f32_16x16x32_bf16 v[148:151], v[24:27], v[60:63], v[148:151]
  v_mfma_f32_16x16x32_bf16 v[152:155], v[28:31], v[56:59], v[152:155]
  v_xor_b32 v10, 64, v8
  v_mfma_f32_16x16x32_bf16 v[156:159], v[28:31], v[60:63], v[156:159]
  ds_read_b128 v[24:27], v10 offset:256
  s_waitcnt lgkmcnt(1)
  v_mfma_f32_16x16x32_bf16 v[144:147], v[16:19], v[64:67], v[144:147]
  ds_read_b128 v[28:31], v10 offset:2304
  v_mfma_f32_16x16x32_bf16 v[148:151], v[16:19], v[68:71], v[148:151]
  v_mfma_f32_16x16x32_bf16 v[152:155], v[20:23], v[64:67], v[152:155]
  v_xor_b32 v9, 128, v8
  v_mfma_f32_16x16x32_bf16 v[156:159], v[20:23], v[68:71], v[156:159]
  ds_read_b128 v[16:19], v9 offset:256
  s_waitcnt lgkmcnt(1)
  v_mfma_f32_16x16x32_bf16 v[144:147], v[24:27], v[72:75], v[144:147]
  ds_read_b128 v[20:23], v9 offset:2304
  v_mfma_f32_16x16x32_bf16 v[148:151], v[24:27], v[76:79], v[148:151]
  v_mfma_f32_16x16x32_bf16 v[152:155], v[28:31], v[72:75], v[152:155]
  v_xor_b32 v10, 192, v8
  v_mfma_f32_16x16x32_bf16 v[156:159], v[28:31], v[76:79], v[156:159]
  ds_read_b128 v[24:27], v10 offset:256
  s_waitcnt lgkmcnt(1)
  v_mfma_f32_16x16x32_bf16 v[144:147], v[16:19], v[80:83], v[144:147]
  ds_read_b128 v[28:31], v10 offset:2304
  v_mfma_f32_16x16x32_bf16 v[148:151], v[16:19], v[84:87], v[148:151]
  s_and_b32 s50, s68, 15
  s_lshr_b64 s[68:69], s[68:69], 4
  s_lshl_b32 s50, s50, 14
  v_add_u32 v8, s50, v6
  v_mfma_f32_16x16x32_bf16 v[152:155], v[20:23], v[80:83], v[152:155]
  v_mfma_f32_16x16x32_bf16 v[156:159], v[20:23], v[84:87], v[156:159]
  s_waitcnt lgkmcnt(0)
  s_branch L_join
L_rescue:
  s_nop 15
  s_bitcmp1_b32 s82, 0
  s_cbranch_scc1 L_rs1
  v_max3_f32 v12, v96, v97, v98
  v_max3_f32 v12, v12, v99, v104
  v_max3_f32 v12, v12, v105, v106
  v_max_f32 v12, v12, v107
  v_max3_f32 v7, v100, v101, v102
  v_max3_f32 v7, v7, v103, v108
  v_max3_f32 v7, v7, v109, v110
  v_max_f32 v7, v7, v111
  s_branch L_rs2
L_rs1:
  v_max3_f32 v12, v112, v113, v114
  v_max3_f32 v12, v12, v115, v120
  v_max3_f32 v12, v12, v121, v122
  v_max_f32 v12, v12, v123
  v_max3_f32 v7, v116, v117, v118
  v_max3_f32 v7, v7, v119, v124
  v_max3_f32 v7, v7, v125, v126
  v_max_f32 v7, v7, v127
L_rs2:
  v_mov_b32 v3, v12
  s_nop 1
  v_permlane16_swap_b32 v12, v3
  v_max_f32 v12, v12, v3
  v_mov_b32 v3, v12
  s_nop 1
  v_permlane32_swap_b32 v12, v3
  v_max_f32 v12, v12, v3
  v_max_f32 v12, 0, v12
  v_ceil_f32 v12, v12
  v_sub_f32 v96, v96, v12
  v_sub_f32 v97, v97, v12
  v_sub_f32 v98, v98, v12
  v_sub_f32 v99, v99, v12
  v_sub_f32 v104, v104, v12
  v_sub_f32 v105, v105, v12
  v_sub_f32 v106, v106, v12
  v_sub_f32 v107, v107, v12
  v_sub_f32 v112, v112, v12
  v_sub_f32 v113, v113, v12
  v_sub_f32 v114, v114, v12
  v_sub_f32 v115, v115, v12
  v_sub_f32 v120, v120, v12
  v_sub_f32 v121, v121, v12
  v_sub_f32 v122, v122, v12
  v_sub_f32 v123, v123, v12
  v_sub_f32 v248, v248, v12
  v_sub_f32 v249, v249, v12
  v_sub_f32 v250, v250, v12
  v_sub_f32 v251, v251, v12
  v_sub_f32 v12, 0, v12
  v_exp_f32 v12, v12
  v_mov_b32 v3, v7
  s_nop 1
  v_permlane16_swap_b32 v7, v3
  v_max_f32 v7, v7, v3
  v_mov_b32 v3, v7
  s_nop 1
  v_permlane32_swap_b32 v7, v3
  v_max_f32 v7, v7, v3
  v_max_f32 v7, 0, v7
  v_ceil_f32 v7, v7
  v_sub_f32 v100, v100, v7
  v_sub_f32 v101, v101, v7
  v_sub_f32 v102, v102, v7
  v_sub_f32 v103, v103, v7
  v_sub_f32 v108, v108, v7
  v_sub_f32 v109, v109, v7
  v_sub_f32 v110, v110, v7
  v_sub_f32 v111, v111, v7
  v_sub_f32 v116, v116, v7
  v_sub_f32 v117, v117, v7
  v_sub_f32 v118, v118, v7
  v_sub_f32 v119, v119, v7
  v_sub_f32 v124, v124, v7
  v_sub_f32 v125, v125, v7
  v_sub_f32 v126, v126, v7
  v_sub_f32 v127, v127, v7
  v_sub_f32 v252, v252, v7
  v_sub_f32 v253, v253, v7
  v_sub_f32 v254, v254, v7
  v_sub_f32 v255, v255, v7
  v_sub_f32 v7, 0, v7
  v_exp_f32 v7, v7
  v_lshlrev_b32 v3, 16, v128
  v_and_b32 v4, s83, v128
  v_mul_f32 v3, v3, v12
  v_mul_f32 v4, v4, v12
  v_cvt_pk_bf16_f32 v128, v3, v4
  v_lshlrev_b32 v3, 16, v129
  v_and_b32 v4, s83, v129
  v_mul_f32 v3, v3, v12
  v_mul_f32 v4, v4, v12
  v_cvt_pk_bf16_f32 v129, v3, v4
  v_lshlrev_b32 v3, 16, v130
  v_and_b32 v4, s83, v130
  v_mul_f32 v3, v3, v12
  v_mul_f32 v4, v4, v12
  v_cvt_pk_bf16_f32 v130, v3, v4
  v_lshlrev_b32 v3, 16, v131
  v_and_b32 v4, s83, v131
  v_mul_f32 v3, v3, v12
  v_mul_f32 v4, v4, v12
  v_cvt_pk_bf16_f32 v131, v3, v4
  v_lshlrev_b32 v3, 16, v132
  v_and_b32 v4, s83, v132
  v_mul_f32 v3, v3, v7
  v_mul_f32 v4, v4, v7
  v_cvt_pk_bf16_f32 v132, v3, v4
  v_lshlrev_b32 v3, 16, v133
  v_and_b32 v4, s83, v133
  v_mul_f32 v3, v3, v7
  v_mul_f32 v4, v4, v7
  v_cvt_pk_bf16_f32 v133, v3, v4
  v_lshlrev_b32 v3, 16, v134
  v_and_b32 v4, s83, v134
  v_mul_f32 v3, v3, v7
  v_mul_f32 v4, v4, v7
  v_cvt_pk_bf16_f32 v134, v3, v4
  v_lshlrev_b32 v3, 16, v135
  v_and_b32 v4, s83, v135
  v_mul_f32 v3, v3, v7
  v_mul_f32 v4, v4, v7
  v_cvt_pk_bf16_f32 v135, v3, v4
  v_lshlrev_b32 v3, 16, v136
  v_and_b32 v4, s83, v136
  v_mul_f32 v3, v3, v12
  v_mul_f32 v4, v4, v12
  v_cvt_pk_bf16_f32 v136, v3, v4
  v_lshlrev_b32 v3, 16, v137
  v_and_b32 v4, s83, v137
  v_mul_f32 v3, v3, v12
  v_mul_f32 v4, v4, v12
  v_cvt_pk_bf16_f32 v137, v3, v4
  v_lshlrev_b32 v3, 16, v138
  v_and_b32 v4, s83, v138
  v_mul_f32 v3, v3, v12
  v_mul_f32 v4, v4, v12
  v_cvt_pk_bf16_f32 v138, v3, v4
  v_lshlrev_b32 v3, 16, v139
  v_and_b32 v4, s83, v139
  v_mul_f32 v3, v3, v12
  v_mul_f32 v4, v4, v12
  v_cvt_pk_bf16_f32 v139, v3, v4
  v_lshlrev_b32 v3, 16, v140
  v_and_b32 v4, s83, v140
  v_mul_f32 v3, v3, v7
  v_mul_f32 v4, v4, v7
  v_cvt_pk_bf16_f32 v140, v3, v4
  v_lshlrev_b32 v3, 16, v141
  v_and_b32 v4, s83, v141
  v_mul_f32 v3, v3, v7
  v_mul_f32 v4, v4, v7
  v_cvt_pk_bf16_f32 v141, v3, v4
  v_lshlrev_b32 v3, 16, v142
  v_and_b32 v4, s83, v142
  v_mul_f32 v3, v3, v7
  v_mul_f32 v4, v4, v7
  v_cvt_pk_bf16_f32 v142, v3, v4
  v_lshlrev_b32 v3, 16, v143
  v_and_b32 v4, s83, v143
  v_mul_f32 v3, v3, v7
  v_mul_f32 v4, v4, v7
  v_cvt_pk_bf16_f32 v143, v3, v4
  v_lshlrev_b32 v3, 16, v144
  v_and_b32 v4, s83, v144
  v_mul_f32 v3, v3, v12
  v_mul_f32 v4, v4, v12
  v_cvt_pk_bf16_f32 v144, v3, v4
  v_lshlrev_b32 v3, 16, v145
  v_and_b32 v4, s83, v145
  v_mul_f32 v3, v3, v12
  v_mul_f32 v4, v4, v12
  v_cvt_pk_bf16_f32 v145, v3, v4
  v_lshlrev_b32 v3, 16, v146
  v_and_b32 v4, s83, v146
  v_mul_f32 v3, v3, v12
  v_mul_f32 v4, v4, v12
  v_cvt_pk_bf16_f32 v146, v3, v4
  v_lshlrev_b32 v3, 16, v147
  v_and_b32 v4, s83, v147
  v_mul_f32 v3, v3, v12
  v_mul_f32 v4, v4, v12
  v_cvt_pk_bf16_f32 v147, v3, v4
  v_lshlrev_b32 v3, 16, v148
  v_and_b32 v4, s83, v148
  v_mul_f32 v3, v3, v7
  v_mul_f32 v4, v4, v7
  v_cvt_pk_bf16_f32 v148, v3, v4
  v_lshlrev_b32 v3, 16, v149
  v_and_b32 v4, s83, v149
  v_mul_f32 v3, v3, v7
  v_mul_f32 v4, v4, v7
  v_cvt_pk_bf16_f32 v149, v3, v4
  v_lshlrev_b32 v3, 16, v150
  v_and_b32 v4, s83, v150
  v_mul_f32 v3, v3, v7
  v_mul_f32 v4, v4, v7
  v_cvt_pk_bf16_f32 v150, v3, v4
  v_lshlrev_b32 v3, 16, v151
  v_and_b32 v4, s83, v151
  v_mul_f32 v3, v3, v7
  v_mul_f32 v4, v4, v7
  v_cvt_pk_bf16_f32 v151, v3, v4
  v_lshlrev_b32 v3, 16, v152
  v_and_b32 v4, s83, v152
  v_mul_f32 v3, v3, v12
  v_mul_f32 v4, v4, v12
  v_cvt_pk_bf16_f32 v152, v3, v4
  v_lshlrev_b32 v3, 16, v153
  v_and_b32 v4, s83, v153
  v_mul_f32 v3, v3, v12
  v_mul_f32 v4, v4, v12
  v_cvt_pk_bf16_f32 v153, v3, v4
  v_lshlrev_b32 v3, 16, v154
  v_and_b32 v4, s83, v154
  v_mul_f32 v3, v3, v12
  v_mul_f32 v4, v4, v12
  v_cvt_pk_bf16_f32 v154, v3, v4
  v_lshlrev_b32 v3, 16, v155
  v_and_b32 v4, s83, v155
  v_mul_f32 v3, v3, v12
  v_mul_f32 v4, v4, v12
  v_cvt_pk_bf16_f32 v155, v3, v4
  v_lshlrev_b32 v3, 16, v156
  v_and_b32 v4, s83, v156
  v_mul_f32 v3, v3, v7
  v_mul_f32 v4, v4, v7
  v_cvt_pk_bf16_f32 v156, v3, v4
  v_lshlrev_b32 v3, 16, v157
  v_and_b32 v4, s83, v157
  v_mul_f32 v3, v3, v7
  v_mul_f32 v4, v4, v7
  v_cvt_pk_bf16_f32 v157, v3, v4
  v_lshlrev_b32 v3, 16, v158
  v_and_b32 v4, s83, v158
  v_mul_f32 v3, v3, v7
  v_mul_f32 v4, v4, v7
  v_cvt_pk_bf16_f32 v158, v3, v4
  v_lshlrev_b32 v3, 16, v159
  v_and_b32 v4, s83, v159
  v_mul_f32 v3, v3, v7
  v_mul_f32 v4, v4, v7
  v_cvt_pk_bf16_f32 v159, v3, v4
  v_lshlrev_b32 v3, 16, v160
  v_and_b32 v4, s83, v160
  v_mul_f32 v3, v3, v12
  v_mul_f32 v4, v4, v12
  v_cvt_pk_bf16_f32 v160, v3, v4
  v_lshlrev_b32 v3, 16, v161
  v_and_b32 v4, s83, v161
  v_mul_f32 v3, v3, v12
  v_mul_f32 v4, v4, v12
  v_cvt_pk_bf16_f32 v161, v3, v4
  v_lshlrev_b32 v3, 16, v162
  v_and_b32 v4, s83, v162
  v_mul_f32 v3, v3, v12
  v_mul_f32 v4, v4, v12
  v_cvt_pk_bf16_f32 v162, v3, v4
  v_lshlrev_b32 v3, 16, v163
  v_and_b32 v4, s83, v163
  v_mul_f32 v3, v3, v12
  v_mul_f32 v4, v4, v12
  v_cvt_pk_bf16_f32 v163, v3, v4
  v_lshlrev_b32 v3, 16, v164
  v_and_b32 v4, s83, v164
  v_mul_f32 v3, v3, v7
  v_mul_f32 v4, v4, v7
  v_cvt_pk_bf16_f32 v164, v3, v4
  v_lshlrev_b32 v3, 16, v165
  v_and_b32 v4, s83, v165
  v_mul_f32 v3, v3, v7
  v_mul_f32 v4, v4, v7
  v_cvt_pk_bf16_f32 v165, v3, v4
  v_lshlrev_b32 v3, 16, v166
  v_and_b32 v4, s83, v166
  v_mul_f32 v3, v3, v7
  v_mul_f32 v4, v4, v7
  v_cvt_pk_bf16_f32 v166, v3, v4
  v_lshlrev_b32 v3, 16, v167
  v_and_b32 v4, s83, v167
  v_mul_f32 v3, v3, v7
  v_mul_f32 v4, v4, v7
  v_cvt_pk_bf16_f32 v167, v3, v4
  v_lshlrev_b32 v3, 16, v168
  v_and_b32 v4, s83, v168
  v_mul_f32 v3, v3, v12
  v_mul_f32 v4, v4, v12
  v_cvt_pk_bf16_f32 v168, v3, v4
  v_lshlrev_b32 v3, 16, v169
  v_and_b32 v4, s83, v169
  v_mul_f32 v3, v3, v12
  v_mul_f32 v4, v4, v12
  v_cvt_pk_bf16_f32 v169, v3, v4
  v_lshlrev_b32 v3, 16, v170
  v_and_b32 v4, s83, v170
  v_mul_f32 v3, v3, v12
  v_mul_f32 v4, v4, v12
  v_cvt_pk_bf16_f32 v170, v3, v4
  v_lshlrev_b32 v3, 16, v171
  v_and_b32 v4, s83, v171
  v_mul_f32 v3, v3, v12
  v_mul_f32 v4, v4, v12
  v_cvt_pk_bf16_f32 v171, v3, v4
  v_lshlrev_b32 v3, 16, v172
  v_and_b32 v4, s83, v172
  v_mul_f32 v3, v3, v7
  v_mul_f32 v4, v4, v7
  v_cvt_pk_bf16_f32 v172, v3, v4
  v_lshlrev_b32 v3, 16, v173
  v_and_b32 v4, s83, v173
  v_mul_f32 v3, v3, v7
  v_mul_f32 v4, v4, v7
  v_cvt_pk_bf16_f32 v173, v3, v4
  v_lshlrev_b32 v3, 16, v174
  v_and_b32 v4, s83, v174
  v_mul_f32 v3, v3, v7
  v_mul_f32 v4, v4, v7
  v_cvt_pk_bf16_f32 v174, v3, v4
  v_lshlrev_b32 v3, 16, v175
  v_and_b32 v4, s83, v175
  v_mul_f32 v3, v3, v7
  v_mul_f32 v4, v4, v7
  v_cvt_pk_bf16_f32 v175, v3, v4
  v_lshlrev_b32 v3, 16, v176
  v_and_b32 v4, s83, v176
  v_mul_f32 v3, v3, v12
  v_mul_f32 v4, v4, v12
  v_cvt_pk_bf16_f32 v176, v3, v4
  v_lshlrev_b32 v3, 16, v177
  v_and_b32 v4, s83, v177
  v_mul_f32 v3, v3, v12
  v_mul_f32 v4, v4, v12
  v_cvt_pk_bf16_f32 v177, v3, v4
  v_lshlrev_b32 v3, 16, v178
  v_and_b32 v4, s83, v178
  v_mul_f32 v3, v3, v12
  v_mul_f32 v4, v4, v12
  v_cvt_pk_bf16_f32 v178, v3, v4
  v_lshlrev_b32 v3, 16, v179
  v_and_b32 v4, s83, v179
  v_mul_f32 v3, v3, v12
  v_mul_f32 v4, v4, v12
  v_cvt_pk_bf16_f32 v179, v3, v4
  v_lshlrev_b32 v3, 16, v180
  v_and_b32 v4, s83, v180
  v_mul_f32 v3, v3, v7
  v_mul_f32 v4, v4, v7
  v_cvt_pk_bf16_f32 v180, v3, v4
  v_lshlrev_b32 v3, 16, v181
  v_and_b32 v4, s83, v181
  v_mul_f32 v3, v3, v7
  v_mul_f32 v4, v4, v7
  v_cvt_pk_bf16_f32 v181, v3, v4
  v_lshlrev_b32 v3, 16, v182
  v_and_b32 v4, s83, v182
  v_mul_f32 v3, v3, v7
  v_mul_f32 v4, v4, v7
  v_cvt_pk_bf16_f32 v182, v3, v4
  v_lshlrev_b32 v3, 16, v183
  v_and_b32 v4, s83, v183
  v_mul_f32 v3, v3, v7
  v_mul_f32 v4, v4, v7
  v_cvt_pk_bf16_f32 v183, v3, v4
  v_lshlrev_b32 v3, 16, v184
  v_and_b32 v4, s83, v184
  v_mul_f32 v3, v3, v12
  v_mul_f32 v4, v4, v12
  v_cvt_pk_bf16_f32 v184, v3, v4
  v_lshlrev_b32 v3, 16, v185
  v_and_b32 v4, s83, v185
  v_mul_f32 v3, v3, v12
  v_mul_f32 v4, v4, v12
  v_cvt_pk_bf16_f32 v185, v3, v4
  v_lshlrev_b32 v3, 16, v186
  v_and_b32 v4, s83, v186
  v_mul_f32 v3, v3, v12
  v_mul_f32 v4, v4, v12
  v_cvt_pk_bf16_f32 v186, v3, v4
  v_lshlrev_b32 v3, 16, v187
  v_and_b32 v4, s83, v187
  v_mul_f32 v3, v3, v12
  v_mul_f32 v4, v4, v12
  v_cvt_pk_bf16_f32 v187, v3, v4
  v_lshlrev_b32 v3, 16, v188
  v_and_b32 v4, s83, v188
  v_mul_f32 v3, v3, v7
  v_mul_f32 v4, v4, v7
  v_cvt_pk_bf16_f32 v188, v3, v4
  v_lshlrev_b32 v3, 16, v189
  v_and_b32 v4, s83, v189
  v_mul_f32 v3, v3, v7
  v_mul_f32 v4, v4, v7
  v_cvt_pk_bf16_f32 v189, v3, v4
  v_lshlrev_b32 v3, 16, v190
  v_and_b32 v4, s83, v190
  v_mul_f32 v3, v3, v7
  v_mul_f32 v4, v4, v7
  v_cvt_pk_bf16_f32 v190, v3, v4
  v_lshlrev_b32 v3, 16, v191
  v_and_b32 v4, s83, v191
  v_mul_f32 v3, v3, v7
  v_mul_f32 v4, v4, v7
  v_cvt_pk_bf16_f32 v191, v3, v4
  v_lshlrev_b32 v3, 16, v192
  v_and_b32 v4, s83, v192
  v_mul_f32 v3, v3, v12
  v_mul_f32 v4, v4, v12
  v_cvt_pk_bf16_f32 v192, v3, v4
  v_lshlrev_b32 v3, 16, v193
  v_and_b32 v4, s83, v193
  v_mul_f32 v3, v3, v12
  v_mul_f32 v4, v4, v12
  v_cvt_pk_bf16_f32 v193, v3, v4
  v_lshlrev_b32 v3, 16, v194
  v_and_b32 v4, s83, v194
  v_mul_f32 v3, v3, v12
  v_mul_f32 v4, v4, v12
  v_cvt_pk_bf16_f32 v194, v3, v4
  v_lshlrev_b32 v3, 16, v195
  v_and_b32 v4, s83, v195
  v_mul_f32 v3, v3, v12
  v_mul_f32 v4, v4, v12
  v_cvt_pk_bf16_f32 v195, v3, v4
  v_lshlrev_b32 v3, 16, v196
  v_and_b32 v4, s83, v196
  v_mul_f32 v3, v3, v7
  v_mul_f32 v4, v4, v7
  v_cvt_pk_bf16_f32 v196, v3, v4
  v_lshlrev_b32 v3, 16, v197
  v_and_b32 v4, s83, v197
  v_mul_f32 v3, v3, v7
  v_mul_f32 v4, v4, v7
  v_cvt_pk_bf16_f32 v197, v3, v4
  v_lshlrev_b32 v3, 16, v198
  v_and_b32 v4, s83, v198
  v_mul_f32 v3, v3, v7
  v_mul_f32 v4, v4, v7
  v_cvt_pk_bf16_f32 v198, v3, v4
  v_lshlrev_b32 v3, 16, v199
  v_and_b32 v4, s83, v199
  v_mul_f32 v3, v3, v7
  v_mul_f32 v4, v4, v7
  v_cvt_pk_bf16_f32 v199, v3, v4
  v_lshlrev_b32 v3, 16, v200
  v_and_b32 v4, s83, v200
  v_mul_f32 v3, v3, v12
  v_mul_f32 v4, v4, v12
  v_cvt_pk_bf16_f32 v200, v3, v4
  v_lshlrev_b32 v3, 16, v201
  v_and_b32 v4, s83, v201
  v_mul_f32 v3, v3, v12
  v_mul_f32 v4, v4, v12
  v_cvt_pk_bf16_f32 v201, v3, v4
  v_lshlrev_b32 v3, 16, v202
  v_and_b32 v4, s83, v202
  v_mul_f32 v3, v3, v12
  v_mul_f32 v4, v4, v12
  v_cvt_pk_bf16_f32 v202, v3, v4
  v_lshlrev_b32 v3, 16, v203
  v_and_b32 v4, s83, v203
  v_mul_f32 v3, v3, v12
  v_mul_f32 v4, v4, v12
  v_cvt_pk_bf16_f32 v203, v3, v4
  v_lshlrev_b32 v3, 16, v204
  v_and_b32 v4, s83, v204
  v_mul_f32 v3, v3, v7
  v_mul_f32 v4, v4, v7
  v_cvt_pk_bf16_f32 v204, v3, v4
  v_lshlrev_b32 v3, 16, v205
  v_and_b32 v4, s83, v205
  v_mul_f32 v3, v3, v7
  v_mul_f32 v4, v4, v7
  v_cvt_pk_bf16_f32 v205, v3, v4
  v_lshlrev_b32 v3, 16, v206
  v_and_b32 v4, s83, v206
  v_mul_f32 v3, v3, v7
  v_mul_f32 v4, v4, v7
  v_cvt_pk_bf16_f32 v206, v3, v4
  v_lshlrev_b32 v3, 16, v207
  v_and_b32 v4, s83, v207
  v_mul_f32 v3, v3, v7
  v_mul_f32 v4, v4, v7
  v_cvt_pk_bf16_f32 v207, v3, v4
  v_lshlrev_b32 v3, 16, v208
  v_and_b32 v4, s83, v208
  v_mul_f32 v3, v3, v12
  v_mul_f32 v4, v4, v12
  v_cvt_pk_bf16_f32 v208, v3, v4
  v_lshlrev_b32 v3, 16, v209
  v_and_b32 v4, s83, v209
  v_mul_f32 v3, v3, v12
  v_mul_f32 v4, v4, v12
  v_cvt_pk_bf16_f32 v209, v3, v4
  v_lshlrev_b32 v3, 16, v210
  v_and_b32 v4, s83, v210
  v_mul_f32 v3, v3, v12
  v_mul_f32 v4, v4, v12
  v_cvt_pk_bf16_f32 v210, v3, v4
  v_lshlrev_b32 v3, 16, v211
  v_and_b32 v4, s83, v211
  v_mul_f32 v3, v3, v12
  v_mul_f32 v4, v4, v12
  v_cvt_pk_bf16_f32 v211, v3, v4
  v_lshlrev_b32 v3, 16, v212
  v_and_b32 v4, s83, v212
  v_mul_f32 v3, v3, v7
  v_mul_f32 v4, v4, v7
  v_cvt_pk_bf16_f32 v212, v3, v4
  s_branch L_pads14
L_pad14:
  s_setpc_b64 s[60:61]
L_pads14:
  v_lshlrev_b32 v3, 16, v213
  v_and_b32 v4, s83, v213
  v_mul_f32 v3, v3, v7
  v_mul_f32 v4, v4, v7
  v_cvt_pk_bf16_f32 v213, v3, v4
  v_lshlrev_b32 v3, 16, v214
  v_and_b32 v4, s83, v214
  v_mul_f32 v3, v3, v7
  v_mul_f32 v4, v4, v7
  v_cvt_pk_bf16_f32 v214, v3, v4
  v_lshlrev_b32 v3, 16, v215
  v_and_b32 v4, s83, v215
  v_mul_f32 v3, v3, v7
  v_mul_f32 v4, v4, v7
  v_cvt_pk_bf16_f32 v215, v3, v4
  v_lshlrev_b32 v3, 16, v216
  v_and_b32 v4, s83, v216
  v_mul_f32 v3, v3, v12
  v_mul_f32 v4, v4, v12
  v_cvt_pk_bf16_f32 v216, v3, v4
  v_lshlrev_b32 v3, 16, v217
  v_and_b32 v4, s83, v217
  v_mul_f32 v3, v3, v12
  v_mul_f32 v4, v4, v12
  v_cvt_pk_bf16_f32 v217, v3, v4
  v_lshlrev_b32 v3, 16, v218
  v_and_b32 v4, s83, v218
  v_mul_f32 v3, v3, v12
  v_mul_f32 v4, v4, v12
  v_cvt_pk_bf16_f32 v218, v3, v4
  v_lshlrev_b32 v3, 16, v219
  v_and_b32 v4, s83, v219
  v_mul_f32 v3, v3, v12
  v_mul_f32 v4, v4, v12
  v_cvt_pk_bf16_f32 v219, v3, v4
  v_lshlrev_b32 v3, 16, v220
  v_and_b32 v4, s83, v220
  v_mul_f32 v3, v3, v7
  v_mul_f32 v4, v4, v7
  v_cvt_pk_bf16_f32 v220, v3, v4
  v_lshlrev_b32 v3, 16, v221
  v_and_b32 v4, s83, v221
  v_mul_f32 v3, v3, v7
  v_mul_f32 v4, v4, v7
  v_cvt_pk_bf16_f32 v221, v3, v4
  v_lshlrev_b32 v3, 16, v222
  v_and_b32 v4, s83, v222
  v_mul_f32 v3, v3, v7
  v_mul_f32 v4, v4, v7
  v_cvt_pk_bf16_f32 v222, v3, v4
  v_lshlrev_b32 v3, 16, v223
  v_and_b32 v4, s83, v223
  v_mul_f32 v3, v3, v7
  v_mul_f32 v4, v4, v7
  v_cvt_pk_bf16_f32 v223, v3, v4
  v_lshlrev_b32 v3, 16, v224
  v_and_b32 v4, s83, v224
  v_mul_f32 v3, v3, v12
  v_mul_f32 v4, v4, v12
  v_cvt_pk_bf16_f32 v224, v3, v4
  v_lshlrev_b32 v3, 16, v225
  v_and_b32 v4, s83, v225
  v_mul_f32 v3, v3, v12
  v_mul_f32 v4, v4, v12
  v_cvt_pk_bf16_f32 v225, v3, v4
  v_lshlrev_b32 v3, 16, v226
  v_and_b32 v4, s83, v226
  v_mul_f32 v3, v3, v12
  v_mul_f32 v4, v4, v12
  v_cvt_pk_bf16_f32 v226, v3, v4
  v_lshlrev_b32 v3, 16, v227
  v_and_b32 v4, s83, v227
  v_mul_f32 v3, v3, v12
  v_mul_f32 v4, v4, v12
  v_cvt_pk_bf16_f32 v227, v3, v4
  v_lshlrev_b32 v3, 16, v228
  v_and_b32 v4, s83, v228
  v_mul_f32 v3, v3, v7
  v_mul_f32 v4, v4, v7
  v_cvt_pk_bf16_f32 v228, v3, v4
  v_lshlrev_b32 v3, 16, v229
  v_and_b32 v4, s83, v229
  v_mul_f32 v3, v3, v7
  v_mul_f32 v4, v4, v7
  v_cvt_pk_bf16_f32 v229, v3, v4
  v_lshlrev_b32 v3, 16, v230
  v_and_b32 v4, s83, v230
  v_mul_f32 v3, v3, v7
  v_mul_f32 v4, v4, v7
  v_cvt_pk_bf16_f32 v230, v3, v4
  v_lshlrev_b32 v3, 16, v231
  v_and_b32 v4, s83, v231
  v_mul_f32 v3, v3, v7
  v_mul_f32 v4, v4, v7
  v_cvt_pk_bf16_f32 v231, v3, v4
  v_lshlrev_b32 v3, 16, v232
  v_and_b32 v4, s83, v232
  v_mul_f32 v3, v3, v12
  v_mul_f32 v4, v4, v12
  v_cvt_pk_bf16_f32 v232, v3, v4
  v_lshlrev_b32 v3, 16, v233
  v_and_b32 v4, s83, v233
  v_mul_f32 v3, v3, v12
  v_mul_f32 v4, v4, v12
  v_cvt_pk_bf16_f32 v233, v3, v4
  v_lshlrev_b32 v3, 16, v234
  v_and_b32 v4, s83, v234
  v_mul_f32 v3, v3, v12
  v_mul_f32 v4, v4, v12
  v_cvt_pk_bf16_f32 v234, v3, v4
  v_lshlrev_b32 v3, 16, v235
  v_and_b32 v4, s83, v235
  v_mul_f32 v3, v3, v12
  v_mul_f32 v4, v4, v12
  v_cvt_pk_bf16_f32 v235, v3, v4
  v_lshlrev_b32 v3, 16, v236
  v_and_b32 v4, s83, v236
  v_mul_f32 v3, v3, v7
  v_mul_f32 v4, v4, v7
  v_cvt_pk_bf16_f32 v236, v3, v4
  v_lshlrev_b32 v3, 16, v237
  v_and_b32 v4, s83, v237
  v_mul_f32 v3, v3, v7
  v_mul_f32 v4, v4, v7
  v_cvt_pk_bf16_f32 v237, v3, v4
  v_lshlrev_b32 v3, 16, v238
  v_and_b32 v4, s83, v238
  v_mul_f32 v3, v3, v7
  v_mul_f32 v4, v4, v7
  v_cvt_pk_bf16_f32 v238, v3, v4
  v_lshlrev_b32 v3, 16, v239
  v_and_b32 v4, s83, v239
  v_mul_f32 v3, v3, v7
  v_mul_f32 v4, v4, v7
  v_cvt_pk_bf16_f32 v239, v3, v4
  v_lshlrev_b32 v3, 16, v240
  v_and_b32 v4, s83, v240
  v_mul_f32 v3, v3, v12
  v_mul_f32 v4, v4, v12
  v_cvt_pk_bf16_f32 v240, v3, v4
  v_lshlrev_b32 v3, 16, v241
  v_and_b32 v4, s83, v241
  v_mul_f32 v3, v3, v12
  v_mul_f32 v4, v4, v12
  v_cvt_pk_bf16_f32 v241, v3, v4
  v_lshlrev_b32 v3, 16, v242
  v_and_b32 v4, s83, v242
  v_mul_f32 v3, v3, v12
  v_mul_f32 v4, v4, v12
  v_cvt_pk_bf16_f32 v242, v3, v4
  v_lshlrev_b32 v3, 16, v243
  v_and_b32 v4, s83, v243
  v_mul_f32 v3, v3, v12
  v_mul_f32 v4, v4, v12
  v_cvt_pk_bf16_f32 v243, v3, v4
  v_lshlrev_b32 v3, 16, v244
  v_and_b32 v4, s83, v244
  v_mul_f32 v3, v3, v7
  v_mul_f32 v4, v4, v7
  v_cvt_pk_bf16_f32 v244, v3, v4
  v_lshlrev_b32 v3, 16, v245
  v_and_b32 v4, s83, v245
  v_mul_f32 v3, v3, v7
  v_mul_f32 v4, v4, v7
  v_cvt_pk_bf16_f32 v245, v3, v4
  v_lshlrev_b32 v3, 16, v246
  v_and_b32 v4, s83, v246
  v_mul_f32 v3, v3, v7
  v_mul_f32 v4, v4, v7
  v_cvt_pk_bf16_f32 v246, v3, v4
  v_lshlrev_b32 v3, 16, v247
  v_and_b32 v4, s83, v247
  v_mul_f32 v3, v3, v7
  v_mul_f32 v4, v4, v7
  v_cvt_pk_bf16_f32 v247, v3, v4
  s_bitcmp1_b32 s82, 1
  s_cbranch_scc0 L_resd
  v_mul_f32 v32, v32, v12
  v_mul_f32 v33, v33, v12
  v_mul_f32 v34, v34, v12
  v_mul_f32 v35, v35, v12
  v_mul_f32 v36, v36, v7
  v_mul_f32 v37, v37, v7
  v_mul_f32 v38, v38, v7
  v_mul_f32 v39, v39, v7
  v_mul_f32 v40, v40, v12
  v_mul_f32 v41, v41, v12
  v_mul_f32 v42, v42, v12
  v_mul_f32 v43, v43, v12
  v_mul_f32 v44, v44, v7
  v_mul_f32 v45, v45, v7
  v_mul_f32 v46, v46, v7
  v_mul_f32 v47, v47, v7
  v_mul_f32 v48, v48, v12
  v_mul_f32 v49, v49, v12
  v_mul_f32 v50, v50, v12
  v_mul_f32 v51, v51, v12
  v_mul_f32 v52, v52, v7
  v_mul_f32 v53, v53, v7
  v_mul_f32 v54, v54, v7
  v_mul_f32 v55, v55, v7
  v_mul_f32 v56, v56, v12
  v_mul_f32 v57, v57, v12
  v_mul_f32 v58, v58, v12
  v_mul_f32 v59, v59, v12
  v_mul_f32 v60, v60, v7
  v_mul_f32 v61, v61, v7
  v_mul_f32 v62, v62, v7
  v_mul_f32 v63, v63, v7
  v_mul_f32 v64, v64, v12
  v_mul_f32 v65, v65, v12
  v_mul_f32 v66, v66, v12
  v_mul_f32 v67, v67, v12
  v_mul_f32 v68, v68, v7
  v_mul_f32 v69, v69, v7
  v_mul_f32 v70, v70, v7
  v_mul_f32 v71, v71, v7
  v_mul_f32 v72, v72, v12
  v_mul_f32 v73, v73, v12
  v_mul_f32 v74, v74, v12
  v_mul_f32 v75, v75, v12
  v_mul_f32 v76, v76, v7
  v_mul_f32 v77, v77, v7
  v_mul_f32 v78, v78, v7
  v_mul_f32 v79, v79, v7
  v_mul_f32 v80, v80, v12
  v_mul_f32 v81, v81, v12
  v_mul_f32 v82, v82, v12
  v_mul_f32 v83, v83, v12
  v_mul_f32 v84, v84, v7
  v_mul_f32 v85, v85, v7
  v_mul_f32 v86, v86, v7
  v_mul_f32 v87, v87, v7
  v_mul_f32 v88, v88, v12
  v_mul_f32 v89, v89, v12
  v_mul_f32 v90, v90, v12
  v_mul_f32 v91, v91, v12
  v_mul_f32 v92, v92, v7
  v_mul_f32 v93, v93, v7
  v_mul_f32 v94, v94, v7
  v_mul_f32 v95, v95, v7
L_resd:
  s_nop 1
  s_setpc_b64 s[60:61]
L_opA:
  s_mov_b32 s36, s12
  s_mov_b32 s37, s13
  s_mov_b32 s38, 3670016
  s_mov_b32 s39, 0x20000
  v_lshrrev_b32 v21, 4, v0
  v_and_b32 v22, 15, v0
  v_lshrrev_b32 v23, 2, v22
  v_lshlrev_b32 v24, 2, v21
  v_add_u32 v24, v24, v23
  v_and_b32 v25, 3, v0
  v_lshlrev_b32 v25, 3, v25
  v_and_b32 v26, 7, v24
  s_lshl_b32 s50, s44, 2
  v_xor_b32 v26, s50, v26
  v_lshlrev_b32 v26, 5, v26
  v_lshlrev_b32 v4, 9, v24
  v_add3_u32 v4, v4, v26, v25
  v_mul_u32_u24 v27, 384, v24
  v_add_u32 v27, v27, v25
  v_bfe_u32 v26, v24, 1, 2
  s_mul_i32 s74, s44, 3
  s_add_u32 s50, s74, 0
  v_xor_b32 v28, s50, v26
  v_lshlrev_b32 v28, 5, v28
  v_add_u32 v5, v27, v28
  s_add_u32 s50, s74, 1
  v_xor_b32 v28, s50, v26
  v_lshlrev_b32 v28, 5, v28
  v_add_u32 v6, v27, v28
  s_add_u32 s50, s74, 2
  v_xor_b32 v28, s50, v26
  v_lshlrev_b32 v28, 5, v28
  v_add_u32 v7, v27, v28
  v_lshlrev_b32 v15, 4, v0
  v_add_u32 v15, 114688, v15
  s_lshl_b32 s80, s45, 3
  s_add_u32 s80, s80, s46
  s_mul_i32 s80, s80, 86016
  s_mul_i32 s51, s44, 1152
  s_add_u32 s86, s80, s51
  s_add_u32 s86, s86, 6144
  s_mul_i32 s51, s44, 1536
  s_add_u32 s80, s80, s51
  s_lshl_b32 s87, s45, 9
  s_lshl_b32 s51, s46, 4
  s_add_u32 s87, s87, s51
  s_lshl_b32 s51, s44, 2
  s_add_u32 s87, s87, s51
  s_add_u32 s87, s87, 23068672
  v_and_b32 v21, 31, v0
  v_lshrrev_b32 v22, 2, v21
  v_mul_u32_u24 v22, 10752, v22
  v_and_b32 v21, 3, v0
  v_lshlrev_b32 v21, 5, v21
  v_add_u32 v22, v22, v21
  v_lshrrev_b32 v21, 5, v0
  v_lshlrev_b32 v21, 4, v21
  v_add_u32 v11, v22, v21
  v_bfe_u32 v22, v0, 2, 3
  v_cmp_eq_u32 vcc, s46, v22
  v_mov_b32 v23, 0x7f000000
  s_nop 0
  v_cndmask_b32 v11, v11, v23, vcc
  s_mov_b64 s[90:91], vcc
  v_and_b32 v22, 3, v0
  v_lshlrev_b32 v22, 5, v22
  v_add_u32 v22, v22, v21
  s_mul_i32 s50, s44, 1536
  s_add_u32 s50, s50, 81920
  v_add_u32 v3, s50, v22
  v_mov_b32 v13, 1
  v_mov_b32 v14, 0
  s_branch L_op46b
L_op46:
  s_barrier
L_op46b:
  s_cmp_eq_u32 s44, 3
  s_cbranch_scc0 L_xi_16
  s_add_u32 s62, s79, 0
  s_add_u32 m0, s65, 16384
  s_call_b64 s[60:61], L_issO1
L_xi_16:
  s_mov_b32 s76, 0
  s_mov_b32 s77, 0
  s_call_b64 s[60:61], L_op0zF
  s_barrier
  s_cmp_eq_u32 s44, 3
  s_cbranch_scc0 L_xi_17
  s_add_u32 s62, s79, 14336
  s_add_u32 m0, s63, 4294959104
  s_call_b64 s[60:61], L_issO0
L_xi_17:
  s_call_b64 s[60:61], L_op0zS
  s_waitcnt vmcnt(8)
  s_barrier
  s_cmp_eq_u32 s44, 3
  s_cbranch_scc0 L_xi_18
  s_add_u32 s62, s79, 28672
  s_add_u32 m0, s63, 0
  s_call_b64 s[60:61], L_issO0
L_xi_18:
  s_mov_b32 s76, 16384
  s_call_b64 s[60:61], L_op1zN
  s_barrier
  s_cmp_eq_u32 s44, 3
  s_cbranch_scc0 L_xi_19
  s_add_u32 s62, s79, 14336
  s_add_u32 m0, s65, 10240
  s_call_b64 s[60:61], L_issO1
L_xi_19:
  s_call_b64 s[60:61], L_op1zS
  s_waitcnt vmcnt(6)
  s_barrier
  s_cmp_eq_u32 s44, 3
  s_cbranch_scc0 L_xi_20
  s_add_u32 s62, s79, 28672
  s_add_u32 m0, s65, 16384
  s_call_b64 s[60:61], L_issO1
L_xi_20:
  s_mov_b32 s76, 0
  s_mov_b32 s77, 6144
  s_call_b64 s[60:61], L_op0F
  s_barrier
  s_cmp_eq_u32 s44, 3
  s_cbranch_scc0 L_xi_21
  s_add_u32 s62, s79, 43008
  s_add_u32 m0, s63, 4294959104
  s_call_b64 s[60:61], L_issO0
L_xi_21:
  s_call_b64 s[60:61], L_op0S
  s_waitcnt vmcnt(8)
  s_barrier
  s_cmp_eq_u32 s44, 3
  s_cbranch_scc0 L_xi_22
  s_add_u32 s62, s79, 57344
  s_add_u32 m0, s63, 0
  s_call_b64 s[60:61], L_issO0
L_xi_22:
  s_mov_b32 s76, 16384
  s_call_b64 s[60:61], L_op1N
  s_barrier
  s_cmp_eq_u32 s44, 3
  s_cbranch_scc0 L_xi_23
  s_add_u32 s62, s79, 43008
  s_add_u32 m0, s65, 10240
  s_call_b64 s[60:61], L_issO1
L_xi_23:
  s_call_b64 s[60:61], L_op1S
  s_waitcnt vmcnt(6)
  s_barrier
  s_cmp_eq_u32 s44, 3
  s_cbranch_scc0 L_xi_24
  s_add_u32 s62, s79, 57344
  s_add_u32 m0, s65, 16384
  s_call_b64 s[60:61], L_issO1
L_xi_24:
  s_mov_b32 s76, 0
  s_mov_b32 s77, 12288
  s_call_b64 s[60:61], L_op0F
  s_barrier
  s_cmp_eq_u32 s44, 3
  s_cbranch_scc0 L_xi_25
  s_add_u32 s62, s79, 71680
  s_add_u32 m0, s63, 4294959104
  s_call_b64 s[60:61], L_issO0
L_xi_25:
  s_call_b64 s[60:61], L_op0S
  s_waitcnt vmcnt(8)
  s_barrier
  s_cmp_eq_u32 s44, 3
  s_cbranch_scc0 L_xi_26
  s_add_u32 s62, s79, 86016
  s_add_u32 m0, s63, 0
  s_call_b64 s[60:61], L_issO0
L_xi_26:
  s_mov_b32 s76, 16384
  s_call_b64 s[60:61], L_op1N
  s_barrier
  s_cmp_eq_u32 s44, 3
  s_cbranch_scc0 L_xi_27
  s_add_u32 s62, s79, 71680
  s_add_u32 m0, s65, 10240
  s_call_b64 s[60:61], L_issO1
L_xi_27:
  s_call_b64 s[60:61], L_op1S
  s_waitcnt vmcnt(6)
  s_barrier
  s_cmp_eq_u32 s44, 3
  s_cbranch_scc0 L_xi_28
  s_add_u32 s62, s79, 86016
  s_add_u32 m0, s65, 16384
  s_call_b64 s[60:61], L_issO1
L_xi_28:
  s_mov_b32 s76, 0
  s_mov_b32 s77, 18432
  s_call_b64 s[60:61], L_op0F
  s_barrier
  s_cmp_eq_u32 s44, 3
  s_cbranch_scc0 L_xi_29
  s_add_u32 s62, s79, 100352
  s_add_u32 m0, s63, 4294959104
  s_call_b64 s[60:61], L_issO0
L_xi_29:
  s_call_b64 s[60:61], L_op0S
  s_waitcnt vmcnt(8)
  s_barrier
  s_cmp_eq_u32 s44, 3
  s_cbranch_scc0 L_xi_30
  s_add_u32 s62, s79, 114688
  s_add_u32 m0, s63, 0
  s_call_b64 s[60:61], L_issO0
  s_add_u32 s62, s79, 100352
  s_add_u32 m0, s65, 26624
  s_call_b64 s[60:61], L_issO1
L_xi_30:
  s_mov_b32 s76, 16384
  s_call_b64 s[60:61], L_op1N
  s_barrier
  s_cmp_eq_u32 s44, 3
  s_cbranch_scc0 L_xi_31
  s_add_u32 s62, s79, 114688
  s_add_u32 m0, s65, 32768
  s_call_b64 s[60:61], L_issO1
L_xi_31:
  s_call_b64 s[60:61], L_op1S
  s_waitcnt vmcnt(12)
  s_barrier
  s_cmp_eq_u32 s44, 3
  s_cbranch_scc0 L_xi_32
  s_add_u32 s62, s79, 129024
  s_add_u32 m0, s63, 8192
  s_call_b64 s[60:61], L_issO0
L_xi_32:
  s_mov_b32 s76, 0
  s_mov_b32 s77, 24576
  s_call_b64 s[60:61], L_op0F
  s_call_b64 s[60:61], L_op0S
  s_waitcnt vmcnt(8)
  s_barrier
  s_cmp_eq_u32 s44, 3
  s_cbranch_scc0 L_xi_33
  s_add_u32 s62, s79, 143360
  s_add_u32 m0, s63, 16384
  s_call_b64 s[60:61], L_issO0
L_xi_33:
  s_mov_b32 s76, 32768
  s_call_b64 s[60:61], L_op1N
  s_barrier
  s_cmp_eq_u32 s44, 3
  s_cbranch_scc0 L_xi_34
  s_add_u32 s62, s79, 129024
  s_add_u32 m0, s65, 4294961152
  s_call_b64 s[60:61], L_issO1
L_xi_34:
  s_call_b64 s[60:61], L_op1S
  s_waitcnt vmcnt(6)
  s_barrier
  s_cmp_eq_u32 s44, 3
  s_cbranch_scc0 L_xi_35
  s_add_u32 s62, s79, 143360
  s_add_u32 m0, s65, 0
  s_call_b64 s[60:61], L_issO1
L_xi_35:
  s_mov_b32 s76, 16384
  s_mov_b32 s77, 30720
  s_call_b64 s[60:61], L_op0F
  s_barrier
  s_cmp_eq_u32 s44, 3
  s_cbranch_scc0 L_xi_36
  s_add_u32 s62, s79, 157696
  s_add_u32 m0, s63, 8192
  s_call_b64 s[60:61], L_issO0
L_xi_36:
  s_call_b64 s[60:61], L_op0S
  s_waitcnt vmcnt(8)
  s_barrier
  s_cmp_eq_u32 s44, 3
  s_cbranch_scc0 L_xi_37
  s_add_u32 s62, s79, 172032
  s_add_u32 m0, s63, 16384
  s_call_b64 s[60:61], L_issO0
  s_add_u32 s62, s79, 157696
  s_add_u32 m0, s65, 26624
  s_call_b64 s[60:61], L_issO1
L_xi_37:
  s_mov_b32 s76, 0
  s_call_b64 s[60:61], L_op1N
  s_barrier
  s_cmp_eq_u32 s44, 3
  s_cbranch_scc0 L_xi_38
  s_add_u32 s62, s79, 172032
  s_add_u32 m0, s65, 32768
  s_call_b64 s[60:61], L_issO1
  s_add_u32 s62, s79, 186368
  s_add_u32 m0, s63, 4294959104
  s_call_b64 s[60:61], L_issO0
L_xi_38:
  s_call_b64 s[60:61], L_op1S
  s_waitcnt vmcnt(20)
  s_barrier
  s_cmp_eq_u32 s44, 3
  s_cbranch_scc0 L_xi_39
  s_add_u32 s62, s79, 200704
  s_add_u32 m0, s63, 0
  s_call_b64 s[60:61], L_issO0
L_xi_39:
  s_mov_b32 s76, 16384
  s_mov_b32 s77, 36864
  s_call_b64 s[60:61], L_op0F
  s_call_b64 s[60:61], L_op0S
  s_waitcnt vmcnt(16)
  s_barrier
  s_cmp_eq_u32 s44, 3
  s_cbranch_scc0 L_xi_40
  s_add_u32 s62, s79, 186368
  s_add_u32 m0, s65, 10240
  s_call_b64 s[60:61], L_issO1
L_xi_40:
  s_mov_b32 s76, 32768
  s_call_b64 s[60:61], L_op1N
  s_call_b64 s[60:61], L_op1S
  s_waitcnt vmcnt(6)
  s_barrier
  s_cmp_eq_u32 s44, 3
  s_cbranch_scc0 L_xi_41
  s_add_u32 s62, s79, 200704
  s_add_u32 m0, s65, 16384
  s_call_b64 s[60:61], L_issO1
  s_add_u32 s62, s79, 215040
  s_add_u32 m0, s63, 24576
  s_call_b64 s[60:61], L_issO0
L_xi_41:
  s_mov_b32 s76, 0
  s_mov_b32 s77, 43008
  s_call_b64 s[60:61], L_op0F
  s_barrier
  s_cmp_eq_u32 s44, 3
  s_cbranch_scc0 L_xi_42
  s_add_u32 s62, s79, 229376
  s_add_u32 m0, s63, 32768
  s_call_b64 s[60:61], L_issO0
L_xi_42:
  s_call_b64 s[60:61], L_op0S
  s_waitcnt vmcnt(16)
  s_barrier
  s_cmp_eq_u32 s44, 3
  s_cbranch_scc0 L_xi_43
  s_add_u32 s62, s79, 243712
  s_add_u32 m0, s63, 4294959104
  s_call_b64 s[60:61], L_issO0
L_xi_43:
  s_mov_b32 s76, 16384
  s_call_b64 s[60:61], L_op1N
  s_call_b64 s[60:61], L_op1S
  s_waitcnt vmcnt(8)
  s_barrier
  s_cmp_eq_u32 s44, 3
  s_cbranch_scc0 L_xi_44
  s_add_u32 s62, s79, 258048
  s_add_u32 m0, s63, 0
  s_call_b64 s[60:61], L_issO0
  s_add_u32 s62, s79, 272384
  s_add_u32 m0, s63, 8192
  s_call_b64 s[60:61], L_issO0
L_xi_44:
  s_mov_b32 s76, 32768
  s_mov_b32 s77, 0
  s_call_b64 s[60:61], L_op0F
  s_barrier
  s_cmp_eq_u32 s44, 3
  s_cbranch_scc0 L_xi_45
  s_add_u32 s62, s79, 286720
  s_add_u32 m0, s63, 16384
  s_call_b64 s[60:61], L_issO0
L_xi_45:
  s_call_b64 s[60:61], L_op0S
  s_waitcnt vmcnt(16)
  s_barrier
  s_mov_b32 s76, 0
  s_mov_b32 s77, 6144
  s_call_b64 s[60:61], L_op0F
  s_call_b64 s[60:61], L_op0S
  s_waitcnt vmcnt(0)
  s_barrier
  s_mov_b32 s76, 16384
  s_mov_b32 s77, 12288
  s_call_b64 s[60:61], L_op0F
  s_call_b64 s[60:61], L_op0S
  s_barrier
  v_add_u32 v8, 81920, v4
  ds_read_b64_tr_b16 v[64:65], v8
  ds_read_b64_tr_b16 v[66:67], v8 offset:8192
  ds_read_b128 v[16:19], v15 offset:18432
  ds_read_b128 v[20:23], v15 offset:19456
  ds_read_b128 v[24:27], v15 offset:20480
  ds_read_b128 v[28:31], v15 offset:21504
  ds_read_b128 v[32:35], v15 offset:22528
  ds_read_b128 v[36:39], v15 offset:23552
  v_xor_b32 v10, 32, v8
  ds_read_b64_tr_b16 v[68:69], v10
  ds_read_b64_tr_b16 v[70:71], v10 offset:8192
  v_xor_b32 v9, 64, v8
  ds_read_b64_tr_b16 v[72:73], v9
  ds_read_b64_tr_b16 v[74:75], v9 offset:8192
  s_mul_i32 s50, s44, 384
  s_sub_u32 s50, 6144, s50
  v_add_u32 v12, s50, v3
  s_waitcnt lgkmcnt(4)
  v_mfma_f32_16x16x32_bf16 v[88:91], v[64:67], v[16:19], v[88:91]
  ds_read_b128 v[40:43], v15 offset:24576
  v_mfma_f32_16x16x32_bf16 v[92:95], v[64:67], v[20:23], v[92:95]
  ds_read_b128 v[44:47], v15 offset:25600
  v_mfma_f32_16x16x32_bf16 v[96:99], v[64:67], v[24:27], v[96:99]
  v_xor_b32 v10, 96, v8
  v_mfma_f32_16x16x32_bf16 v[100:103], v[64:67], v[28:31], v[100:103]
  ds_read_b64_tr_b16 v[76:77], v10
  v_mfma_f32_16x16x32_bf16 v[104:107], v[64:67], v[32:35], v[104:107]
  ds_read_b64_tr_b16 v[78:79], v10 offset:8192
  v_mfma_f32_16x16x32_bf16 v[108:111], v[64:67], v[36:39], v[108:111]
  s_waitcnt lgkmcnt(6)
  v_mfma_f32_16x16x32_bf16 v[112:115], v[68:71], v[16:19], v[112:115]
  ds_read_b128 v[48:51], v15 offset:26624
  v_mfma_f32_16x16x32_bf16 v[116:119], v[68:71], v[20:23], v[116:119]
  ds_read_b128 v[52:55], v15 offset:27648
  v_mfma_f32_16x16x32_bf16 v[120:123], v[68:71], v[24:27], v[120:123]
  v_add_u32 v8, 32768, v4
  v_mfma_f32_16x16x32_bf16 v[124:127], v[68:71], v[28:31], v[124:127]
  ds_read_b64_tr_b16 v[80:81], v8
  v_mfma_f32_16x16x32_bf16 v[128:131], v[68:71], v[32:35], v[128:131]
  ds_read_b64_tr_b16 v[82:83], v8 offset:8192
  v_mfma_f32_16x16x32_bf16 v[132:135], v[68:71], v[36:39], v[132:135]
  s_waitcnt lgkmcnt(8)
  v_mfma_f32_16x16x32_bf16 v[136:139], v[72:75], v[16:19], v[136:139]
  ds_read_b128 v[56:59], v15 offset:28672
  v_mfma_f32_16x16x32_bf16 v[140:143], v[72:75], v[20:23], v[140:143]
  ds_read_b128 v[60:63], v15 offset:29696
  v_mfma_f32_16x16x32_bf16 v[144:147], v[72:75], v[24:27], v[144:147]
  v_xor_b32 v10, 32, v8
  v_mfma_f32_16x16x32_bf16 v[148:151], v[72:75], v[28:31], v[148:151]
  ds_read_b64_tr_b16 v[84:85], v10
  v_mfma_f32_16x16x32_bf16 v[152:155], v[72:75], v[32:35], v[152:155]
  ds_read_b64_tr_b16 v[86:87], v10 offset:8192
  v_mfma_f32_16x16x32_bf16 v[156:159], v[72:75], v[36:39], v[156:159]
  s_waitcnt lgkmcnt(8)
  v_mfma_f32_16x16x32_bf16 v[160:163], v[76:79], v[16:19], v[160:163]
  v_mfma_f32_16x16x32_bf16 v[164:167], v[76:79], v[20:23], v[164:167]
  v_mfma_f32_16x16x32_bf16 v[168:171], v[76:79], v[24:27], v[168:171]
  v_xor_b32 v9, 64, v8
  v_mfma_f32_16x16x32_bf16 v[172:175], v[76:79], v[28:31], v[172:175]
  ds_read_b64_tr_b16 v[64:65], v9
  v_mfma_f32_16x16x32_bf16 v[176:179], v[76:79], v[32:35], v[176:179]
  ds_read_b64_tr_b16 v[66:67], v9 offset:8192
  v_mfma_f32_16x16x32_bf16 v[180:183], v[76:79], v[36:39], v[180:183]
  s_waitcnt lgkmcnt(4)
  v_mfma_f32_16x16x32_bf16 v[88:91], v[80:83], v[40:43], v[88:91]
  ds_read_b128 v[16:19], v15 offset:30720
  v_mfma_f32_16x16x32_bf16 v[92:95], v[80:83], v[44:47], v[92:95]
  ds_read_b128 v[20:23], v15 offset:31744
  v_mfma_f32_16x16x32_bf16 v[96:99], v[80:83], v[48:51], v[96:99]
  v_xor_b32 v10, 96, v8
  v_mfma_f32_16x16x32_bf16 v[100:103], v[80:83], v[52:55], v[100:103]
  ds_read_b64_tr_b16 v[68:69], v10
  v_mfma_f32_16x16x32_bf16 v[104:107], v[80:83], v[56:59], v[104:107]
  ds_read_b64_tr_b16 v[70:71], v10 offset:8192
  v_mfma_f32_16x16x32_bf16 v[108:111], v[80:83], v[60:63], v[108:111]
  s_waitcnt lgkmcnt(6)
  v_mfma_f32_16x16x32_bf16 v[112:115], v[84:87], v[40:43], v[112:115]
  ds_read_b128 v[24:27], v15 offset:32768
  v_mfma_f32_16x16x32_bf16 v[116:119], v[84:87], v[44:47], v[116:119]
  ds_read_b128 v[28:31], v15 offset:33792
  v_mfma_f32_16x16x32_bf16 v[120:123], v[84:87], v[48:51], v[120:123]
  s_waitcnt lgkmcnt(2)
  s_barrier
  v_add_u32 v8, 98304, v4
  v_mfma_f32_16x16x32_bf16 v[124:127], v[84:87], v[52:55], v[124:127]
  ds_read_b64_tr_b16 v[72:73], v8
  v_mfma_f32_16x16x32_bf16 v[128:131], v[84:87], v[56:59], v[128:131]
  ds_read_b64_tr_b16 v[74:75], v8 offset:8192
  v_mfma_f32_16x16x32_bf16 v[132:135], v[84:87], v[60:63], v[132:135]
  v_mfma_f32_16x16x32_bf16 v[136:139], v[64:67], v[40:43], v[136:139]
  ds_read_b128 v[32:35], v15 offset:34816
  v_mfma_f32_16x16x32_bf16 v[140:143], v[64:67], v[44:47], v[140:143]
  ds_read_b128 v[36:39], v15 offset:35840
  v_mfma_f32_16x16x32_bf16 v[144:147], v[64:67], v[48:51], v[144:147]
  v_xor_b32 v10, 32, v8
  v_mfma_f32_16x16x32_bf16 v[148:151], v[64:67], v[52:55], v[148:151]
  ds_read_b64_tr_b16 v[76:77], v10
  v_mfma_f32_16x16x32_bf16 v[152:155], v[64:67], v[56:59], v[152:155]
  ds_read_b64_tr_b16 v[78:79], v10 offset:8192
  v_mfma_f32_16x16x32_bf16 v[156:159], v[64:67], v[60:63], v[156:159]
  v_mfma_f32_16x16x32_bf16 v[160:163], v[68:71], v[40:43], v[160:163]
  v_mfma_f32_16x16x32_bf16 v[164:167], v[68:71], v[44:47], v[164:167]
  v_mfma_f32_16x16x32_bf16 v[168:171], v[68:71], v[48:51], v[168:171]
  v_xor_b32 v9, 64, v8
  v_mfma_f32_16x16x32_bf16 v[172:175], v[68:71], v[52:55], v[172:175]
  ds_read_b64_tr_b16 v[80:81], v9
  v_mfma_f32_16x16x32_bf16 v[176:179], v[68:71], v[56:59], v[176:179]
  ds_read_b64_tr_b16 v[82:83], v9 offset:8192
  v_mfma_f32_16x16x32_bf16 v[180:183], v[68:71], v[60:63], v[180:183]
  s_waitcnt lgkmcnt(4)
  v_mfma_f32_16x16x32_bf16 v[88:91], v[72:75], v[16:19], v[88:91]
  ds_read_b128 v[40:43], v15 offset:36864
  v_mfma_f32_16x16x32_bf16 v[92:95], v[72:75], v[20:23], v[92:95]
  ds_read_b128 v[44:47], v15 offset:37888
  v_mfma_f32_16x16x32_bf16 v[96:99], v[72:75], v[24:27], v[96:99]
  v_xor_b32 v10, 96, v8
  v_mfma_f32_16x16x32_bf16 v[100:103], v[72:75], v[28:31], v[100:103]
  ds_read_b64_tr_b16 v[84:85], v10
  v_mfma_f32_16x16x32_bf16 v[104:107], v[72:75], v[32:35], v[104:107]
  ds_read_b64_tr_b16 v[86:87], v10 offset:8192
  v_mfma_f32_16x16x32_bf16 v[108:111], v[72:75], v[36:39], v[108:111]
  s_waitcnt lgkmcnt(6)
  v_mfma_f32_16x16x32_bf16 v[112:115], v[76:79], v[16:19], v[112:115]
  ds_read_b128 v[48:51], v15 offset:38912
  v_mfma_f32_16x16x32_bf16 v[116:119], v[76:79], v[20:23], v[116:119]
  ds_read_b128 v[52:55], v15 offset:39936
  v_mfma_f32_16x16x32_bf16 v[120:123], v[76:79], v[24:27], v[120:123]
  v_add_u32 v8, 65536, v4
  v_mfma_f32_16x16x32_bf16 v[124:127], v[76:79], v[28:31], v[124:127]
  ds_read_b64_tr_b16 v[64:65], v8
  v_mfma_f32_16x16x32_bf16 v[128:131], v[76:79], v[32:35], v[128:131]
  ds_read_b64_tr_b16 v[66:67], v8 offset:8192
  v_mfma_f32_16x16x32_bf16 v[132:135], v[76:79], v[36:39], v[132:135]
  s_waitcnt lgkmcnt(8)
  v_mfma_f32_16x16x32_bf16 v[136:139], v[80:83], v[16:19], v[136:139]
  ds_read_b128 v[56:59], v15 offset:40960
  v_mfma_f32_16x16x32_bf16 v[140:143], v[80:83], v[20:23], v[140:143]
  ds_read_b128 v[60:63], v15 offset:41984
  v_mfma_f32_16x16x32_bf16 v[144:147], v[80:83], v[24:27], v[144:147]
  v_xor_b32 v10, 32, v8
  v_mfma_f32_16x16x32_bf16 v[148:151], v[80:83], v[28:31], v[148:151]
  ds_read_b64_tr_b16 v[68:69], v10
  v_mfma_f32_16x16x32_bf16 v[152:155], v[80:83], v[32:35], v[152:155]
  ds_read_b64_tr_b16 v[70:71], v10 offset:8192
  v_mfma_f32_16x16x32_bf16 v[156:159], v[80:83], v[36:39], v[156:159]
  s_waitcnt lgkmcnt(8)
  v_mfma_f32_16x16x32_bf16 v[160:163], v[84:87], v[16:19], v[160:163]
  v_mfma_f32_16x16x32_bf16 v[164:167], v[84:87], v[20:23], v[164:167]
  v_mfma_f32_16x16x32_bf16 v[168:171], v[84:87], v[24:27], v[168:171]
  v_xor_b32 v9, 64, v8
  v_mfma_f32_16x16x32_bf16 v[172:175], v[84:87], v[28:31], v[172:175]
  ds_read_b64_tr_b16 v[72:73], v9
  v_mfma_f32_16x16x32_bf16 v[176:179], v[84:87], v[32:35], v[176:179]
  ds_read_b64_tr_b16 v[74:75], v9 offset:8192
  s_branch L_pads15
L_pad15:
  s_setpc_b64 s[60:61]
L_pads15:
  v_mfma_f32_16x16x32_bf16 v[180:183], v[84:87], v[36:39], v[180:183]
  s_waitcnt lgkmcnt(4)
  v_mfma_f32_16x16x32_bf16 v[88:91], v[64:67], v[40:43], v[88:91]
  ds_read_b128 v[16:19], v15 offset:43008
  v_mfma_f32_16x16x32_bf16 v[92:95], v[64:67], v[44:47], v[92:95]
  ds_read_b128 v[20:23], v15 offset:44032
  v_mfma_f32_16x16x32_bf16 v[96:99], v[64:67], v[48:51], v[96:99]
  v_xor_b32 v10, 96, v8
  v_mfma_f32_16x16x32_bf16 v[100:103], v[64:67], v[52:55], v[100:103]
  ds_read_b64_tr_b16 v[76:77], v10
  v_mfma_f32_16x16x32_bf16 v[104:107], v[64:67], v[56:59], v[104:107]
  ds_read_b64_tr_b16 v[78:79], v10 offset:8192
  v_mfma_f32_16x16x32_bf16 v[108:111], v[64:67], v[60:63], v[108:111]
  s_waitcnt lgkmcnt(6)
  v_mfma_f32_16x16x32_bf16 v[112:115], v[68:71], v[40:43], v[112:115]
  ds_read_b128 v[24:27], v15 offset:45056
  v_mfma_f32_16x16x32_bf16 v[116:119], v[68:71], v[44:47], v[116:119]
  ds_read_b128 v[28:31], v15 offset:46080
  v_mfma_f32_16x16x32_bf16 v[120:123], v[68:71], v[48:51], v[120:123]
  s_waitcnt lgkmcnt(2)
  s_barrier
  v_add_u32 v8, 0, v4
  v_mfma_f32_16x16x32_bf16 v[124:127], v[68:71], v[52:55], v[124:127]
  ds_read_b64_tr_b16 v[80:81], v8
  v_mfma_f32_16x16x32_bf16 v[128:131], v[68:71], v[56:59], v[128:131]
  ds_read_b64_tr_b16 v[82:83], v8 offset:8192
  v_mfma_f32_16x16x32_bf16 v[132:135], v[68:71], v[60:63], v[132:135]
  v_mfma_f32_16x16x32_bf16 v[136:139], v[72:75], v[40:43], v[136:139]
  ds_read_b128 v[32:35], v15 offset:47104
  v_mfma_f32_16x16x32_bf16 v[140:143], v[72:75], v[44:47], v[140:143]
  ds_read_b128 v[36:39], v15 offset:48128
  v_mfma_f32_16x16x32_bf16 v[144:147], v[72:75], v[48:51], v[144:147]
  v_xor_b32 v10, 32, v8
  v_mfma_f32_16x16x32_bf16 v[148:151], v[72:75], v[52:55], v[148:151]
  ds_read_b64_tr_b16 v[84:85], v10
  v_mfma_f32_16x16x32_bf16 v[152:155], v[72:75], v[56:59], v[152:155]
  ds_read_b64_tr_b16 v[86:87], v10 offset:8192
  v_mfma_f32_16x16x32_bf16 v[156:159], v[72:75], v[60:63], v[156:159]
  v_mfma_f32_16x16x32_bf16 v[160:163], v[76:79], v[40:43], v[160:163]
  v_mfma_f32_16x16x32_bf16 v[164:167], v[76:79], v[44:47], v[164:167]
  v_mfma_f32_16x16x32_bf16 v[168:171], v[76:79], v[48:51], v[168:171]
  v_xor_b32 v9, 64, v8
  v_mfma_f32_16x16x32_bf16 v[172:175], v[76:79], v[52:55], v[172:175]
  ds_read_b64_tr_b16 v[64:65], v9
  v_mfma_f32_16x16x32_bf16 v[176:179], v[76:79], v[56:59], v[176:179]
  ds_read_b64_tr_b16 v[66:67], v9 offset:8192
  v_mfma_f32_16x16x32_bf16 v[180:183], v[76:79], v[60:63], v[180:183]
  s_waitcnt lgkmcnt(4)
  v_mfma_f32_16x16x32_bf16 v[88:91], v[80:83], v[16:19], v[88:91]
  ds_read_b128 v[40:43], v15 offset:0
  v_mfma_f32_16x16x32_bf16 v[92:95], v[80:83], v[20:23], v[92:95]
  ds_read_b128 v[44:47], v15 offset:1024
  v_mfma_f32_16x16x32_bf16 v[96:99], v[80:83], v[24:27], v[96:99]
  v_xor_b32 v10, 96, v8
  v_mfma_f32_16x16x32_bf16 v[100:103], v[80:83], v[28:31], v[100:103]
  ds_read_b64_tr_b16 v[68:69], v10
  v_mfma_f32_16x16x32_bf16 v[104:107], v[80:83], v[32:35], v[104:107]
  ds_read_b64_tr_b16 v[70:71], v10 offset:8192
  v_mfma_f32_16x16x32_bf16 v[108:111], v[80:83], v[36:39], v[108:111]
  s_waitcnt lgkmcnt(6)
  v_mfma_f32_16x16x32_bf16 v[112:115], v[84:87], v[16:19], v[112:115]
  ds_read_b128 v[48:51], v15 offset:2048
  v_mfma_f32_16x16x32_bf16 v[116:119], v[84:87], v[20:23], v[116:119]
  ds_read_b128 v[52:55], v15 offset:3072
  v_mfma_f32_16x16x32_bf16 v[120:123], v[84:87], v[24:27], v[120:123]
  v_add_u32 v8, 49152, v5
  v_mfma_f32_16x16x32_bf16 v[124:127], v[84:87], v[28:31], v[124:127]
  ds_read_b64_tr_b16 v[72:73], v8
  v_mfma_f32_16x16x32_bf16 v[128:131], v[84:87], v[32:35], v[128:131]
  ds_read_b64_tr_b16 v[74:75], v8 offset:6144
  v_mfma_f32_16x16x32_bf16 v[132:135], v[84:87], v[36:39], v[132:135]
  s_waitcnt lgkmcnt(8)
  v_mfma_f32_16x16x32_bf16 v[136:139], v[64:67], v[16:19], v[136:139]
  ds_read_b128 v[56:59], v15 offset:4096
  v_mfma_f32_16x16x32_bf16 v[140:143], v[64:67], v[20:23], v[140:143]
  ds_read_b128 v[60:63], v15 offset:5120
  v_mfma_f32_16x16x32_bf16 v[144:147], v[64:67], v[24:27], v[144:147]
  v_add_u32 v9, 49152, v6
  v_mfma_f32_16x16x32_bf16 v[148:151], v[64:67], v[28:31], v[148:151]
  ds_read_b64_tr_b16 v[76:77], v9
  v_mfma_f32_16x16x32_bf16 v[152:155], v[64:67], v[32:35], v[152:155]
  ds_read_b64_tr_b16 v[78:79], v9 offset:6144
  v_mfma_f32_16x16x32_bf16 v[156:159], v[64:67], v[36:39], v[156:159]
  s_waitcnt lgkmcnt(8)
  v_mfma_f32_16x16x32_bf16 v[160:163], v[68:71], v[16:19], v[160:163]
  v_mfma_f32_16x16x32_bf16 v[164:167], v[68:71], v[20:23], v[164:167]
  v_mfma_f32_16x16x32_bf16 v[168:171], v[68:71], v[24:27], v[168:171]
  v_add_u32 v10, 49152, v7
  v_mfma_f32_16x16x32_bf16 v[172:175], v[68:71], v[28:31], v[172:175]
  ds_read_b64_tr_b16 v[80:81], v10
  v_mfma_f32_16x16x32_bf16 v[176:179], v[68:71], v[32:35], v[176:179]
  ds_read_b64_tr_b16 v[82:83], v10 offset:6144
  v_mfma_f32_16x16x32_bf16 v[180:183], v[68:71], v[36:39], v[180:183]
  s_waitcnt lgkmcnt(4)
  v_mfma_f32_16x16x32_bf16 v[184:187], v[72:75], v[40:43], v[184:187]
  ds_read_b128 v[16:19], v15 offset:6144
  v_mfma_f32_16x16x32_bf16 v[188:191], v[72:75], v[44:47], v[188:191]
  ds_read_b128 v[20:23], v15 offset:7168
  v_mfma_f32_16x16x32_bf16 v[192:195], v[72:75], v[48:51], v[192:195]
  s_waitcnt lgkmcnt(2)
  s_barrier
  v_add_u32 v8, 16384, v5
  v_mfma_f32_16x16x32_bf16 v[196:199], v[72:75], v[52:55], v[196:199]
  ds_read_b64_tr_b16 v[84:85], v8
  v_mfma_f32_16x16x32_bf16 v[200:203], v[72:75], v[56:59], v[200:203]
  ds_read_b64_tr_b16 v[86:87], v8 offset:6144
  v_mfma_f32_16x16x32_bf16 v[204:207], v[72:75], v[60:63], v[204:207]
  v_mfma_f32_16x16x32_bf16 v[208:211], v[76:79], v[40:43], v[208:211]
  ds_read_b128 v[24:27], v15 offset:8192
  v_cvt_pk_bf16_f32 v88, v88, v89
  v_cvt_pk_bf16_f32 v89, v90, v91
  v_cvt_pk_bf16_f32 v90, v92, v93
  v_cvt_pk_bf16_f32 v91, v94, v95
  v_mfma_f32_16x16x32_bf16 v[212:215], v[76:79], v[44:47], v[212:215]
  ds_read_b128 v[28:31], v15 offset:9216
  v_permlane16_swap_b32 v88, v90
  v_permlane16_swap_b32 v89, v91
  buffer_store_dwordx4 v[88:91], v11, s[40:43], s80 offen offset:0 sc1
  s_mov_b64 exec, s[90:91]
  ds_write_b128 v3, v[88:91] offset:0
  s_mov_b64 exec, -1
  v_mfma_f32_16x16x32_bf16 v[216:219], v[76:79], v[48:51], v[216:219]
  v_add_u32 v9, 16384, v6
  v_cvt_pk_bf16_f32 v96, v96, v97
  v_cvt_pk_bf16_f32 v97, v98, v99
  v_cvt_pk_bf16_f32 v98, v100, v101
  v_cvt_pk_bf16_f32 v99, v102, v103
  v_mfma_f32_16x16x32_bf16 v[220:223], v[76:79], v[52:55], v[220:223]
  ds_read_b64_tr_b16 v[64:65], v9
  v_permlane16_swap_b32 v96, v98
  v_permlane16_swap_b32 v97, v99
  buffer_store_dwordx4 v[96:99], v11, s[40:43], s80 offen offset:128 sc1
  s_mov_b64 exec, s[90:91]
  ds_write_b128 v3, v[96:99] offset:128
  s_mov_b64 exec, -1
  v_mfma_f32_16x16x32_bf16 v[224:227], v[76:79], v[56:59], v[224:227]
  ds_read_b64_tr_b16 v[66:67], v9 offset:6144
  v_cvt_pk_bf16_f32 v104, v104, v105
  v_cvt_pk_bf16_f32 v105, v106, v107
  v_cvt_pk_bf16_f32 v106, v108, v109
  v_cvt_pk_bf16_f32 v107, v110, v111
  v_mfma_f32_16x16x32_bf16 v[228:231], v[76:79], v[60:63], v[228:231]
  v_permlane16_swap_b32 v104, v106
  v_permlane16_swap_b32 v105, v107
  buffer_store_dwordx4 v[104:107], v11, s[40:43], s80 offen offset:256 sc1
  s_mov_b64 exec, s[90:91]
  ds_write_b128 v3, v[104:107] offset:256
  s_mov_b64 exec, -1
  v_mfma_f32_16x16x32_bf16 v[232:235], v[80:83], v[40:43], v[232:235]
  ds_read_b128 v[32:35], v15 offset:10240
  v_cvt_pk_bf16_f32 v112, v112, v113
  v_cvt_pk_bf16_f32 v113, v114, v115
  v_cvt_pk_bf16_f32 v114, v116, v117
  v_cvt_pk_bf16_f32 v115, v118, v119
  v_mfma_f32_16x16x32_bf16 v[236:239], v[80:83], v[44:47], v[236:239]
  ds_read_b128 v[36:39], v15 offset:11264
  v_permlane16_swap_b32 v112, v114
  v_permlane16_swap_b32 v113, v115
  buffer_store_dwordx4 v[112:115], v11, s[40:43], s80 offen offset:384 sc1
  s_mov_b64 exec, s[90:91]
  ds_write_b128 v3, v[112:115] offset:384
  s_mov_b64 exec, -1
  v_mfma_f32_16x16x32_bf16 v[240:243], v[80:83], v[48:51], v[240:243]
  v_add_u32 v10, 16384, v7
  v_cvt_pk_bf16_f32 v120, v120, v121
  v_cvt_pk_bf16_f32 v121, v122, v123
  v_cvt_pk_bf16_f32 v122, v124, v125
  v_cvt_pk_bf16_f32 v123, v126, v127
  v_mfma_f32_16x16x32_bf16 v[244:247], v[80:83], v[52:55], v[244:247]
  ds_read_b64_tr_b16 v[68:69], v10
  v_permlane16_swap_b32 v120, v122
  v_permlane16_swap_b32 v121, v123
  buffer_store_dwordx4 v[120:123], v11, s[40:43], s80 offen offset:512 sc1
  s_mov_b64 exec, s[90:91]
  ds_write_b128 v3, v[120:123] offset:512
  s_mov_b64 exec, -1
  v_mfma_f32_16x16x32_bf16 v[248:251], v[80:83], v[56:59], v[248:251]
  ds_read_b64_tr_b16 v[70:71], v10 offset:6144
  v_cvt_pk_bf16_f32 v128, v128, v129
  v_cvt_pk_bf16_f32 v129, v130, v131
  v_cvt_pk_bf16_f32 v130, v132, v133
  v_cvt_pk_bf16_f32 v131, v134, v135
  v_mfma_f32_16x16x32_bf16 v[252:255], v[80:83], v[60:63], v[252:255]
  v_permlane16_swap_b32 v128, v130
  v_permlane16_swap_b32 v129, v131
  buffer_store_dwordx4 v[128:131], v11, s[40:43], s80 offen offset:640 sc1
  s_mov_b64 exec, s[90:91]
  ds_write_b128 v3, v[128:131] offset:640
  s_mov_b64 exec, -1
  s_waitcnt lgkmcnt(5)
  v_mfma_f32_16x16x32_bf16 v[184:187], v[84:87], v[16:19], v[184:187]
  ds_read_b128 v[40:43], v15 offset:12288
  v_cvt_pk_bf16_f32 v136, v136, v137
  v_cvt_pk_bf16_f32 v137, v138, v139
  v_cvt_pk_bf16_f32 v138, v140, v141
  v_cvt_pk_bf16_f32 v139, v142, v143
  v_mfma_f32_16x16x32_bf16 v[188:191], v[84:87], v[20:23], v[188:191]
  ds_read_b128 v[44:47], v15 offset:13312
  v_permlane16_swap_b32 v136, v138
  v_permlane16_swap_b32 v137, v139
  buffer_store_dwordx4 v[136:139], v11, s[40:43], s80 offen offset:768 sc1
  s_mov_b64 exec, s[90:91]
  ds_write_b128 v3, v[136:139] offset:768
  s_mov_b64 exec, -1
  v_mfma_f32_16x16x32_bf16 v[192:195], v[84:87], v[24:27], v[192:195]
  v_add_u32 v8, 32768, v5
  v_cvt_pk_bf16_f32 v144, v144, v145
  v_cvt_pk_bf16_f32 v145, v146, v147
  v_cvt_pk_bf16_f32 v146, v148, v149
  v_cvt_pk_bf16_f32 v147, v150, v151
  v_mfma_f32_16x16x32_bf16 v[196:199], v[84:87], v[28:31], v[196:199]
  ds_read_b64_tr_b16 v[72:73], v8
  v_permlane16_swap_b32 v144, v146
  v_permlane16_swap_b32 v145, v147
  buffer_store_dwordx4 v[144:147], v11, s[40:43], s80 offen offset:896 sc1
  s_mov_b64 exec, s[90:91]
  ds_write_b128 v3, v[144:147] offset:896
  s_mov_b64 exec, -1
  v_mfma_f32_16x16x32_bf16 v[200:203], v[84:87], v[32:35], v[200:203]
  ds_read_b64_tr_b16 v[74:75], v8 offset:6144
  v_cvt_pk_bf16_f32 v152, v152, v153
  v_cvt_pk_bf16_f32 v153, v154, v155
  v_cvt_pk_bf16_f32 v154, v156, v157
  v_cvt_pk_bf16_f32 v155, v158, v159
  v_mfma_f32_16x16x32_bf16 v[204:207], v[84:87], v[36:39], v[204:207]
  v_permlane16_swap_b32 v152, v154
  v_permlane16_swap_b32 v153, v155
  buffer_store_dwordx4 v[152:155], v11, s[40:43], s80 offen offset:1024 sc1
  s_mov_b64 exec, s[90:91]
  ds_write_b128 v3, v[152:155] offset:1024
  s_mov_b64 exec, -1
  v_mfma_f32_16x16x32_bf16 v[208:211], v[64:67], v[16:19], v[208:211]
  ds_read_b128 v[48:51], v15 offset:14336
  v_cvt_pk_bf16_f32 v160, v160, v161
  v_cvt_pk_bf16_f32 v161, v162, v163
  v_cvt_pk_bf16_f32 v162, v164, v165
  v_cvt_pk_bf16_f32 v163, v166, v167
  v_mfma_f32_16x16x32_bf16 v[212:215], v[64:67], v[20:23], v[212:215]
  ds_read_b128 v[52:55], v15 offset:15360
  v_permlane16_swap_b32 v160, v162
  v_permlane16_swap_b32 v161, v163
  buffer_store_dwordx4 v[160:163], v11, s[40:43], s80 offen offset:1152 sc1
  s_mov_b64 exec, s[90:91]
  ds_write_b128 v3, v[160:163] offset:1152
  s_mov_b64 exec, -1
  v_mfma_f32_16x16x32_bf16 v[216:219], v[64:67], v[24:27], v[216:219]
  v_add_u32 v9, 32768, v6
  v_cvt_pk_bf16_f32 v168, v168, v169
  v_cvt_pk_bf16_f32 v169, v170, v171
  v_cvt_pk_bf16_f32 v170, v172, v173
  v_cvt_pk_bf16_f32 v171, v174, v175
  v_mfma_f32_16x16x32_bf16 v[220:223], v[64:67], v[28:31], v[220:223]
  ds_read_b64_tr_b16 v[76:77], v9
  v_permlane16_swap_b32 v168, v170
  v_permlane16_swap_b32 v169, v171
  buffer_store_dwordx4 v[168:171], v11, s[40:43], s80 offen offset:1280 sc1
  s_mov_b64 exec, s[90:91]
  ds_write_b128 v3, v[168:171] offset:1280
  s_mov_b64 exec, -1
  v_mfma_f32_16x16x32_bf16 v[224:227], v[64:67], v[32:35], v[224:227]
  ds_read_b64_tr_b16 v[78:79], v9 offset:6144
  v_cvt_pk_bf16_f32 v176, v176, v177
  v_cvt_pk_bf16_f32 v177, v178, v179
  v_cvt_pk_bf16_f32 v178, v180, v181
  v_cvt_pk_bf16_f32 v179, v182, v183
  v_mfma_f32_16x16x32_bf16 v[228:231], v[64:67], v[36:39], v[228:231]
  v_permlane16_swap_b32 v176, v178
  v_permlane16_swap_b32 v177, v179
  buffer_store_dwordx4 v[176:179], v11, s[40:43], s80 offen offset:1408 sc1
  s_mov_b64 exec, s[90:91]
  ds_write_b128 v3, v[176:179] offset:1408
  s_mov_b64 exec, -1
  s_waitcnt lgkmcnt(15)
  v_mfma_f32_16x16x32_bf16 v[232:235], v[68:71], v[16:19], v[232:235]
  ds_read_b128 v[56:59], v15 offset:16384
  v_mfma_f32_16x16x32_bf16 v[236:239], v[68:71], v[20:23], v[236:239]
  ds_read_b128 v[60:63], v15 offset:17408
  v_mfma_f32_16x16x32_bf16 v[240:243], v[68:71], v[24:27], v[240:243]
  v_add_u32 v10, 32768, v7
  v_mfma_f32_16x16x32_bf16 v[244:247], v[68:71], v[28:31], v[244:247]
  ds_read_b64_tr_b16 v[80:81], v10
  v_mfma_f32_16x16x32_bf16 v[248:251], v[68:71], v[32:35], v[248:251]
  ds_read_b64_tr_b16 v[82:83], v10 offset:6144
  v_mfma_f32_16x16x32_bf16 v[252:255], v[68:71], v[36:39], v[252:255]
  s_waitcnt lgkmcnt(2)
  v_mfma_f32_16x16x32_bf16 v[184:187], v[72:75], v[40:43], v[184:187]
  ds_read_b128 v[16:19], v15 offset:18432
  v_mfma_f32_16x16x32_bf16 v[188:191], v[72:75], v[44:47], v[188:191]
  ds_read_b128 v[20:23], v15 offset:19456
  v_mfma_f32_16x16x32_bf16 v[192:195], v[72:75], v[48:51], v[192:195]
  s_waitcnt lgkmcnt(2)
  s_barrier
  v_add_u32 v8, 98304, v5
  v_mfma_f32_16x16x32_bf16 v[196:199], v[72:75], v[52:55], v[196:199]
  ds_read_b64_tr_b16 v[84:85], v8
  v_mfma_f32_16x16x32_bf16 v[200:203], v[72:75], v[56:59], v[200:203]
  ds_read_b64_tr_b16 v[86:87], v8 offset:6144
  v_mfma_f32_16x16x32_bf16 v[204:207], v[72:75], v[60:63], v[204:207]
  v_mfma_f32_16x16x32_bf16 v[208:211], v[76:79], v[40:43], v[208:211]
  ds_read_b128 v[24:27], v15 offset:20480
  v_mfma_f32_16x16x32_bf16 v[212:215], v[76:79], v[44:47], v[212:215]
  ds_read_b128 v[28:31], v15 offset:21504
  v_mfma_f32_16x16x32_bf16 v[216:219], v[76:79], v[48:51], v[216:219]
  v_add_u32 v9, 98304, v6
  v_mfma_f32_16x16x32_bf16 v[220:223], v[76:79], v[52:55], v[220:223]
  ds_read_b64_tr_b16 v[64:65], v9
  v_mfma_f32_16x16x32_bf16 v[224:227], v[76:79], v[56:59], v[224:227]
  ds_read_b64_tr_b16 v[66:67], v9 offset:6144
  v_mfma_f32_16x16x32_bf16 v[228:231], v[76:79], v[60:63], v[228:231]
  v_mfma_f32_16x16x32_bf16 v[232:235], v[80:83], v[40:43], v[232:235]
  ds_read_b128 v[32:35], v15 offset:22528
  v_mfma_f32_16x16x32_bf16 v[236:239], v[80:83], v[44:47], v[236:239]
  ds_read_b128 v[36:39], v15 offset:23552
  v_mfma_f32_16x16x32_bf16 v[240:243], v[80:83], v[48:51], v[240:243]
  v_add_u32 v10, 98304, v7
  v_mfma_f32_16x16x32_bf16 v[244:247], v[80:83], v[52:55], v[244:247]
  ds_read_b64_tr_b16 v[68:69], v10
  v_mfma_f32_16x16x32_bf16 v[248:251], v[80:83], v[56:59], v[248:251]
  ds_read_b64_tr_b16 v[70:71], v10 offset:6144
  v_mfma_f32_16x16x32_bf16 v[252:255], v[80:83], v[60:63], v[252:255]
  s_waitcnt lgkmcnt(2)
  v_mfma_f32_16x16x32_bf16 v[184:187], v[84:87], v[16:19], v[184:187]
  ds_read_b128 v[40:43], v15 offset:24576
  v_mfma_f32_16x16x32_bf16 v[188:191], v[84:87], v[20:23], v[188:191]
  ds_read_b128 v[44:47], v15 offset:25600
  v_mfma_f32_16x16x32_bf16 v[192:195], v[84:87], v[24:27], v[192:195]
  v_add_u32 v8, 65536, v5
  v_mfma_f32_16x16x32_bf16 v[196:199], v[84:87], v[28:31], v[196:199]
  ds_read_b64_tr_b16 v[72:73], v8
  v_mfma_f32_16x16x32_bf16 v[200:203], v[84:87], v[32:35], v[200:203]
  ds_read_b64_tr_b16 v[74:75], v8 offset:6144
  v_mfma_f32_16x16x32_bf16 v[204:207], v[84:87], v[36:39], v[204:207]
  v_mfma_f32_16x16x32_bf16 v[208:211], v[64:67], v[16:19], v[208:211]
  ds_read_b128 v[48:51], v15 offset:26624
  v_mfma_f32_16x16x32_bf16 v[212:215], v[64:67], v[20:23], v[212:215]
  ds_read_b128 v[52:55], v15 offset:27648
  v_mfma_f32_16x16x32_bf16 v[216:219], v[64:67], v[24:27], v[216:219]
  v_add_u32 v9, 65536, v6
  v_mfma_f32_16x16x32_bf16 v[220:223], v[64:67], v[28:31], v[220:223]
  ds_read_b64_tr_b16 v[76:77], v9
  v_mfma_f32_16x16x32_bf16 v[224:227], v[64:67], v[32:35], v[224:227]
  ds_read_b64_tr_b16 v[78:79], v9 offset:6144
  v_mfma_f32_16x16x32_bf16 v[228:231], v[64:67], v[36:39], v[228:231]
  s_waitcnt lgkmcnt(8)
  v_mfma_f32_16x16x32_bf16 v[232:235], v[68:71], v[16:19], v[232:235]
  ds_read_b128 v[56:59], v15 offset:28672
  v_mfma_f32_16x16x32_bf16 v[236:239], v[68:71], v[20:23], v[236:239]
  ds_read_b128 v[60:63], v15 offset:29696
  v_mfma_f32_16x16x32_bf16 v[240:243], v[68:71], v[24:27], v[240:243]
  v_add_u32 v10, 65536, v7
  v_mfma_f32_16x16x32_bf16 v[244:247], v[68:71], v[28:31], v[244:247]
  ds_read_b64_tr_b16 v[80:81], v10
  v_mfma_f32_16x16x32_bf16 v[248:251], v[68:71], v[32:35], v[248:251]
  ds_read_b64_tr_b16 v[82:83], v10 offset:6144
  v_mfma_f32_16x16x32_bf16 v[252:255], v[68:71], v[36:39], v[252:255]
  s_waitcnt lgkmcnt(2)
  v_mfma_f32_16x16x32_bf16 v[184:187], v[72:75], v[40:43], v[184:187]
  ds_read_b128 v[16:19], v15 offset:30720
  v_mfma_f32_16x16x32_bf16 v[188:191], v[72:75], v[44:47], v[188:191]
  ds_read_b128 v[20:23], v15 offset:31744
  v_mfma_f32_16x16x32_bf16 v[192:195], v[72:75], v[48:51], v[192:195]
  s_waitcnt lgkmcnt(2)
  s_barrier
  v_add_u32 v8, 49152, v5
  v_mfma_f32_16x16x32_bf16 v[196:199], v[72:75], v[52:55], v[196:199]
  ds_read_b64_tr_b16 v[84:85], v8
  v_mfma_f32_16x16x32_bf16 v[200:203], v[72:75], v[56:59], v[200:203]
  ds_read_b64_tr_b16 v[86:87], v8 offset:6144
  v_mfma_f32_16x16x32_bf16 v[204:207], v[72:75], v[60:63], v[204:207]
  v_mfma_f32_16x16x32_bf16 v[208:211], v[76:79], v[40:43], v[208:211]
  ds_read_b128 v[24:27], v15 offset:32768
  v_mfma_f32_16x16x32_bf16 v[212:215], v[76:79], v[44:47], v[212:215]
  ds_read_b128 v[28:31], v15 offset:33792
  v_mfma_f32_16x16x32_bf16 v[216:219], v[76:79], v[48:51], v[216:219]
  v_add_u32 v9, 49152, v6
  v_mfma_f32_16x16x32_bf16 v[220:223], v[76:79], v[52:55], v[220:223]
  ds_read_b64_tr_b16 v[64:65], v9
  v_mfma_f32_16x16x32_bf16 v[224:227], v[76:79], v[56:59], v[224:227]
  ds_read_b64_tr_b16 v[66:67], v9 offset:6144
  v_mfma_f32_16x16x32_bf16 v[228:231], v[76:79], v[60:63], v[228:231]
  v_mfma_f32_16x16x32_bf16 v[232:235], v[80:83], v[40:43], v[232:235]
  ds_read_b128 v[32:35], v15 offset:34816
  v_mfma_f32_16x16x32_bf16 v[236:239], v[80:83], v[44:47], v[236:239]
  ds_read_b128 v[36:39], v15 offset:35840
  v_mfma_f32_16x16x32_bf16 v[240:243], v[80:83], v[48:51], v[240:243]
  v_add_u32 v10, 49152, v7
  v_mfma_f32_16x16x32_bf16 v[244:247], v[80:83], v[52:55], v[244:247]
  ds_read_b64_tr_b16 v[68:69], v10
  v_mfma_f32_16x16x32_bf16 v[248:251], v[80:83], v[56:59], v[248:251]
  ds_read_b64_tr_b16 v[70:71], v10 offset:6144
  v_mfma_f32_16x16x32_bf16 v[252:255], v[80:83], v[60:63], v[252:255]
  s_waitcnt vmcnt(0)
  s_mov_b64 exec, 1
  buffer_store_dword v13, v14, s[40:43], s87 offen offset:0 sc1
  s_mov_b64 exec, -1
  s_waitcnt lgkmcnt(2)
  v_mfma_f32_16x16x32_bf16 v[184:187], v[84:87], v[16:19], v[184:187]
  ds_read_b128 v[40:43], v15 offset:36864
  v_mfma_f32_16x16x32_bf16 v[188:191], v[84:87], v[20:23], v[188:191]
  ds_read_b128 v[44:47], v15 offset:37888
  v_mfma_f32_16x16x32_bf16 v[192:195], v[84:87], v[24:27], v[192:195]
  v_add_u32 v8, 0, v5
  v_mfma_f32_16x16x32_bf16 v[196:199], v[84:87], v[28:31], v[196:199]
  ds_read_b64_tr_b16 v[72:73], v8
  v_mfma_f32_16x16x32_bf16 v[200:203], v[84:87], v[32:35], v[200:203]
  ds_read_b64_tr_b16 v[74:75], v8 offset:6144
  v_mfma_f32_16x16x32_bf16 v[204:207], v[84:87], v[36:39], v[204:207]
  v_mfma_f32_16x16x32_bf16 v[208:211], v[64:67], v[16:19], v[208:211]
  ds_read_b128 v[48:51], v15 offset:38912
  v_mfma_f32_16x16x32_bf16 v[212:215], v[64:67], v[20:23], v[212:215]
  ds_read_b128 v[52:55], v15 offset:39936
  v_mfma_f32_16x16x32_bf16 v[216:219], v[64:67], v[24:27], v[216:219]
  v_add_u32 v9, 0, v6
  v_mfma_f32_16x16x32_bf16 v[220:223], v[64:67], v[28:31], v[220:223]
  ds_read_b64_tr_b16 v[76:77], v9
  v_mfma_f32_16x16x32_bf16 v[224:227], v[64:67], v[32:35], v[224:227]
  ds_read_b64_tr_b16 v[78:79], v9 offset:6144
  v_mfma_f32_16x16x32_bf16 v[228:231], v[64:67], v[36:39], v[228:231]
  s_waitcnt lgkmcnt(8)
  v_mfma_f32_16x16x32_bf16 v[232:235], v[68:71], v[16:19], v[232:235]
  ds_read_b128 v[56:59], v15 offset:40960
  v_mfma_f32_16x16x32_bf16 v[236:239], v[68:71], v[20:23], v[236:239]
  ds_read_b128 v[60:63], v15 offset:41984
  v_mfma_f32_16x16x32_bf16 v[240:243], v[68:71], v[24:27], v[240:243]
  v_add_u32 v10, 0, v7
  v_mfma_f32_16x16x32_bf16 v[244:247], v[68:71], v[28:31], v[244:247]
  ds_read_b64_tr_b16 v[80:81], v10
  v_mfma_f32_16x16x32_bf16 v[248:251], v[68:71], v[32:35], v[248:251]
  ds_read_b64_tr_b16 v[82:83], v10 offset:6144
  v_mfma_f32_16x16x32_bf16 v[252:255], v[68:71], v[36:39], v[252:255]
  s_waitcnt lgkmcnt(2)
  v_mfma_f32_16x16x32_bf16 v[184:187], v[72:75], v[40:43], v[184:187]
  ds_read_b128 v[16:19], v15 offset:43008
  v_mfma_f32_16x16x32_bf16 v[188:191], v[72:75], v[44:47], v[188:191]
  ds_read_b128 v[20:23], v15 offset:44032
  v_mfma_f32_16x16x32_bf16 v[192:195], v[72:75], v[48:51], v[192:195]
  s_waitcnt lgkmcnt(2)
  s_barrier
  v_add_u32 v8, 32768, v5
  v_mfma_f32_16x16x32_bf16 v[196:199], v[72:75], v[52:55], v[196:199]
  ds_read_b64_tr_b16 v[84:85], v8
  v_mfma_f32_16x16x32_bf16 v[200:203], v[72:75], v[56:59], v[200:203]
  ds_read_b64_tr_b16 v[86:87], v8 offset:6144
  v_mfma_f32_16x16x32_bf16 v[204:207], v[72:75], v[60:63], v[204:207]
  v_mfma_f32_16x16x32_bf16 v[208:211], v[76:79], v[40:43], v[208:211]
  ds_read_b128 v[24:27], v15 offset:45056
  v_mfma_f32_16x16x32_bf16 v[212:215], v[76:79], v[44:47], v[212:215]
  ds_read_b128 v[28:31], v15 offset:46080
  v_mfma_f32_16x16x32_bf16 v[216:219], v[76:79], v[48:51], v[216:219]
  v_add_u32 v9, 32768, v6
  v_mfma_f32_16x16x32_bf16 v[220:223], v[76:79], v[52:55], v[220:223]
  ds_read_b64_tr_b16 v[64:65], v9
  v_mfma_f32_16x16x32_bf16 v[224:227], v[76:79], v[56:59], v[224:227]
  ds_read_b64_tr_b16 v[66:67], v9 offset:6144
  v_mfma_f32_16x16x32_bf16 v[228:231], v[76:79], v[60:63], v[228:231]
  v_mfma_f32_16x16x32_bf16 v[232:235], v[80:83], v[40:43], v[232:235]
  ds_read_b128 v[32:35], v15 offset:47104
  v_mfma_f32_16x16x32_bf16 v[236:239], v[80:83], v[44:47], v[236:239]
  ds_read_b128 v[36:39], v15 offset:48128
  v_mfma_f32_16x16x32_bf16 v[240:243], v[80:83], v[48:51], v[240:243]
  v_add_u32 v10, 32768, v7
  v_mfma_f32_16x16x32_bf16 v[244:247], v[80:83], v[52:55], v[244:247]
  ds_read_b64_tr_b16 v[68:69], v10
  v_mfma_f32_16x16x32_bf16 v[248:251], v[80:83], v[56:59], v[248:251]
  ds_read_b64_tr_b16 v[70:71], v10 offset:6144
  v_mfma_f32_16x16x32_bf16 v[252:255], v[80:83], v[60:63], v[252:255]
  s_waitcnt lgkmcnt(2)
  v_mfma_f32_16x16x32_bf16 v[184:187], v[84:87], v[16:19], v[184:187]
  v_mfma_f32_16x16x32_bf16 v[188:191], v[84:87], v[20:23], v[188:191]
  v_mfma_f32_16x16x32_bf16 v[192:195], v[84:87], v[24:27], v[192:195]
  v_mfma_f32_16x16x32_bf16 v[196:199], v[84:87], v[28:31], v[196:199]
  v_mfma_f32_16x16x32_bf16 v[200:203], v[84:87], v[32:35], v[200:203]
  v_mfma_f32_16x16x32_bf16 v[204:207], v[84:87], v[36:39], v[204:207]
  v_mfma_f32_16x16x32_bf16 v[208:211], v[64:67], v[16:19], v[208:211]
  v_mfma_f32_16x16x32_bf16 v[212:215], v[64:67], v[20:23], v[212:215]
  v_mfma_f32_16x16x32_bf16 v[216:219], v[64:67], v[24:27], v[216:219]
  v_mfma_f32_16x16x32_bf16 v[220:223], v[64:67], v[28:31], v[220:223]
  v_mfma_f32_16x16x32_bf16 v[224:227], v[64:67], v[32:35], v[224:227]
  v_mfma_f32_16x16x32_bf16 v[228:231], v[64:67], v[36:39], v[228:231]
  s_waitcnt lgkmcnt(0)
  v_mfma_f32_16x16x32_bf16 v[232:235], v[68:71], v[16:19], v[232:235]
  v_mfma_f32_16x16x32_bf16 v[236:239], v[68:71], v[20:23], v[236:239]
  v_mfma_f32_16x16x32_bf16 v[240:243], v[68:71], v[24:27], v[240:243]
  v_mfma_f32_16x16x32_bf16 v[244:247], v[68:71], v[28:31], v[244:247]
  v_mfma_f32_16x16x32_bf16 v[248:251], v[68:71], v[32:35], v[248:251]
  v_mfma_f32_16x16x32_bf16 v[252:255], v[68:71], v[36:39], v[252:255]
  v_cvt_pk_bf16_f32 v184, v184, v185
  v_cvt_pk_bf16_f32 v185, v186, v187
  v_cvt_pk_bf16_f32 v186, v188, v189
  v_cvt_pk_bf16_f32 v187, v190, v191
  s_nop 0
  v_permlane16_swap_b32 v184, v186
  v_permlane16_swap_b32 v185, v187
  buffer_store_dwordx4 v[184:187], v11, s[40:43], s86 offen offset:0 sc1
  s_mov_b64 exec, s[90:91]
  ds_write_b128 v12, v[184:187] offset:0
  s_mov_b64 exec, -1
  v_cvt_pk_bf16_f32 v192, v192, v193
  v_cvt_pk_bf16_f32 v193, v194, v195
  v_cvt_pk_bf16_f32 v194, v196, v197
  v_cvt_pk_bf16_f32 v195, v198, v199
  s_nop 0
  v_permlane16_swap_b32 v192, v194
  v_permlane16_swap_b32 v193, v195
  buffer_store_dwordx4 v[192:195], v11, s[40:43], s86 offen offset:128 sc1
  s_mov_b64 exec, s[90:91]
  ds_write_b128 v12, v[192:195] offset:128
  s_mov_b64 exec, -1
  v_cvt_pk_bf16_f32 v200, v200, v201
  v_cvt_pk_bf16_f32 v201, v202, v203
  v_cvt_pk_bf16_f32 v202, v204, v205
  v_cvt_pk_bf16_f32 v203, v206, v207
  s_nop 0
  v_permlane16_swap_b32 v200, v202
  v_permlane16_swap_b32 v201, v203
  buffer_store_dwordx4 v[200:203], v11, s[40:43], s86 offen offset:256 sc1
  s_mov_b64 exec, s[90:91]
  ds_write_b128 v12, v[200:203] offset:256
  s_mov_b64 exec, -1
  v_cvt_pk_bf16_f32 v208, v208, v209
  v_cvt_pk_bf16_f32 v209, v210, v211
  v_cvt_pk_bf16_f32 v210, v212, v213
  v_cvt_pk_bf16_f32 v211, v214, v215
  s_nop 0
  v_permlane16_swap_b32 v208, v210
  v_permlane16_swap_b32 v209, v211
  buffer_store_dwordx4 v[208:211], v11, s[40:43], s86 offen offset:384 sc1
  s_mov_b64 exec, s[90:91]
  ds_write_b128 v12, v[208:211] offset:384
  s_mov_b64 exec, -1
  v_cvt_pk_bf16_f32 v216, v216, v217
  v_cvt_pk_bf16_f32 v217, v218, v219
  v_cvt_pk_bf16_f32 v218, v220, v221
  v_cvt_pk_bf16_f32 v219, v222, v223
  s_nop 0
  v_permlane16_swap_b32 v216, v218
  v_permlane16_swap_b32 v217, v219
  buffer_store_dwordx4 v[216:219], v11, s[40:43], s86 offen offset:512 sc1
  s_mov_b64 exec, s[90:91]
  ds_write_b128 v12, v[216:219] offset:512
  s_mov_b64 exec, -1
  v_cvt_pk_bf16_f32 v224, v224, v225
  v_cvt_pk_bf16_f32 v225, v226, v227
  v_cvt_pk_bf16_f32 v226, v228, v229
  v_cvt_pk_bf16_f32 v227, v230, v231
  s_nop 0
  v_permlane16_swap_b32 v224, v226
  v_permlane16_swap_b32 v225, v227
  buffer_store_dwordx4 v[224:227], v11, s[40:43], s86 offen offset:640 sc1
  s_mov_b64 exec, s[90:91]
  ds_write_b128 v12, v[224:227] offset:640
  s_mov_b64 exec, -1
  v_cvt_pk_bf16_f32 v232, v232, v233
  v_cvt_pk_bf16_f32 v233, v234, v235
  v_cvt_pk_bf16_f32 v234, v236, v237
  v_cvt_pk_bf16_f32 v235, v238, v239
  s_nop 0
  v_permlane16_swap_b32 v232, v234
  v_permlane16_swap_b32 v233, v235
  buffer_store_dwordx4 v[232:235], v11, s[40:43], s86 offen offset:768 sc1
  s_mov_b64 exec, s[90:91]
  ds_write_b128 v12, v[232:235] offset:768
  s_mov_b64 exec, -1
  v_cvt_pk_bf16_f32 v240, v240, v241
  v_cvt_pk_bf16_f32 v241, v242, v243
  v_cvt_pk_bf16_f32 v242, v244, v245
  v_cvt_pk_bf16_f32 v243, v246, v247
  s_nop 0
  v_permlane16_swap_b32 v240, v242
  v_permlane16_swap_b32 v241, v243
  buffer_store_dwordx4 v[240:243], v11, s[40:43], s86 offen offset:896 sc1
  s_mov_b64 exec, s[90:91]
  ds_write_b128 v12, v[240:243] offset:896
  s_branch L_pads16
L_pad16:
  s_setpc_b64 s[60:61]
L_pads16:
  s_mov_b64 exec, -1
  v_cvt_pk_bf16_f32 v248, v248, v249
  v_cvt_pk_bf16_f32 v249, v250, v251
  v_cvt_pk_bf16_f32 v250, v252, v253
  v_cvt_pk_bf16_f32 v251, v254, v255
  s_nop 0
  v_permlane16_swap_b32 v248, v250
  v_permlane16_swap_b32 v249, v251
  buffer_store_dwordx4 v[248:251], v11, s[40:43], s86 offen offset:1024 sc1
  s_mov_b64 exec, s[90:91]
  ds_write_b128 v12, v[248:251] offset:1024
  s_mov_b64 exec, -1
  s_waitcnt vmcnt(0)
  s_mov_b64 exec, 1
  buffer_store_dword v13, v14, s[40:43], s87 offen offset:128 sc1
  s_mov_b64 exec, -1
  s_branch L_redop
L_op0zF:
  v_add_u32 v12, s77, v15
  v_add_u32 v8, s76, v4
  ds_read_b64_tr_b16 v[64:65], v8
  ds_read_b64_tr_b16 v[66:67], v8 offset:8192
  ds_read_b128 v[16:19], v12 offset:0
  ds_read_b128 v[20:23], v12 offset:1024
  v_xor_b32 v10, 32, v8
  ds_read_b64_tr_b16 v[68:69], v10
  ds_read_b64_tr_b16 v[70:71], v10 offset:8192
  v_xor_b32 v9, 64, v8
  ds_read_b64_tr_b16 v[72:73], v9
  ds_read_b64_tr_b16 v[74:75], v9 offset:8192
  v_xor_b32 v10, 96, v8
  ds_read_b64_tr_b16 v[76:77], v10
  ds_read_b64_tr_b16 v[78:79], v10 offset:8192
  ds_read_b128 v[24:27], v12 offset:2048
  ds_read_b128 v[28:31], v12 offset:3072
  ds_read_b128 v[32:35], v12 offset:4096
  ds_read_b128 v[36:39], v12 offset:5120
  s_waitcnt lgkmcnt(11)
  v_mfma_f32_16x16x32_bf16 v[88:91], v[64:67], v[16:19], 0
  s_waitcnt lgkmcnt(10)
  v_mfma_f32_16x16x32_bf16 v[92:95], v[64:67], v[20:23], 0
  s_waitcnt lgkmcnt(8)
  v_mfma_f32_16x16x32_bf16 v[112:115], v[68:71], v[16:19], 0
  v_mfma_f32_16x16x32_bf16 v[116:119], v[68:71], v[20:23], 0
  s_waitcnt lgkmcnt(6)
  v_mfma_f32_16x16x32_bf16 v[136:139], v[72:75], v[16:19], 0
  v_mfma_f32_16x16x32_bf16 v[140:143], v[72:75], v[20:23], 0
  s_waitcnt lgkmcnt(4)
  v_mfma_f32_16x16x32_bf16 v[160:163], v[76:79], v[16:19], 0
  v_mfma_f32_16x16x32_bf16 v[164:167], v[76:79], v[20:23], 0
  s_waitcnt lgkmcnt(3)
  v_mfma_f32_16x16x32_bf16 v[96:99], v[64:67], v[24:27], 0
  s_waitcnt lgkmcnt(2)
  v_mfma_f32_16x16x32_bf16 v[100:103], v[64:67], v[28:31], 0
  v_mfma_f32_16x16x32_bf16 v[120:123], v[68:71], v[24:27], 0
  v_mfma_f32_16x16x32_bf16 v[124:127], v[68:71], v[28:31], 0
  s_waitcnt lgkmcnt(0)
  s_setpc_b64 s[60:61]
L_op0zS:
  v_mfma_f32_16x16x32_bf16 v[144:147], v[72:75], v[24:27], 0
  v_mfma_f32_16x16x32_bf16 v[148:151], v[72:75], v[28:31], 0
  v_mfma_f32_16x16x32_bf16 v[168:171], v[76:79], v[24:27], 0
  v_mfma_f32_16x16x32_bf16 v[172:175], v[76:79], v[28:31], 0
  v_mfma_f32_16x16x32_bf16 v[104:107], v[64:67], v[32:35], 0
  v_mfma_f32_16x16x32_bf16 v[108:111], v[64:67], v[36:39], 0
  v_mfma_f32_16x16x32_bf16 v[128:131], v[68:71], v[32:35], 0
  v_mfma_f32_16x16x32_bf16 v[132:135], v[68:71], v[36:39], 0
  v_mfma_f32_16x16x32_bf16 v[152:155], v[72:75], v[32:35], 0
  v_mfma_f32_16x16x32_bf16 v[156:159], v[72:75], v[36:39], 0
  v_mfma_f32_16x16x32_bf16 v[176:179], v[76:79], v[32:35], 0
  v_mfma_f32_16x16x32_bf16 v[180:183], v[76:79], v[36:39], 0
  s_setpc_b64 s[60:61]
L_op0F:
  v_add_u32 v12, s77, v15
  v_add_u32 v8, s76, v4
  ds_read_b64_tr_b16 v[64:65], v8
  ds_read_b64_tr_b16 v[66:67], v8 offset:8192
  ds_read_b128 v[16:19], v12 offset:0
  ds_read_b128 v[20:23], v12 offset:1024
  v_xor_b32 v10, 32, v8
  ds_read_b64_tr_b16 v[68:69], v10
  ds_read_b64_tr_b16 v[70:71], v10 offset:8192
  v_xor_b32 v9, 64, v8
  ds_read_b64_tr_b16 v[72:73], v9
  ds_read_b64_tr_b16 v[74:75], v9 offset:8192
  v_xor_b32 v10, 96, v8
  ds_read_b64_tr_b16 v[76:77], v10
  ds_read_b64_tr_b16 v[78:79], v10 offset:8192
  ds_read_b128 v[24:27], v12 offset:2048
  ds_read_b128 v[28:31], v12 offset:3072
  ds_read_b128 v[32:35], v12 offset:4096
  ds_read_b128 v[36:39], v12 offset:5120
  s_waitcnt lgkmcnt(11)
  v_mfma_f32_16x16x32_bf16 v[88:91], v[64:67], v[16:19], v[88:91]
  s_waitcnt lgkmcnt(10)
  v_mfma_f32_16x16x32_bf16 v[92:95], v[64:67], v[20:23], v[92:95]
  s_waitcnt lgkmcnt(8)
  v_mfma_f32_16x16x32_bf16 v[112:115], v[68:71], v[16:19], v[112:115]
  v_mfma_f32_16x16x32_bf16 v[116:119], v[68:71], v[20:23], v[116:119]
  s_waitcnt lgkmcnt(6)
  v_mfma_f32_16x16x32_bf16 v[136:139], v[72:75], v[16:19], v[136:139]
  v_mfma_f32_16x16x32_bf16 v[140:143], v[72:75], v[20:23], v[140:143]
  s_waitcnt lgkmcnt(4)
  v_mfma_f32_16x16x32_bf16 v[160:163], v[76:79], v[16:19], v[160:163]
  v_mfma_f32_16x16x32_bf16 v[164:167], v[76:79], v[20:23], v[164:167]
  s_waitcnt lgkmcnt(3)
  v_mfma_f32_16x16x32_bf16 v[96:99], v[64:67], v[24:27], v[96:99]
  s_waitcnt lgkmcnt(2)
  v_mfma_f32_16x16x32_bf16 v[100:103], v[64:67], v[28:31], v[100:103]
  v_mfma_f32_16x16x32_bf16 v[120:123], v[68:71], v[24:27], v[120:123]
  v_mfma_f32_16x16x32_bf16 v[124:127], v[68:71], v[28:31], v[124:127]
  s_waitcnt lgkmcnt(0)
  s_setpc_b64 s[60:61]
L_op0S:
  v_mfma_f32_16x16x32_bf16 v[144:147], v[72:75], v[24:27], v[144:147]
  v_mfma_f32_16x16x32_bf16 v[148:151], v[72:75], v[28:31], v[148:151]
  v_mfma_f32_16x16x32_bf16 v[168:171], v[76:79], v[24:27], v[168:171]
  v_mfma_f32_16x16x32_bf16 v[172:175], v[76:79], v[28:31], v[172:175]
  v_mfma_f32_16x16x32_bf16 v[104:107], v[64:67], v[32:35], v[104:107]
  v_mfma_f32_16x16x32_bf16 v[108:111], v[64:67], v[36:39], v[108:111]
  v_mfma_f32_16x16x32_bf16 v[128:131], v[68:71], v[32:35], v[128:131]
  v_mfma_f32_16x16x32_bf16 v[132:135], v[68:71], v[36:39], v[132:135]
  v_mfma_f32_16x16x32_bf16 v[152:155], v[72:75], v[32:35], v[152:155]
  v_mfma_f32_16x16x32_bf16 v[156:159], v[72:75], v[36:39], v[156:159]
  v_mfma_f32_16x16x32_bf16 v[176:179], v[76:79], v[32:35], v[176:179]
  v_mfma_f32_16x16x32_bf16 v[180:183], v[76:79], v[36:39], v[180:183]
  s_setpc_b64 s[60:61]
L_op1zF:
  v_add_u32 v12, s77, v15
  v_add_u32 v8, s76, v5
  ds_read_b64_tr_b16 v[64:65], v8
  ds_read_b64_tr_b16 v[66:67], v8 offset:6144
  ds_read_b128 v[16:19], v12 offset:0
  ds_read_b128 v[20:23], v12 offset:1024
  v_add_u32 v9, s76, v6
  ds_read_b64_tr_b16 v[68:69], v9
  ds_read_b64_tr_b16 v[70:71], v9 offset:6144
  v_add_u32 v10, s76, v7
  ds_read_b64_tr_b16 v[72:73], v10
  ds_read_b64_tr_b16 v[74:75], v10 offset:6144
  ds_read_b128 v[24:27], v12 offset:2048
  ds_read_b128 v[28:31], v12 offset:3072
  ds_read_b128 v[32:35], v12 offset:4096
  ds_read_b128 v[36:39], v12 offset:5120
  s_waitcnt lgkmcnt(9)
  v_mfma_f32_16x16x32_bf16 v[184:187], v[64:67], v[16:19], 0
  s_waitcnt lgkmcnt(8)
  v_mfma_f32_16x16x32_bf16 v[188:191], v[64:67], v[20:23], 0
  s_waitcnt lgkmcnt(6)
  v_mfma_f32_16x16x32_bf16 v[208:211], v[68:71], v[16:19], 0
  v_mfma_f32_16x16x32_bf16 v[212:215], v[68:71], v[20:23], 0
  s_waitcnt lgkmcnt(4)
  v_mfma_f32_16x16x32_bf16 v[232:235], v[72:75], v[16:19], 0
  v_mfma_f32_16x16x32_bf16 v[236:239], v[72:75], v[20:23], 0
  s_waitcnt lgkmcnt(3)
  v_mfma_f32_16x16x32_bf16 v[192:195], v[64:67], v[24:27], 0
  s_waitcnt lgkmcnt(2)
  v_mfma_f32_16x16x32_bf16 v[196:199], v[64:67], v[28:31], 0
  v_mfma_f32_16x16x32_bf16 v[216:219], v[68:71], v[24:27], 0
  s_waitcnt lgkmcnt(0)
  s_setpc_b64 s[60:61]
L_op1zN:
  v_add_u32 v8, s76, v5
  ds_read_b64_tr_b16 v[64:65], v8
  ds_read_b64_tr_b16 v[66:67], v8 offset:6144
  v_add_u32 v9, s76, v6
  ds_read_b64_tr_b16 v[68:69], v9
  ds_read_b64_tr_b16 v[70:71], v9 offset:6144
  v_add_u32 v10, s76, v7
  ds_read_b64_tr_b16 v[72:73], v10
  ds_read_b64_tr_b16 v[74:75], v10 offset:6144
  s_waitcnt lgkmcnt(4)
  v_mfma_f32_16x16x32_bf16 v[184:187], v[64:67], v[16:19], 0
  v_mfma_f32_16x16x32_bf16 v[188:191], v[64:67], v[20:23], 0
  s_waitcnt lgkmcnt(2)
  v_mfma_f32_16x16x32_bf16 v[208:211], v[68:71], v[16:19], 0
  v_mfma_f32_16x16x32_bf16 v[212:215], v[68:71], v[20:23], 0
  s_waitcnt lgkmcnt(0)
  v_mfma_f32_16x16x32_bf16 v[232:235], v[72:75], v[16:19], 0
  v_mfma_f32_16x16x32_bf16 v[236:239], v[72:75], v[20:23], 0
  v_mfma_f32_16x16x32_bf16 v[192:195], v[64:67], v[24:27], 0
  v_mfma_f32_16x16x32_bf16 v[196:199], v[64:67], v[28:31], 0
  v_mfma_f32_16x16x32_bf16 v[216:219], v[68:71], v[24:27], 0
  s_waitcnt lgkmcnt(0)
  s_setpc_b64 s[60:61]
L_op1zS:
  v_mfma_f32_16x16x32_bf16 v[220:223], v[68:71], v[28:31], 0
  v_mfma_f32_16x16x32_bf16 v[240:243], v[72:75], v[24:27], 0
  v_mfma_f32_16x16x32_bf16 v[244:247], v[72:75], v[28:31], 0
  v_mfma_f32_16x16x32_bf16 v[200:203], v[64:67], v[32:35], 0
  v_mfma_f32_16x16x32_bf16 v[204:207], v[64:67], v[36:39], 0
  v_mfma_f32_16x16x32_bf16 v[224:227], v[68:71], v[32:35], 0
  v_mfma_f32_16x16x32_bf16 v[228:231], v[68:71], v[36:39], 0
  v_mfma_f32_16x16x32_bf16 v[248:251], v[72:75], v[32:35], 0
  v_mfma_f32_16x16x32_bf16 v[252:255], v[72:75], v[36:39], 0
  s_setpc_b64 s[60:61]
L_op1F:
  v_add_u32 v12, s77, v15
  v_add_u32 v8, s76, v5
  ds_read_b64_tr_b16 v[64:65], v8
  ds_read_b64_tr_b16 v[66:67], v8 offset:6144
  ds_read_b128 v[16:19], v12 offset:0
  ds_read_b128 v[20:23], v12 offset:1024
  v_add_u32 v9, s76, v6
  ds_read_b64_tr_b16 v[68:69], v9
  ds_read_b64_tr_b16 v[70:71], v9 offset:6144
  v_add_u32 v10, s76, v7
  ds_read_b64_tr_b16 v[72:73], v10
  ds_read_b64_tr_b16 v[74:75], v10 offset:6144
  ds_read_b128 v[24:27], v12 offset:2048
  ds_read_b128 v[28:31], v12 offset:3072
  ds_read_b128 v[32:35], v12 offset:4096
  ds_read_b128 v[36:39], v12 offset:5120
  s_waitcnt lgkmcnt(9)
  v_mfma_f32_16x16x32_bf16 v[184:187], v[64:67], v[16:19], v[184:187]
  s_waitcnt lgkmcnt(8)
  v_mfma_f32_16x16x32_bf16 v[188:191], v[64:67], v[20:23], v[188:191]
  s_waitcnt lgkmcnt(6)
  v_mfma_f32_16x16x32_bf16 v[208:211], v[68:71], v[16:19], v[208:211]
  v_mfma_f32_16x16x32_bf16 v[212:215], v[68:71], v[20:23], v[212:215]
  s_waitcnt lgkmcnt(4)
  v_mfma_f32_16x16x32_bf16 v[232:235], v[72:75], v[16:19], v[232:235]
  v_mfma_f32_16x16x32_bf16 v[236:239], v[72:75], v[20:23], v[236:239]
  s_waitcnt lgkmcnt(3)
  v_mfma_f32_16x16x32_bf16 v[192:195], v[64:67], v[24:27], v[192:195]
  s_waitcnt lgkmcnt(2)
  v_mfma_f32_16x16x32_bf16 v[196:199], v[64:67], v[28:31], v[196:199]
  v_mfma_f32_16x16x32_bf16 v[216:219], v[68:71], v[24:27], v[216:219]
  s_waitcnt lgkmcnt(0)
  s_setpc_b64 s[60:61]
L_op1N:
  v_add_u32 v8, s76, v5
  ds_read_b64_tr_b16 v[64:65], v8
  ds_read_b64_tr_b16 v[66:67], v8 offset:6144
  v_add_u32 v9, s76, v6
  ds_read_b64_tr_b16 v[68:69], v9
  ds_read_b64_tr_b16 v[70:71], v9 offset:6144
  v_add_u32 v10, s76, v7
  ds_read_b64_tr_b16 v[72:73], v10
  ds_read_b64_tr_b16 v[74:75], v10 offset:6144
  s_waitcnt lgkmcnt(4)
  v_mfma_f32_16x16x32_bf16 v[184:187], v[64:67], v[16:19], v[184:187]
  v_mfma_f32_16x16x32_bf16 v[188:191], v[64:67], v[20:23], v[188:191]
  s_waitcnt lgkmcnt(2)
  v_mfma_f32_16x16x32_bf16 v[208:211], v[68:71], v[16:19], v[208:211]
  v_mfma_f32_16x16x32_bf16 v[212:215], v[68:71], v[20:23], v[212:215]
  s_waitcnt lgkmcnt(0)
  v_mfma_f32_16x16x32_bf16 v[232:235], v[72:75], v[16:19], v[232:235]
  v_mfma_f32_16x16x32_bf16 v[236:239], v[72:75], v[20:23], v[236:239]
  v_mfma_f32_16x16x32_bf16 v[192:195], v[64:67], v[24:27], v[192:195]
  v_mfma_f32_16x16x32_bf16 v[196:199], v[64:67], v[28:31], v[196:199]
  v_mfma_f32_16x16x32_bf16 v[216:219], v[68:71], v[24:27], v[216:219]
  s_waitcnt lgkmcnt(0)
  s_setpc_b64 s[60:61]
L_op1S:
  v_mfma_f32_16x16x32_bf16 v[220:223], v[68:71], v[28:31], v[220:223]
  v_mfma_f32_16x16x32_bf16 v[240:243], v[72:75], v[24:27], v[240:243]
  v_mfma_f32_16x16x32_bf16 v[244:247], v[72:75], v[28:31], v[244:247]
  v_mfma_f32_16x16x32_bf16 v[200:203], v[64:67], v[32:35], v[200:203]
  v_mfma_f32_16x16x32_bf16 v[204:207], v[64:67], v[36:39], v[204:207]
  v_mfma_f32_16x16x32_bf16 v[224:227], v[68:71], v[32:35], v[224:227]
  v_mfma_f32_16x16x32_bf16 v[228:231], v[68:71], v[36:39], v[228:231]
  v_mfma_f32_16x16x32_bf16 v[248:251], v[72:75], v[32:35], v[248:251]
  v_mfma_f32_16x16x32_bf16 v[252:255], v[72:75], v[36:39], v[252:255]
  s_setpc_b64 s[60:61]
L_red:
  s_waitcnt lgkmcnt(0)
  s_setprio 0
  s_mov_b32 s24, s14
  s_mov_b32 s25, s15
  s_mov_b32 s26, 2752512
  s_mov_b32 s27, 0x20000
  v_lshlrev_b32 v6, 2, v0
  s_lshl_b32 s65, s45, 9
  s_add_u32 s65, s65, 23068672
  v_mov_b32 v8, 0
  s_mov_b32 s83, 0xffff0000
  s_branch L_gate
L_redop:
  s_waitcnt lgkmcnt(0)
  s_setprio 0
  s_mov_b32 s24, s14
  s_mov_b32 s25, s15
  s_mov_b32 s26, 2752512
  s_mov_b32 s27, 0x20000
  v_lshlrev_b32 v6, 2, v0
  s_lshl_b32 s65, s45, 9
  s_add_u32 s65, s65, 23068672
  v_mov_b32 v8, 0
  s_mov_b32 s83, 0xffff0000
L_gate:
  s_barrier
  buffer_load_dword v3, v6, s[40:43], s65 offen sc1
  s_lshl_b32 s66, s44, 3
  s_add_u32 s66, s66, s46
  s_mov_b32 s69, 0
  s_cmp_ge_u32 s66, 48
  s_cbranch_scc1 L_st1
  s_call_b64 s[60:61], L_unit
  s_mov_b32 s69, 1
L_st1:
  s_cmp_lt_u32 s44, 3
  s_cbranch_scc1 L_fin
  s_add_u32 s66, s44, 3
  s_lshl_b32 s66, s66, 3
  s_add_u32 s66, s66, s46
  s_call_b64 s[60:61], L_unit
  s_branch L_fin
L_unit:
  s_cmp_lt_u32 s66, 48
  s_cselect_b32 s70, -1, 0
  s_cselect_b32 s71, 0, -1
  s_lshl_b32 s50, s46, 2
  s_lshl_b32 s50, 15, s50
  s_andn2_b32 s70, s70, s50
  s_andn2_b32 s71, s71, s50
  s_and_b32 s68, s66, 7
  s_lshr_b32 s66, s66, 3
  s_lshl_b32 s50, s66, 6
  v_add_u32 v4, s50, v0
  v_lshlrev_b32 v5, 4, v4
  v_add_u32 v9, 81920, v5
  ds_read_b128 v[16:19], v9
  v_lshrrev_b32 v9, 3, v4
  v_mul_u32_u24 v10, 21846, v9
  v_lshrrev_b32 v10, 16, v10
  v_mul_u32_u24 v12, 3, v10
  v_sub_u32 v9, v9, v12
  v_mul_u32_u24 v9, 28672, v9
  v_lshlrev_b32 v10, 5, v10
  v_add_u32 v9, v9, v10
  v_bfe_u32 v10, v4, 1, 2
  v_mul_u32_u24 v10, 896, v10
  v_add_u32 v9, v9, v10
  v_and_b32 v10, 1, v4
  v_lshlrev_b32 v10, 4, v10
  v_add_u32 v7, v9, v10
  v_cmp_le_u32 vcc, 672, v4
  v_mov_b32 v9, 0x7f000000
  s_nop 0
  v_cndmask_b32 v7, v7, v9, vcc
  v_cndmask_b32 v5, v5, v9, vcc
  s_mul_i32 s62, s45, 688128
  s_mul_i32 s50, s68, 10752
  s_add_u32 s62, s62, s50
  s_mul_i32 s63, s45, 96
  s_lshl_b32 s50, s68, 2
  s_add_u32 s63, s63, s50
  s_mul_i32 s63, s63, 896
  s_mov_b32 s51, 0
  s_cmp_eq_u32 s69, 0
  s_cbranch_scc1 L_poll1
  s_waitcnt vmcnt(1)
  s_branch L_poll2
L_poll:
  s_sleep 4
  buffer_load_dword v3, v6, s[40:43], s65 offen sc1
L_poll1:
  s_waitcnt vmcnt(0)
L_poll2:
  s_add_u32 s51, s51, 1
  v_cmp_ne_u32 vcc, 1, v3
  s_cmp_ge_u32 s51, 0x200000
  s_cbranch_scc1 L_pdone
  s_and_b64 s[72:73], vcc, s[70:71]
  s_cbranch_scc1 L_poll
L_pdone:
  s_add_u32 s50, s46, 1
  s_and_b32 s50, s50, 7
  s_mul_i32 s50, s50, 86016
  s_add_u32 s50, s50, s62
  buffer_load_dwordx4 v[20:23], v5, s[40:43], s50 offen sc1
  s_add_u32 s50, s46, 2
  s_and_b32 s50, s50, 7
  s_mul_i32 s50, s50, 86016
  s_add_u32 s50, s50, s62
  buffer_load_dwordx4 v[24:27], v5, s[40:43], s50 offen sc1
  s_add_u32 s50, s46, 3
  s_and_b32 s50, s50, 7
  s_mul_i32 s50, s50, 86016
  s_add_u32 s50, s50, s62
  buffer_load_dwordx4 v[28:31], v5, s[40:43], s50 offen sc1
  s_add_u32 s50, s46, 4
  s_and_b32 s50, s50, 7
  s_mul_i32 s50, s50, 86016
  s_add_u32 s50, s50, s62
  buffer_load_dwordx4 v[32:35], v5, s[40:43], s50 offen sc1
  s_add_u32 s50, s46, 5
  s_and_b32 s50, s50, 7
  s_mul_i32 s50, s50, 86016
  s_add_u32 s50, s50, s62
  buffer_load_dwordx4 v[36:39], v5, s[40:43], s50 offen sc1
  s_add_u32 s50, s46, 6
  s_and_b32 s50, s50, 7
  s_mul_i32 s50, s50, 86016
  s_add_u32 s50, s50, s62
  buffer_load_dwordx4 v[40:43], v5, s[40:43], s50 offen sc1
  s_add_u32 s50, s46, 7
  s_and_b32 s50, s50, 7
  s_mul_i32 s50, s50, 86016
  s_add_u32 s50, s50, s62
  buffer_load_dwordx4 v[44:47], v5, s[40:43], s50 offen sc1
  buffer_load_dword v3, v6, s[40:43], s65 offen sc1
  s_waitcnt lgkmcnt(0)
  v_lshlrev_b32 v80, 16, v16
  v_and_b32 v81, s83, v16
  v_lshlrev_b32 v82, 16, v17
  v_and_b32 v83, s83, v17
  v_lshlrev_b32 v84, 16, v18
  v_and_b32 v85, s83, v18
  v_lshlrev_b32 v86, 16, v19
  v_and_b32 v87, s83, v19
  s_waitcnt vmcnt(7)
  v_lshlrev_b32 v9, 16, v20
  v_and_b32 v10, s83, v20
  v_add_f32 v80, v80, v9
  v_add_f32 v81, v81, v10
  v_lshlrev_b32 v9, 16, v21
  v_and_b32 v10, s83, v21
  v_add_f32 v82, v82, v9
  v_add_f32 v83, v83, v10
  v_lshlrev_b32 v9, 16, v22
  v_and_b32 v10, s83, v22
  v_add_f32 v84, v84, v9
  v_add_f32 v85, v85, v10
  v_lshlrev_b32 v9, 16, v23
  v_and_b32 v10, s83, v23
  v_add_f32 v86, v86, v9
  v_add_f32 v87, v87, v10
  s_waitcnt vmcnt(6)
  v_lshlrev_b32 v9, 16, v24
  v_and_b32 v10, s83, v24
  v_add_f32 v80, v80, v9
  v_add_f32 v81, v81, v10
  v_lshlrev_b32 v9, 16, v25
  v_and_b32 v10, s83, v25
  v_add_f32 v82, v82, v9
  v_add_f32 v83, v83, v10
  v_lshlrev_b32 v9, 16, v26
  v_and_b32 v10, s83, v26
  v_add_f32 v84, v84, v9
  v_add_f32 v85, v85, v10
  v_lshlrev_b32 v9, 16, v27
  v_and_b32 v10, s83, v27
  v_add_f32 v86, v86, v9
  v_add_f32 v87, v87, v10
  s_waitcnt vmcnt(5)
  v_lshlrev_b32 v9, 16, v28
  v_and_b32 v10, s83, v28
  v_add_f32 v80, v80, v9
  v_add_f32 v81, v81, v10
  v_lshlrev_b32 v9, 16, v29
  v_and_b32 v10, s83, v29
  v_add_f32 v82, v82, v9
  v_add_f32 v83, v83, v10
  v_lshlrev_b32 v9, 16, v30
  v_and_b32 v10, s83, v30
  v_add_f32 v84, v84, v9
  v_add_f32 v85, v85, v10
  v_lshlrev_b32 v9, 16, v31
  v_and_b32 v10, s83, v31
  v_add_f32 v86, v86, v9
  v_add_f32 v87, v87, v10
  s_waitcnt vmcnt(4)
  v_lshlrev_b32 v9, 16, v32
  v_and_b32 v10, s83, v32
  v_add_f32 v80, v80, v9
  v_add_f32 v81, v81, v10
  v_lshlrev_b32 v9, 16, v33
  v_and_b32 v10, s83, v33
  v_add_f32 v82, v82, v9
  v_add_f32 v83, v83, v10
  v_lshlrev_b32 v9, 16, v34
  v_and_b32 v10, s83, v34
  v_add_f32 v84, v84, v9
  v_add_f32 v85, v85, v10
  v_lshlrev_b32 v9, 16, v35
  v_and_b32 v10, s83, v35
  v_add_f32 v86, v86, v9
  v_add_f32 v87, v87, v10
  s_waitcnt vmcnt(3)
  v_lshlrev_b32 v9, 16, v36
  v_and_b32 v10, s83, v36
  v_add_f32 v80, v80, v9
  v_add_f32 v81, v81, v10
  v_lshlrev_b32 v9, 16, v37
  v_and_b32 v10, s83, v37
  v_add_f32 v82, v82, v9
  v_add_f32 v83, v83, v10
  v_lshlrev_b32 v9, 16, v38
  v_and_b32 v10, s83, v38
  v_add_f32 v84, v84, v9
  v_add_f32 v85, v85, v10
  v_lshlrev_b32 v9, 16, v39
  v_and_b32 v10, s83, v39
  v_add_f32 v86, v86, v9
  v_add_f32 v87, v87, v10
  s_waitcnt vmcnt(2)
  v_lshlrev_b32 v9, 16, v40
  v_and_b32 v10, s83, v40
  v_add_f32 v80, v80, v9
  v_add_f32 v81, v81, v10
  v_lshlrev_b32 v9, 16, v41
  v_and_b32 v10, s83, v41
  v_add_f32 v82, v82, v9
  v_add_f32 v83, v83, v10
  v_lshlrev_b32 v9, 16, v42
  v_and_b32 v10, s83, v42
  v_add_f32 v84, v84, v9
  v_add_f32 v85, v85, v10
  v_lshlrev_b32 v9, 16, v43
  v_and_b32 v10, s83, v43
  v_add_f32 v86, v86, v9
  v_add_f32 v87, v87, v10
  s_waitcnt vmcnt(1)
  v_lshlrev_b32 v9, 16, v44
  v_and_b32 v10, s83, v44
  v_add_f32 v80, v80, v9
  v_add_f32 v81, v81, v10
  v_lshlrev_b32 v9, 16, v45
  v_and_b32 v10, s83, v45
  v_add_f32 v82, v82, v9
  v_add_f32 v83, v83, v10
  v_lshlrev_b32 v9, 16, v46
  v_and_b32 v10, s83, v46
  v_add_f32 v84, v84, v9
  v_add_f32 v85, v85, v10
  v_lshlrev_b32 v9, 16, v47
  v_and_b32 v10, s83, v47
  v_add_f32 v86, v86, v9
  v_add_f32 v87, v87, v10
  v_cvt_pk_bf16_f32 v88, v80, v81
  v_cvt_pk_bf16_f32 v89, v82, v83
  v_cvt_pk_bf16_f32 v90, v84, v85
  v_cvt_pk_bf16_f32 v91, v86, v87
  buffer_store_dwordx4 v[88:91], v7, s[24:27], s63 offen
  s_nop 1
  s_setpc_b64 s[60:61]
L_fin:
L_end:
  s_endpgm
L_codeend:
.section .rodata,"a"
.p2align 6
.amdhsa_kernel standalone__mha_block_cached__near_ridge_kernel
  .amdhsa_next_free_vgpr 256
  .amdhsa_next_free_sgpr 96
  .amdhsa_accum_offset 256
  .amdhsa_group_segment_fixed_size 0
  .amdhsa_kernarg_size 64
  .amdhsa_user_sgpr_count 2
  .amdhsa_user_sgpr_kernarg_segment_ptr 1
  .amdhsa_system_sgpr_workgroup_id_x 1
.end_amdhsa_kernel
```
